```python
import torch

def _softmax(x, axis=-1):
    return torch.softmax(x, dim=axis)
def _gelu(x):
    return torch.nn.functional.gelu(x, approximate="tanh")
def _silu(x):
    return torch.nn.functional.silu(x)
def _sigmoid(x):
    return torch.sigmoid(x)
def _layernorm(x, axis=-1, eps=1e-5):
    m = x.mean(dim=axis, keepdim=True)
    v = x.var(dim=axis, keepdim=True, unbiased=False)
    return (x - m) / torch.sqrt(v + eps)
def _scatter_add(tgt, idx, src, axis=0):
    return tgt.clone().index_add_(axis, idx, src)
def _segment_sum(src, seg, n):
    out = torch.zeros((n,) + src.shape[1:], dtype=src.dtype)
    return out.index_add_(0, seg, src)
def _pad(x, pw):
    flat = tuple(v for pair in reversed(pw) for v in pair)
    return torch.nn.functional.pad(x, flat)

kernel_name = 'gated_mix__softmax_full_mha__dense_activation_squared_relu__prompt'

def setup_inputs():

    _w = (lambda a: (lambda t: t.to(torch.bfloat16) if t.is_floating_point() else t)(torch.as_tensor(a)))
    def _A_setup():
        B, S, D = 1, 2048, 576
        return {
            "x": _w((lambda *s: torch.randn(*s, dtype=torch.bfloat16) * 0.05)(B, S, D)),
            "wqkv": _w((lambda *s: torch.randn(*s, dtype=torch.bfloat16) * 0.8)(D, 3 * D)),
            "wo": _w((lambda *s: torch.randn(*s, dtype=torch.bfloat16) * 0.1)(D, D)),
        }
    _A_in = _A_setup()

    def _B_setup():
        B, S, D, F = 1, 2048, 576, 4608
        return {
            "x": _w((lambda *s: torch.randn(*s, dtype=torch.bfloat16) * 0.05)(B, S, D)),
            "w1": _w((lambda *s: torch.randn(*s, dtype=torch.bfloat16) * 0.05)(D, F)),
            "b1": _w((lambda *s: torch.randn(*s, dtype=torch.bfloat16) * 0.05)(F)),
            "w2": _w((lambda *s: torch.randn(*s, dtype=torch.bfloat16) * 0.05)(F, D)),
            "b2": _w((lambda *s: torch.randn(*s, dtype=torch.bfloat16) * 0.05)(D)),
        }
    _B_in = _B_setup()

    return {
        "A_x": _A_in["x"],
        "A_wqkv": _A_in["wqkv"],
        "A_wo": _A_in["wo"],
        "B_x": _B_in["x"],
        "B_w1": _B_in["w1"],
        "B_b1": _B_in["b1"],
        "B_w2": _B_in["w2"],
        "B_b2": _B_in["b2"],
        "gate_w": _w((lambda *s: torch.randn(*s, dtype=torch.bfloat16) * 0.05)(576) * 16.0),
    }

def reference(A_x, A_wqkv, A_wo, B_x, B_w1, B_b1, B_w2, B_b2, gate_w):
    def _A_ref(x, wqkv, wo):
        B, S, D = x.shape
        H = 32; Dh = D // H
        qkv = (lambda x, *d: x.permute(*d))((x @ wqkv).reshape(B, S, 3, H, Dh), 2, 0, 3, 1, 4)
        q, k, v = qkv[0], qkv[1], qkv[2]
        scale = Dh ** -0.5
        scores = torch.einsum("bhqd,bhkd->bhqk", q, k) * scale
        p = _softmax(scores, axis=-1)
        o = torch.einsum("bhqk,bhkd->bhqd", p, v)
        return (lambda x, *d: x.permute(*d))(o, 0, 2, 1, 3).reshape(B, S, D) @ wo

    def _B_ref(x, w1, b1, w2, b2):
        h = torch.einsum("bsd,df->bsf", x, w1) + b1
        zero = torch.zeros_like(h)
        r = torch.where(h > zero, h, zero)
        h = r * r
        out = torch.einsum("bsf,fd->bsd", h, w2) + b2
        return out

    x = A_x
    g = _sigmoid((x * gate_w).sum(-1, keepdims=True))
    a = _A_ref(x, A_wqkv, A_wo)
    b = _B_ref(x, B_w1, B_b1, B_w2, B_b2)
    return g * a + (1 - g) * b
```

```asm
; @launch kernel=k1_kernel grid=(512,1,1) block=(256,1,1) lds=79872
; @launch kernel=k2_kernel grid=(768,1,1) block=(256,1,1) lds=52224
; @launch kernel=k3_kernel grid=(256,1,1) block=(192,1,1) lds=64512
.amdgcn_target "amdgcn-amd-amdhsa--gfx950"
.text
.globl k1_kernel
.p2align 8
.type k1_kernel,@function
k1_kernel:
  s_cmp_ge_u32 s2, 512
  s_cbranch_scc1 k1_kernel_END
  v_mov_b32 v230, v0
  s_load_dwordx4 s[4:7], s[0:1], 0
  s_load_dwordx4 s[8:11], s[0:1], 24
  s_load_dwordx2 s[12:13], s[0:1], 40
  s_load_dwordx2 s[14:15], s[0:1], 64
  s_load_dwordx2 s[16:17], s[0:1], 88
  v_lshrrev_b32 v221, 6, v230
  s_nop 0
  v_readfirstlane_b32 s21, v221
  s_cmp_ge_u32 s2, 448
  s_cbranch_scc1 k1_kernel_GATE
  s_cmp_ge_u32 s2, 256
  s_cbranch_scc1 k1_kernel_QKV
  s_setprio 3
  s_and_b32 s18, s2, 7
  s_lshr_b32 s19, s2, 3
  s_and_b32 s23, s18, 3
  s_lshl_b32 s23, s23, 2
  s_and_b32 s24, s19, 3
  s_add_u32 s23, s23, s24
  s_lshr_b32 s24, s18, 2
  s_lshl_b32 s24, s24, 3
  s_lshr_b32 s25, s19, 2
  s_add_u32 s24, s24, s25
  s_mul_i32 s44, s24, 128*1152
  s_mul_i32 s26, s23, 576
  s_waitcnt lgkmcnt(0)
  s_mov_b32 s28, s4
  s_mov_b32 s29, s5
  s_mov_b32 s30, 2359296
  s_mov_b32 s31, 0x20000
  s_mov_b32 s32, s10
  s_mov_b32 s33, s11
  s_mov_b32 s34, 5308416
  s_mov_b32 s35, 0x20000
  s_mov_b32 s36, s12
  s_mov_b32 s37, s13
  s_mov_b32 s38, 9216
  s_mov_b32 s39, 0x20000
  s_mov_b32 s40, s16
  s_mov_b32 s41, s17
  s_mov_b32 s42, 18874368
  s_mov_b32 s43, 0x20000
  s_and_b32 s27, s21, 1
  s_mul_i32 s27, s27, 288
  s_add_u32 s27, s27, s26
  s_lshr_b32 s22, s21, 1
  s_lshl_b32 s22, s22, 6
  s_lshl_b32 s25, s24, 7
  s_add_u32 s22, s22, s25
  v_bfe_u32 v221, v230, 4, 2
  v_lshlrev_b32 v221, 3, v221
  v_add_u32 v221, s27, v221
  buffer_load_dwordx2 v[144:145], v221, s[36:39], 0 offen offset:0
  buffer_load_dwordx2 v[146:147], v221, s[36:39], 0 offen offset:32
  buffer_load_dwordx2 v[148:149], v221, s[36:39], 0 offen offset:64
  buffer_load_dwordx2 v[150:151], v221, s[36:39], 0 offen offset:96
  buffer_load_dwordx2 v[152:153], v221, s[36:39], 0 offen offset:128
  buffer_load_dwordx2 v[154:155], v221, s[36:39], 0 offen offset:160
  buffer_load_dwordx2 v[156:157], v221, s[36:39], 0 offen offset:192
  buffer_load_dwordx2 v[158:159], v221, s[36:39], 0 offen offset:224
  buffer_load_dwordx2 v[160:161], v221, s[36:39], 0 offen offset:256
  s_mov_b32 s56, s44
  v_and_b32 v221, 63, v230
  s_mul_i32 s52, s21, 288
  v_add_u32 v222, s52, v221
  v_min_u32 v222, 1151, v222
  v_cmp_le_u32 vcc, 576, v222
  v_mov_b32 v224, 0
  v_mov_b32 v225, 576
  v_cndmask_b32 v225, v224, v225, vcc
  v_sub_u32 v222, v222, v225
  v_lshrrev_b32 v212, 1, v225
  v_mul_u32_u24 v223, 3641, v222
  v_lshrrev_b32 v223, 16, v223
  v_mul_u32_u24 v224, 18, v223
  v_sub_u32 v224, v222, v224
  v_bfe_u32 v225, v223, 2, 2
  v_lshlrev_b32 v225, 3, v225
  v_and_b32 v222, 3, v223
  v_add_u32 v225, v225, v222
  v_lshrrev_b32 v222, 4, v223
  v_lshl_add_u32 v225, v222, 2, v225
  v_mul_u32_u24 v225, 9216, v225
  v_lshl_add_u32 v225, v224, 4, v225
  v_add_u32 v225, v225, v212
  v_mov_b32 v212, v225
  v_add_u32 v222, s52, v221
  v_add_u32 v222, 64, v222
  v_min_u32 v222, 1151, v222
  v_cmp_le_u32 vcc, 576, v222
  v_mov_b32 v224, 0
  v_mov_b32 v225, 576
  v_cndmask_b32 v225, v224, v225, vcc
  v_sub_u32 v222, v222, v225
  v_lshrrev_b32 v213, 1, v225
  v_mul_u32_u24 v223, 3641, v222
  v_lshrrev_b32 v223, 16, v223
  v_mul_u32_u24 v224, 18, v223
  v_sub_u32 v224, v222, v224
  v_bfe_u32 v225, v223, 2, 2
  v_lshlrev_b32 v225, 3, v225
  v_and_b32 v222, 3, v223
  v_add_u32 v225, v225, v222
  v_lshrrev_b32 v222, 4, v223
  v_lshl_add_u32 v225, v222, 2, v225
  v_mul_u32_u24 v225, 9216, v225
  v_lshl_add_u32 v225, v224, 4, v225
  v_add_u32 v225, v225, v213
  v_subrev_u32 v213, 1024, v225
  v_add_u32 v222, s52, v221
  v_add_u32 v222, 128, v222
  v_min_u32 v222, 1151, v222
  v_cmp_le_u32 vcc, 576, v222
  v_mov_b32 v224, 0
  v_mov_b32 v225, 576
  v_cndmask_b32 v225, v224, v225, vcc
  v_sub_u32 v222, v222, v225
  v_lshrrev_b32 v214, 1, v225
  v_mul_u32_u24 v223, 3641, v222
  v_lshrrev_b32 v223, 16, v223
  v_mul_u32_u24 v224, 18, v223
  v_sub_u32 v224, v222, v224
  v_bfe_u32 v225, v223, 2, 2
  v_lshlrev_b32 v225, 3, v225
  v_and_b32 v222, 3, v223
  v_add_u32 v225, v225, v222
  v_lshrrev_b32 v222, 4, v223
  v_lshl_add_u32 v225, v222, 2, v225
  v_mul_u32_u24 v225, 9216, v225
  v_lshl_add_u32 v225, v224, 4, v225
  v_add_u32 v225, v225, v214
  v_subrev_u32 v214, 2048, v225
  v_add_u32 v222, s52, v221
  v_add_u32 v222, 192, v222
  v_min_u32 v222, 1151, v222
  v_cmp_le_u32 vcc, 576, v222
  v_mov_b32 v224, 0
  v_mov_b32 v225, 576
  v_cndmask_b32 v225, v224, v225, vcc
  v_sub_u32 v222, v222, v225
  v_lshrrev_b32 v215, 1, v225
  v_mul_u32_u24 v223, 3641, v222
  v_lshrrev_b32 v223, 16, v223
  v_mul_u32_u24 v224, 18, v223
  v_sub_u32 v224, v222, v224
  v_bfe_u32 v225, v223, 2, 2
  v_lshlrev_b32 v225, 3, v225
  v_and_b32 v222, 3, v223
  v_add_u32 v225, v225, v222
  v_lshrrev_b32 v222, 4, v223
  v_lshl_add_u32 v225, v222, 2, v225
  v_mul_u32_u24 v225, 9216, v225
  v_lshl_add_u32 v225, v224, 4, v225
  v_add_u32 v225, v225, v215
  v_subrev_u32 v215, 3072, v225
  v_add_u32 v222, s52, v221
  v_add_u32 v222, 256, v222
  v_min_u32 v222, 1151, v222
  v_cmp_le_u32 vcc, 576, v222
  v_mov_b32 v224, 0
  v_mov_b32 v225, 576
  v_cndmask_b32 v225, v224, v225, vcc
  v_sub_u32 v222, v222, v225
  v_lshrrev_b32 v216, 1, v225
  v_mul_u32_u24 v223, 3641, v222
  v_lshrrev_b32 v223, 16, v223
  v_mul_u32_u24 v224, 18, v223
  v_sub_u32 v224, v222, v224
  v_bfe_u32 v225, v223, 2, 2
  v_lshlrev_b32 v225, 3, v225
  v_and_b32 v222, 3, v223
  v_add_u32 v225, v225, v222
  v_lshrrev_b32 v222, 4, v223
  v_lshl_add_u32 v225, v222, 2, v225
  v_mul_u32_u24 v225, 9216, v225
  v_lshl_add_u32 v225, v224, 4, v225
  v_add_u32 v225, v225, v216
  v_mov_b32 v216, v225
  s_lshl_b32 s52, s52, 4
  s_add_u32 s52, s52, 8192
  v_lshrrev_b32 v222, 2, v221
  v_mul_u32_u24 v222, 288, v222
  v_and_b32 v223, 3, v221
  v_lshl_add_u32 v219, v223, 3, v222
  s_and_b32 s54, s21, 1
  s_mul_i32 s54, s54, 9216
  s_add_u32 s54, s54, 8192
  v_add_u32 v219, s54, v219
  s_mul_i32 s53, s21, 128
  v_add_u32 v222, s53, v221
  v_lshrrev_b32 v223, 2, v222
  v_bfe_u32 v224, v223, 3, 1
  v_mul_u32_u24 v224, 3, v224
  v_and_b32 v222, 3, v222
  v_xor_b32 v222, v222, v224
  v_mul_u32_u24 v223, 1152, v223
  v_lshl_add_u32 v223, v222, 4, v223
  v_mov_b32 v217, v223
  v_add_u32 v222, s53, v221
  v_add_u32 v222, 64, v222
  v_lshrrev_b32 v223, 2, v222
  v_bfe_u32 v224, v223, 3, 1
  v_mul_u32_u24 v224, 3, v224
  v_and_b32 v222, 3, v222
  v_xor_b32 v222, v222, v224
  v_mul_u32_u24 v223, 1152, v223
  v_lshl_add_u32 v223, v222, 4, v223
  v_subrev_u32 v218, 1024, v223
  s_lshl_b32 s53, s53, 4
  v_and_b32 v222, 15, v221
  v_bfe_u32 v223, v221, 3, 1
  v_mul_u32_u24 v223, 3, v223
  v_lshrrev_b32 v224, 4, v221
  v_xor_b32 v223, v223, v224
  v_lshlrev_b32 v223, 4, v223
  v_lshl_add_u32 v220, v222, 6, v223
  s_lshr_b32 s54, s21, 1
  s_mul_i32 s54, s54, 4096
  v_add_u32 v220, s54, v220
  s_add_u32 m0, s52, 0
  s_nop 0
  buffer_load_dwordx4 v212, s[32:35], s26 offen offset:0 lds
  buffer_load_dwordx4 v213, s[32:35], s26 offen offset:1024 lds
  buffer_load_dwordx4 v214, s[32:35], s26 offen offset:2048 lds
  buffer_load_dwordx4 v215, s[32:35], s26 offen offset:3072 lds
  s_add_u32 m0, s52, 4096
  s_nop 0
  s_mov_b32 exec_hi, 0
  buffer_load_dwordx4 v216, s[32:35], s26 offen offset:0 lds
  s_mov_b64 exec, -1
  s_add_u32 s26, s26, 294912
  s_add_u32 m0, s53, 0
  s_nop 0
  buffer_load_dwordx4 v217, s[28:31], s44 offen offset:0 lds
  buffer_load_dwordx4 v218, s[28:31], s44 offen offset:1024 lds
  s_add_u32 s44, s44, 64
  s_add_u32 m0, s52, 26624
  s_nop 0
  buffer_load_dwordx4 v212, s[32:35], s26 offen offset:0 lds
  buffer_load_dwordx4 v213, s[32:35], s26 offen offset:1024 lds
  buffer_load_dwordx4 v214, s[32:35], s26 offen offset:2048 lds
  buffer_load_dwordx4 v215, s[32:35], s26 offen offset:3072 lds
  s_add_u32 m0, s52, 30720
  s_nop 0
  s_mov_b32 exec_hi, 0
  buffer_load_dwordx4 v216, s[32:35], s26 offen offset:0 lds
  s_mov_b64 exec, -1
  s_add_u32 s26, s26, 294912
  s_add_u32 m0, s53, 26624
  s_nop 0
  buffer_load_dwordx4 v217, s[28:31], s44 offen offset:0 lds
  buffer_load_dwordx4 v218, s[28:31], s44 offen offset:1024 lds
  s_add_u32 s44, s44, 64
  s_add_u32 m0, s52, 53248
  s_nop 0
  buffer_load_dwordx4 v212, s[32:35], s26 offen offset:0 lds
  buffer_load_dwordx4 v213, s[32:35], s26 offen offset:1024 lds
  buffer_load_dwordx4 v214, s[32:35], s26 offen offset:2048 lds
  buffer_load_dwordx4 v215, s[32:35], s26 offen offset:3072 lds
  s_add_u32 m0, s52, 57344
  s_nop 0
  s_mov_b32 exec_hi, 0
  buffer_load_dwordx4 v216, s[32:35], s26 offen offset:0 lds
  s_mov_b64 exec, -1
  s_add_u32 s26, s26, 294912
  s_add_u32 m0, s53, 53248
  s_nop 0
  buffer_load_dwordx4 v217, s[28:31], s44 offen offset:0 lds
  buffer_load_dwordx4 v218, s[28:31], s44 offen offset:1024 lds
  s_add_u32 s44, s44, 64
  s_waitcnt vmcnt(21)
  v_lshlrev_b32 v0, 16, v144
  v_and_b32 v1, 0xffff0000, v144
  v_lshlrev_b32 v2, 16, v145
  v_and_b32 v3, 0xffff0000, v145
  v_lshlrev_b32 v36, 16, v144
  v_and_b32 v37, 0xffff0000, v144
  v_lshlrev_b32 v38, 16, v145
  v_and_b32 v39, 0xffff0000, v145
  v_lshlrev_b32 v72, 16, v144
  v_and_b32 v73, 0xffff0000, v144
  v_lshlrev_b32 v74, 16, v145
  v_and_b32 v75, 0xffff0000, v145
  v_lshlrev_b32 v108, 16, v144
  v_and_b32 v109, 0xffff0000, v144
  v_lshlrev_b32 v110, 16, v145
  v_and_b32 v111, 0xffff0000, v145
  v_lshlrev_b32 v4, 16, v146
  v_and_b32 v5, 0xffff0000, v146
  v_lshlrev_b32 v6, 16, v147
  v_and_b32 v7, 0xffff0000, v147
  v_lshlrev_b32 v40, 16, v146
  v_and_b32 v41, 0xffff0000, v146
  v_lshlrev_b32 v42, 16, v147
  v_and_b32 v43, 0xffff0000, v147
  v_lshlrev_b32 v76, 16, v146
  v_and_b32 v77, 0xffff0000, v146
  v_lshlrev_b32 v78, 16, v147
  v_and_b32 v79, 0xffff0000, v147
  v_lshlrev_b32 v112, 16, v146
  v_and_b32 v113, 0xffff0000, v146
  v_lshlrev_b32 v114, 16, v147
  v_and_b32 v115, 0xffff0000, v147
  v_lshlrev_b32 v8, 16, v148
  v_and_b32 v9, 0xffff0000, v148
  v_lshlrev_b32 v10, 16, v149
  v_and_b32 v11, 0xffff0000, v149
  v_lshlrev_b32 v44, 16, v148
  v_and_b32 v45, 0xffff0000, v148
  v_lshlrev_b32 v46, 16, v149
  v_and_b32 v47, 0xffff0000, v149
  v_lshlrev_b32 v80, 16, v148
  v_and_b32 v81, 0xffff0000, v148
  v_lshlrev_b32 v82, 16, v149
  v_and_b32 v83, 0xffff0000, v149
  v_lshlrev_b32 v116, 16, v148
  v_and_b32 v117, 0xffff0000, v148
  v_lshlrev_b32 v118, 16, v149
  v_and_b32 v119, 0xffff0000, v149
  v_lshlrev_b32 v12, 16, v150
  v_and_b32 v13, 0xffff0000, v150
  v_lshlrev_b32 v14, 16, v151
  v_and_b32 v15, 0xffff0000, v151
  v_lshlrev_b32 v48, 16, v150
  v_and_b32 v49, 0xffff0000, v150
  v_lshlrev_b32 v50, 16, v151
  v_and_b32 v51, 0xffff0000, v151
  v_lshlrev_b32 v84, 16, v150
  v_and_b32 v85, 0xffff0000, v150
  v_lshlrev_b32 v86, 16, v151
  v_and_b32 v87, 0xffff0000, v151
  v_lshlrev_b32 v120, 16, v150
  v_and_b32 v121, 0xffff0000, v150
  v_lshlrev_b32 v122, 16, v151
  v_and_b32 v123, 0xffff0000, v151
  v_lshlrev_b32 v16, 16, v152
  v_and_b32 v17, 0xffff0000, v152
  v_lshlrev_b32 v18, 16, v153
  v_and_b32 v19, 0xffff0000, v153
  v_lshlrev_b32 v52, 16, v152
  v_and_b32 v53, 0xffff0000, v152
  v_lshlrev_b32 v54, 16, v153
  v_and_b32 v55, 0xffff0000, v153
  v_lshlrev_b32 v88, 16, v152
  v_and_b32 v89, 0xffff0000, v152
  v_lshlrev_b32 v90, 16, v153
  v_and_b32 v91, 0xffff0000, v153
  v_lshlrev_b32 v124, 16, v152
  v_and_b32 v125, 0xffff0000, v152
  v_lshlrev_b32 v126, 16, v153
  v_and_b32 v127, 0xffff0000, v153
  v_lshlrev_b32 v20, 16, v154
  v_and_b32 v21, 0xffff0000, v154
  v_lshlrev_b32 v22, 16, v155
  v_and_b32 v23, 0xffff0000, v155
  v_lshlrev_b32 v56, 16, v154
  v_and_b32 v57, 0xffff0000, v154
  v_lshlrev_b32 v58, 16, v155
  v_and_b32 v59, 0xffff0000, v155
  v_lshlrev_b32 v92, 16, v154
  v_and_b32 v93, 0xffff0000, v154
  v_lshlrev_b32 v94, 16, v155
  v_and_b32 v95, 0xffff0000, v155
  v_lshlrev_b32 v128, 16, v154
  v_and_b32 v129, 0xffff0000, v154
  v_lshlrev_b32 v130, 16, v155
  v_and_b32 v131, 0xffff0000, v155
  v_lshlrev_b32 v24, 16, v156
  v_and_b32 v25, 0xffff0000, v156
  v_lshlrev_b32 v26, 16, v157
  v_and_b32 v27, 0xffff0000, v157
  v_lshlrev_b32 v60, 16, v156
  v_and_b32 v61, 0xffff0000, v156
  v_lshlrev_b32 v62, 16, v157
  v_and_b32 v63, 0xffff0000, v157
  v_lshlrev_b32 v96, 16, v156
  v_and_b32 v97, 0xffff0000, v156
  v_lshlrev_b32 v98, 16, v157
  v_and_b32 v99, 0xffff0000, v157
  v_lshlrev_b32 v132, 16, v156
  v_and_b32 v133, 0xffff0000, v156
  v_lshlrev_b32 v134, 16, v157
  v_and_b32 v135, 0xffff0000, v157
  v_lshlrev_b32 v28, 16, v158
  v_and_b32 v29, 0xffff0000, v158
  v_lshlrev_b32 v30, 16, v159
  v_and_b32 v31, 0xffff0000, v159
  v_lshlrev_b32 v64, 16, v158
  v_and_b32 v65, 0xffff0000, v158
  v_lshlrev_b32 v66, 16, v159
  v_and_b32 v67, 0xffff0000, v159
  v_lshlrev_b32 v100, 16, v158
  v_and_b32 v101, 0xffff0000, v158
  v_lshlrev_b32 v102, 16, v159
  v_and_b32 v103, 0xffff0000, v159
  v_lshlrev_b32 v136, 16, v158
  v_and_b32 v137, 0xffff0000, v158
  v_lshlrev_b32 v138, 16, v159
  v_and_b32 v139, 0xffff0000, v159
  v_lshlrev_b32 v32, 16, v160
  v_and_b32 v33, 0xffff0000, v160
  v_lshlrev_b32 v34, 16, v161
  v_and_b32 v35, 0xffff0000, v161
  v_lshlrev_b32 v68, 16, v160
  v_and_b32 v69, 0xffff0000, v160
  v_lshlrev_b32 v70, 16, v161
  v_and_b32 v71, 0xffff0000, v161
  v_lshlrev_b32 v104, 16, v160
  v_and_b32 v105, 0xffff0000, v160
  v_lshlrev_b32 v106, 16, v161
  v_and_b32 v107, 0xffff0000, v161
  v_lshlrev_b32 v140, 16, v160
  v_and_b32 v141, 0xffff0000, v160
  v_lshlrev_b32 v142, 16, v161
  v_and_b32 v143, 0xffff0000, v161
  s_waitcnt vmcnt(14)
  s_barrier
  ds_read_b128 v[180:183], v220 offset:0
  ds_read_b128 v[184:187], v220 offset:1024
  ds_read_b128 v[188:191], v220 offset:2048
  ds_read_b128 v[192:195], v220 offset:3072
  ds_read_b64_tr_b16 v[144:145], v219 offset:0
  ds_read_b64_tr_b16 v[146:147], v219 offset:4608
  ds_read_b64_tr_b16 v[148:149], v219 offset:32
  ds_read_b64_tr_b16 v[150:151], v219 offset:4640
  ds_read_b64_tr_b16 v[152:153], v219 offset:64
  ds_read_b64_tr_b16 v[154:155], v219 offset:4672
  ds_read_b64_tr_b16 v[156:157], v219 offset:96
  ds_read_b64_tr_b16 v[158:159], v219 offset:4704
  ds_read_b64_tr_b16 v[160:161], v219 offset:128
  ds_read_b64_tr_b16 v[162:163], v219 offset:4736
  ds_read_b64_tr_b16 v[164:165], v219 offset:160
  ds_read_b64_tr_b16 v[166:167], v219 offset:4768
  ds_read_b64_tr_b16 v[168:169], v219 offset:192
  ds_read_b64_tr_b16 v[170:171], v219 offset:4800
  ds_read_b64_tr_b16 v[172:173], v219 offset:224
  ds_read_b64_tr_b16 v[174:175], v219 offset:4832
  ds_read_b64_tr_b16 v[176:177], v219 offset:256
  ds_read_b64_tr_b16 v[178:179], v219 offset:4864
  s_waitcnt vmcnt(7)
  s_waitcnt lgkmcnt(0)
  s_barrier
  ds_read_b128 v[196:199], v220 offset:26624
  ds_read_b128 v[200:203], v220 offset:27648
  ds_read_b128 v[204:207], v220 offset:28672
  ds_read_b128 v[208:211], v220 offset:29696
  v_mfma_f32_16x16x32_bf16 v[0:3], v[144:147], v[180:183], v[0:3]
  s_add_u32 m0, s52, 0
  s_nop 0
  buffer_load_dwordx4 v212, s[32:35], s26 offen offset:0 lds
  v_mfma_f32_16x16x32_bf16 v[36:39], v[144:147], v[184:187], v[36:39]
  v_mfma_f32_16x16x32_bf16 v[72:75], v[144:147], v[188:191], v[72:75]
  v_mfma_f32_16x16x32_bf16 v[108:111], v[144:147], v[192:195], v[108:111]
  ds_read_b64_tr_b16 v[144:145], v219 offset:26624
  ds_read_b64_tr_b16 v[146:147], v219 offset:31232
  v_mfma_f32_16x16x32_bf16 v[4:7], v[148:151], v[180:183], v[4:7]
  buffer_load_dwordx4 v213, s[32:35], s26 offen offset:1024 lds
  v_mfma_f32_16x16x32_bf16 v[40:43], v[148:151], v[184:187], v[40:43]
  v_mfma_f32_16x16x32_bf16 v[76:79], v[148:151], v[188:191], v[76:79]
  v_mfma_f32_16x16x32_bf16 v[112:115], v[148:151], v[192:195], v[112:115]
  ds_read_b64_tr_b16 v[148:149], v219 offset:26656
  ds_read_b64_tr_b16 v[150:151], v219 offset:31264
  v_mfma_f32_16x16x32_bf16 v[8:11], v[152:155], v[180:183], v[8:11]
  buffer_load_dwordx4 v214, s[32:35], s26 offen offset:2048 lds
  v_mfma_f32_16x16x32_bf16 v[44:47], v[152:155], v[184:187], v[44:47]
  v_mfma_f32_16x16x32_bf16 v[80:83], v[152:155], v[188:191], v[80:83]
  v_mfma_f32_16x16x32_bf16 v[116:119], v[152:155], v[192:195], v[116:119]
  ds_read_b64_tr_b16 v[152:153], v219 offset:26688
  ds_read_b64_tr_b16 v[154:155], v219 offset:31296
  v_mfma_f32_16x16x32_bf16 v[12:15], v[156:159], v[180:183], v[12:15]
  buffer_load_dwordx4 v215, s[32:35], s26 offen offset:3072 lds
  v_mfma_f32_16x16x32_bf16 v[48:51], v[156:159], v[184:187], v[48:51]
  v_mfma_f32_16x16x32_bf16 v[84:87], v[156:159], v[188:191], v[84:87]
  v_mfma_f32_16x16x32_bf16 v[120:123], v[156:159], v[192:195], v[120:123]
  ds_read_b64_tr_b16 v[156:157], v219 offset:26720
  ds_read_b64_tr_b16 v[158:159], v219 offset:31328
  v_mfma_f32_16x16x32_bf16 v[16:19], v[160:163], v[180:183], v[16:19]
  s_add_u32 m0, s52, 4096
  s_nop 0
  s_mov_b32 exec_hi, 0
  buffer_load_dwordx4 v216, s[32:35], s26 offen offset:0 lds
  s_mov_b64 exec, -1
  s_add_u32 s26, s26, 294912
  v_mfma_f32_16x16x32_bf16 v[52:55], v[160:163], v[184:187], v[52:55]
  v_mfma_f32_16x16x32_bf16 v[88:91], v[160:163], v[188:191], v[88:91]
  v_mfma_f32_16x16x32_bf16 v[124:127], v[160:163], v[192:195], v[124:127]
  ds_read_b64_tr_b16 v[160:161], v219 offset:26752
  ds_read_b64_tr_b16 v[162:163], v219 offset:31360
  v_mfma_f32_16x16x32_bf16 v[20:23], v[164:167], v[180:183], v[20:23]
  s_add_u32 m0, s53, 0
  s_nop 0
  buffer_load_dwordx4 v217, s[28:31], s44 offen offset:0 lds
  v_mfma_f32_16x16x32_bf16 v[56:59], v[164:167], v[184:187], v[56:59]
  v_mfma_f32_16x16x32_bf16 v[92:95], v[164:167], v[188:191], v[92:95]
  v_mfma_f32_16x16x32_bf16 v[128:131], v[164:167], v[192:195], v[128:131]
  ds_read_b64_tr_b16 v[164:165], v219 offset:26784
  ds_read_b64_tr_b16 v[166:167], v219 offset:31392
  v_mfma_f32_16x16x32_bf16 v[24:27], v[168:171], v[180:183], v[24:27]
  buffer_load_dwordx4 v218, s[28:31], s44 offen offset:1024 lds
  s_add_u32 s44, s44, 64
  v_mfma_f32_16x16x32_bf16 v[60:63], v[168:171], v[184:187], v[60:63]
  v_mfma_f32_16x16x32_bf16 v[96:99], v[168:171], v[188:191], v[96:99]
  v_mfma_f32_16x16x32_bf16 v[132:135], v[168:171], v[192:195], v[132:135]
  ds_read_b64_tr_b16 v[168:169], v219 offset:26816
  ds_read_b64_tr_b16 v[170:171], v219 offset:31424
  v_mfma_f32_16x16x32_bf16 v[28:31], v[172:175], v[180:183], v[28:31]
  v_mfma_f32_16x16x32_bf16 v[64:67], v[172:175], v[184:187], v[64:67]
  v_mfma_f32_16x16x32_bf16 v[100:103], v[172:175], v[188:191], v[100:103]
  v_mfma_f32_16x16x32_bf16 v[136:139], v[172:175], v[192:195], v[136:139]
  ds_read_b64_tr_b16 v[172:173], v219 offset:26848
  ds_read_b64_tr_b16 v[174:175], v219 offset:31456
  v_mfma_f32_16x16x32_bf16 v[32:35], v[176:179], v[180:183], v[32:35]
  v_mfma_f32_16x16x32_bf16 v[68:71], v[176:179], v[184:187], v[68:71]
  v_mfma_f32_16x16x32_bf16 v[104:107], v[176:179], v[188:191], v[104:107]
  v_mfma_f32_16x16x32_bf16 v[140:143], v[176:179], v[192:195], v[140:143]
  ds_read_b64_tr_b16 v[176:177], v219 offset:26880
  ds_read_b64_tr_b16 v[178:179], v219 offset:31488
  s_waitcnt vmcnt(7)
  s_waitcnt lgkmcnt(0)
  s_barrier
  ds_read_b128 v[180:183], v220 offset:53248
  ds_read_b128 v[184:187], v220 offset:54272
  ds_read_b128 v[188:191], v220 offset:55296
  ds_read_b128 v[192:195], v220 offset:56320
  v_mfma_f32_16x16x32_bf16 v[0:3], v[144:147], v[196:199], v[0:3]
  s_add_u32 m0, s52, 26624
  s_nop 0
  buffer_load_dwordx4 v212, s[32:35], s26 offen offset:0 lds
  v_mfma_f32_16x16x32_bf16 v[36:39], v[144:147], v[200:203], v[36:39]
  v_mfma_f32_16x16x32_bf16 v[72:75], v[144:147], v[204:207], v[72:75]
  v_mfma_f32_16x16x32_bf16 v[108:111], v[144:147], v[208:211], v[108:111]
  ds_read_b64_tr_b16 v[144:145], v219 offset:53248
  ds_read_b64_tr_b16 v[146:147], v219 offset:57856
  v_mfma_f32_16x16x32_bf16 v[4:7], v[148:151], v[196:199], v[4:7]
  buffer_load_dwordx4 v213, s[32:35], s26 offen offset:1024 lds
  v_mfma_f32_16x16x32_bf16 v[40:43], v[148:151], v[200:203], v[40:43]
  v_mfma_f32_16x16x32_bf16 v[76:79], v[148:151], v[204:207], v[76:79]
  v_mfma_f32_16x16x32_bf16 v[112:115], v[148:151], v[208:211], v[112:115]
  ds_read_b64_tr_b16 v[148:149], v219 offset:53280
  ds_read_b64_tr_b16 v[150:151], v219 offset:57888
  v_mfma_f32_16x16x32_bf16 v[8:11], v[152:155], v[196:199], v[8:11]
  buffer_load_dwordx4 v214, s[32:35], s26 offen offset:2048 lds
  v_mfma_f32_16x16x32_bf16 v[44:47], v[152:155], v[200:203], v[44:47]
  v_mfma_f32_16x16x32_bf16 v[80:83], v[152:155], v[204:207], v[80:83]
  v_mfma_f32_16x16x32_bf16 v[116:119], v[152:155], v[208:211], v[116:119]
  ds_read_b64_tr_b16 v[152:153], v219 offset:53312
  ds_read_b64_tr_b16 v[154:155], v219 offset:57920
  v_mfma_f32_16x16x32_bf16 v[12:15], v[156:159], v[196:199], v[12:15]
  buffer_load_dwordx4 v215, s[32:35], s26 offen offset:3072 lds
  v_mfma_f32_16x16x32_bf16 v[48:51], v[156:159], v[200:203], v[48:51]
  v_mfma_f32_16x16x32_bf16 v[84:87], v[156:159], v[204:207], v[84:87]
  v_mfma_f32_16x16x32_bf16 v[120:123], v[156:159], v[208:211], v[120:123]
  ds_read_b64_tr_b16 v[156:157], v219 offset:53344
  ds_read_b64_tr_b16 v[158:159], v219 offset:57952
  v_mfma_f32_16x16x32_bf16 v[16:19], v[160:163], v[196:199], v[16:19]
  s_add_u32 m0, s52, 30720
  s_nop 0
  s_mov_b32 exec_hi, 0
  buffer_load_dwordx4 v216, s[32:35], s26 offen offset:0 lds
  s_mov_b64 exec, -1
  s_add_u32 s26, s26, 294912
  v_mfma_f32_16x16x32_bf16 v[52:55], v[160:163], v[200:203], v[52:55]
  v_mfma_f32_16x16x32_bf16 v[88:91], v[160:163], v[204:207], v[88:91]
  v_mfma_f32_16x16x32_bf16 v[124:127], v[160:163], v[208:211], v[124:127]
  ds_read_b64_tr_b16 v[160:161], v219 offset:53376
  ds_read_b64_tr_b16 v[162:163], v219 offset:57984
  v_mfma_f32_16x16x32_bf16 v[20:23], v[164:167], v[196:199], v[20:23]
  s_add_u32 m0, s53, 26624
  s_nop 0
  buffer_load_dwordx4 v217, s[28:31], s44 offen offset:0 lds
  v_mfma_f32_16x16x32_bf16 v[56:59], v[164:167], v[200:203], v[56:59]
  v_mfma_f32_16x16x32_bf16 v[92:95], v[164:167], v[204:207], v[92:95]
  v_mfma_f32_16x16x32_bf16 v[128:131], v[164:167], v[208:211], v[128:131]
  ds_read_b64_tr_b16 v[164:165], v219 offset:53408
  ds_read_b64_tr_b16 v[166:167], v219 offset:58016
  v_mfma_f32_16x16x32_bf16 v[24:27], v[168:171], v[196:199], v[24:27]
  buffer_load_dwordx4 v218, s[28:31], s44 offen offset:1024 lds
  s_add_u32 s44, s44, 64
  v_mfma_f32_16x16x32_bf16 v[60:63], v[168:171], v[200:203], v[60:63]
  v_mfma_f32_16x16x32_bf16 v[96:99], v[168:171], v[204:207], v[96:99]
  v_mfma_f32_16x16x32_bf16 v[132:135], v[168:171], v[208:211], v[132:135]
  ds_read_b64_tr_b16 v[168:169], v219 offset:53440
  ds_read_b64_tr_b16 v[170:171], v219 offset:58048
  v_mfma_f32_16x16x32_bf16 v[28:31], v[172:175], v[196:199], v[28:31]
  v_mfma_f32_16x16x32_bf16 v[64:67], v[172:175], v[200:203], v[64:67]
  v_mfma_f32_16x16x32_bf16 v[100:103], v[172:175], v[204:207], v[100:103]
  v_mfma_f32_16x16x32_bf16 v[136:139], v[172:175], v[208:211], v[136:139]
  ds_read_b64_tr_b16 v[172:173], v219 offset:53472
  ds_read_b64_tr_b16 v[174:175], v219 offset:58080
  v_mfma_f32_16x16x32_bf16 v[32:35], v[176:179], v[196:199], v[32:35]
  v_mfma_f32_16x16x32_bf16 v[68:71], v[176:179], v[200:203], v[68:71]
  v_mfma_f32_16x16x32_bf16 v[104:107], v[176:179], v[204:207], v[104:107]
  v_mfma_f32_16x16x32_bf16 v[140:143], v[176:179], v[208:211], v[140:143]
  ds_read_b64_tr_b16 v[176:177], v219 offset:53504
  ds_read_b64_tr_b16 v[178:179], v219 offset:58112
  s_waitcnt vmcnt(7)
  s_waitcnt lgkmcnt(0)
  s_barrier
  ds_read_b128 v[196:199], v220 offset:0
  ds_read_b128 v[200:203], v220 offset:1024
  ds_read_b128 v[204:207], v220 offset:2048
  ds_read_b128 v[208:211], v220 offset:3072
  v_mfma_f32_16x16x32_bf16 v[0:3], v[144:147], v[180:183], v[0:3]
  s_add_u32 m0, s52, 53248
  s_nop 0
  buffer_load_dwordx4 v212, s[32:35], s26 offen offset:0 lds
  v_mfma_f32_16x16x32_bf16 v[36:39], v[144:147], v[184:187], v[36:39]
  v_mfma_f32_16x16x32_bf16 v[72:75], v[144:147], v[188:191], v[72:75]
  v_mfma_f32_16x16x32_bf16 v[108:111], v[144:147], v[192:195], v[108:111]
  ds_read_b64_tr_b16 v[144:145], v219 offset:0
  ds_read_b64_tr_b16 v[146:147], v219 offset:4608
  v_mfma_f32_16x16x32_bf16 v[4:7], v[148:151], v[180:183], v[4:7]
  buffer_load_dwordx4 v213, s[32:35], s26 offen offset:1024 lds
  v_mfma_f32_16x16x32_bf16 v[40:43], v[148:151], v[184:187], v[40:43]
  v_mfma_f32_16x16x32_bf16 v[76:79], v[148:151], v[188:191], v[76:79]
  v_mfma_f32_16x16x32_bf16 v[112:115], v[148:151], v[192:195], v[112:115]
  ds_read_b64_tr_b16 v[148:149], v219 offset:32
  ds_read_b64_tr_b16 v[150:151], v219 offset:4640
  v_mfma_f32_16x16x32_bf16 v[8:11], v[152:155], v[180:183], v[8:11]
  buffer_load_dwordx4 v214, s[32:35], s26 offen offset:2048 lds
  v_mfma_f32_16x16x32_bf16 v[44:47], v[152:155], v[184:187], v[44:47]
  v_mfma_f32_16x16x32_bf16 v[80:83], v[152:155], v[188:191], v[80:83]
  v_mfma_f32_16x16x32_bf16 v[116:119], v[152:155], v[192:195], v[116:119]
  ds_read_b64_tr_b16 v[152:153], v219 offset:64
  ds_read_b64_tr_b16 v[154:155], v219 offset:4672
  v_mfma_f32_16x16x32_bf16 v[12:15], v[156:159], v[180:183], v[12:15]
  buffer_load_dwordx4 v215, s[32:35], s26 offen offset:3072 lds
  v_mfma_f32_16x16x32_bf16 v[48:51], v[156:159], v[184:187], v[48:51]
  v_mfma_f32_16x16x32_bf16 v[84:87], v[156:159], v[188:191], v[84:87]
  v_mfma_f32_16x16x32_bf16 v[120:123], v[156:159], v[192:195], v[120:123]
  ds_read_b64_tr_b16 v[156:157], v219 offset:96
  ds_read_b64_tr_b16 v[158:159], v219 offset:4704
  v_mfma_f32_16x16x32_bf16 v[16:19], v[160:163], v[180:183], v[16:19]
  s_add_u32 m0, s52, 57344
  s_nop 0
  s_mov_b32 exec_hi, 0
  buffer_load_dwordx4 v216, s[32:35], s26 offen offset:0 lds
  s_mov_b64 exec, -1
  s_add_u32 s26, s26, 294912
  v_mfma_f32_16x16x32_bf16 v[52:55], v[160:163], v[184:187], v[52:55]
  v_mfma_f32_16x16x32_bf16 v[88:91], v[160:163], v[188:191], v[88:91]
  v_mfma_f32_16x16x32_bf16 v[124:127], v[160:163], v[192:195], v[124:127]
  ds_read_b64_tr_b16 v[160:161], v219 offset:128
  ds_read_b64_tr_b16 v[162:163], v219 offset:4736
  v_mfma_f32_16x16x32_bf16 v[20:23], v[164:167], v[180:183], v[20:23]
  s_add_u32 m0, s53, 53248
  s_nop 0
  buffer_load_dwordx4 v217, s[28:31], s44 offen offset:0 lds
  v_mfma_f32_16x16x32_bf16 v[56:59], v[164:167], v[184:187], v[56:59]
  v_mfma_f32_16x16x32_bf16 v[92:95], v[164:167], v[188:191], v[92:95]
  v_mfma_f32_16x16x32_bf16 v[128:131], v[164:167], v[192:195], v[128:131]
  ds_read_b64_tr_b16 v[164:165], v219 offset:160
  ds_read_b64_tr_b16 v[166:167], v219 offset:4768
  v_mfma_f32_16x16x32_bf16 v[24:27], v[168:171], v[180:183], v[24:27]
  buffer_load_dwordx4 v218, s[28:31], s44 offen offset:1024 lds
  s_add_u32 s44, s44, 64
  v_mfma_f32_16x16x32_bf16 v[60:63], v[168:171], v[184:187], v[60:63]
  v_mfma_f32_16x16x32_bf16 v[96:99], v[168:171], v[188:191], v[96:99]
  v_mfma_f32_16x16x32_bf16 v[132:135], v[168:171], v[192:195], v[132:135]
  ds_read_b64_tr_b16 v[168:169], v219 offset:192
  ds_read_b64_tr_b16 v[170:171], v219 offset:4800
  v_mfma_f32_16x16x32_bf16 v[28:31], v[172:175], v[180:183], v[28:31]
  v_mfma_f32_16x16x32_bf16 v[64:67], v[172:175], v[184:187], v[64:67]
  v_mfma_f32_16x16x32_bf16 v[100:103], v[172:175], v[188:191], v[100:103]
  v_mfma_f32_16x16x32_bf16 v[136:139], v[172:175], v[192:195], v[136:139]
  ds_read_b64_tr_b16 v[172:173], v219 offset:224
  ds_read_b64_tr_b16 v[174:175], v219 offset:4832
  v_mfma_f32_16x16x32_bf16 v[32:35], v[176:179], v[180:183], v[32:35]
  v_mfma_f32_16x16x32_bf16 v[68:71], v[176:179], v[184:187], v[68:71]
  v_mfma_f32_16x16x32_bf16 v[104:107], v[176:179], v[188:191], v[104:107]
  v_mfma_f32_16x16x32_bf16 v[140:143], v[176:179], v[192:195], v[140:143]
  ds_read_b64_tr_b16 v[176:177], v219 offset:256
  ds_read_b64_tr_b16 v[178:179], v219 offset:4864
  s_waitcnt vmcnt(7)
  s_waitcnt lgkmcnt(0)
  s_barrier
  ds_read_b128 v[180:183], v220 offset:26624
  ds_read_b128 v[184:187], v220 offset:27648
  ds_read_b128 v[188:191], v220 offset:28672
  ds_read_b128 v[192:195], v220 offset:29696
  v_mfma_f32_16x16x32_bf16 v[0:3], v[144:147], v[196:199], v[0:3]
  s_add_u32 m0, s52, 0
  s_nop 0
  buffer_load_dwordx4 v212, s[32:35], s26 offen offset:0 lds
  v_mfma_f32_16x16x32_bf16 v[36:39], v[144:147], v[200:203], v[36:39]
  v_mfma_f32_16x16x32_bf16 v[72:75], v[144:147], v[204:207], v[72:75]
  v_mfma_f32_16x16x32_bf16 v[108:111], v[144:147], v[208:211], v[108:111]
  ds_read_b64_tr_b16 v[144:145], v219 offset:26624
  ds_read_b64_tr_b16 v[146:147], v219 offset:31232
  v_mfma_f32_16x16x32_bf16 v[4:7], v[148:151], v[196:199], v[4:7]
  buffer_load_dwordx4 v213, s[32:35], s26 offen offset:1024 lds
  v_mfma_f32_16x16x32_bf16 v[40:43], v[148:151], v[200:203], v[40:43]
  v_mfma_f32_16x16x32_bf16 v[76:79], v[148:151], v[204:207], v[76:79]
  v_mfma_f32_16x16x32_bf16 v[112:115], v[148:151], v[208:211], v[112:115]
  ds_read_b64_tr_b16 v[148:149], v219 offset:26656
  ds_read_b64_tr_b16 v[150:151], v219 offset:31264
  v_mfma_f32_16x16x32_bf16 v[8:11], v[152:155], v[196:199], v[8:11]
  buffer_load_dwordx4 v214, s[32:35], s26 offen offset:2048 lds
  v_mfma_f32_16x16x32_bf16 v[44:47], v[152:155], v[200:203], v[44:47]
  v_mfma_f32_16x16x32_bf16 v[80:83], v[152:155], v[204:207], v[80:83]
  v_mfma_f32_16x16x32_bf16 v[116:119], v[152:155], v[208:211], v[116:119]
  ds_read_b64_tr_b16 v[152:153], v219 offset:26688
  ds_read_b64_tr_b16 v[154:155], v219 offset:31296
  v_mfma_f32_16x16x32_bf16 v[12:15], v[156:159], v[196:199], v[12:15]
  buffer_load_dwordx4 v215, s[32:35], s26 offen offset:3072 lds
  v_mfma_f32_16x16x32_bf16 v[48:51], v[156:159], v[200:203], v[48:51]
  v_mfma_f32_16x16x32_bf16 v[84:87], v[156:159], v[204:207], v[84:87]
  v_mfma_f32_16x16x32_bf16 v[120:123], v[156:159], v[208:211], v[120:123]
  ds_read_b64_tr_b16 v[156:157], v219 offset:26720
  ds_read_b64_tr_b16 v[158:159], v219 offset:31328
  v_mfma_f32_16x16x32_bf16 v[16:19], v[160:163], v[196:199], v[16:19]
  s_add_u32 m0, s52, 4096
  s_nop 0
  s_mov_b32 exec_hi, 0
  buffer_load_dwordx4 v216, s[32:35], s26 offen offset:0 lds
  s_mov_b64 exec, -1
  s_add_u32 s26, s26, 294912
  v_mfma_f32_16x16x32_bf16 v[52:55], v[160:163], v[200:203], v[52:55]
  v_mfma_f32_16x16x32_bf16 v[88:91], v[160:163], v[204:207], v[88:91]
  v_mfma_f32_16x16x32_bf16 v[124:127], v[160:163], v[208:211], v[124:127]
  ds_read_b64_tr_b16 v[160:161], v219 offset:26752
  ds_read_b64_tr_b16 v[162:163], v219 offset:31360
  v_mfma_f32_16x16x32_bf16 v[20:23], v[164:167], v[196:199], v[20:23]
  s_add_u32 m0, s53, 0
  s_nop 0
  buffer_load_dwordx4 v217, s[28:31], s44 offen offset:0 lds
  v_mfma_f32_16x16x32_bf16 v[56:59], v[164:167], v[200:203], v[56:59]
  v_mfma_f32_16x16x32_bf16 v[92:95], v[164:167], v[204:207], v[92:95]
  v_mfma_f32_16x16x32_bf16 v[128:131], v[164:167], v[208:211], v[128:131]
  ds_read_b64_tr_b16 v[164:165], v219 offset:26784
  ds_read_b64_tr_b16 v[166:167], v219 offset:31392
  v_mfma_f32_16x16x32_bf16 v[24:27], v[168:171], v[196:199], v[24:27]
  buffer_load_dwordx4 v218, s[28:31], s44 offen offset:1024 lds
  s_add_u32 s44, s44, 64
  v_mfma_f32_16x16x32_bf16 v[60:63], v[168:171], v[200:203], v[60:63]
  v_mfma_f32_16x16x32_bf16 v[96:99], v[168:171], v[204:207], v[96:99]
  v_mfma_f32_16x16x32_bf16 v[132:135], v[168:171], v[208:211], v[132:135]
  ds_read_b64_tr_b16 v[168:169], v219 offset:26816
  ds_read_b64_tr_b16 v[170:171], v219 offset:31424
  v_mfma_f32_16x16x32_bf16 v[28:31], v[172:175], v[196:199], v[28:31]
  v_mfma_f32_16x16x32_bf16 v[64:67], v[172:175], v[200:203], v[64:67]
  v_mfma_f32_16x16x32_bf16 v[100:103], v[172:175], v[204:207], v[100:103]
  v_mfma_f32_16x16x32_bf16 v[136:139], v[172:175], v[208:211], v[136:139]
  ds_read_b64_tr_b16 v[172:173], v219 offset:26848
  ds_read_b64_tr_b16 v[174:175], v219 offset:31456
  v_mfma_f32_16x16x32_bf16 v[32:35], v[176:179], v[196:199], v[32:35]
  v_mfma_f32_16x16x32_bf16 v[68:71], v[176:179], v[200:203], v[68:71]
  v_mfma_f32_16x16x32_bf16 v[104:107], v[176:179], v[204:207], v[104:107]
  v_mfma_f32_16x16x32_bf16 v[140:143], v[176:179], v[208:211], v[140:143]
  ds_read_b64_tr_b16 v[176:177], v219 offset:26880
  ds_read_b64_tr_b16 v[178:179], v219 offset:31488
  s_waitcnt vmcnt(7)
  s_waitcnt lgkmcnt(0)
  s_barrier
  ds_read_b128 v[196:199], v220 offset:53248
  ds_read_b128 v[200:203], v220 offset:54272
  ds_read_b128 v[204:207], v220 offset:55296
  ds_read_b128 v[208:211], v220 offset:56320
  v_mfma_f32_16x16x32_bf16 v[0:3], v[144:147], v[180:183], v[0:3]
  s_add_u32 m0, s52, 26624
  s_nop 0
  buffer_load_dwordx4 v212, s[32:35], s26 offen offset:0 lds
  v_mfma_f32_16x16x32_bf16 v[36:39], v[144:147], v[184:187], v[36:39]
  v_mfma_f32_16x16x32_bf16 v[72:75], v[144:147], v[188:191], v[72:75]
  v_mfma_f32_16x16x32_bf16 v[108:111], v[144:147], v[192:195], v[108:111]
  ds_read_b64_tr_b16 v[144:145], v219 offset:53248
  ds_read_b64_tr_b16 v[146:147], v219 offset:57856
  v_mfma_f32_16x16x32_bf16 v[4:7], v[148:151], v[180:183], v[4:7]
  buffer_load_dwordx4 v213, s[32:35], s26 offen offset:1024 lds
  v_mfma_f32_16x16x32_bf16 v[40:43], v[148:151], v[184:187], v[40:43]
  v_mfma_f32_16x16x32_bf16 v[76:79], v[148:151], v[188:191], v[76:79]
  v_mfma_f32_16x16x32_bf16 v[112:115], v[148:151], v[192:195], v[112:115]
  ds_read_b64_tr_b16 v[148:149], v219 offset:53280
  ds_read_b64_tr_b16 v[150:151], v219 offset:57888
  v_mfma_f32_16x16x32_bf16 v[8:11], v[152:155], v[180:183], v[8:11]
  buffer_load_dwordx4 v214, s[32:35], s26 offen offset:2048 lds
  v_mfma_f32_16x16x32_bf16 v[44:47], v[152:155], v[184:187], v[44:47]
  v_mfma_f32_16x16x32_bf16 v[80:83], v[152:155], v[188:191], v[80:83]
  v_mfma_f32_16x16x32_bf16 v[116:119], v[152:155], v[192:195], v[116:119]
  ds_read_b64_tr_b16 v[152:153], v219 offset:53312
  ds_read_b64_tr_b16 v[154:155], v219 offset:57920
  v_mfma_f32_16x16x32_bf16 v[12:15], v[156:159], v[180:183], v[12:15]
  buffer_load_dwordx4 v215, s[32:35], s26 offen offset:3072 lds
  v_mfma_f32_16x16x32_bf16 v[48:51], v[156:159], v[184:187], v[48:51]
  v_mfma_f32_16x16x32_bf16 v[84:87], v[156:159], v[188:191], v[84:87]
  v_mfma_f32_16x16x32_bf16 v[120:123], v[156:159], v[192:195], v[120:123]
  ds_read_b64_tr_b16 v[156:157], v219 offset:53344
  ds_read_b64_tr_b16 v[158:159], v219 offset:57952
  v_mfma_f32_16x16x32_bf16 v[16:19], v[160:163], v[180:183], v[16:19]
  s_add_u32 m0, s52, 30720
  s_nop 0
  s_mov_b32 exec_hi, 0
  buffer_load_dwordx4 v216, s[32:35], s26 offen offset:0 lds
  s_mov_b64 exec, -1
  s_add_u32 s26, s26, 294912
  v_mfma_f32_16x16x32_bf16 v[52:55], v[160:163], v[184:187], v[52:55]
  v_mfma_f32_16x16x32_bf16 v[88:91], v[160:163], v[188:191], v[88:91]
  v_mfma_f32_16x16x32_bf16 v[124:127], v[160:163], v[192:195], v[124:127]
  ds_read_b64_tr_b16 v[160:161], v219 offset:53376
  ds_read_b64_tr_b16 v[162:163], v219 offset:57984
  v_mfma_f32_16x16x32_bf16 v[20:23], v[164:167], v[180:183], v[20:23]
  s_add_u32 m0, s53, 26624
  s_nop 0
  buffer_load_dwordx4 v217, s[28:31], s44 offen offset:0 lds
  v_mfma_f32_16x16x32_bf16 v[56:59], v[164:167], v[184:187], v[56:59]
  v_mfma_f32_16x16x32_bf16 v[92:95], v[164:167], v[188:191], v[92:95]
  v_mfma_f32_16x16x32_bf16 v[128:131], v[164:167], v[192:195], v[128:131]
  ds_read_b64_tr_b16 v[164:165], v219 offset:53408
  ds_read_b64_tr_b16 v[166:167], v219 offset:58016
  v_mfma_f32_16x16x32_bf16 v[24:27], v[168:171], v[180:183], v[24:27]
  buffer_load_dwordx4 v218, s[28:31], s44 offen offset:1024 lds
  s_add_u32 s44, s44, 64
  v_mfma_f32_16x16x32_bf16 v[60:63], v[168:171], v[184:187], v[60:63]
  v_mfma_f32_16x16x32_bf16 v[96:99], v[168:171], v[188:191], v[96:99]
  v_mfma_f32_16x16x32_bf16 v[132:135], v[168:171], v[192:195], v[132:135]
  ds_read_b64_tr_b16 v[168:169], v219 offset:53440
  ds_read_b64_tr_b16 v[170:171], v219 offset:58048
  v_mfma_f32_16x16x32_bf16 v[28:31], v[172:175], v[180:183], v[28:31]
  v_mfma_f32_16x16x32_bf16 v[64:67], v[172:175], v[184:187], v[64:67]
  v_mfma_f32_16x16x32_bf16 v[100:103], v[172:175], v[188:191], v[100:103]
  v_mfma_f32_16x16x32_bf16 v[136:139], v[172:175], v[192:195], v[136:139]
  ds_read_b64_tr_b16 v[172:173], v219 offset:53472
  ds_read_b64_tr_b16 v[174:175], v219 offset:58080
  v_mfma_f32_16x16x32_bf16 v[32:35], v[176:179], v[180:183], v[32:35]
  v_mfma_f32_16x16x32_bf16 v[68:71], v[176:179], v[184:187], v[68:71]
  v_mfma_f32_16x16x32_bf16 v[104:107], v[176:179], v[188:191], v[104:107]
  v_mfma_f32_16x16x32_bf16 v[140:143], v[176:179], v[192:195], v[140:143]
  ds_read_b64_tr_b16 v[176:177], v219 offset:53504
  ds_read_b64_tr_b16 v[178:179], v219 offset:58112
  s_waitcnt vmcnt(7)
  s_waitcnt lgkmcnt(0)
  s_barrier
  ds_read_b128 v[180:183], v220 offset:0
  ds_read_b128 v[184:187], v220 offset:1024
  ds_read_b128 v[188:191], v220 offset:2048
  ds_read_b128 v[192:195], v220 offset:3072
  v_mfma_f32_16x16x32_bf16 v[0:3], v[144:147], v[196:199], v[0:3]
  s_add_u32 m0, s52, 53248
  s_nop 0
  buffer_load_dwordx4 v212, s[32:35], s26 offen offset:0 lds
  v_mfma_f32_16x16x32_bf16 v[36:39], v[144:147], v[200:203], v[36:39]
  v_mfma_f32_16x16x32_bf16 v[72:75], v[144:147], v[204:207], v[72:75]
  v_mfma_f32_16x16x32_bf16 v[108:111], v[144:147], v[208:211], v[108:111]
  ds_read_b64_tr_b16 v[144:145], v219 offset:0
  ds_read_b64_tr_b16 v[146:147], v219 offset:4608
  v_mfma_f32_16x16x32_bf16 v[4:7], v[148:151], v[196:199], v[4:7]
  buffer_load_dwordx4 v213, s[32:35], s26 offen offset:1024 lds
  v_mfma_f32_16x16x32_bf16 v[40:43], v[148:151], v[200:203], v[40:43]
  v_mfma_f32_16x16x32_bf16 v[76:79], v[148:151], v[204:207], v[76:79]
  v_mfma_f32_16x16x32_bf16 v[112:115], v[148:151], v[208:211], v[112:115]
  ds_read_b64_tr_b16 v[148:149], v219 offset:32
  ds_read_b64_tr_b16 v[150:151], v219 offset:4640
  v_mfma_f32_16x16x32_bf16 v[8:11], v[152:155], v[196:199], v[8:11]
  buffer_load_dwordx4 v214, s[32:35], s26 offen offset:2048 lds
  v_mfma_f32_16x16x32_bf16 v[44:47], v[152:155], v[200:203], v[44:47]
  v_mfma_f32_16x16x32_bf16 v[80:83], v[152:155], v[204:207], v[80:83]
  v_mfma_f32_16x16x32_bf16 v[116:119], v[152:155], v[208:211], v[116:119]
  ds_read_b64_tr_b16 v[152:153], v219 offset:64
  ds_read_b64_tr_b16 v[154:155], v219 offset:4672
  v_mfma_f32_16x16x32_bf16 v[12:15], v[156:159], v[196:199], v[12:15]
  buffer_load_dwordx4 v215, s[32:35], s26 offen offset:3072 lds
  v_mfma_f32_16x16x32_bf16 v[48:51], v[156:159], v[200:203], v[48:51]
  v_mfma_f32_16x16x32_bf16 v[84:87], v[156:159], v[204:207], v[84:87]
  v_mfma_f32_16x16x32_bf16 v[120:123], v[156:159], v[208:211], v[120:123]
  ds_read_b64_tr_b16 v[156:157], v219 offset:96
  ds_read_b64_tr_b16 v[158:159], v219 offset:4704
  v_mfma_f32_16x16x32_bf16 v[16:19], v[160:163], v[196:199], v[16:19]
  s_add_u32 m0, s52, 57344
  s_nop 0
  s_mov_b32 exec_hi, 0
  buffer_load_dwordx4 v216, s[32:35], s26 offen offset:0 lds
  s_mov_b64 exec, -1
  s_add_u32 s26, s26, 294912
  v_mfma_f32_16x16x32_bf16 v[52:55], v[160:163], v[200:203], v[52:55]
  v_mfma_f32_16x16x32_bf16 v[88:91], v[160:163], v[204:207], v[88:91]
  v_mfma_f32_16x16x32_bf16 v[124:127], v[160:163], v[208:211], v[124:127]
  ds_read_b64_tr_b16 v[160:161], v219 offset:128
  ds_read_b64_tr_b16 v[162:163], v219 offset:4736
  v_mfma_f32_16x16x32_bf16 v[20:23], v[164:167], v[196:199], v[20:23]
  s_add_u32 m0, s53, 53248
  s_nop 0
  buffer_load_dwordx4 v217, s[28:31], s44 offen offset:0 lds
  v_mfma_f32_16x16x32_bf16 v[56:59], v[164:167], v[200:203], v[56:59]
  v_mfma_f32_16x16x32_bf16 v[92:95], v[164:167], v[204:207], v[92:95]
  v_mfma_f32_16x16x32_bf16 v[128:131], v[164:167], v[208:211], v[128:131]
  ds_read_b64_tr_b16 v[164:165], v219 offset:160
  ds_read_b64_tr_b16 v[166:167], v219 offset:4768
  v_mfma_f32_16x16x32_bf16 v[24:27], v[168:171], v[196:199], v[24:27]
  buffer_load_dwordx4 v218, s[28:31], s44 offen offset:1024 lds
  s_add_u32 s44, s44, 64
  v_mfma_f32_16x16x32_bf16 v[60:63], v[168:171], v[200:203], v[60:63]
  v_mfma_f32_16x16x32_bf16 v[96:99], v[168:171], v[204:207], v[96:99]
  v_mfma_f32_16x16x32_bf16 v[132:135], v[168:171], v[208:211], v[132:135]
  ds_read_b64_tr_b16 v[168:169], v219 offset:192
  ds_read_b64_tr_b16 v[170:171], v219 offset:4800
  v_mfma_f32_16x16x32_bf16 v[28:31], v[172:175], v[196:199], v[28:31]
  v_mfma_f32_16x16x32_bf16 v[64:67], v[172:175], v[200:203], v[64:67]
  v_mfma_f32_16x16x32_bf16 v[100:103], v[172:175], v[204:207], v[100:103]
  v_mfma_f32_16x16x32_bf16 v[136:139], v[172:175], v[208:211], v[136:139]
  ds_read_b64_tr_b16 v[172:173], v219 offset:224
  ds_read_b64_tr_b16 v[174:175], v219 offset:4832
  v_mfma_f32_16x16x32_bf16 v[32:35], v[176:179], v[196:199], v[32:35]
  v_mfma_f32_16x16x32_bf16 v[68:71], v[176:179], v[200:203], v[68:71]
  v_mfma_f32_16x16x32_bf16 v[104:107], v[176:179], v[204:207], v[104:107]
  v_mfma_f32_16x16x32_bf16 v[140:143], v[176:179], v[208:211], v[140:143]
  ds_read_b64_tr_b16 v[176:177], v219 offset:256
  ds_read_b64_tr_b16 v[178:179], v219 offset:4864
  s_waitcnt vmcnt(7)
  s_waitcnt lgkmcnt(0)
  s_barrier
  ds_read_b128 v[196:199], v220 offset:26624
  ds_read_b128 v[200:203], v220 offset:27648
  ds_read_b128 v[204:207], v220 offset:28672
  ds_read_b128 v[208:211], v220 offset:29696
  v_mfma_f32_16x16x32_bf16 v[0:3], v[144:147], v[180:183], v[0:3]
  s_add_u32 m0, s52, 0
  s_nop 0
  buffer_load_dwordx4 v212, s[32:35], s26 offen offset:0 lds
  v_mfma_f32_16x16x32_bf16 v[36:39], v[144:147], v[184:187], v[36:39]
  v_mfma_f32_16x16x32_bf16 v[72:75], v[144:147], v[188:191], v[72:75]
  v_mfma_f32_16x16x32_bf16 v[108:111], v[144:147], v[192:195], v[108:111]
  ds_read_b64_tr_b16 v[144:145], v219 offset:26624
  ds_read_b64_tr_b16 v[146:147], v219 offset:31232
  v_mfma_f32_16x16x32_bf16 v[4:7], v[148:151], v[180:183], v[4:7]
  buffer_load_dwordx4 v213, s[32:35], s26 offen offset:1024 lds
  v_mfma_f32_16x16x32_bf16 v[40:43], v[148:151], v[184:187], v[40:43]
  v_mfma_f32_16x16x32_bf16 v[76:79], v[148:151], v[188:191], v[76:79]
  v_mfma_f32_16x16x32_bf16 v[112:115], v[148:151], v[192:195], v[112:115]
  ds_read_b64_tr_b16 v[148:149], v219 offset:26656
  ds_read_b64_tr_b16 v[150:151], v219 offset:31264
  v_mfma_f32_16x16x32_bf16 v[8:11], v[152:155], v[180:183], v[8:11]
  buffer_load_dwordx4 v214, s[32:35], s26 offen offset:2048 lds
  v_mfma_f32_16x16x32_bf16 v[44:47], v[152:155], v[184:187], v[44:47]
  v_mfma_f32_16x16x32_bf16 v[80:83], v[152:155], v[188:191], v[80:83]
  v_mfma_f32_16x16x32_bf16 v[116:119], v[152:155], v[192:195], v[116:119]
  ds_read_b64_tr_b16 v[152:153], v219 offset:26688
  ds_read_b64_tr_b16 v[154:155], v219 offset:31296
  v_mfma_f32_16x16x32_bf16 v[12:15], v[156:159], v[180:183], v[12:15]
  buffer_load_dwordx4 v215, s[32:35], s26 offen offset:3072 lds
  v_mfma_f32_16x16x32_bf16 v[48:51], v[156:159], v[184:187], v[48:51]
  v_mfma_f32_16x16x32_bf16 v[84:87], v[156:159], v[188:191], v[84:87]
  v_mfma_f32_16x16x32_bf16 v[120:123], v[156:159], v[192:195], v[120:123]
  ds_read_b64_tr_b16 v[156:157], v219 offset:26720
  ds_read_b64_tr_b16 v[158:159], v219 offset:31328
  v_mfma_f32_16x16x32_bf16 v[16:19], v[160:163], v[180:183], v[16:19]
  s_add_u32 m0, s52, 4096
  s_nop 0
  s_mov_b32 exec_hi, 0
  buffer_load_dwordx4 v216, s[32:35], s26 offen offset:0 lds
  s_mov_b64 exec, -1
  s_add_u32 s26, s26, 294912
  v_mfma_f32_16x16x32_bf16 v[52:55], v[160:163], v[184:187], v[52:55]
  v_mfma_f32_16x16x32_bf16 v[88:91], v[160:163], v[188:191], v[88:91]
  v_mfma_f32_16x16x32_bf16 v[124:127], v[160:163], v[192:195], v[124:127]
  ds_read_b64_tr_b16 v[160:161], v219 offset:26752
  ds_read_b64_tr_b16 v[162:163], v219 offset:31360
  v_mfma_f32_16x16x32_bf16 v[20:23], v[164:167], v[180:183], v[20:23]
  s_add_u32 m0, s53, 0
  s_nop 0
  buffer_load_dwordx4 v217, s[28:31], s44 offen offset:0 lds
  v_mfma_f32_16x16x32_bf16 v[56:59], v[164:167], v[184:187], v[56:59]
  v_mfma_f32_16x16x32_bf16 v[92:95], v[164:167], v[188:191], v[92:95]
  v_mfma_f32_16x16x32_bf16 v[128:131], v[164:167], v[192:195], v[128:131]
  ds_read_b64_tr_b16 v[164:165], v219 offset:26784
  ds_read_b64_tr_b16 v[166:167], v219 offset:31392
  v_mfma_f32_16x16x32_bf16 v[24:27], v[168:171], v[180:183], v[24:27]
  buffer_load_dwordx4 v218, s[28:31], s44 offen offset:1024 lds
  s_add_u32 s44, s44, 64
  v_mfma_f32_16x16x32_bf16 v[60:63], v[168:171], v[184:187], v[60:63]
  v_mfma_f32_16x16x32_bf16 v[96:99], v[168:171], v[188:191], v[96:99]
  v_mfma_f32_16x16x32_bf16 v[132:135], v[168:171], v[192:195], v[132:135]
  ds_read_b64_tr_b16 v[168:169], v219 offset:26816
  ds_read_b64_tr_b16 v[170:171], v219 offset:31424
  v_mfma_f32_16x16x32_bf16 v[28:31], v[172:175], v[180:183], v[28:31]
  v_mfma_f32_16x16x32_bf16 v[64:67], v[172:175], v[184:187], v[64:67]
  v_mfma_f32_16x16x32_bf16 v[100:103], v[172:175], v[188:191], v[100:103]
  v_mfma_f32_16x16x32_bf16 v[136:139], v[172:175], v[192:195], v[136:139]
  ds_read_b64_tr_b16 v[172:173], v219 offset:26848
  ds_read_b64_tr_b16 v[174:175], v219 offset:31456
  v_mfma_f32_16x16x32_bf16 v[32:35], v[176:179], v[180:183], v[32:35]
  v_mfma_f32_16x16x32_bf16 v[68:71], v[176:179], v[184:187], v[68:71]
  v_mfma_f32_16x16x32_bf16 v[104:107], v[176:179], v[188:191], v[104:107]
  v_mfma_f32_16x16x32_bf16 v[140:143], v[176:179], v[192:195], v[140:143]
  ds_read_b64_tr_b16 v[176:177], v219 offset:26880
  ds_read_b64_tr_b16 v[178:179], v219 offset:31488
  s_waitcnt vmcnt(7)
  s_waitcnt lgkmcnt(0)
  s_barrier
  ds_read_b128 v[180:183], v220 offset:53248
  ds_read_b128 v[184:187], v220 offset:54272
  ds_read_b128 v[188:191], v220 offset:55296
  ds_read_b128 v[192:195], v220 offset:56320
  v_mfma_f32_16x16x32_bf16 v[0:3], v[144:147], v[196:199], v[0:3]
  s_add_u32 m0, s52, 26624
  s_nop 0
  buffer_load_dwordx4 v212, s[32:35], s26 offen offset:0 lds
  v_mfma_f32_16x16x32_bf16 v[36:39], v[144:147], v[200:203], v[36:39]
  v_mfma_f32_16x16x32_bf16 v[72:75], v[144:147], v[204:207], v[72:75]
  v_mfma_f32_16x16x32_bf16 v[108:111], v[144:147], v[208:211], v[108:111]
  ds_read_b64_tr_b16 v[144:145], v219 offset:53248
  ds_read_b64_tr_b16 v[146:147], v219 offset:57856
  v_mfma_f32_16x16x32_bf16 v[4:7], v[148:151], v[196:199], v[4:7]
  buffer_load_dwordx4 v213, s[32:35], s26 offen offset:1024 lds
  v_mfma_f32_16x16x32_bf16 v[40:43], v[148:151], v[200:203], v[40:43]
  v_mfma_f32_16x16x32_bf16 v[76:79], v[148:151], v[204:207], v[76:79]
  v_mfma_f32_16x16x32_bf16 v[112:115], v[148:151], v[208:211], v[112:115]
  ds_read_b64_tr_b16 v[148:149], v219 offset:53280
  ds_read_b64_tr_b16 v[150:151], v219 offset:57888
  v_mfma_f32_16x16x32_bf16 v[8:11], v[152:155], v[196:199], v[8:11]
  buffer_load_dwordx4 v214, s[32:35], s26 offen offset:2048 lds
  v_mfma_f32_16x16x32_bf16 v[44:47], v[152:155], v[200:203], v[44:47]
  v_mfma_f32_16x16x32_bf16 v[80:83], v[152:155], v[204:207], v[80:83]
  v_mfma_f32_16x16x32_bf16 v[116:119], v[152:155], v[208:211], v[116:119]
  ds_read_b64_tr_b16 v[152:153], v219 offset:53312
  ds_read_b64_tr_b16 v[154:155], v219 offset:57920
  v_mfma_f32_16x16x32_bf16 v[12:15], v[156:159], v[196:199], v[12:15]
  buffer_load_dwordx4 v215, s[32:35], s26 offen offset:3072 lds
  v_mfma_f32_16x16x32_bf16 v[48:51], v[156:159], v[200:203], v[48:51]
  v_mfma_f32_16x16x32_bf16 v[84:87], v[156:159], v[204:207], v[84:87]
  v_mfma_f32_16x16x32_bf16 v[120:123], v[156:159], v[208:211], v[120:123]
  ds_read_b64_tr_b16 v[156:157], v219 offset:53344
  ds_read_b64_tr_b16 v[158:159], v219 offset:57952
  v_mfma_f32_16x16x32_bf16 v[16:19], v[160:163], v[196:199], v[16:19]
  s_add_u32 m0, s52, 30720
  s_nop 0
  s_mov_b32 exec_hi, 0
  buffer_load_dwordx4 v216, s[32:35], s26 offen offset:0 lds
  s_mov_b64 exec, -1
  s_add_u32 s26, s26, 294912
  v_mfma_f32_16x16x32_bf16 v[52:55], v[160:163], v[200:203], v[52:55]
  v_mfma_f32_16x16x32_bf16 v[88:91], v[160:163], v[204:207], v[88:91]
  v_mfma_f32_16x16x32_bf16 v[124:127], v[160:163], v[208:211], v[124:127]
  ds_read_b64_tr_b16 v[160:161], v219 offset:53376
  ds_read_b64_tr_b16 v[162:163], v219 offset:57984
  v_mfma_f32_16x16x32_bf16 v[20:23], v[164:167], v[196:199], v[20:23]
  s_add_u32 m0, s53, 26624
  s_nop 0
  buffer_load_dwordx4 v217, s[28:31], s44 offen offset:0 lds
  v_mfma_f32_16x16x32_bf16 v[56:59], v[164:167], v[200:203], v[56:59]
  v_mfma_f32_16x16x32_bf16 v[92:95], v[164:167], v[204:207], v[92:95]
  v_mfma_f32_16x16x32_bf16 v[128:131], v[164:167], v[208:211], v[128:131]
  ds_read_b64_tr_b16 v[164:165], v219 offset:53408
  ds_read_b64_tr_b16 v[166:167], v219 offset:58016
  v_mfma_f32_16x16x32_bf16 v[24:27], v[168:171], v[196:199], v[24:27]
  buffer_load_dwordx4 v218, s[28:31], s44 offen offset:1024 lds
  s_add_u32 s44, s44, 64
  v_mfma_f32_16x16x32_bf16 v[60:63], v[168:171], v[200:203], v[60:63]
  v_mfma_f32_16x16x32_bf16 v[96:99], v[168:171], v[204:207], v[96:99]
  v_mfma_f32_16x16x32_bf16 v[132:135], v[168:171], v[208:211], v[132:135]
  ds_read_b64_tr_b16 v[168:169], v219 offset:53440
  ds_read_b64_tr_b16 v[170:171], v219 offset:58048
  v_mfma_f32_16x16x32_bf16 v[28:31], v[172:175], v[196:199], v[28:31]
  v_mfma_f32_16x16x32_bf16 v[64:67], v[172:175], v[200:203], v[64:67]
  v_mfma_f32_16x16x32_bf16 v[100:103], v[172:175], v[204:207], v[100:103]
  v_mfma_f32_16x16x32_bf16 v[136:139], v[172:175], v[208:211], v[136:139]
  ds_read_b64_tr_b16 v[172:173], v219 offset:53472
  ds_read_b64_tr_b16 v[174:175], v219 offset:58080
  v_mfma_f32_16x16x32_bf16 v[32:35], v[176:179], v[196:199], v[32:35]
  v_mfma_f32_16x16x32_bf16 v[68:71], v[176:179], v[200:203], v[68:71]
  v_mfma_f32_16x16x32_bf16 v[104:107], v[176:179], v[204:207], v[104:107]
  v_mfma_f32_16x16x32_bf16 v[140:143], v[176:179], v[208:211], v[140:143]
  ds_read_b64_tr_b16 v[176:177], v219 offset:53504
  ds_read_b64_tr_b16 v[178:179], v219 offset:58112
  s_waitcnt vmcnt(7)
  s_waitcnt lgkmcnt(0)
  s_barrier
  ds_read_b128 v[196:199], v220 offset:0
  ds_read_b128 v[200:203], v220 offset:1024
  ds_read_b128 v[204:207], v220 offset:2048
  ds_read_b128 v[208:211], v220 offset:3072
  v_mfma_f32_16x16x32_bf16 v[0:3], v[144:147], v[180:183], v[0:3]
  s_add_u32 m0, s52, 53248
  s_nop 0
  buffer_load_dwordx4 v212, s[32:35], s26 offen offset:0 lds
  v_mfma_f32_16x16x32_bf16 v[36:39], v[144:147], v[184:187], v[36:39]
  v_mfma_f32_16x16x32_bf16 v[72:75], v[144:147], v[188:191], v[72:75]
  v_mfma_f32_16x16x32_bf16 v[108:111], v[144:147], v[192:195], v[108:111]
  ds_read_b64_tr_b16 v[144:145], v219 offset:0
  ds_read_b64_tr_b16 v[146:147], v219 offset:4608
  v_mfma_f32_16x16x32_bf16 v[4:7], v[148:151], v[180:183], v[4:7]
  buffer_load_dwordx4 v213, s[32:35], s26 offen offset:1024 lds
  v_mfma_f32_16x16x32_bf16 v[40:43], v[148:151], v[184:187], v[40:43]
  v_mfma_f32_16x16x32_bf16 v[76:79], v[148:151], v[188:191], v[76:79]
  v_mfma_f32_16x16x32_bf16 v[112:115], v[148:151], v[192:195], v[112:115]
  ds_read_b64_tr_b16 v[148:149], v219 offset:32
  ds_read_b64_tr_b16 v[150:151], v219 offset:4640
  v_mfma_f32_16x16x32_bf16 v[8:11], v[152:155], v[180:183], v[8:11]
  buffer_load_dwordx4 v214, s[32:35], s26 offen offset:2048 lds
  v_mfma_f32_16x16x32_bf16 v[44:47], v[152:155], v[184:187], v[44:47]
  v_mfma_f32_16x16x32_bf16 v[80:83], v[152:155], v[188:191], v[80:83]
  v_mfma_f32_16x16x32_bf16 v[116:119], v[152:155], v[192:195], v[116:119]
  ds_read_b64_tr_b16 v[152:153], v219 offset:64
  ds_read_b64_tr_b16 v[154:155], v219 offset:4672
  v_mfma_f32_16x16x32_bf16 v[12:15], v[156:159], v[180:183], v[12:15]
  buffer_load_dwordx4 v215, s[32:35], s26 offen offset:3072 lds
  v_mfma_f32_16x16x32_bf16 v[48:51], v[156:159], v[184:187], v[48:51]
  v_mfma_f32_16x16x32_bf16 v[84:87], v[156:159], v[188:191], v[84:87]
  v_mfma_f32_16x16x32_bf16 v[120:123], v[156:159], v[192:195], v[120:123]
  ds_read_b64_tr_b16 v[156:157], v219 offset:96
  ds_read_b64_tr_b16 v[158:159], v219 offset:4704
  v_mfma_f32_16x16x32_bf16 v[16:19], v[160:163], v[180:183], v[16:19]
  s_add_u32 m0, s52, 57344
  s_nop 0
  s_mov_b32 exec_hi, 0
  buffer_load_dwordx4 v216, s[32:35], s26 offen offset:0 lds
  s_mov_b64 exec, -1
  s_add_u32 s26, s26, 294912
  v_mfma_f32_16x16x32_bf16 v[52:55], v[160:163], v[184:187], v[52:55]
  v_mfma_f32_16x16x32_bf16 v[88:91], v[160:163], v[188:191], v[88:91]
  v_mfma_f32_16x16x32_bf16 v[124:127], v[160:163], v[192:195], v[124:127]
  ds_read_b64_tr_b16 v[160:161], v219 offset:128
  ds_read_b64_tr_b16 v[162:163], v219 offset:4736
  v_mfma_f32_16x16x32_bf16 v[20:23], v[164:167], v[180:183], v[20:23]
  s_add_u32 m0, s53, 53248
  s_nop 0
  buffer_load_dwordx4 v217, s[28:31], s44 offen offset:0 lds
  v_mfma_f32_16x16x32_bf16 v[56:59], v[164:167], v[184:187], v[56:59]
  v_mfma_f32_16x16x32_bf16 v[92:95], v[164:167], v[188:191], v[92:95]
  v_mfma_f32_16x16x32_bf16 v[128:131], v[164:167], v[192:195], v[128:131]
  ds_read_b64_tr_b16 v[164:165], v219 offset:160
  ds_read_b64_tr_b16 v[166:167], v219 offset:4768
  v_mfma_f32_16x16x32_bf16 v[24:27], v[168:171], v[180:183], v[24:27]
  buffer_load_dwordx4 v218, s[28:31], s44 offen offset:1024 lds
  s_add_u32 s44, s44, 64
  v_mfma_f32_16x16x32_bf16 v[60:63], v[168:171], v[184:187], v[60:63]
  v_mfma_f32_16x16x32_bf16 v[96:99], v[168:171], v[188:191], v[96:99]
  v_mfma_f32_16x16x32_bf16 v[132:135], v[168:171], v[192:195], v[132:135]
  ds_read_b64_tr_b16 v[168:169], v219 offset:192
  ds_read_b64_tr_b16 v[170:171], v219 offset:4800
  v_mfma_f32_16x16x32_bf16 v[28:31], v[172:175], v[180:183], v[28:31]
  v_mfma_f32_16x16x32_bf16 v[64:67], v[172:175], v[184:187], v[64:67]
  v_mfma_f32_16x16x32_bf16 v[100:103], v[172:175], v[188:191], v[100:103]
  v_mfma_f32_16x16x32_bf16 v[136:139], v[172:175], v[192:195], v[136:139]
  ds_read_b64_tr_b16 v[172:173], v219 offset:224
  ds_read_b64_tr_b16 v[174:175], v219 offset:4832
  v_mfma_f32_16x16x32_bf16 v[32:35], v[176:179], v[180:183], v[32:35]
  v_mfma_f32_16x16x32_bf16 v[68:71], v[176:179], v[184:187], v[68:71]
  v_mfma_f32_16x16x32_bf16 v[104:107], v[176:179], v[188:191], v[104:107]
  v_mfma_f32_16x16x32_bf16 v[140:143], v[176:179], v[192:195], v[140:143]
  ds_read_b64_tr_b16 v[176:177], v219 offset:256
  ds_read_b64_tr_b16 v[178:179], v219 offset:4864
  s_waitcnt vmcnt(7)
  s_waitcnt lgkmcnt(0)
  s_barrier
  ds_read_b128 v[180:183], v220 offset:26624
  ds_read_b128 v[184:187], v220 offset:27648
  ds_read_b128 v[188:191], v220 offset:28672
  ds_read_b128 v[192:195], v220 offset:29696
  v_mfma_f32_16x16x32_bf16 v[0:3], v[144:147], v[196:199], v[0:3]
  s_add_u32 m0, s52, 0
  s_nop 0
  buffer_load_dwordx4 v212, s[32:35], s26 offen offset:0 lds
  v_mfma_f32_16x16x32_bf16 v[36:39], v[144:147], v[200:203], v[36:39]
  v_mfma_f32_16x16x32_bf16 v[72:75], v[144:147], v[204:207], v[72:75]
  v_mfma_f32_16x16x32_bf16 v[108:111], v[144:147], v[208:211], v[108:111]
  ds_read_b64_tr_b16 v[144:145], v219 offset:26624
  ds_read_b64_tr_b16 v[146:147], v219 offset:31232
  v_mfma_f32_16x16x32_bf16 v[4:7], v[148:151], v[196:199], v[4:7]
  buffer_load_dwordx4 v213, s[32:35], s26 offen offset:1024 lds
  v_mfma_f32_16x16x32_bf16 v[40:43], v[148:151], v[200:203], v[40:43]
  v_mfma_f32_16x16x32_bf16 v[76:79], v[148:151], v[204:207], v[76:79]
  v_mfma_f32_16x16x32_bf16 v[112:115], v[148:151], v[208:211], v[112:115]
  ds_read_b64_tr_b16 v[148:149], v219 offset:26656
  ds_read_b64_tr_b16 v[150:151], v219 offset:31264
  v_mfma_f32_16x16x32_bf16 v[8:11], v[152:155], v[196:199], v[8:11]
  buffer_load_dwordx4 v214, s[32:35], s26 offen offset:2048 lds
  v_mfma_f32_16x16x32_bf16 v[44:47], v[152:155], v[200:203], v[44:47]
  v_mfma_f32_16x16x32_bf16 v[80:83], v[152:155], v[204:207], v[80:83]
  v_mfma_f32_16x16x32_bf16 v[116:119], v[152:155], v[208:211], v[116:119]
  ds_read_b64_tr_b16 v[152:153], v219 offset:26688
  ds_read_b64_tr_b16 v[154:155], v219 offset:31296
  v_mfma_f32_16x16x32_bf16 v[12:15], v[156:159], v[196:199], v[12:15]
  buffer_load_dwordx4 v215, s[32:35], s26 offen offset:3072 lds
  v_mfma_f32_16x16x32_bf16 v[48:51], v[156:159], v[200:203], v[48:51]
  v_mfma_f32_16x16x32_bf16 v[84:87], v[156:159], v[204:207], v[84:87]
  v_mfma_f32_16x16x32_bf16 v[120:123], v[156:159], v[208:211], v[120:123]
  ds_read_b64_tr_b16 v[156:157], v219 offset:26720
  ds_read_b64_tr_b16 v[158:159], v219 offset:31328
  v_mfma_f32_16x16x32_bf16 v[16:19], v[160:163], v[196:199], v[16:19]
  s_add_u32 m0, s52, 4096
  s_nop 0
  s_mov_b32 exec_hi, 0
  buffer_load_dwordx4 v216, s[32:35], s26 offen offset:0 lds
  s_mov_b64 exec, -1
  s_add_u32 s26, s26, 294912
  v_mfma_f32_16x16x32_bf16 v[52:55], v[160:163], v[200:203], v[52:55]
  v_mfma_f32_16x16x32_bf16 v[88:91], v[160:163], v[204:207], v[88:91]
  v_mfma_f32_16x16x32_bf16 v[124:127], v[160:163], v[208:211], v[124:127]
  ds_read_b64_tr_b16 v[160:161], v219 offset:26752
  ds_read_b64_tr_b16 v[162:163], v219 offset:31360
  v_mfma_f32_16x16x32_bf16 v[20:23], v[164:167], v[196:199], v[20:23]
  s_add_u32 m0, s53, 0
  s_nop 0
  buffer_load_dwordx4 v217, s[28:31], s44 offen offset:0 lds
  v_mfma_f32_16x16x32_bf16 v[56:59], v[164:167], v[200:203], v[56:59]
  v_mfma_f32_16x16x32_bf16 v[92:95], v[164:167], v[204:207], v[92:95]
  v_mfma_f32_16x16x32_bf16 v[128:131], v[164:167], v[208:211], v[128:131]
  ds_read_b64_tr_b16 v[164:165], v219 offset:26784
  ds_read_b64_tr_b16 v[166:167], v219 offset:31392
  v_mfma_f32_16x16x32_bf16 v[24:27], v[168:171], v[196:199], v[24:27]
  buffer_load_dwordx4 v218, s[28:31], s44 offen offset:1024 lds
  s_add_u32 s44, s44, 64
  v_mfma_f32_16x16x32_bf16 v[60:63], v[168:171], v[200:203], v[60:63]
  v_mfma_f32_16x16x32_bf16 v[96:99], v[168:171], v[204:207], v[96:99]
  v_mfma_f32_16x16x32_bf16 v[132:135], v[168:171], v[208:211], v[132:135]
  ds_read_b64_tr_b16 v[168:169], v219 offset:26816
  ds_read_b64_tr_b16 v[170:171], v219 offset:31424
  v_mfma_f32_16x16x32_bf16 v[28:31], v[172:175], v[196:199], v[28:31]
  v_mfma_f32_16x16x32_bf16 v[64:67], v[172:175], v[200:203], v[64:67]
  v_mfma_f32_16x16x32_bf16 v[100:103], v[172:175], v[204:207], v[100:103]
  v_mfma_f32_16x16x32_bf16 v[136:139], v[172:175], v[208:211], v[136:139]
  ds_read_b64_tr_b16 v[172:173], v219 offset:26848
  ds_read_b64_tr_b16 v[174:175], v219 offset:31456
  v_mfma_f32_16x16x32_bf16 v[32:35], v[176:179], v[196:199], v[32:35]
  v_mfma_f32_16x16x32_bf16 v[68:71], v[176:179], v[200:203], v[68:71]
  v_mfma_f32_16x16x32_bf16 v[104:107], v[176:179], v[204:207], v[104:107]
  v_mfma_f32_16x16x32_bf16 v[140:143], v[176:179], v[208:211], v[140:143]
  ds_read_b64_tr_b16 v[176:177], v219 offset:26880
  ds_read_b64_tr_b16 v[178:179], v219 offset:31488
  s_waitcnt vmcnt(7)
  s_waitcnt lgkmcnt(0)
  s_barrier
  ds_read_b128 v[196:199], v220 offset:53248
  ds_read_b128 v[200:203], v220 offset:54272
  ds_read_b128 v[204:207], v220 offset:55296
  ds_read_b128 v[208:211], v220 offset:56320
  v_mfma_f32_16x16x32_bf16 v[0:3], v[144:147], v[180:183], v[0:3]
  s_add_u32 m0, s52, 26624
  s_nop 0
  buffer_load_dwordx4 v212, s[32:35], s26 offen offset:0 lds
  v_mfma_f32_16x16x32_bf16 v[36:39], v[144:147], v[184:187], v[36:39]
  v_mfma_f32_16x16x32_bf16 v[72:75], v[144:147], v[188:191], v[72:75]
  v_mfma_f32_16x16x32_bf16 v[108:111], v[144:147], v[192:195], v[108:111]
  ds_read_b64_tr_b16 v[144:145], v219 offset:53248
  ds_read_b64_tr_b16 v[146:147], v219 offset:57856
  v_mfma_f32_16x16x32_bf16 v[4:7], v[148:151], v[180:183], v[4:7]
  buffer_load_dwordx4 v213, s[32:35], s26 offen offset:1024 lds
  v_mfma_f32_16x16x32_bf16 v[40:43], v[148:151], v[184:187], v[40:43]
  v_mfma_f32_16x16x32_bf16 v[76:79], v[148:151], v[188:191], v[76:79]
  v_mfma_f32_16x16x32_bf16 v[112:115], v[148:151], v[192:195], v[112:115]
  ds_read_b64_tr_b16 v[148:149], v219 offset:53280
  ds_read_b64_tr_b16 v[150:151], v219 offset:57888
  v_mfma_f32_16x16x32_bf16 v[8:11], v[152:155], v[180:183], v[8:11]
  buffer_load_dwordx4 v214, s[32:35], s26 offen offset:2048 lds
  v_mfma_f32_16x16x32_bf16 v[44:47], v[152:155], v[184:187], v[44:47]
  v_mfma_f32_16x16x32_bf16 v[80:83], v[152:155], v[188:191], v[80:83]
  v_mfma_f32_16x16x32_bf16 v[116:119], v[152:155], v[192:195], v[116:119]
  ds_read_b64_tr_b16 v[152:153], v219 offset:53312
  ds_read_b64_tr_b16 v[154:155], v219 offset:57920
  v_mfma_f32_16x16x32_bf16 v[12:15], v[156:159], v[180:183], v[12:15]
  buffer_load_dwordx4 v215, s[32:35], s26 offen offset:3072 lds
  v_mfma_f32_16x16x32_bf16 v[48:51], v[156:159], v[184:187], v[48:51]
  v_mfma_f32_16x16x32_bf16 v[84:87], v[156:159], v[188:191], v[84:87]
  v_mfma_f32_16x16x32_bf16 v[120:123], v[156:159], v[192:195], v[120:123]
  ds_read_b64_tr_b16 v[156:157], v219 offset:53344
  ds_read_b64_tr_b16 v[158:159], v219 offset:57952
  v_mfma_f32_16x16x32_bf16 v[16:19], v[160:163], v[180:183], v[16:19]
  s_add_u32 m0, s52, 30720
  s_nop 0
  s_mov_b32 exec_hi, 0
  buffer_load_dwordx4 v216, s[32:35], s26 offen offset:0 lds
  s_mov_b64 exec, -1
  s_add_u32 s26, s26, 294912
  v_mfma_f32_16x16x32_bf16 v[52:55], v[160:163], v[184:187], v[52:55]
  v_mfma_f32_16x16x32_bf16 v[88:91], v[160:163], v[188:191], v[88:91]
  v_mfma_f32_16x16x32_bf16 v[124:127], v[160:163], v[192:195], v[124:127]
  ds_read_b64_tr_b16 v[160:161], v219 offset:53376
  ds_read_b64_tr_b16 v[162:163], v219 offset:57984
  v_mfma_f32_16x16x32_bf16 v[20:23], v[164:167], v[180:183], v[20:23]
  s_add_u32 m0, s53, 26624
  s_nop 0
  buffer_load_dwordx4 v217, s[28:31], s44 offen offset:0 lds
  v_mfma_f32_16x16x32_bf16 v[56:59], v[164:167], v[184:187], v[56:59]
  v_mfma_f32_16x16x32_bf16 v[92:95], v[164:167], v[188:191], v[92:95]
  v_mfma_f32_16x16x32_bf16 v[128:131], v[164:167], v[192:195], v[128:131]
  ds_read_b64_tr_b16 v[164:165], v219 offset:53408
  ds_read_b64_tr_b16 v[166:167], v219 offset:58016
  v_mfma_f32_16x16x32_bf16 v[24:27], v[168:171], v[180:183], v[24:27]
  buffer_load_dwordx4 v218, s[28:31], s44 offen offset:1024 lds
  s_add_u32 s44, s44, 64
  v_mfma_f32_16x16x32_bf16 v[60:63], v[168:171], v[184:187], v[60:63]
  v_mfma_f32_16x16x32_bf16 v[96:99], v[168:171], v[188:191], v[96:99]
  v_mfma_f32_16x16x32_bf16 v[132:135], v[168:171], v[192:195], v[132:135]
  ds_read_b64_tr_b16 v[168:169], v219 offset:53440
  ds_read_b64_tr_b16 v[170:171], v219 offset:58048
  v_mfma_f32_16x16x32_bf16 v[28:31], v[172:175], v[180:183], v[28:31]
  v_mfma_f32_16x16x32_bf16 v[64:67], v[172:175], v[184:187], v[64:67]
  v_mfma_f32_16x16x32_bf16 v[100:103], v[172:175], v[188:191], v[100:103]
  v_mfma_f32_16x16x32_bf16 v[136:139], v[172:175], v[192:195], v[136:139]
  ds_read_b64_tr_b16 v[172:173], v219 offset:53472
  ds_read_b64_tr_b16 v[174:175], v219 offset:58080
  v_mfma_f32_16x16x32_bf16 v[32:35], v[176:179], v[180:183], v[32:35]
  v_mfma_f32_16x16x32_bf16 v[68:71], v[176:179], v[184:187], v[68:71]
  v_mfma_f32_16x16x32_bf16 v[104:107], v[176:179], v[188:191], v[104:107]
  v_mfma_f32_16x16x32_bf16 v[140:143], v[176:179], v[192:195], v[140:143]
  ds_read_b64_tr_b16 v[176:177], v219 offset:53504
  ds_read_b64_tr_b16 v[178:179], v219 offset:58112
  s_waitcnt vmcnt(7)
  s_waitcnt lgkmcnt(0)
  s_barrier
  ds_read_b128 v[180:183], v220 offset:0
  ds_read_b128 v[184:187], v220 offset:1024
  ds_read_b128 v[188:191], v220 offset:2048
  ds_read_b128 v[192:195], v220 offset:3072
  v_mfma_f32_16x16x32_bf16 v[0:3], v[144:147], v[196:199], v[0:3]
  s_add_u32 m0, s52, 53248
  s_nop 0
  buffer_load_dwordx4 v212, s[32:35], s26 offen offset:0 lds
  v_mfma_f32_16x16x32_bf16 v[36:39], v[144:147], v[200:203], v[36:39]
  v_mfma_f32_16x16x32_bf16 v[72:75], v[144:147], v[204:207], v[72:75]
  v_mfma_f32_16x16x32_bf16 v[108:111], v[144:147], v[208:211], v[108:111]
  ds_read_b64_tr_b16 v[144:145], v219 offset:0
  ds_read_b64_tr_b16 v[146:147], v219 offset:4608
  v_mfma_f32_16x16x32_bf16 v[4:7], v[148:151], v[196:199], v[4:7]
  buffer_load_dwordx4 v213, s[32:35], s26 offen offset:1024 lds
  v_mfma_f32_16x16x32_bf16 v[40:43], v[148:151], v[200:203], v[40:43]
  v_mfma_f32_16x16x32_bf16 v[76:79], v[148:151], v[204:207], v[76:79]
  v_mfma_f32_16x16x32_bf16 v[112:115], v[148:151], v[208:211], v[112:115]
  ds_read_b64_tr_b16 v[148:149], v219 offset:32
  ds_read_b64_tr_b16 v[150:151], v219 offset:4640
  v_mfma_f32_16x16x32_bf16 v[8:11], v[152:155], v[196:199], v[8:11]
  buffer_load_dwordx4 v214, s[32:35], s26 offen offset:2048 lds
  v_mfma_f32_16x16x32_bf16 v[44:47], v[152:155], v[200:203], v[44:47]
  v_mfma_f32_16x16x32_bf16 v[80:83], v[152:155], v[204:207], v[80:83]
  v_mfma_f32_16x16x32_bf16 v[116:119], v[152:155], v[208:211], v[116:119]
  ds_read_b64_tr_b16 v[152:153], v219 offset:64
  ds_read_b64_tr_b16 v[154:155], v219 offset:4672
  v_mfma_f32_16x16x32_bf16 v[12:15], v[156:159], v[196:199], v[12:15]
  buffer_load_dwordx4 v215, s[32:35], s26 offen offset:3072 lds
  v_mfma_f32_16x16x32_bf16 v[48:51], v[156:159], v[200:203], v[48:51]
  v_mfma_f32_16x16x32_bf16 v[84:87], v[156:159], v[204:207], v[84:87]
  v_mfma_f32_16x16x32_bf16 v[120:123], v[156:159], v[208:211], v[120:123]
  ds_read_b64_tr_b16 v[156:157], v219 offset:96
  ds_read_b64_tr_b16 v[158:159], v219 offset:4704
  v_mfma_f32_16x16x32_bf16 v[16:19], v[160:163], v[196:199], v[16:19]
  s_add_u32 m0, s52, 57344
  s_nop 0
  s_mov_b32 exec_hi, 0
  buffer_load_dwordx4 v216, s[32:35], s26 offen offset:0 lds
  s_mov_b64 exec, -1
  s_add_u32 s26, s26, 294912
  v_mfma_f32_16x16x32_bf16 v[52:55], v[160:163], v[200:203], v[52:55]
  v_mfma_f32_16x16x32_bf16 v[88:91], v[160:163], v[204:207], v[88:91]
  v_mfma_f32_16x16x32_bf16 v[124:127], v[160:163], v[208:211], v[124:127]
  ds_read_b64_tr_b16 v[160:161], v219 offset:128
  ds_read_b64_tr_b16 v[162:163], v219 offset:4736
  v_mfma_f32_16x16x32_bf16 v[20:23], v[164:167], v[196:199], v[20:23]
  s_add_u32 m0, s53, 53248
  s_nop 0
  buffer_load_dwordx4 v217, s[28:31], s44 offen offset:0 lds
  v_mfma_f32_16x16x32_bf16 v[56:59], v[164:167], v[200:203], v[56:59]
  v_mfma_f32_16x16x32_bf16 v[92:95], v[164:167], v[204:207], v[92:95]
  v_mfma_f32_16x16x32_bf16 v[128:131], v[164:167], v[208:211], v[128:131]
  ds_read_b64_tr_b16 v[164:165], v219 offset:160
  ds_read_b64_tr_b16 v[166:167], v219 offset:4768
  v_mfma_f32_16x16x32_bf16 v[24:27], v[168:171], v[196:199], v[24:27]
  buffer_load_dwordx4 v218, s[28:31], s44 offen offset:1024 lds
  s_add_u32 s44, s44, 64
  v_mfma_f32_16x16x32_bf16 v[60:63], v[168:171], v[200:203], v[60:63]
  v_mfma_f32_16x16x32_bf16 v[96:99], v[168:171], v[204:207], v[96:99]
  v_mfma_f32_16x16x32_bf16 v[132:135], v[168:171], v[208:211], v[132:135]
  ds_read_b64_tr_b16 v[168:169], v219 offset:192
  ds_read_b64_tr_b16 v[170:171], v219 offset:4800
  v_mfma_f32_16x16x32_bf16 v[28:31], v[172:175], v[196:199], v[28:31]
  v_mfma_f32_16x16x32_bf16 v[64:67], v[172:175], v[200:203], v[64:67]
  v_mfma_f32_16x16x32_bf16 v[100:103], v[172:175], v[204:207], v[100:103]
  v_mfma_f32_16x16x32_bf16 v[136:139], v[172:175], v[208:211], v[136:139]
  ds_read_b64_tr_b16 v[172:173], v219 offset:224
  ds_read_b64_tr_b16 v[174:175], v219 offset:4832
  v_mfma_f32_16x16x32_bf16 v[32:35], v[176:179], v[196:199], v[32:35]
  v_mfma_f32_16x16x32_bf16 v[68:71], v[176:179], v[200:203], v[68:71]
  v_mfma_f32_16x16x32_bf16 v[104:107], v[176:179], v[204:207], v[104:107]
  v_mfma_f32_16x16x32_bf16 v[140:143], v[176:179], v[208:211], v[140:143]
  ds_read_b64_tr_b16 v[176:177], v219 offset:256
  ds_read_b64_tr_b16 v[178:179], v219 offset:4864
  s_waitcnt vmcnt(7)
  s_waitcnt lgkmcnt(0)
  s_barrier
  ds_read_b128 v[196:199], v220 offset:26624
  ds_read_b128 v[200:203], v220 offset:27648
  ds_read_b128 v[204:207], v220 offset:28672
  ds_read_b128 v[208:211], v220 offset:29696
  v_mfma_f32_16x16x32_bf16 v[0:3], v[144:147], v[180:183], v[0:3]
  s_add_u32 m0, s52, 0
  s_nop 0
  buffer_load_dwordx4 v212, s[32:35], s26 offen offset:0 lds
  v_mfma_f32_16x16x32_bf16 v[36:39], v[144:147], v[184:187], v[36:39]
  v_mfma_f32_16x16x32_bf16 v[72:75], v[144:147], v[188:191], v[72:75]
  v_mfma_f32_16x16x32_bf16 v[108:111], v[144:147], v[192:195], v[108:111]
  ds_read_b64_tr_b16 v[144:145], v219 offset:26624
  ds_read_b64_tr_b16 v[146:147], v219 offset:31232
  v_mfma_f32_16x16x32_bf16 v[4:7], v[148:151], v[180:183], v[4:7]
  buffer_load_dwordx4 v213, s[32:35], s26 offen offset:1024 lds
  v_mfma_f32_16x16x32_bf16 v[40:43], v[148:151], v[184:187], v[40:43]
  v_mfma_f32_16x16x32_bf16 v[76:79], v[148:151], v[188:191], v[76:79]
  v_mfma_f32_16x16x32_bf16 v[112:115], v[148:151], v[192:195], v[112:115]
  ds_read_b64_tr_b16 v[148:149], v219 offset:26656
  ds_read_b64_tr_b16 v[150:151], v219 offset:31264
  v_mfma_f32_16x16x32_bf16 v[8:11], v[152:155], v[180:183], v[8:11]
  buffer_load_dwordx4 v214, s[32:35], s26 offen offset:2048 lds
  v_mfma_f32_16x16x32_bf16 v[44:47], v[152:155], v[184:187], v[44:47]
  v_mfma_f32_16x16x32_bf16 v[80:83], v[152:155], v[188:191], v[80:83]
  v_mfma_f32_16x16x32_bf16 v[116:119], v[152:155], v[192:195], v[116:119]
  ds_read_b64_tr_b16 v[152:153], v219 offset:26688
  ds_read_b64_tr_b16 v[154:155], v219 offset:31296
  v_mfma_f32_16x16x32_bf16 v[12:15], v[156:159], v[180:183], v[12:15]
  buffer_load_dwordx4 v215, s[32:35], s26 offen offset:3072 lds
  v_mfma_f32_16x16x32_bf16 v[48:51], v[156:159], v[184:187], v[48:51]
  v_mfma_f32_16x16x32_bf16 v[84:87], v[156:159], v[188:191], v[84:87]
  v_mfma_f32_16x16x32_bf16 v[120:123], v[156:159], v[192:195], v[120:123]
  ds_read_b64_tr_b16 v[156:157], v219 offset:26720
  ds_read_b64_tr_b16 v[158:159], v219 offset:31328
  v_mfma_f32_16x16x32_bf16 v[16:19], v[160:163], v[180:183], v[16:19]
  s_add_u32 m0, s52, 4096
  s_nop 0
  s_mov_b32 exec_hi, 0
  buffer_load_dwordx4 v216, s[32:35], s26 offen offset:0 lds
  s_mov_b64 exec, -1
  s_add_u32 s26, s26, 294912
  v_mfma_f32_16x16x32_bf16 v[52:55], v[160:163], v[184:187], v[52:55]
  v_mfma_f32_16x16x32_bf16 v[88:91], v[160:163], v[188:191], v[88:91]
  v_mfma_f32_16x16x32_bf16 v[124:127], v[160:163], v[192:195], v[124:127]
  ds_read_b64_tr_b16 v[160:161], v219 offset:26752
  ds_read_b64_tr_b16 v[162:163], v219 offset:31360
  v_mfma_f32_16x16x32_bf16 v[20:23], v[164:167], v[180:183], v[20:23]
  s_add_u32 m0, s53, 0
  s_nop 0
  buffer_load_dwordx4 v217, s[28:31], s44 offen offset:0 lds
  v_mfma_f32_16x16x32_bf16 v[56:59], v[164:167], v[184:187], v[56:59]
  v_mfma_f32_16x16x32_bf16 v[92:95], v[164:167], v[188:191], v[92:95]
  v_mfma_f32_16x16x32_bf16 v[128:131], v[164:167], v[192:195], v[128:131]
  ds_read_b64_tr_b16 v[164:165], v219 offset:26784
  ds_read_b64_tr_b16 v[166:167], v219 offset:31392
  v_mfma_f32_16x16x32_bf16 v[24:27], v[168:171], v[180:183], v[24:27]
  buffer_load_dwordx4 v218, s[28:31], s44 offen offset:1024 lds
  s_add_u32 s44, s44, 64
  v_mfma_f32_16x16x32_bf16 v[60:63], v[168:171], v[184:187], v[60:63]
  v_mfma_f32_16x16x32_bf16 v[96:99], v[168:171], v[188:191], v[96:99]
  v_mfma_f32_16x16x32_bf16 v[132:135], v[168:171], v[192:195], v[132:135]
  ds_read_b64_tr_b16 v[168:169], v219 offset:26816
  ds_read_b64_tr_b16 v[170:171], v219 offset:31424
  v_mfma_f32_16x16x32_bf16 v[28:31], v[172:175], v[180:183], v[28:31]
  v_mfma_f32_16x16x32_bf16 v[64:67], v[172:175], v[184:187], v[64:67]
  v_mfma_f32_16x16x32_bf16 v[100:103], v[172:175], v[188:191], v[100:103]
  v_mfma_f32_16x16x32_bf16 v[136:139], v[172:175], v[192:195], v[136:139]
  ds_read_b64_tr_b16 v[172:173], v219 offset:26848
  ds_read_b64_tr_b16 v[174:175], v219 offset:31456
  v_mfma_f32_16x16x32_bf16 v[32:35], v[176:179], v[180:183], v[32:35]
  v_mfma_f32_16x16x32_bf16 v[68:71], v[176:179], v[184:187], v[68:71]
  v_mfma_f32_16x16x32_bf16 v[104:107], v[176:179], v[188:191], v[104:107]
  v_mfma_f32_16x16x32_bf16 v[140:143], v[176:179], v[192:195], v[140:143]
  ds_read_b64_tr_b16 v[176:177], v219 offset:26880
  ds_read_b64_tr_b16 v[178:179], v219 offset:31488
  s_waitcnt vmcnt(7)
  s_waitcnt lgkmcnt(0)
  s_barrier
  ds_read_b128 v[180:183], v220 offset:53248
  ds_read_b128 v[184:187], v220 offset:54272
  ds_read_b128 v[188:191], v220 offset:55296
  ds_read_b128 v[192:195], v220 offset:56320
  v_mfma_f32_16x16x32_bf16 v[0:3], v[144:147], v[196:199], v[0:3]
  s_add_u32 m0, s52, 26624
  s_nop 0
  buffer_load_dwordx4 v212, s[32:35], s26 offen offset:0 lds
  v_mfma_f32_16x16x32_bf16 v[36:39], v[144:147], v[200:203], v[36:39]
  v_mfma_f32_16x16x32_bf16 v[72:75], v[144:147], v[204:207], v[72:75]
  v_mfma_f32_16x16x32_bf16 v[108:111], v[144:147], v[208:211], v[108:111]
  ds_read_b64_tr_b16 v[144:145], v219 offset:53248
  ds_read_b64_tr_b16 v[146:147], v219 offset:57856
  v_mfma_f32_16x16x32_bf16 v[4:7], v[148:151], v[196:199], v[4:7]
  buffer_load_dwordx4 v213, s[32:35], s26 offen offset:1024 lds
  v_mfma_f32_16x16x32_bf16 v[40:43], v[148:151], v[200:203], v[40:43]
  v_mfma_f32_16x16x32_bf16 v[76:79], v[148:151], v[204:207], v[76:79]
  v_mfma_f32_16x16x32_bf16 v[112:115], v[148:151], v[208:211], v[112:115]
  ds_read_b64_tr_b16 v[148:149], v219 offset:53280
  ds_read_b64_tr_b16 v[150:151], v219 offset:57888
  v_mfma_f32_16x16x32_bf16 v[8:11], v[152:155], v[196:199], v[8:11]
  buffer_load_dwordx4 v214, s[32:35], s26 offen offset:2048 lds
  v_mfma_f32_16x16x32_bf16 v[44:47], v[152:155], v[200:203], v[44:47]
  v_mfma_f32_16x16x32_bf16 v[80:83], v[152:155], v[204:207], v[80:83]
  v_mfma_f32_16x16x32_bf16 v[116:119], v[152:155], v[208:211], v[116:119]
  ds_read_b64_tr_b16 v[152:153], v219 offset:53312
  ds_read_b64_tr_b16 v[154:155], v219 offset:57920
  v_mfma_f32_16x16x32_bf16 v[12:15], v[156:159], v[196:199], v[12:15]
  buffer_load_dwordx4 v215, s[32:35], s26 offen offset:3072 lds
  v_mfma_f32_16x16x32_bf16 v[48:51], v[156:159], v[200:203], v[48:51]
  v_mfma_f32_16x16x32_bf16 v[84:87], v[156:159], v[204:207], v[84:87]
  v_mfma_f32_16x16x32_bf16 v[120:123], v[156:159], v[208:211], v[120:123]
  ds_read_b64_tr_b16 v[156:157], v219 offset:53344
  ds_read_b64_tr_b16 v[158:159], v219 offset:57952
  v_mfma_f32_16x16x32_bf16 v[16:19], v[160:163], v[196:199], v[16:19]
  s_add_u32 m0, s52, 30720
  s_nop 0
  s_mov_b32 exec_hi, 0
  buffer_load_dwordx4 v216, s[32:35], s26 offen offset:0 lds
  s_mov_b64 exec, -1
  s_add_u32 s26, s26, 294912
  v_mfma_f32_16x16x32_bf16 v[52:55], v[160:163], v[200:203], v[52:55]
  v_mfma_f32_16x16x32_bf16 v[88:91], v[160:163], v[204:207], v[88:91]
  v_mfma_f32_16x16x32_bf16 v[124:127], v[160:163], v[208:211], v[124:127]
  ds_read_b64_tr_b16 v[160:161], v219 offset:53376
  ds_read_b64_tr_b16 v[162:163], v219 offset:57984
  v_mfma_f32_16x16x32_bf16 v[20:23], v[164:167], v[196:199], v[20:23]
  s_add_u32 m0, s53, 26624
  s_nop 0
  buffer_load_dwordx4 v217, s[28:31], s44 offen offset:0 lds
  v_mfma_f32_16x16x32_bf16 v[56:59], v[164:167], v[200:203], v[56:59]
  v_mfma_f32_16x16x32_bf16 v[92:95], v[164:167], v[204:207], v[92:95]
  v_mfma_f32_16x16x32_bf16 v[128:131], v[164:167], v[208:211], v[128:131]
  ds_read_b64_tr_b16 v[164:165], v219 offset:53408
  ds_read_b64_tr_b16 v[166:167], v219 offset:58016
  v_mfma_f32_16x16x32_bf16 v[24:27], v[168:171], v[196:199], v[24:27]
  buffer_load_dwordx4 v218, s[28:31], s44 offen offset:1024 lds
  s_add_u32 s44, s44, 64
  v_mfma_f32_16x16x32_bf16 v[60:63], v[168:171], v[200:203], v[60:63]
  v_mfma_f32_16x16x32_bf16 v[96:99], v[168:171], v[204:207], v[96:99]
  v_mfma_f32_16x16x32_bf16 v[132:135], v[168:171], v[208:211], v[132:135]
  ds_read_b64_tr_b16 v[168:169], v219 offset:53440
  ds_read_b64_tr_b16 v[170:171], v219 offset:58048
  v_mfma_f32_16x16x32_bf16 v[28:31], v[172:175], v[196:199], v[28:31]
  v_mfma_f32_16x16x32_bf16 v[64:67], v[172:175], v[200:203], v[64:67]
  v_mfma_f32_16x16x32_bf16 v[100:103], v[172:175], v[204:207], v[100:103]
  v_mfma_f32_16x16x32_bf16 v[136:139], v[172:175], v[208:211], v[136:139]
  ds_read_b64_tr_b16 v[172:173], v219 offset:53472
  ds_read_b64_tr_b16 v[174:175], v219 offset:58080
  v_mfma_f32_16x16x32_bf16 v[32:35], v[176:179], v[196:199], v[32:35]
  v_mfma_f32_16x16x32_bf16 v[68:71], v[176:179], v[200:203], v[68:71]
  v_mfma_f32_16x16x32_bf16 v[104:107], v[176:179], v[204:207], v[104:107]
  v_mfma_f32_16x16x32_bf16 v[140:143], v[176:179], v[208:211], v[140:143]
  ds_read_b64_tr_b16 v[176:177], v219 offset:53504
  ds_read_b64_tr_b16 v[178:179], v219 offset:58112
  s_waitcnt vmcnt(7)
  s_waitcnt lgkmcnt(0)
  s_barrier
  ds_read_b128 v[196:199], v220 offset:0
  ds_read_b128 v[200:203], v220 offset:1024
  ds_read_b128 v[204:207], v220 offset:2048
  ds_read_b128 v[208:211], v220 offset:3072
  v_mfma_f32_16x16x32_bf16 v[0:3], v[144:147], v[180:183], v[0:3]
  s_add_u32 m0, s52, 53248
  s_nop 0
  buffer_load_dwordx4 v212, s[32:35], s26 offen offset:0 lds
  v_mfma_f32_16x16x32_bf16 v[36:39], v[144:147], v[184:187], v[36:39]
  v_mfma_f32_16x16x32_bf16 v[72:75], v[144:147], v[188:191], v[72:75]
  v_mfma_f32_16x16x32_bf16 v[108:111], v[144:147], v[192:195], v[108:111]
  ds_read_b64_tr_b16 v[144:145], v219 offset:0
  ds_read_b64_tr_b16 v[146:147], v219 offset:4608
  v_mfma_f32_16x16x32_bf16 v[4:7], v[148:151], v[180:183], v[4:7]
  buffer_load_dwordx4 v213, s[32:35], s26 offen offset:1024 lds
  v_mfma_f32_16x16x32_bf16 v[40:43], v[148:151], v[184:187], v[40:43]
  v_mfma_f32_16x16x32_bf16 v[76:79], v[148:151], v[188:191], v[76:79]
  v_mfma_f32_16x16x32_bf16 v[112:115], v[148:151], v[192:195], v[112:115]
  ds_read_b64_tr_b16 v[148:149], v219 offset:32
  ds_read_b64_tr_b16 v[150:151], v219 offset:4640
  v_mfma_f32_16x16x32_bf16 v[8:11], v[152:155], v[180:183], v[8:11]
  buffer_load_dwordx4 v214, s[32:35], s26 offen offset:2048 lds
  v_mfma_f32_16x16x32_bf16 v[44:47], v[152:155], v[184:187], v[44:47]
  v_mfma_f32_16x16x32_bf16 v[80:83], v[152:155], v[188:191], v[80:83]
  v_mfma_f32_16x16x32_bf16 v[116:119], v[152:155], v[192:195], v[116:119]
  ds_read_b64_tr_b16 v[152:153], v219 offset:64
  ds_read_b64_tr_b16 v[154:155], v219 offset:4672
  v_mfma_f32_16x16x32_bf16 v[12:15], v[156:159], v[180:183], v[12:15]
  buffer_load_dwordx4 v215, s[32:35], s26 offen offset:3072 lds
  v_mfma_f32_16x16x32_bf16 v[48:51], v[156:159], v[184:187], v[48:51]
  v_mfma_f32_16x16x32_bf16 v[84:87], v[156:159], v[188:191], v[84:87]
  v_mfma_f32_16x16x32_bf16 v[120:123], v[156:159], v[192:195], v[120:123]
  ds_read_b64_tr_b16 v[156:157], v219 offset:96
  ds_read_b64_tr_b16 v[158:159], v219 offset:4704
  v_mfma_f32_16x16x32_bf16 v[16:19], v[160:163], v[180:183], v[16:19]
  s_add_u32 m0, s52, 57344
  s_nop 0
  s_mov_b32 exec_hi, 0
  buffer_load_dwordx4 v216, s[32:35], s26 offen offset:0 lds
  s_mov_b64 exec, -1
  s_add_u32 s26, s26, 294912
  v_mfma_f32_16x16x32_bf16 v[52:55], v[160:163], v[184:187], v[52:55]
  v_mfma_f32_16x16x32_bf16 v[88:91], v[160:163], v[188:191], v[88:91]
  v_mfma_f32_16x16x32_bf16 v[124:127], v[160:163], v[192:195], v[124:127]
  ds_read_b64_tr_b16 v[160:161], v219 offset:128
  ds_read_b64_tr_b16 v[162:163], v219 offset:4736
  v_mfma_f32_16x16x32_bf16 v[20:23], v[164:167], v[180:183], v[20:23]
  s_add_u32 m0, s53, 53248
  s_nop 0
  buffer_load_dwordx4 v217, s[28:31], s44 offen offset:0 lds
  v_mfma_f32_16x16x32_bf16 v[56:59], v[164:167], v[184:187], v[56:59]
  v_mfma_f32_16x16x32_bf16 v[92:95], v[164:167], v[188:191], v[92:95]
  v_mfma_f32_16x16x32_bf16 v[128:131], v[164:167], v[192:195], v[128:131]
  ds_read_b64_tr_b16 v[164:165], v219 offset:160
  ds_read_b64_tr_b16 v[166:167], v219 offset:4768
  v_mfma_f32_16x16x32_bf16 v[24:27], v[168:171], v[180:183], v[24:27]
  buffer_load_dwordx4 v218, s[28:31], s44 offen offset:1024 lds
  s_add_u32 s44, s44, 64
  v_mfma_f32_16x16x32_bf16 v[60:63], v[168:171], v[184:187], v[60:63]
  v_mfma_f32_16x16x32_bf16 v[96:99], v[168:171], v[188:191], v[96:99]
  v_mfma_f32_16x16x32_bf16 v[132:135], v[168:171], v[192:195], v[132:135]
  ds_read_b64_tr_b16 v[168:169], v219 offset:192
  ds_read_b64_tr_b16 v[170:171], v219 offset:4800
  v_mfma_f32_16x16x32_bf16 v[28:31], v[172:175], v[180:183], v[28:31]
  v_mfma_f32_16x16x32_bf16 v[64:67], v[172:175], v[184:187], v[64:67]
  v_mfma_f32_16x16x32_bf16 v[100:103], v[172:175], v[188:191], v[100:103]
  v_mfma_f32_16x16x32_bf16 v[136:139], v[172:175], v[192:195], v[136:139]
  ds_read_b64_tr_b16 v[172:173], v219 offset:224
  ds_read_b64_tr_b16 v[174:175], v219 offset:4832
  v_mfma_f32_16x16x32_bf16 v[32:35], v[176:179], v[180:183], v[32:35]
  v_mfma_f32_16x16x32_bf16 v[68:71], v[176:179], v[184:187], v[68:71]
  v_mfma_f32_16x16x32_bf16 v[104:107], v[176:179], v[188:191], v[104:107]
  v_mfma_f32_16x16x32_bf16 v[140:143], v[176:179], v[192:195], v[140:143]
  ds_read_b64_tr_b16 v[176:177], v219 offset:256
  ds_read_b64_tr_b16 v[178:179], v219 offset:4864
  s_waitcnt vmcnt(7)
  s_waitcnt lgkmcnt(0)
  s_barrier
  ds_read_b128 v[180:183], v220 offset:26624
  ds_read_b128 v[184:187], v220 offset:27648
  ds_read_b128 v[188:191], v220 offset:28672
  ds_read_b128 v[192:195], v220 offset:29696
  v_mfma_f32_16x16x32_bf16 v[0:3], v[144:147], v[196:199], v[0:3]
  v_mfma_f32_16x16x32_bf16 v[36:39], v[144:147], v[200:203], v[36:39]
  v_mfma_f32_16x16x32_bf16 v[72:75], v[144:147], v[204:207], v[72:75]
  v_mfma_f32_16x16x32_bf16 v[108:111], v[144:147], v[208:211], v[108:111]
  ds_read_b64_tr_b16 v[144:145], v219 offset:26624
  ds_read_b64_tr_b16 v[146:147], v219 offset:31232
  v_mfma_f32_16x16x32_bf16 v[4:7], v[148:151], v[196:199], v[4:7]
  v_mfma_f32_16x16x32_bf16 v[40:43], v[148:151], v[200:203], v[40:43]
  v_mfma_f32_16x16x32_bf16 v[76:79], v[148:151], v[204:207], v[76:79]
  v_mfma_f32_16x16x32_bf16 v[112:115], v[148:151], v[208:211], v[112:115]
  ds_read_b64_tr_b16 v[148:149], v219 offset:26656
  ds_read_b64_tr_b16 v[150:151], v219 offset:31264
  v_mfma_f32_16x16x32_bf16 v[8:11], v[152:155], v[196:199], v[8:11]
  v_mfma_f32_16x16x32_bf16 v[44:47], v[152:155], v[200:203], v[44:47]
  v_mfma_f32_16x16x32_bf16 v[80:83], v[152:155], v[204:207], v[80:83]
  v_mfma_f32_16x16x32_bf16 v[116:119], v[152:155], v[208:211], v[116:119]
  ds_read_b64_tr_b16 v[152:153], v219 offset:26688
  ds_read_b64_tr_b16 v[154:155], v219 offset:31296
  v_mfma_f32_16x16x32_bf16 v[12:15], v[156:159], v[196:199], v[12:15]
  v_mfma_f32_16x16x32_bf16 v[48:51], v[156:159], v[200:203], v[48:51]
  v_mfma_f32_16x16x32_bf16 v[84:87], v[156:159], v[204:207], v[84:87]
  v_mfma_f32_16x16x32_bf16 v[120:123], v[156:159], v[208:211], v[120:123]
  ds_read_b64_tr_b16 v[156:157], v219 offset:26720
  ds_read_b64_tr_b16 v[158:159], v219 offset:31328
  v_mfma_f32_16x16x32_bf16 v[16:19], v[160:163], v[196:199], v[16:19]
  v_mfma_f32_16x16x32_bf16 v[52:55], v[160:163], v[200:203], v[52:55]
  v_mfma_f32_16x16x32_bf16 v[88:91], v[160:163], v[204:207], v[88:91]
  v_mfma_f32_16x16x32_bf16 v[124:127], v[160:163], v[208:211], v[124:127]
  ds_read_b64_tr_b16 v[160:161], v219 offset:26752
  ds_read_b64_tr_b16 v[162:163], v219 offset:31360
  v_mfma_f32_16x16x32_bf16 v[20:23], v[164:167], v[196:199], v[20:23]
  v_mfma_f32_16x16x32_bf16 v[56:59], v[164:167], v[200:203], v[56:59]
  v_mfma_f32_16x16x32_bf16 v[92:95], v[164:167], v[204:207], v[92:95]
  v_mfma_f32_16x16x32_bf16 v[128:131], v[164:167], v[208:211], v[128:131]
  ds_read_b64_tr_b16 v[164:165], v219 offset:26784
  ds_read_b64_tr_b16 v[166:167], v219 offset:31392
  v_mfma_f32_16x16x32_bf16 v[24:27], v[168:171], v[196:199], v[24:27]
  v_mfma_f32_16x16x32_bf16 v[60:63], v[168:171], v[200:203], v[60:63]
  v_mfma_f32_16x16x32_bf16 v[96:99], v[168:171], v[204:207], v[96:99]
  v_mfma_f32_16x16x32_bf16 v[132:135], v[168:171], v[208:211], v[132:135]
  ds_read_b64_tr_b16 v[168:169], v219 offset:26816
  ds_read_b64_tr_b16 v[170:171], v219 offset:31424
  v_mfma_f32_16x16x32_bf16 v[28:31], v[172:175], v[196:199], v[28:31]
  v_mfma_f32_16x16x32_bf16 v[64:67], v[172:175], v[200:203], v[64:67]
  v_mfma_f32_16x16x32_bf16 v[100:103], v[172:175], v[204:207], v[100:103]
  v_mfma_f32_16x16x32_bf16 v[136:139], v[172:175], v[208:211], v[136:139]
  ds_read_b64_tr_b16 v[172:173], v219 offset:26848
  ds_read_b64_tr_b16 v[174:175], v219 offset:31456
  v_mfma_f32_16x16x32_bf16 v[32:35], v[176:179], v[196:199], v[32:35]
  v_mfma_f32_16x16x32_bf16 v[68:71], v[176:179], v[200:203], v[68:71]
  v_mfma_f32_16x16x32_bf16 v[104:107], v[176:179], v[204:207], v[104:107]
  v_mfma_f32_16x16x32_bf16 v[140:143], v[176:179], v[208:211], v[140:143]
  ds_read_b64_tr_b16 v[176:177], v219 offset:26880
  ds_read_b64_tr_b16 v[178:179], v219 offset:31488
  s_waitcnt vmcnt(0)
  s_waitcnt lgkmcnt(0)
  s_barrier
  ds_read_b128 v[196:199], v220 offset:53248
  ds_read_b128 v[200:203], v220 offset:54272
  ds_read_b128 v[204:207], v220 offset:55296
  ds_read_b128 v[208:211], v220 offset:56320
  v_mfma_f32_16x16x32_bf16 v[0:3], v[144:147], v[180:183], v[0:3]
  v_mfma_f32_16x16x32_bf16 v[36:39], v[144:147], v[184:187], v[36:39]
  v_mfma_f32_16x16x32_bf16 v[72:75], v[144:147], v[188:191], v[72:75]
  v_mfma_f32_16x16x32_bf16 v[108:111], v[144:147], v[192:195], v[108:111]
  ds_read_b64_tr_b16 v[144:145], v219 offset:53248
  ds_read_b64_tr_b16 v[146:147], v219 offset:57856
  v_mfma_f32_16x16x32_bf16 v[4:7], v[148:151], v[180:183], v[4:7]
  v_mfma_f32_16x16x32_bf16 v[40:43], v[148:151], v[184:187], v[40:43]
  v_mfma_f32_16x16x32_bf16 v[76:79], v[148:151], v[188:191], v[76:79]
  v_mfma_f32_16x16x32_bf16 v[112:115], v[148:151], v[192:195], v[112:115]
  ds_read_b64_tr_b16 v[148:149], v219 offset:53280
  ds_read_b64_tr_b16 v[150:151], v219 offset:57888
  v_mfma_f32_16x16x32_bf16 v[8:11], v[152:155], v[180:183], v[8:11]
  v_mfma_f32_16x16x32_bf16 v[44:47], v[152:155], v[184:187], v[44:47]
  v_mfma_f32_16x16x32_bf16 v[80:83], v[152:155], v[188:191], v[80:83]
  v_mfma_f32_16x16x32_bf16 v[116:119], v[152:155], v[192:195], v[116:119]
  ds_read_b64_tr_b16 v[152:153], v219 offset:53312
  ds_read_b64_tr_b16 v[154:155], v219 offset:57920
  v_mfma_f32_16x16x32_bf16 v[12:15], v[156:159], v[180:183], v[12:15]
  v_mfma_f32_16x16x32_bf16 v[48:51], v[156:159], v[184:187], v[48:51]
  v_mfma_f32_16x16x32_bf16 v[84:87], v[156:159], v[188:191], v[84:87]
  v_mfma_f32_16x16x32_bf16 v[120:123], v[156:159], v[192:195], v[120:123]
  ds_read_b64_tr_b16 v[156:157], v219 offset:53344
  ds_read_b64_tr_b16 v[158:159], v219 offset:57952
  v_mfma_f32_16x16x32_bf16 v[16:19], v[160:163], v[180:183], v[16:19]
  v_mfma_f32_16x16x32_bf16 v[52:55], v[160:163], v[184:187], v[52:55]
  v_mfma_f32_16x16x32_bf16 v[88:91], v[160:163], v[188:191], v[88:91]
  v_mfma_f32_16x16x32_bf16 v[124:127], v[160:163], v[192:195], v[124:127]
  ds_read_b64_tr_b16 v[160:161], v219 offset:53376
  ds_read_b64_tr_b16 v[162:163], v219 offset:57984
  v_mfma_f32_16x16x32_bf16 v[20:23], v[164:167], v[180:183], v[20:23]
  v_mfma_f32_16x16x32_bf16 v[56:59], v[164:167], v[184:187], v[56:59]
  v_mfma_f32_16x16x32_bf16 v[92:95], v[164:167], v[188:191], v[92:95]
  v_mfma_f32_16x16x32_bf16 v[128:131], v[164:167], v[192:195], v[128:131]
  ds_read_b64_tr_b16 v[164:165], v219 offset:53408
  ds_read_b64_tr_b16 v[166:167], v219 offset:58016
  v_mfma_f32_16x16x32_bf16 v[24:27], v[168:171], v[180:183], v[24:27]
  v_mfma_f32_16x16x32_bf16 v[60:63], v[168:171], v[184:187], v[60:63]
  v_mfma_f32_16x16x32_bf16 v[96:99], v[168:171], v[188:191], v[96:99]
  v_mfma_f32_16x16x32_bf16 v[132:135], v[168:171], v[192:195], v[132:135]
  ds_read_b64_tr_b16 v[168:169], v219 offset:53440
  ds_read_b64_tr_b16 v[170:171], v219 offset:58048
  v_mfma_f32_16x16x32_bf16 v[28:31], v[172:175], v[180:183], v[28:31]
  v_mfma_f32_16x16x32_bf16 v[64:67], v[172:175], v[184:187], v[64:67]
  v_mfma_f32_16x16x32_bf16 v[100:103], v[172:175], v[188:191], v[100:103]
  v_mfma_f32_16x16x32_bf16 v[136:139], v[172:175], v[192:195], v[136:139]
  ds_read_b64_tr_b16 v[172:173], v219 offset:53472
  ds_read_b64_tr_b16 v[174:175], v219 offset:58080
  v_mfma_f32_16x16x32_bf16 v[32:35], v[176:179], v[180:183], v[32:35]
  v_mfma_f32_16x16x32_bf16 v[68:71], v[176:179], v[184:187], v[68:71]
  v_mfma_f32_16x16x32_bf16 v[104:107], v[176:179], v[188:191], v[104:107]
  v_mfma_f32_16x16x32_bf16 v[140:143], v[176:179], v[192:195], v[140:143]
  ds_read_b64_tr_b16 v[176:177], v219 offset:53504
  ds_read_b64_tr_b16 v[178:179], v219 offset:58112
  s_waitcnt lgkmcnt(0)
  s_barrier
  v_mfma_f32_16x16x32_bf16 v[0:3], v[144:147], v[196:199], v[0:3]
  v_mfma_f32_16x16x32_bf16 v[36:39], v[144:147], v[200:203], v[36:39]
  v_mfma_f32_16x16x32_bf16 v[72:75], v[144:147], v[204:207], v[72:75]
  v_mfma_f32_16x16x32_bf16 v[108:111], v[144:147], v[208:211], v[108:111]
  v_mfma_f32_16x16x32_bf16 v[4:7], v[148:151], v[196:199], v[4:7]
  v_mfma_f32_16x16x32_bf16 v[40:43], v[148:151], v[200:203], v[40:43]
  v_mfma_f32_16x16x32_bf16 v[76:79], v[148:151], v[204:207], v[76:79]
  v_mfma_f32_16x16x32_bf16 v[112:115], v[148:151], v[208:211], v[112:115]
  v_mfma_f32_16x16x32_bf16 v[8:11], v[152:155], v[196:199], v[8:11]
  v_mfma_f32_16x16x32_bf16 v[44:47], v[152:155], v[200:203], v[44:47]
  v_mfma_f32_16x16x32_bf16 v[80:83], v[152:155], v[204:207], v[80:83]
  v_mfma_f32_16x16x32_bf16 v[116:119], v[152:155], v[208:211], v[116:119]
  v_mfma_f32_16x16x32_bf16 v[12:15], v[156:159], v[196:199], v[12:15]
  v_mfma_f32_16x16x32_bf16 v[48:51], v[156:159], v[200:203], v[48:51]
  v_mfma_f32_16x16x32_bf16 v[84:87], v[156:159], v[204:207], v[84:87]
  v_mfma_f32_16x16x32_bf16 v[120:123], v[156:159], v[208:211], v[120:123]
  v_mfma_f32_16x16x32_bf16 v[16:19], v[160:163], v[196:199], v[16:19]
  v_mfma_f32_16x16x32_bf16 v[52:55], v[160:163], v[200:203], v[52:55]
  v_mfma_f32_16x16x32_bf16 v[88:91], v[160:163], v[204:207], v[88:91]
  v_mfma_f32_16x16x32_bf16 v[124:127], v[160:163], v[208:211], v[124:127]
  v_mfma_f32_16x16x32_bf16 v[20:23], v[164:167], v[196:199], v[20:23]
  v_mfma_f32_16x16x32_bf16 v[56:59], v[164:167], v[200:203], v[56:59]
  v_mfma_f32_16x16x32_bf16 v[92:95], v[164:167], v[204:207], v[92:95]
  v_mfma_f32_16x16x32_bf16 v[128:131], v[164:167], v[208:211], v[128:131]
  v_mfma_f32_16x16x32_bf16 v[24:27], v[168:171], v[196:199], v[24:27]
  v_mfma_f32_16x16x32_bf16 v[60:63], v[168:171], v[200:203], v[60:63]
  v_mfma_f32_16x16x32_bf16 v[96:99], v[168:171], v[204:207], v[96:99]
  v_mfma_f32_16x16x32_bf16 v[132:135], v[168:171], v[208:211], v[132:135]
  v_mfma_f32_16x16x32_bf16 v[28:31], v[172:175], v[196:199], v[28:31]
  v_mfma_f32_16x16x32_bf16 v[64:67], v[172:175], v[200:203], v[64:67]
  v_mfma_f32_16x16x32_bf16 v[100:103], v[172:175], v[204:207], v[100:103]
  v_mfma_f32_16x16x32_bf16 v[136:139], v[172:175], v[208:211], v[136:139]
  v_mfma_f32_16x16x32_bf16 v[32:35], v[176:179], v[196:199], v[32:35]
  v_mfma_f32_16x16x32_bf16 v[68:71], v[176:179], v[200:203], v[68:71]
  v_mfma_f32_16x16x32_bf16 v[104:107], v[176:179], v[204:207], v[104:107]
  v_mfma_f32_16x16x32_bf16 v[140:143], v[176:179], v[208:211], v[140:143]
  s_nop 7
  s_nop 1
  v_max_f32 v0, 0, v0
  v_max_f32 v1, 0, v1
  v_max_f32 v2, 0, v2
  v_max_f32 v3, 0, v3
  v_max_f32 v4, 0, v4
  v_max_f32 v5, 0, v5
  v_max_f32 v6, 0, v6
  v_max_f32 v7, 0, v7
  v_max_f32 v8, 0, v8
  v_max_f32 v9, 0, v9
  v_max_f32 v10, 0, v10
  v_max_f32 v11, 0, v11
  v_max_f32 v12, 0, v12
  v_max_f32 v13, 0, v13
  v_max_f32 v14, 0, v14
  v_max_f32 v15, 0, v15
  v_max_f32 v16, 0, v16
  v_max_f32 v17, 0, v17
  v_max_f32 v18, 0, v18
  v_max_f32 v19, 0, v19
  v_max_f32 v20, 0, v20
  v_max_f32 v21, 0, v21
  v_max_f32 v22, 0, v22
  v_max_f32 v23, 0, v23
  v_max_f32 v24, 0, v24
  v_max_f32 v25, 0, v25
  v_max_f32 v26, 0, v26
  v_max_f32 v27, 0, v27
  v_max_f32 v28, 0, v28
  v_max_f32 v29, 0, v29
  v_max_f32 v30, 0, v30
  v_max_f32 v31, 0, v31
  v_max_f32 v32, 0, v32
  v_max_f32 v33, 0, v33
  v_max_f32 v34, 0, v34
  v_max_f32 v35, 0, v35
  v_max_f32 v36, 0, v36
  v_max_f32 v37, 0, v37
  v_max_f32 v38, 0, v38
  v_max_f32 v39, 0, v39
  v_max_f32 v40, 0, v40
  v_max_f32 v41, 0, v41
  v_max_f32 v42, 0, v42
  v_max_f32 v43, 0, v43
  v_max_f32 v44, 0, v44
  v_max_f32 v45, 0, v45
  v_max_f32 v46, 0, v46
  v_max_f32 v47, 0, v47
  v_max_f32 v48, 0, v48
  v_max_f32 v49, 0, v49
  v_max_f32 v50, 0, v50
  v_max_f32 v51, 0, v51
  v_max_f32 v52, 0, v52
  v_max_f32 v53, 0, v53
  v_max_f32 v54, 0, v54
  v_max_f32 v55, 0, v55
  v_max_f32 v56, 0, v56
  v_max_f32 v57, 0, v57
  v_max_f32 v58, 0, v58
  v_max_f32 v59, 0, v59
  v_max_f32 v60, 0, v60
  v_max_f32 v61, 0, v61
  v_max_f32 v62, 0, v62
  v_max_f32 v63, 0, v63
  v_max_f32 v64, 0, v64
  v_max_f32 v65, 0, v65
  v_max_f32 v66, 0, v66
  v_max_f32 v67, 0, v67
  v_max_f32 v68, 0, v68
  v_max_f32 v69, 0, v69
  v_max_f32 v70, 0, v70
  v_max_f32 v71, 0, v71
  v_max_f32 v72, 0, v72
  v_max_f32 v73, 0, v73
  v_max_f32 v74, 0, v74
  v_max_f32 v75, 0, v75
  v_max_f32 v76, 0, v76
  v_max_f32 v77, 0, v77
  v_max_f32 v78, 0, v78
  v_max_f32 v79, 0, v79
  v_max_f32 v80, 0, v80
  v_max_f32 v81, 0, v81
  v_max_f32 v82, 0, v82
  v_max_f32 v83, 0, v83
  v_max_f32 v84, 0, v84
  v_max_f32 v85, 0, v85
  v_max_f32 v86, 0, v86
  v_max_f32 v87, 0, v87
  v_max_f32 v88, 0, v88
  v_max_f32 v89, 0, v89
  v_max_f32 v90, 0, v90
  v_max_f32 v91, 0, v91
  v_max_f32 v92, 0, v92
  v_max_f32 v93, 0, v93
  v_max_f32 v94, 0, v94
  v_max_f32 v95, 0, v95
  v_max_f32 v96, 0, v96
  v_max_f32 v97, 0, v97
  v_max_f32 v98, 0, v98
  v_max_f32 v99, 0, v99
  v_max_f32 v100, 0, v100
  v_max_f32 v101, 0, v101
  v_max_f32 v102, 0, v102
  v_max_f32 v103, 0, v103
  v_max_f32 v104, 0, v104
  v_max_f32 v105, 0, v105
  v_max_f32 v106, 0, v106
  v_max_f32 v107, 0, v107
  v_max_f32 v108, 0, v108
  v_max_f32 v109, 0, v109
  v_max_f32 v110, 0, v110
  v_max_f32 v111, 0, v111
  v_max_f32 v112, 0, v112
  v_max_f32 v113, 0, v113
  v_max_f32 v114, 0, v114
  v_max_f32 v115, 0, v115
  v_max_f32 v116, 0, v116
  v_max_f32 v117, 0, v117
  v_max_f32 v118, 0, v118
  v_max_f32 v119, 0, v119
  v_max_f32 v120, 0, v120
  v_max_f32 v121, 0, v121
  v_max_f32 v122, 0, v122
  v_max_f32 v123, 0, v123
  v_max_f32 v124, 0, v124
  v_max_f32 v125, 0, v125
  v_max_f32 v126, 0, v126
  v_max_f32 v127, 0, v127
  v_max_f32 v128, 0, v128
  v_max_f32 v129, 0, v129
  v_max_f32 v130, 0, v130
  v_max_f32 v131, 0, v131
  v_max_f32 v132, 0, v132
  v_max_f32 v133, 0, v133
  v_max_f32 v134, 0, v134
  v_max_f32 v135, 0, v135
  v_max_f32 v136, 0, v136
  v_max_f32 v137, 0, v137
  v_max_f32 v138, 0, v138
  v_max_f32 v139, 0, v139
  v_max_f32 v140, 0, v140
  v_max_f32 v141, 0, v141
  v_max_f32 v142, 0, v142
  v_max_f32 v143, 0, v143
  v_pk_mul_f32 v[0:1], v[0:1], v[0:1]
  v_pk_mul_f32 v[2:3], v[2:3], v[2:3]
  v_pk_mul_f32 v[4:5], v[4:5], v[4:5]
  v_pk_mul_f32 v[6:7], v[6:7], v[6:7]
  v_pk_mul_f32 v[8:9], v[8:9], v[8:9]
  v_pk_mul_f32 v[10:11], v[10:11], v[10:11]
  v_pk_mul_f32 v[12:13], v[12:13], v[12:13]
  v_pk_mul_f32 v[14:15], v[14:15], v[14:15]
  v_pk_mul_f32 v[16:17], v[16:17], v[16:17]
  v_pk_mul_f32 v[18:19], v[18:19], v[18:19]
  v_pk_mul_f32 v[20:21], v[20:21], v[20:21]
  v_pk_mul_f32 v[22:23], v[22:23], v[22:23]
  v_pk_mul_f32 v[24:25], v[24:25], v[24:25]
  v_pk_mul_f32 v[26:27], v[26:27], v[26:27]
  v_pk_mul_f32 v[28:29], v[28:29], v[28:29]
  v_pk_mul_f32 v[30:31], v[30:31], v[30:31]
  v_pk_mul_f32 v[32:33], v[32:33], v[32:33]
  v_pk_mul_f32 v[34:35], v[34:35], v[34:35]
  v_pk_mul_f32 v[36:37], v[36:37], v[36:37]
  v_pk_mul_f32 v[38:39], v[38:39], v[38:39]
  v_pk_mul_f32 v[40:41], v[40:41], v[40:41]
  v_pk_mul_f32 v[42:43], v[42:43], v[42:43]
  v_pk_mul_f32 v[44:45], v[44:45], v[44:45]
  v_pk_mul_f32 v[46:47], v[46:47], v[46:47]
  v_pk_mul_f32 v[48:49], v[48:49], v[48:49]
  v_pk_mul_f32 v[50:51], v[50:51], v[50:51]
  v_pk_mul_f32 v[52:53], v[52:53], v[52:53]
  v_pk_mul_f32 v[54:55], v[54:55], v[54:55]
  v_pk_mul_f32 v[56:57], v[56:57], v[56:57]
  v_pk_mul_f32 v[58:59], v[58:59], v[58:59]
  v_pk_mul_f32 v[60:61], v[60:61], v[60:61]
  v_pk_mul_f32 v[62:63], v[62:63], v[62:63]
  v_pk_mul_f32 v[64:65], v[64:65], v[64:65]
  v_pk_mul_f32 v[66:67], v[66:67], v[66:67]
  v_pk_mul_f32 v[68:69], v[68:69], v[68:69]
  v_pk_mul_f32 v[70:71], v[70:71], v[70:71]
  v_pk_mul_f32 v[72:73], v[72:73], v[72:73]
  v_pk_mul_f32 v[74:75], v[74:75], v[74:75]
  v_pk_mul_f32 v[76:77], v[76:77], v[76:77]
  v_pk_mul_f32 v[78:79], v[78:79], v[78:79]
  v_pk_mul_f32 v[80:81], v[80:81], v[80:81]
  v_pk_mul_f32 v[82:83], v[82:83], v[82:83]
  v_pk_mul_f32 v[84:85], v[84:85], v[84:85]
  v_pk_mul_f32 v[86:87], v[86:87], v[86:87]
  v_pk_mul_f32 v[88:89], v[88:89], v[88:89]
  v_pk_mul_f32 v[90:91], v[90:91], v[90:91]
  v_pk_mul_f32 v[92:93], v[92:93], v[92:93]
  v_pk_mul_f32 v[94:95], v[94:95], v[94:95]
  v_pk_mul_f32 v[96:97], v[96:97], v[96:97]
  v_pk_mul_f32 v[98:99], v[98:99], v[98:99]
  v_pk_mul_f32 v[100:101], v[100:101], v[100:101]
  v_pk_mul_f32 v[102:103], v[102:103], v[102:103]
  v_pk_mul_f32 v[104:105], v[104:105], v[104:105]
  v_pk_mul_f32 v[106:107], v[106:107], v[106:107]
  v_pk_mul_f32 v[108:109], v[108:109], v[108:109]
  v_pk_mul_f32 v[110:111], v[110:111], v[110:111]
  v_pk_mul_f32 v[112:113], v[112:113], v[112:113]
  v_pk_mul_f32 v[114:115], v[114:115], v[114:115]
  v_pk_mul_f32 v[116:117], v[116:117], v[116:117]
  v_pk_mul_f32 v[118:119], v[118:119], v[118:119]
  v_pk_mul_f32 v[120:121], v[120:121], v[120:121]
  v_pk_mul_f32 v[122:123], v[122:123], v[122:123]
  v_pk_mul_f32 v[124:125], v[124:125], v[124:125]
  v_pk_mul_f32 v[126:127], v[126:127], v[126:127]
  v_pk_mul_f32 v[128:129], v[128:129], v[128:129]
  v_pk_mul_f32 v[130:131], v[130:131], v[130:131]
  v_pk_mul_f32 v[132:133], v[132:133], v[132:133]
  v_pk_mul_f32 v[134:135], v[134:135], v[134:135]
  v_pk_mul_f32 v[136:137], v[136:137], v[136:137]
  v_pk_mul_f32 v[138:139], v[138:139], v[138:139]
  v_pk_mul_f32 v[140:141], v[140:141], v[140:141]
  v_pk_mul_f32 v[142:143], v[142:143], v[142:143]
  v_and_b32 v221, 15, v230
  v_bfe_u32 v222, v230, 3, 1
  v_mul_u32_u24 v222, 3, v222
  v_bfe_u32 v223, v230, 4, 1
  v_bfe_u32 v224, v230, 5, 1
  s_lshr_b32 s45, s21, 1
  s_lshl_b32 s45, s45, 12
  v_lshlrev_b32 v221, 6, v221
  v_add_u32 v221, s45, v221
  v_lshl_add_u32 v225, v223, 1, v224
  v_xor_b32 v225, v225, v222
  v_lshl_add_u32 v225, v225, 4, v221
  s_and_b32 s46, s21, 1
  s_lshl_b32 s47, s46, 1
  v_add_u32 v226, s47, v224
  v_xor_b32 v226, v226, v222
  v_lshl_add_u32 v226, v226, 4, v221
  v_lshl_add_u32 v226, v223, 3, v226
  s_mul_i32 s45, s24, 144
  s_mul_i32 s47, s23, 9
  s_add_u32 s45, s45, s47
  s_lshl_b32 s45, s45, 13
  s_cmp_eq_u32 s46, 1
  s_cbranch_scc1 k1_kernel_HE1
  s_add_u32 s47, s45, 0
  v_cvt_pk_bf16_f32 v144, v0, v1
  v_cvt_pk_bf16_f32 v145, v2, v3
  v_cvt_pk_bf16_f32 v146, v4, v5
  v_cvt_pk_bf16_f32 v147, v6, v7
  s_nop 1
  v_permlane16_swap_b32 v144, v146
  v_permlane16_swap_b32 v145, v147
  buffer_store_dwordx4 v[144:147], v225, s[40:43], s47 offen offset:0 sc1
  v_cvt_pk_bf16_f32 v148, v36, v37
  v_cvt_pk_bf16_f32 v149, v38, v39
  v_cvt_pk_bf16_f32 v150, v40, v41
  v_cvt_pk_bf16_f32 v151, v42, v43
  s_nop 1
  v_permlane16_swap_b32 v148, v150
  v_permlane16_swap_b32 v149, v151
  buffer_store_dwordx4 v[148:151], v225, s[40:43], s47 offen offset:1024 sc1
  v_cvt_pk_bf16_f32 v152, v72, v73
  v_cvt_pk_bf16_f32 v153, v74, v75
  v_cvt_pk_bf16_f32 v154, v76, v77
  v_cvt_pk_bf16_f32 v155, v78, v79
  s_nop 1
  v_permlane16_swap_b32 v152, v154
  v_permlane16_swap_b32 v153, v155
  buffer_store_dwordx4 v[152:155], v225, s[40:43], s47 offen offset:2048 sc1
  v_cvt_pk_bf16_f32 v156, v108, v109
  v_cvt_pk_bf16_f32 v157, v110, v111
  v_cvt_pk_bf16_f32 v158, v112, v113
  v_cvt_pk_bf16_f32 v159, v114, v115
  s_nop 1
  v_permlane16_swap_b32 v156, v158
  v_permlane16_swap_b32 v157, v159
  buffer_store_dwordx4 v[156:159], v225, s[40:43], s47 offen offset:3072 sc1
  s_add_u32 s47, s45, 8192
  v_cvt_pk_bf16_f32 v160, v8, v9
  v_cvt_pk_bf16_f32 v161, v10, v11
  v_cvt_pk_bf16_f32 v162, v12, v13
  v_cvt_pk_bf16_f32 v163, v14, v15
  s_nop 1
  v_permlane16_swap_b32 v160, v162
  v_permlane16_swap_b32 v161, v163
  buffer_store_dwordx4 v[160:163], v225, s[40:43], s47 offen offset:0 sc1
  v_cvt_pk_bf16_f32 v164, v44, v45
  v_cvt_pk_bf16_f32 v165, v46, v47
  v_cvt_pk_bf16_f32 v166, v48, v49
  v_cvt_pk_bf16_f32 v167, v50, v51
  s_nop 1
  v_permlane16_swap_b32 v164, v166
  v_permlane16_swap_b32 v165, v167
  buffer_store_dwordx4 v[164:167], v225, s[40:43], s47 offen offset:1024 sc1
  v_cvt_pk_bf16_f32 v168, v80, v81
  v_cvt_pk_bf16_f32 v169, v82, v83
  v_cvt_pk_bf16_f32 v170, v84, v85
  v_cvt_pk_bf16_f32 v171, v86, v87
  s_nop 1
  v_permlane16_swap_b32 v168, v170
  v_permlane16_swap_b32 v169, v171
  buffer_store_dwordx4 v[168:171], v225, s[40:43], s47 offen offset:2048 sc1
  v_cvt_pk_bf16_f32 v172, v116, v117
  v_cvt_pk_bf16_f32 v173, v118, v119
  v_cvt_pk_bf16_f32 v174, v120, v121
  v_cvt_pk_bf16_f32 v175, v122, v123
  s_nop 1
  v_permlane16_swap_b32 v172, v174
  v_permlane16_swap_b32 v173, v175
  buffer_store_dwordx4 v[172:175], v225, s[40:43], s47 offen offset:3072 sc1
  s_add_u32 s47, s45, 16384
  v_cvt_pk_bf16_f32 v176, v16, v17
  v_cvt_pk_bf16_f32 v177, v18, v19
  v_cvt_pk_bf16_f32 v178, v20, v21
  v_cvt_pk_bf16_f32 v179, v22, v23
  s_nop 1
  v_permlane16_swap_b32 v176, v178
  v_permlane16_swap_b32 v177, v179
  buffer_store_dwordx4 v[176:179], v225, s[40:43], s47 offen offset:0 sc1
  v_cvt_pk_bf16_f32 v180, v52, v53
  v_cvt_pk_bf16_f32 v181, v54, v55
  v_cvt_pk_bf16_f32 v182, v56, v57
  v_cvt_pk_bf16_f32 v183, v58, v59
  s_nop 1
  v_permlane16_swap_b32 v180, v182
  v_permlane16_swap_b32 v181, v183
  buffer_store_dwordx4 v[180:183], v225, s[40:43], s47 offen offset:1024 sc1
  v_cvt_pk_bf16_f32 v184, v88, v89
  v_cvt_pk_bf16_f32 v185, v90, v91
  v_cvt_pk_bf16_f32 v186, v92, v93
  v_cvt_pk_bf16_f32 v187, v94, v95
  s_nop 1
  v_permlane16_swap_b32 v184, v186
  v_permlane16_swap_b32 v185, v187
  buffer_store_dwordx4 v[184:187], v225, s[40:43], s47 offen offset:2048 sc1
  v_cvt_pk_bf16_f32 v188, v124, v125
  v_cvt_pk_bf16_f32 v189, v126, v127
  v_cvt_pk_bf16_f32 v190, v128, v129
  v_cvt_pk_bf16_f32 v191, v130, v131
  s_nop 1
  v_permlane16_swap_b32 v188, v190
  v_permlane16_swap_b32 v189, v191
  buffer_store_dwordx4 v[188:191], v225, s[40:43], s47 offen offset:3072 sc1
  s_add_u32 s47, s45, 24576
  v_cvt_pk_bf16_f32 v192, v24, v25
  v_cvt_pk_bf16_f32 v193, v26, v27
  v_cvt_pk_bf16_f32 v194, v28, v29
  v_cvt_pk_bf16_f32 v195, v30, v31
  s_nop 1
  v_permlane16_swap_b32 v192, v194
  v_permlane16_swap_b32 v193, v195
  buffer_store_dwordx4 v[192:195], v225, s[40:43], s47 offen offset:0 sc1
  v_cvt_pk_bf16_f32 v196, v60, v61
  v_cvt_pk_bf16_f32 v197, v62, v63
  v_cvt_pk_bf16_f32 v198, v64, v65
  v_cvt_pk_bf16_f32 v199, v66, v67
  s_nop 1
  v_permlane16_swap_b32 v196, v198
  v_permlane16_swap_b32 v197, v199
  buffer_store_dwordx4 v[196:199], v225, s[40:43], s47 offen offset:1024 sc1
  v_cvt_pk_bf16_f32 v200, v96, v97
  v_cvt_pk_bf16_f32 v201, v98, v99
  v_cvt_pk_bf16_f32 v202, v100, v101
  v_cvt_pk_bf16_f32 v203, v102, v103
  s_nop 1
  v_permlane16_swap_b32 v200, v202
  v_permlane16_swap_b32 v201, v203
  buffer_store_dwordx4 v[200:203], v225, s[40:43], s47 offen offset:2048 sc1
  v_cvt_pk_bf16_f32 v204, v132, v133
  v_cvt_pk_bf16_f32 v205, v134, v135
  v_cvt_pk_bf16_f32 v206, v136, v137
  v_cvt_pk_bf16_f32 v207, v138, v139
  s_nop 1
  v_permlane16_swap_b32 v204, v206
  v_permlane16_swap_b32 v205, v207
  buffer_store_dwordx4 v[204:207], v225, s[40:43], s47 offen offset:3072 sc1
  s_add_u32 s47, s45, 32768
  v_cvt_pk_bf16_f32 v144, v32, v33
  v_cvt_pk_bf16_f32 v145, v34, v35
  buffer_store_dwordx2 v[144:145], v226, s[40:43], s47 offen offset:0 sc1
  v_cvt_pk_bf16_f32 v148, v68, v69
  v_cvt_pk_bf16_f32 v149, v70, v71
  buffer_store_dwordx2 v[148:149], v226, s[40:43], s47 offen offset:1024 sc1
  v_cvt_pk_bf16_f32 v152, v104, v105
  v_cvt_pk_bf16_f32 v153, v106, v107
  buffer_store_dwordx2 v[152:153], v226, s[40:43], s47 offen offset:2048 sc1
  v_cvt_pk_bf16_f32 v156, v140, v141
  v_cvt_pk_bf16_f32 v157, v142, v143
  buffer_store_dwordx2 v[156:157], v226, s[40:43], s47 offen offset:3072 sc1
  s_endpgm
k1_kernel_HE1:
  s_add_u32 s47, s45, 40960
  v_cvt_pk_bf16_f32 v144, v4, v5
  v_cvt_pk_bf16_f32 v145, v6, v7
  v_cvt_pk_bf16_f32 v146, v8, v9
  v_cvt_pk_bf16_f32 v147, v10, v11
  s_nop 1
  v_permlane16_swap_b32 v144, v146
  v_permlane16_swap_b32 v145, v147
  buffer_store_dwordx4 v[144:147], v225, s[40:43], s47 offen offset:0 sc1
  v_cvt_pk_bf16_f32 v148, v40, v41
  v_cvt_pk_bf16_f32 v149, v42, v43
  v_cvt_pk_bf16_f32 v150, v44, v45
  v_cvt_pk_bf16_f32 v151, v46, v47
  s_nop 1
  v_permlane16_swap_b32 v148, v150
  v_permlane16_swap_b32 v149, v151
  buffer_store_dwordx4 v[148:151], v225, s[40:43], s47 offen offset:1024 sc1
  v_cvt_pk_bf16_f32 v152, v76, v77
  v_cvt_pk_bf16_f32 v153, v78, v79
  v_cvt_pk_bf16_f32 v154, v80, v81
  v_cvt_pk_bf16_f32 v155, v82, v83
  s_nop 1
  v_permlane16_swap_b32 v152, v154
  v_permlane16_swap_b32 v153, v155
  buffer_store_dwordx4 v[152:155], v225, s[40:43], s47 offen offset:2048 sc1
  v_cvt_pk_bf16_f32 v156, v112, v113
  v_cvt_pk_bf16_f32 v157, v114, v115
  v_cvt_pk_bf16_f32 v158, v116, v117
  v_cvt_pk_bf16_f32 v159, v118, v119
  s_nop 1
  v_permlane16_swap_b32 v156, v158
  v_permlane16_swap_b32 v157, v159
  buffer_store_dwordx4 v[156:159], v225, s[40:43], s47 offen offset:3072 sc1
  s_add_u32 s47, s45, 49152
  v_cvt_pk_bf16_f32 v160, v12, v13
  v_cvt_pk_bf16_f32 v161, v14, v15
  v_cvt_pk_bf16_f32 v162, v16, v17
  v_cvt_pk_bf16_f32 v163, v18, v19
  s_nop 1
  v_permlane16_swap_b32 v160, v162
  v_permlane16_swap_b32 v161, v163
  buffer_store_dwordx4 v[160:163], v225, s[40:43], s47 offen offset:0 sc1
  v_cvt_pk_bf16_f32 v164, v48, v49
  v_cvt_pk_bf16_f32 v165, v50, v51
  v_cvt_pk_bf16_f32 v166, v52, v53
  v_cvt_pk_bf16_f32 v167, v54, v55
  s_nop 1
  v_permlane16_swap_b32 v164, v166
  v_permlane16_swap_b32 v165, v167
  buffer_store_dwordx4 v[164:167], v225, s[40:43], s47 offen offset:1024 sc1
  v_cvt_pk_bf16_f32 v168, v84, v85
  v_cvt_pk_bf16_f32 v169, v86, v87
  v_cvt_pk_bf16_f32 v170, v88, v89
  v_cvt_pk_bf16_f32 v171, v90, v91
  s_nop 1
  v_permlane16_swap_b32 v168, v170
  v_permlane16_swap_b32 v169, v171
  buffer_store_dwordx4 v[168:171], v225, s[40:43], s47 offen offset:2048 sc1
  v_cvt_pk_bf16_f32 v172, v120, v121
  v_cvt_pk_bf16_f32 v173, v122, v123
  v_cvt_pk_bf16_f32 v174, v124, v125
  v_cvt_pk_bf16_f32 v175, v126, v127
  s_nop 1
  v_permlane16_swap_b32 v172, v174
  v_permlane16_swap_b32 v173, v175
  buffer_store_dwordx4 v[172:175], v225, s[40:43], s47 offen offset:3072 sc1
  s_add_u32 s47, s45, 57344
  v_cvt_pk_bf16_f32 v176, v20, v21
  v_cvt_pk_bf16_f32 v177, v22, v23
  v_cvt_pk_bf16_f32 v178, v24, v25
  v_cvt_pk_bf16_f32 v179, v26, v27
  s_nop 1
  v_permlane16_swap_b32 v176, v178
  v_permlane16_swap_b32 v177, v179
  buffer_store_dwordx4 v[176:179], v225, s[40:43], s47 offen offset:0 sc1
  v_cvt_pk_bf16_f32 v180, v56, v57
  v_cvt_pk_bf16_f32 v181, v58, v59
  v_cvt_pk_bf16_f32 v182, v60, v61
  v_cvt_pk_bf16_f32 v183, v62, v63
  s_nop 1
  v_permlane16_swap_b32 v180, v182
  v_permlane16_swap_b32 v181, v183
  buffer_store_dwordx4 v[180:183], v225, s[40:43], s47 offen offset:1024 sc1
  v_cvt_pk_bf16_f32 v184, v92, v93
  v_cvt_pk_bf16_f32 v185, v94, v95
  v_cvt_pk_bf16_f32 v186, v96, v97
  v_cvt_pk_bf16_f32 v187, v98, v99
  s_nop 1
  v_permlane16_swap_b32 v184, v186
  v_permlane16_swap_b32 v185, v187
  buffer_store_dwordx4 v[184:187], v225, s[40:43], s47 offen offset:2048 sc1
  v_cvt_pk_bf16_f32 v188, v128, v129
  v_cvt_pk_bf16_f32 v189, v130, v131
  v_cvt_pk_bf16_f32 v190, v132, v133
  v_cvt_pk_bf16_f32 v191, v134, v135
  s_nop 1
  v_permlane16_swap_b32 v188, v190
  v_permlane16_swap_b32 v189, v191
  buffer_store_dwordx4 v[188:191], v225, s[40:43], s47 offen offset:3072 sc1
  s_add_u32 s47, s45, 65536
  v_cvt_pk_bf16_f32 v192, v28, v29
  v_cvt_pk_bf16_f32 v193, v30, v31
  v_cvt_pk_bf16_f32 v194, v32, v33
  v_cvt_pk_bf16_f32 v195, v34, v35
  s_nop 1
  v_permlane16_swap_b32 v192, v194
  v_permlane16_swap_b32 v193, v195
  buffer_store_dwordx4 v[192:195], v225, s[40:43], s47 offen offset:0 sc1
  v_cvt_pk_bf16_f32 v196, v64, v65
  v_cvt_pk_bf16_f32 v197, v66, v67
  v_cvt_pk_bf16_f32 v198, v68, v69
  v_cvt_pk_bf16_f32 v199, v70, v71
  s_nop 1
  v_permlane16_swap_b32 v196, v198
  v_permlane16_swap_b32 v197, v199
  buffer_store_dwordx4 v[196:199], v225, s[40:43], s47 offen offset:1024 sc1
  v_cvt_pk_bf16_f32 v200, v100, v101
  v_cvt_pk_bf16_f32 v201, v102, v103
  v_cvt_pk_bf16_f32 v202, v104, v105
  v_cvt_pk_bf16_f32 v203, v106, v107
  s_nop 1
  v_permlane16_swap_b32 v200, v202
  v_permlane16_swap_b32 v201, v203
  buffer_store_dwordx4 v[200:203], v225, s[40:43], s47 offen offset:2048 sc1
  v_cvt_pk_bf16_f32 v204, v136, v137
  v_cvt_pk_bf16_f32 v205, v138, v139
  v_cvt_pk_bf16_f32 v206, v140, v141
  v_cvt_pk_bf16_f32 v207, v142, v143
  s_nop 1
  v_permlane16_swap_b32 v204, v206
  v_permlane16_swap_b32 v205, v207
  buffer_store_dwordx4 v[204:207], v225, s[40:43], s47 offen offset:3072 sc1
  s_add_u32 s47, s45, 32768
  v_cvt_pk_bf16_f32 v144, v0, v1
  v_cvt_pk_bf16_f32 v145, v2, v3
  buffer_store_dwordx2 v[144:145], v226, s[40:43], s47 offen offset:0 sc1
  v_cvt_pk_bf16_f32 v148, v36, v37
  v_cvt_pk_bf16_f32 v149, v38, v39
  buffer_store_dwordx2 v[148:149], v226, s[40:43], s47 offen offset:1024 sc1
  v_cvt_pk_bf16_f32 v152, v72, v73
  v_cvt_pk_bf16_f32 v153, v74, v75
  buffer_store_dwordx2 v[152:153], v226, s[40:43], s47 offen offset:2048 sc1
  v_cvt_pk_bf16_f32 v156, v108, v109
  v_cvt_pk_bf16_f32 v157, v110, v111
  buffer_store_dwordx2 v[156:157], v226, s[40:43], s47 offen offset:3072 sc1
  s_endpgm
k1_kernel_QKV:
  s_sub_u32 s18, s2, 256
  s_and_b32 s19, s18, 7
  s_lshr_b32 s25, s18, 3
  s_lshr_b32 s24, s19, 2
  s_lshl_b32 s24, s24, 3
  s_and_b32 s23, s25, 7
  s_add_u32 s24, s24, s23
  s_and_b32 s23, s19, 3
  s_mul_i32 s23, s23, 3
  s_lshr_b32 s25, s25, 3
  s_add_u32 s23, s23, s25
  s_lshl_b32 s20, s24, 7
  s_mul_i32 s44, s24, 128*1152
  s_lshl_b32 s22, s21, 5
  s_add_u32 s22, s22, s20
  s_mul_i32 s26, s23, 288
  s_waitcnt lgkmcnt(0)
  s_mov_b32 s28, s4
  s_mov_b32 s29, s5
  s_mov_b32 s30, 2359296
  s_mov_b32 s31, 0x20000
  s_mov_b32 s32, s6
  s_mov_b32 s33, s7
  s_mov_b32 s34, 1990656
  s_mov_b32 s35, 0x20000
  s_add_u32 s36, s16, 18874368
  s_addc_u32 s37, s17, 0
  s_mov_b32 s38, 2359296
  s_mov_b32 s39, 0x20000
  s_add_u32 s40, s16, 21233664
  s_addc_u32 s41, s17, 0
  s_mov_b32 s42, 5242880
  s_mov_b32 s43, 0x20000
  s_add_u32 s48, s16, 26476544
  s_addc_u32 s49, s17, 0
  s_mov_b32 s50, 4096
  s_mov_b32 s51, 0x20000
  s_cmp_ge_u32 s23, 8
  s_cbranch_scc1 k1_kernel_V
  v_and_b32 v221, 63, v230
  s_mul_i32 s52, s21, 144
  v_add_u32 v222, s52, v221
  v_min_u32 v222, 575, v222
  v_mul_u32_u24 v223, 3641, v222
  v_lshrrev_b32 v223, 16, v223
  v_mul_u32_u24 v224, 18, v223
  v_sub_u32 v224, v222, v224
  v_bfe_u32 v225, v223, 2, 2
  v_lshlrev_b32 v225, 3, v225
  v_and_b32 v222, 3, v223
  v_add_u32 v225, v225, v222
  v_lshrrev_b32 v222, 4, v223
  v_lshl_add_u32 v225, v222, 2, v225
  v_mul_u32_u24 v225, 3456, v225
  v_lshl_add_u32 v225, v224, 4, v225
  v_mov_b32 v212, v225
  v_add_u32 v222, s52, v221
  v_add_u32 v222, 64, v222
  v_min_u32 v222, 575, v222
  v_mul_u32_u24 v223, 3641, v222
  v_lshrrev_b32 v223, 16, v223
  v_mul_u32_u24 v224, 18, v223
  v_sub_u32 v224, v222, v224
  v_bfe_u32 v225, v223, 2, 2
  v_lshlrev_b32 v225, 3, v225
  v_and_b32 v222, 3, v223
  v_add_u32 v225, v225, v222
  v_lshrrev_b32 v222, 4, v223
  v_lshl_add_u32 v225, v222, 2, v225
  v_mul_u32_u24 v225, 3456, v225
  v_lshl_add_u32 v225, v224, 4, v225
  v_subrev_u32 v213, 1024, v225
  v_add_u32 v222, s52, v221
  v_add_u32 v222, 128, v222
  v_min_u32 v222, 575, v222
  v_mul_u32_u24 v223, 3641, v222
  v_lshrrev_b32 v223, 16, v223
  v_mul_u32_u24 v224, 18, v223
  v_sub_u32 v224, v222, v224
  v_bfe_u32 v225, v223, 2, 2
  v_lshlrev_b32 v225, 3, v225
  v_and_b32 v222, 3, v223
  v_add_u32 v225, v225, v222
  v_lshrrev_b32 v222, 4, v223
  v_lshl_add_u32 v225, v222, 2, v225
  v_mul_u32_u24 v225, 3456, v225
  v_lshl_add_u32 v225, v224, 4, v225
  v_subrev_u32 v214, 2048, v225
  s_lshl_b32 s52, s52, 4
  s_add_u32 s52, s52, 8192
  v_lshrrev_b32 v222, 2, v221
  v_mul_u32_u24 v222, 288, v222
  v_and_b32 v223, 3, v221
  v_lshl_add_u32 v219, v223, 3, v222
  s_mov_b32 s54, 8192
  v_add_u32 v219, s54, v219
  s_mul_i32 s53, s21, 128
  v_add_u32 v222, s53, v221
  v_lshrrev_b32 v223, 2, v222
  v_bfe_u32 v224, v223, 3, 1
  v_mul_u32_u24 v224, 3, v224
  v_and_b32 v222, 3, v222
  v_xor_b32 v222, v222, v224
  v_mul_u32_u24 v223, 1152, v223
  v_lshl_add_u32 v223, v222, 4, v223
  v_mov_b32 v217, v223
  v_add_u32 v222, s53, v221
  v_add_u32 v222, 64, v222
  v_lshrrev_b32 v223, 2, v222
  v_bfe_u32 v224, v223, 3, 1
  v_mul_u32_u24 v224, 3, v224
  v_and_b32 v222, 3, v222
  v_xor_b32 v222, v222, v224
  v_mul_u32_u24 v223, 1152, v223
  v_lshl_add_u32 v223, v222, 4, v223
  v_subrev_u32 v218, 1024, v223
  s_lshl_b32 s53, s53, 4
  v_and_b32 v222, 15, v221
  v_bfe_u32 v223, v221, 3, 1
  v_mul_u32_u24 v223, 3, v223
  v_lshrrev_b32 v224, 4, v221
  v_xor_b32 v223, v223, v224
  v_lshlrev_b32 v223, 4, v223
  v_lshl_add_u32 v220, v222, 6, v223
  s_lshr_b32 s54, s21, 0
  s_mul_i32 s54, s54, 2048
  v_add_u32 v220, s54, v220
  s_add_u32 m0, s52, 0
  s_nop 0
  buffer_load_dwordx4 v212, s[32:35], s26 offen offset:0 lds
  buffer_load_dwordx4 v213, s[32:35], s26 offen offset:1024 lds
  s_mov_b64 exec, 0xffff
  buffer_load_dwordx4 v214, s[32:35], s26 offen offset:2048 lds
  s_mov_b64 exec, -1
  s_add_u32 s26, s26, 110592
  s_add_u32 m0, s53, 0
  s_nop 0
  buffer_load_dwordx4 v217, s[28:31], s44 offen offset:0 lds
  buffer_load_dwordx4 v218, s[28:31], s44 offen offset:1024 lds
  s_add_u32 s44, s44, 64
  s_add_u32 m0, s52, 17408
  s_nop 0
  buffer_load_dwordx4 v212, s[32:35], s26 offen offset:0 lds
  buffer_load_dwordx4 v213, s[32:35], s26 offen offset:1024 lds
  s_mov_b64 exec, 0xffff
  buffer_load_dwordx4 v214, s[32:35], s26 offen offset:2048 lds
  s_mov_b64 exec, -1
  s_add_u32 s26, s26, 110592
  s_add_u32 m0, s53, 17408
  s_nop 0
  buffer_load_dwordx4 v217, s[28:31], s44 offen offset:0 lds
  buffer_load_dwordx4 v218, s[28:31], s44 offen offset:1024 lds
  s_add_u32 s44, s44, 64
  s_add_u32 m0, s52, 34816
  s_nop 0
  buffer_load_dwordx4 v212, s[32:35], s26 offen offset:0 lds
  buffer_load_dwordx4 v213, s[32:35], s26 offen offset:1024 lds
  s_mov_b64 exec, 0xffff
  buffer_load_dwordx4 v214, s[32:35], s26 offen offset:2048 lds
  s_mov_b64 exec, -1
  s_add_u32 s26, s26, 110592
  s_add_u32 m0, s53, 34816
  s_nop 0
  buffer_load_dwordx4 v217, s[28:31], s44 offen offset:0 lds
  buffer_load_dwordx4 v218, s[28:31], s44 offen offset:1024 lds
  s_add_u32 s44, s44, 64
  s_add_u32 m0, s52, 52224
  s_nop 0
  buffer_load_dwordx4 v212, s[32:35], s26 offen offset:0 lds
  buffer_load_dwordx4 v213, s[32:35], s26 offen offset:1024 lds
  s_mov_b64 exec, 0xffff
  buffer_load_dwordx4 v214, s[32:35], s26 offen offset:2048 lds
  s_mov_b64 exec, -1
  s_add_u32 s26, s26, 110592
  s_add_u32 m0, s53, 52224
  s_nop 0
  buffer_load_dwordx4 v217, s[28:31], s44 offen offset:0 lds
  buffer_load_dwordx4 v218, s[28:31], s44 offen offset:1024 lds
  s_add_u32 s44, s44, 64
  v_mov_b32 v0, 0
  v_mov_b32 v1, 0
  v_mov_b32 v2, 0
  v_mov_b32 v3, 0
  v_mov_b32 v4, 0
  v_mov_b32 v5, 0
  v_mov_b32 v6, 0
  v_mov_b32 v7, 0
  v_mov_b32 v8, 0
  v_mov_b32 v9, 0
  v_mov_b32 v10, 0
  v_mov_b32 v11, 0
  v_mov_b32 v12, 0
  v_mov_b32 v13, 0
  v_mov_b32 v14, 0
  v_mov_b32 v15, 0
  v_mov_b32 v16, 0
  v_mov_b32 v17, 0
  v_mov_b32 v18, 0
  v_mov_b32 v19, 0
  v_mov_b32 v20, 0
  v_mov_b32 v21, 0
  v_mov_b32 v22, 0
  v_mov_b32 v23, 0
  v_mov_b32 v24, 0
  v_mov_b32 v25, 0
  v_mov_b32 v26, 0
  v_mov_b32 v27, 0
  v_mov_b32 v28, 0
  v_mov_b32 v29, 0
  v_mov_b32 v30, 0
  v_mov_b32 v31, 0
  v_mov_b32 v32, 0
  v_mov_b32 v33, 0
  v_mov_b32 v34, 0
  v_mov_b32 v35, 0
  v_mov_b32 v36, 0
  v_mov_b32 v37, 0
  v_mov_b32 v38, 0
  v_mov_b32 v39, 0
  v_mov_b32 v40, 0
  v_mov_b32 v41, 0
  v_mov_b32 v42, 0
  v_mov_b32 v43, 0
  v_mov_b32 v44, 0
  v_mov_b32 v45, 0
  v_mov_b32 v46, 0
  v_mov_b32 v47, 0
  v_mov_b32 v48, 0
  v_mov_b32 v49, 0
  v_mov_b32 v50, 0
  v_mov_b32 v51, 0
  v_mov_b32 v52, 0
  v_mov_b32 v53, 0
  v_mov_b32 v54, 0
  v_mov_b32 v55, 0
  v_mov_b32 v56, 0
  v_mov_b32 v57, 0
  v_mov_b32 v58, 0
  v_mov_b32 v59, 0
  v_mov_b32 v60, 0
  v_mov_b32 v61, 0
  v_mov_b32 v62, 0
  v_mov_b32 v63, 0
  v_mov_b32 v64, 0
  v_mov_b32 v65, 0
  v_mov_b32 v66, 0
  v_mov_b32 v67, 0
  v_mov_b32 v68, 0
  v_mov_b32 v69, 0
  v_mov_b32 v70, 0
  v_mov_b32 v71, 0
  s_waitcnt vmcnt(15)
  s_barrier
  ds_read_b128 v[180:183], v220 offset:0
  ds_read_b128 v[184:187], v220 offset:1024
  ds_read_b64_tr_b16 v[144:145], v219 offset:0
  ds_read_b64_tr_b16 v[146:147], v219 offset:4608
  ds_read_b64_tr_b16 v[148:149], v219 offset:32
  ds_read_b64_tr_b16 v[150:151], v219 offset:4640
  ds_read_b64_tr_b16 v[152:153], v219 offset:64
  ds_read_b64_tr_b16 v[154:155], v219 offset:4672
  ds_read_b64_tr_b16 v[156:157], v219 offset:96
  ds_read_b64_tr_b16 v[158:159], v219 offset:4704
  ds_read_b64_tr_b16 v[160:161], v219 offset:128
  ds_read_b64_tr_b16 v[162:163], v219 offset:4736
  ds_read_b64_tr_b16 v[164:165], v219 offset:160
  ds_read_b64_tr_b16 v[166:167], v219 offset:4768
  ds_read_b64_tr_b16 v[168:169], v219 offset:192
  ds_read_b64_tr_b16 v[170:171], v219 offset:4800
  ds_read_b64_tr_b16 v[172:173], v219 offset:224
  ds_read_b64_tr_b16 v[174:175], v219 offset:4832
  ds_read_b64_tr_b16 v[176:177], v219 offset:256
  ds_read_b64_tr_b16 v[178:179], v219 offset:4864
  s_waitcnt vmcnt(10)
  s_waitcnt lgkmcnt(0)
  s_barrier
  ds_read_b128 v[188:191], v220 offset:17408
  ds_read_b128 v[192:195], v220 offset:18432
  v_mfma_f32_16x16x32_bf16 v[0:3], v[144:147], v[180:183], v[0:3]
  s_add_u32 m0, s52, 0
  s_nop 0
  buffer_load_dwordx4 v212, s[32:35], s26 offen offset:0 lds
  v_mfma_f32_16x16x32_bf16 v[36:39], v[144:147], v[184:187], v[36:39]
  ds_read_b64_tr_b16 v[144:145], v219 offset:17408
  ds_read_b64_tr_b16 v[146:147], v219 offset:22016
  v_mfma_f32_16x16x32_bf16 v[4:7], v[148:151], v[180:183], v[4:7]
  buffer_load_dwordx4 v213, s[32:35], s26 offen offset:1024 lds
  v_mfma_f32_16x16x32_bf16 v[40:43], v[148:151], v[184:187], v[40:43]
  ds_read_b64_tr_b16 v[148:149], v219 offset:17440
  ds_read_b64_tr_b16 v[150:151], v219 offset:22048
  v_mfma_f32_16x16x32_bf16 v[8:11], v[152:155], v[180:183], v[8:11]
  s_mov_b64 exec, 0xffff
  buffer_load_dwordx4 v214, s[32:35], s26 offen offset:2048 lds
  s_mov_b64 exec, -1
  s_add_u32 s26, s26, 110592
  v_mfma_f32_16x16x32_bf16 v[44:47], v[152:155], v[184:187], v[44:47]
  ds_read_b64_tr_b16 v[152:153], v219 offset:17472
  ds_read_b64_tr_b16 v[154:155], v219 offset:22080
  v_mfma_f32_16x16x32_bf16 v[12:15], v[156:159], v[180:183], v[12:15]
  s_add_u32 m0, s53, 0
  s_nop 0
  buffer_load_dwordx4 v217, s[28:31], s44 offen offset:0 lds
  v_mfma_f32_16x16x32_bf16 v[48:51], v[156:159], v[184:187], v[48:51]
  ds_read_b64_tr_b16 v[156:157], v219 offset:17504
  ds_read_b64_tr_b16 v[158:159], v219 offset:22112
  v_mfma_f32_16x16x32_bf16 v[16:19], v[160:163], v[180:183], v[16:19]
  buffer_load_dwordx4 v218, s[28:31], s44 offen offset:1024 lds
  s_add_u32 s44, s44, 64
  v_mfma_f32_16x16x32_bf16 v[52:55], v[160:163], v[184:187], v[52:55]
  ds_read_b64_tr_b16 v[160:161], v219 offset:17536
  ds_read_b64_tr_b16 v[162:163], v219 offset:22144
  v_mfma_f32_16x16x32_bf16 v[20:23], v[164:167], v[180:183], v[20:23]
  v_mfma_f32_16x16x32_bf16 v[56:59], v[164:167], v[184:187], v[56:59]
  ds_read_b64_tr_b16 v[164:165], v219 offset:17568
  ds_read_b64_tr_b16 v[166:167], v219 offset:22176
  v_mfma_f32_16x16x32_bf16 v[24:27], v[168:171], v[180:183], v[24:27]
  v_mfma_f32_16x16x32_bf16 v[60:63], v[168:171], v[184:187], v[60:63]
  ds_read_b64_tr_b16 v[168:169], v219 offset:17600
  ds_read_b64_tr_b16 v[170:171], v219 offset:22208
  v_mfma_f32_16x16x32_bf16 v[28:31], v[172:175], v[180:183], v[28:31]
  v_mfma_f32_16x16x32_bf16 v[64:67], v[172:175], v[184:187], v[64:67]
  ds_read_b64_tr_b16 v[172:173], v219 offset:17632
  ds_read_b64_tr_b16 v[174:175], v219 offset:22240
  v_mfma_f32_16x16x32_bf16 v[32:35], v[176:179], v[180:183], v[32:35]
  v_mfma_f32_16x16x32_bf16 v[68:71], v[176:179], v[184:187], v[68:71]
  ds_read_b64_tr_b16 v[176:177], v219 offset:17664
  ds_read_b64_tr_b16 v[178:179], v219 offset:22272
  s_waitcnt vmcnt(10)
  s_waitcnt lgkmcnt(0)
  s_barrier
  ds_read_b128 v[180:183], v220 offset:34816
  ds_read_b128 v[184:187], v220 offset:35840
  v_mfma_f32_16x16x32_bf16 v[0:3], v[144:147], v[188:191], v[0:3]
  s_add_u32 m0, s52, 17408
  s_nop 0
  buffer_load_dwordx4 v212, s[32:35], s26 offen offset:0 lds
  v_mfma_f32_16x16x32_bf16 v[36:39], v[144:147], v[192:195], v[36:39]
  ds_read_b64_tr_b16 v[144:145], v219 offset:34816
  ds_read_b64_tr_b16 v[146:147], v219 offset:39424
  v_mfma_f32_16x16x32_bf16 v[4:7], v[148:151], v[188:191], v[4:7]
  buffer_load_dwordx4 v213, s[32:35], s26 offen offset:1024 lds
  v_mfma_f32_16x16x32_bf16 v[40:43], v[148:151], v[192:195], v[40:43]
  ds_read_b64_tr_b16 v[148:149], v219 offset:34848
  ds_read_b64_tr_b16 v[150:151], v219 offset:39456
  v_mfma_f32_16x16x32_bf16 v[8:11], v[152:155], v[188:191], v[8:11]
  s_mov_b64 exec, 0xffff
  buffer_load_dwordx4 v214, s[32:35], s26 offen offset:2048 lds
  s_mov_b64 exec, -1
  s_add_u32 s26, s26, 110592
  v_mfma_f32_16x16x32_bf16 v[44:47], v[152:155], v[192:195], v[44:47]
  ds_read_b64_tr_b16 v[152:153], v219 offset:34880
  ds_read_b64_tr_b16 v[154:155], v219 offset:39488
  v_mfma_f32_16x16x32_bf16 v[12:15], v[156:159], v[188:191], v[12:15]
  s_add_u32 m0, s53, 17408
  s_nop 0
  buffer_load_dwordx4 v217, s[28:31], s44 offen offset:0 lds
  v_mfma_f32_16x16x32_bf16 v[48:51], v[156:159], v[192:195], v[48:51]
  ds_read_b64_tr_b16 v[156:157], v219 offset:34912
  ds_read_b64_tr_b16 v[158:159], v219 offset:39520
  v_mfma_f32_16x16x32_bf16 v[16:19], v[160:163], v[188:191], v[16:19]
  buffer_load_dwordx4 v218, s[28:31], s44 offen offset:1024 lds
  s_add_u32 s44, s44, 64
  v_mfma_f32_16x16x32_bf16 v[52:55], v[160:163], v[192:195], v[52:55]
  ds_read_b64_tr_b16 v[160:161], v219 offset:34944
  ds_read_b64_tr_b16 v[162:163], v219 offset:39552
  v_mfma_f32_16x16x32_bf16 v[20:23], v[164:167], v[188:191], v[20:23]
  v_mfma_f32_16x16x32_bf16 v[56:59], v[164:167], v[192:195], v[56:59]
  ds_read_b64_tr_b16 v[164:165], v219 offset:34976
  ds_read_b64_tr_b16 v[166:167], v219 offset:39584
  v_mfma_f32_16x16x32_bf16 v[24:27], v[168:171], v[188:191], v[24:27]
  v_mfma_f32_16x16x32_bf16 v[60:63], v[168:171], v[192:195], v[60:63]
  ds_read_b64_tr_b16 v[168:169], v219 offset:35008
  ds_read_b64_tr_b16 v[170:171], v219 offset:39616
  v_mfma_f32_16x16x32_bf16 v[28:31], v[172:175], v[188:191], v[28:31]
  v_mfma_f32_16x16x32_bf16 v[64:67], v[172:175], v[192:195], v[64:67]
  ds_read_b64_tr_b16 v[172:173], v219 offset:35040
  ds_read_b64_tr_b16 v[174:175], v219 offset:39648
  v_mfma_f32_16x16x32_bf16 v[32:35], v[176:179], v[188:191], v[32:35]
  v_mfma_f32_16x16x32_bf16 v[68:71], v[176:179], v[192:195], v[68:71]
  ds_read_b64_tr_b16 v[176:177], v219 offset:35072
  ds_read_b64_tr_b16 v[178:179], v219 offset:39680
  s_waitcnt vmcnt(10)
  s_waitcnt lgkmcnt(0)
  s_barrier
  ds_read_b128 v[188:191], v220 offset:52224
  ds_read_b128 v[192:195], v220 offset:53248
  v_mfma_f32_16x16x32_bf16 v[0:3], v[144:147], v[180:183], v[0:3]
  s_add_u32 m0, s52, 34816
  s_nop 0
  buffer_load_dwordx4 v212, s[32:35], s26 offen offset:0 lds
  v_mfma_f32_16x16x32_bf16 v[36:39], v[144:147], v[184:187], v[36:39]
  ds_read_b64_tr_b16 v[144:145], v219 offset:52224
  ds_read_b64_tr_b16 v[146:147], v219 offset:56832
  v_mfma_f32_16x16x32_bf16 v[4:7], v[148:151], v[180:183], v[4:7]
  buffer_load_dwordx4 v213, s[32:35], s26 offen offset:1024 lds
  v_mfma_f32_16x16x32_bf16 v[40:43], v[148:151], v[184:187], v[40:43]
  ds_read_b64_tr_b16 v[148:149], v219 offset:52256
  ds_read_b64_tr_b16 v[150:151], v219 offset:56864
  v_mfma_f32_16x16x32_bf16 v[8:11], v[152:155], v[180:183], v[8:11]
  s_mov_b64 exec, 0xffff
  buffer_load_dwordx4 v214, s[32:35], s26 offen offset:2048 lds
  s_mov_b64 exec, -1
  s_add_u32 s26, s26, 110592
  v_mfma_f32_16x16x32_bf16 v[44:47], v[152:155], v[184:187], v[44:47]
  ds_read_b64_tr_b16 v[152:153], v219 offset:52288
  ds_read_b64_tr_b16 v[154:155], v219 offset:56896
  v_mfma_f32_16x16x32_bf16 v[12:15], v[156:159], v[180:183], v[12:15]
  s_add_u32 m0, s53, 34816
  s_nop 0
  buffer_load_dwordx4 v217, s[28:31], s44 offen offset:0 lds
  v_mfma_f32_16x16x32_bf16 v[48:51], v[156:159], v[184:187], v[48:51]
  ds_read_b64_tr_b16 v[156:157], v219 offset:52320
  ds_read_b64_tr_b16 v[158:159], v219 offset:56928
  v_mfma_f32_16x16x32_bf16 v[16:19], v[160:163], v[180:183], v[16:19]
  buffer_load_dwordx4 v218, s[28:31], s44 offen offset:1024 lds
  s_add_u32 s44, s44, 64
  v_mfma_f32_16x16x32_bf16 v[52:55], v[160:163], v[184:187], v[52:55]
  ds_read_b64_tr_b16 v[160:161], v219 offset:52352
  ds_read_b64_tr_b16 v[162:163], v219 offset:56960
  v_mfma_f32_16x16x32_bf16 v[20:23], v[164:167], v[180:183], v[20:23]
  v_mfma_f32_16x16x32_bf16 v[56:59], v[164:167], v[184:187], v[56:59]
  ds_read_b64_tr_b16 v[164:165], v219 offset:52384
  ds_read_b64_tr_b16 v[166:167], v219 offset:56992
  v_mfma_f32_16x16x32_bf16 v[24:27], v[168:171], v[180:183], v[24:27]
  v_mfma_f32_16x16x32_bf16 v[60:63], v[168:171], v[184:187], v[60:63]
  ds_read_b64_tr_b16 v[168:169], v219 offset:52416
  ds_read_b64_tr_b16 v[170:171], v219 offset:57024
  v_mfma_f32_16x16x32_bf16 v[28:31], v[172:175], v[180:183], v[28:31]
  v_mfma_f32_16x16x32_bf16 v[64:67], v[172:175], v[184:187], v[64:67]
  ds_read_b64_tr_b16 v[172:173], v219 offset:52448
  ds_read_b64_tr_b16 v[174:175], v219 offset:57056
  v_mfma_f32_16x16x32_bf16 v[32:35], v[176:179], v[180:183], v[32:35]
  v_mfma_f32_16x16x32_bf16 v[68:71], v[176:179], v[184:187], v[68:71]
  ds_read_b64_tr_b16 v[176:177], v219 offset:52480
  ds_read_b64_tr_b16 v[178:179], v219 offset:57088
  s_waitcnt vmcnt(10)
  s_waitcnt lgkmcnt(0)
  s_barrier
  ds_read_b128 v[180:183], v220 offset:0
  ds_read_b128 v[184:187], v220 offset:1024
  v_mfma_f32_16x16x32_bf16 v[0:3], v[144:147], v[188:191], v[0:3]
  s_add_u32 m0, s52, 52224
  s_nop 0
  buffer_load_dwordx4 v212, s[32:35], s26 offen offset:0 lds
  v_mfma_f32_16x16x32_bf16 v[36:39], v[144:147], v[192:195], v[36:39]
  ds_read_b64_tr_b16 v[144:145], v219 offset:0
  ds_read_b64_tr_b16 v[146:147], v219 offset:4608
  v_mfma_f32_16x16x32_bf16 v[4:7], v[148:151], v[188:191], v[4:7]
  buffer_load_dwordx4 v213, s[32:35], s26 offen offset:1024 lds
  v_mfma_f32_16x16x32_bf16 v[40:43], v[148:151], v[192:195], v[40:43]
  ds_read_b64_tr_b16 v[148:149], v219 offset:32
  ds_read_b64_tr_b16 v[150:151], v219 offset:4640
  v_mfma_f32_16x16x32_bf16 v[8:11], v[152:155], v[188:191], v[8:11]
  s_mov_b64 exec, 0xffff
  buffer_load_dwordx4 v214, s[32:35], s26 offen offset:2048 lds
  s_mov_b64 exec, -1
  s_add_u32 s26, s26, 110592
  v_mfma_f32_16x16x32_bf16 v[44:47], v[152:155], v[192:195], v[44:47]
  ds_read_b64_tr_b16 v[152:153], v219 offset:64
  ds_read_b64_tr_b16 v[154:155], v219 offset:4672
  v_mfma_f32_16x16x32_bf16 v[12:15], v[156:159], v[188:191], v[12:15]
  s_add_u32 m0, s53, 52224
  s_nop 0
  buffer_load_dwordx4 v217, s[28:31], s44 offen offset:0 lds
  v_mfma_f32_16x16x32_bf16 v[48:51], v[156:159], v[192:195], v[48:51]
  ds_read_b64_tr_b16 v[156:157], v219 offset:96
  ds_read_b64_tr_b16 v[158:159], v219 offset:4704
  v_mfma_f32_16x16x32_bf16 v[16:19], v[160:163], v[188:191], v[16:19]
  buffer_load_dwordx4 v218, s[28:31], s44 offen offset:1024 lds
  s_add_u32 s44, s44, 64
  v_mfma_f32_16x16x32_bf16 v[52:55], v[160:163], v[192:195], v[52:55]
  ds_read_b64_tr_b16 v[160:161], v219 offset:128
  ds_read_b64_tr_b16 v[162:163], v219 offset:4736
  v_mfma_f32_16x16x32_bf16 v[20:23], v[164:167], v[188:191], v[20:23]
  v_mfma_f32_16x16x32_bf16 v[56:59], v[164:167], v[192:195], v[56:59]
  ds_read_b64_tr_b16 v[164:165], v219 offset:160
  ds_read_b64_tr_b16 v[166:167], v219 offset:4768
  v_mfma_f32_16x16x32_bf16 v[24:27], v[168:171], v[188:191], v[24:27]
  v_mfma_f32_16x16x32_bf16 v[60:63], v[168:171], v[192:195], v[60:63]
  ds_read_b64_tr_b16 v[168:169], v219 offset:192
  ds_read_b64_tr_b16 v[170:171], v219 offset:4800
  v_mfma_f32_16x16x32_bf16 v[28:31], v[172:175], v[188:191], v[28:31]
  v_mfma_f32_16x16x32_bf16 v[64:67], v[172:175], v[192:195], v[64:67]
  ds_read_b64_tr_b16 v[172:173], v219 offset:224
  ds_read_b64_tr_b16 v[174:175], v219 offset:4832
  v_mfma_f32_16x16x32_bf16 v[32:35], v[176:179], v[188:191], v[32:35]
  v_mfma_f32_16x16x32_bf16 v[68:71], v[176:179], v[192:195], v[68:71]
  ds_read_b64_tr_b16 v[176:177], v219 offset:256
  ds_read_b64_tr_b16 v[178:179], v219 offset:4864
  s_waitcnt vmcnt(10)
  s_waitcnt lgkmcnt(0)
  s_barrier
  ds_read_b128 v[188:191], v220 offset:17408
  ds_read_b128 v[192:195], v220 offset:18432
  v_mfma_f32_16x16x32_bf16 v[0:3], v[144:147], v[180:183], v[0:3]
  s_add_u32 m0, s52, 0
  s_nop 0
  buffer_load_dwordx4 v212, s[32:35], s26 offen offset:0 lds
  v_mfma_f32_16x16x32_bf16 v[36:39], v[144:147], v[184:187], v[36:39]
  ds_read_b64_tr_b16 v[144:145], v219 offset:17408
  ds_read_b64_tr_b16 v[146:147], v219 offset:22016
  v_mfma_f32_16x16x32_bf16 v[4:7], v[148:151], v[180:183], v[4:7]
  buffer_load_dwordx4 v213, s[32:35], s26 offen offset:1024 lds
  v_mfma_f32_16x16x32_bf16 v[40:43], v[148:151], v[184:187], v[40:43]
  ds_read_b64_tr_b16 v[148:149], v219 offset:17440
  ds_read_b64_tr_b16 v[150:151], v219 offset:22048
  v_mfma_f32_16x16x32_bf16 v[8:11], v[152:155], v[180:183], v[8:11]
  s_mov_b64 exec, 0xffff
  buffer_load_dwordx4 v214, s[32:35], s26 offen offset:2048 lds
  s_mov_b64 exec, -1
  s_add_u32 s26, s26, 110592
  v_mfma_f32_16x16x32_bf16 v[44:47], v[152:155], v[184:187], v[44:47]
  ds_read_b64_tr_b16 v[152:153], v219 offset:17472
  ds_read_b64_tr_b16 v[154:155], v219 offset:22080
  v_mfma_f32_16x16x32_bf16 v[12:15], v[156:159], v[180:183], v[12:15]
  s_add_u32 m0, s53, 0
  s_nop 0
  buffer_load_dwordx4 v217, s[28:31], s44 offen offset:0 lds
  v_mfma_f32_16x16x32_bf16 v[48:51], v[156:159], v[184:187], v[48:51]
  ds_read_b64_tr_b16 v[156:157], v219 offset:17504
  ds_read_b64_tr_b16 v[158:159], v219 offset:22112
  v_mfma_f32_16x16x32_bf16 v[16:19], v[160:163], v[180:183], v[16:19]
  buffer_load_dwordx4 v218, s[28:31], s44 offen offset:1024 lds
  s_add_u32 s44, s44, 64
  v_mfma_f32_16x16x32_bf16 v[52:55], v[160:163], v[184:187], v[52:55]
  ds_read_b64_tr_b16 v[160:161], v219 offset:17536
  ds_read_b64_tr_b16 v[162:163], v219 offset:22144
  v_mfma_f32_16x16x32_bf16 v[20:23], v[164:167], v[180:183], v[20:23]
  v_mfma_f32_16x16x32_bf16 v[56:59], v[164:167], v[184:187], v[56:59]
  ds_read_b64_tr_b16 v[164:165], v219 offset:17568
  ds_read_b64_tr_b16 v[166:167], v219 offset:22176
  v_mfma_f32_16x16x32_bf16 v[24:27], v[168:171], v[180:183], v[24:27]
  v_mfma_f32_16x16x32_bf16 v[60:63], v[168:171], v[184:187], v[60:63]
  ds_read_b64_tr_b16 v[168:169], v219 offset:17600
  ds_read_b64_tr_b16 v[170:171], v219 offset:22208
  v_mfma_f32_16x16x32_bf16 v[28:31], v[172:175], v[180:183], v[28:31]
  v_mfma_f32_16x16x32_bf16 v[64:67], v[172:175], v[184:187], v[64:67]
  ds_read_b64_tr_b16 v[172:173], v219 offset:17632
  ds_read_b64_tr_b16 v[174:175], v219 offset:22240
  v_mfma_f32_16x16x32_bf16 v[32:35], v[176:179], v[180:183], v[32:35]
  v_mfma_f32_16x16x32_bf16 v[68:71], v[176:179], v[184:187], v[68:71]
  ds_read_b64_tr_b16 v[176:177], v219 offset:17664
  ds_read_b64_tr_b16 v[178:179], v219 offset:22272
  s_waitcnt vmcnt(10)
  s_waitcnt lgkmcnt(0)
  s_barrier
  ds_read_b128 v[180:183], v220 offset:34816
  ds_read_b128 v[184:187], v220 offset:35840
  v_mfma_f32_16x16x32_bf16 v[0:3], v[144:147], v[188:191], v[0:3]
  s_add_u32 m0, s52, 17408
  s_nop 0
  buffer_load_dwordx4 v212, s[32:35], s26 offen offset:0 lds
  v_mfma_f32_16x16x32_bf16 v[36:39], v[144:147], v[192:195], v[36:39]
  ds_read_b64_tr_b16 v[144:145], v219 offset:34816
  ds_read_b64_tr_b16 v[146:147], v219 offset:39424
  v_mfma_f32_16x16x32_bf16 v[4:7], v[148:151], v[188:191], v[4:7]
  buffer_load_dwordx4 v213, s[32:35], s26 offen offset:1024 lds
  v_mfma_f32_16x16x32_bf16 v[40:43], v[148:151], v[192:195], v[40:43]
  ds_read_b64_tr_b16 v[148:149], v219 offset:34848
  ds_read_b64_tr_b16 v[150:151], v219 offset:39456
  v_mfma_f32_16x16x32_bf16 v[8:11], v[152:155], v[188:191], v[8:11]
  s_mov_b64 exec, 0xffff
  buffer_load_dwordx4 v214, s[32:35], s26 offen offset:2048 lds
  s_mov_b64 exec, -1
  s_add_u32 s26, s26, 110592
  v_mfma_f32_16x16x32_bf16 v[44:47], v[152:155], v[192:195], v[44:47]
  ds_read_b64_tr_b16 v[152:153], v219 offset:34880
  ds_read_b64_tr_b16 v[154:155], v219 offset:39488
  v_mfma_f32_16x16x32_bf16 v[12:15], v[156:159], v[188:191], v[12:15]
  s_add_u32 m0, s53, 17408
  s_nop 0
  buffer_load_dwordx4 v217, s[28:31], s44 offen offset:0 lds
  v_mfma_f32_16x16x32_bf16 v[48:51], v[156:159], v[192:195], v[48:51]
  ds_read_b64_tr_b16 v[156:157], v219 offset:34912
  ds_read_b64_tr_b16 v[158:159], v219 offset:39520
  v_mfma_f32_16x16x32_bf16 v[16:19], v[160:163], v[188:191], v[16:19]
  buffer_load_dwordx4 v218, s[28:31], s44 offen offset:1024 lds
  s_add_u32 s44, s44, 64
  v_mfma_f32_16x16x32_bf16 v[52:55], v[160:163], v[192:195], v[52:55]
  ds_read_b64_tr_b16 v[160:161], v219 offset:34944
  ds_read_b64_tr_b16 v[162:163], v219 offset:39552
  v_mfma_f32_16x16x32_bf16 v[20:23], v[164:167], v[188:191], v[20:23]
  v_mfma_f32_16x16x32_bf16 v[56:59], v[164:167], v[192:195], v[56:59]
  ds_read_b64_tr_b16 v[164:165], v219 offset:34976
  ds_read_b64_tr_b16 v[166:167], v219 offset:39584
  v_mfma_f32_16x16x32_bf16 v[24:27], v[168:171], v[188:191], v[24:27]
  v_mfma_f32_16x16x32_bf16 v[60:63], v[168:171], v[192:195], v[60:63]
  ds_read_b64_tr_b16 v[168:169], v219 offset:35008
  ds_read_b64_tr_b16 v[170:171], v219 offset:39616
  v_mfma_f32_16x16x32_bf16 v[28:31], v[172:175], v[188:191], v[28:31]
  v_mfma_f32_16x16x32_bf16 v[64:67], v[172:175], v[192:195], v[64:67]
  ds_read_b64_tr_b16 v[172:173], v219 offset:35040
  ds_read_b64_tr_b16 v[174:175], v219 offset:39648
  v_mfma_f32_16x16x32_bf16 v[32:35], v[176:179], v[188:191], v[32:35]
  v_mfma_f32_16x16x32_bf16 v[68:71], v[176:179], v[192:195], v[68:71]
  ds_read_b64_tr_b16 v[176:177], v219 offset:35072
  ds_read_b64_tr_b16 v[178:179], v219 offset:39680
  s_waitcnt vmcnt(10)
  s_waitcnt lgkmcnt(0)
  s_barrier
  ds_read_b128 v[188:191], v220 offset:52224
  ds_read_b128 v[192:195], v220 offset:53248
  v_mfma_f32_16x16x32_bf16 v[0:3], v[144:147], v[180:183], v[0:3]
  s_add_u32 m0, s52, 34816
  s_nop 0
  buffer_load_dwordx4 v212, s[32:35], s26 offen offset:0 lds
  v_mfma_f32_16x16x32_bf16 v[36:39], v[144:147], v[184:187], v[36:39]
  ds_read_b64_tr_b16 v[144:145], v219 offset:52224
  ds_read_b64_tr_b16 v[146:147], v219 offset:56832
  v_mfma_f32_16x16x32_bf16 v[4:7], v[148:151], v[180:183], v[4:7]
  buffer_load_dwordx4 v213, s[32:35], s26 offen offset:1024 lds
  v_mfma_f32_16x16x32_bf16 v[40:43], v[148:151], v[184:187], v[40:43]
  ds_read_b64_tr_b16 v[148:149], v219 offset:52256
  ds_read_b64_tr_b16 v[150:151], v219 offset:56864
  v_mfma_f32_16x16x32_bf16 v[8:11], v[152:155], v[180:183], v[8:11]
  s_mov_b64 exec, 0xffff
  buffer_load_dwordx4 v214, s[32:35], s26 offen offset:2048 lds
  s_mov_b64 exec, -1
  s_add_u32 s26, s26, 110592
  v_mfma_f32_16x16x32_bf16 v[44:47], v[152:155], v[184:187], v[44:47]
  ds_read_b64_tr_b16 v[152:153], v219 offset:52288
  ds_read_b64_tr_b16 v[154:155], v219 offset:56896
  v_mfma_f32_16x16x32_bf16 v[12:15], v[156:159], v[180:183], v[12:15]
  s_add_u32 m0, s53, 34816
  s_nop 0
  buffer_load_dwordx4 v217, s[28:31], s44 offen offset:0 lds
  v_mfma_f32_16x16x32_bf16 v[48:51], v[156:159], v[184:187], v[48:51]
  ds_read_b64_tr_b16 v[156:157], v219 offset:52320
  ds_read_b64_tr_b16 v[158:159], v219 offset:56928
  v_mfma_f32_16x16x32_bf16 v[16:19], v[160:163], v[180:183], v[16:19]
  buffer_load_dwordx4 v218, s[28:31], s44 offen offset:1024 lds
  s_add_u32 s44, s44, 64
  v_mfma_f32_16x16x32_bf16 v[52:55], v[160:163], v[184:187], v[52:55]
  ds_read_b64_tr_b16 v[160:161], v219 offset:52352
  ds_read_b64_tr_b16 v[162:163], v219 offset:56960
  v_mfma_f32_16x16x32_bf16 v[20:23], v[164:167], v[180:183], v[20:23]
  v_mfma_f32_16x16x32_bf16 v[56:59], v[164:167], v[184:187], v[56:59]
  ds_read_b64_tr_b16 v[164:165], v219 offset:52384
  ds_read_b64_tr_b16 v[166:167], v219 offset:56992
  v_mfma_f32_16x16x32_bf16 v[24:27], v[168:171], v[180:183], v[24:27]
  v_mfma_f32_16x16x32_bf16 v[60:63], v[168:171], v[184:187], v[60:63]
  ds_read_b64_tr_b16 v[168:169], v219 offset:52416
  ds_read_b64_tr_b16 v[170:171], v219 offset:57024
  v_mfma_f32_16x16x32_bf16 v[28:31], v[172:175], v[180:183], v[28:31]
  v_mfma_f32_16x16x32_bf16 v[64:67], v[172:175], v[184:187], v[64:67]
  ds_read_b64_tr_b16 v[172:173], v219 offset:52448
  ds_read_b64_tr_b16 v[174:175], v219 offset:57056
  v_mfma_f32_16x16x32_bf16 v[32:35], v[176:179], v[180:183], v[32:35]
  v_mfma_f32_16x16x32_bf16 v[68:71], v[176:179], v[184:187], v[68:71]
  ds_read_b64_tr_b16 v[176:177], v219 offset:52480
  ds_read_b64_tr_b16 v[178:179], v219 offset:57088
  s_waitcnt vmcnt(10)
  s_waitcnt lgkmcnt(0)
  s_barrier
  ds_read_b128 v[180:183], v220 offset:0
  ds_read_b128 v[184:187], v220 offset:1024
  v_mfma_f32_16x16x32_bf16 v[0:3], v[144:147], v[188:191], v[0:3]
  s_add_u32 m0, s52, 52224
  s_nop 0
  buffer_load_dwordx4 v212, s[32:35], s26 offen offset:0 lds
  v_mfma_f32_16x16x32_bf16 v[36:39], v[144:147], v[192:195], v[36:39]
  ds_read_b64_tr_b16 v[144:145], v219 offset:0
  ds_read_b64_tr_b16 v[146:147], v219 offset:4608
  v_mfma_f32_16x16x32_bf16 v[4:7], v[148:151], v[188:191], v[4:7]
  buffer_load_dwordx4 v213, s[32:35], s26 offen offset:1024 lds
  v_mfma_f32_16x16x32_bf16 v[40:43], v[148:151], v[192:195], v[40:43]
  ds_read_b64_tr_b16 v[148:149], v219 offset:32
  ds_read_b64_tr_b16 v[150:151], v219 offset:4640
  v_mfma_f32_16x16x32_bf16 v[8:11], v[152:155], v[188:191], v[8:11]
  s_mov_b64 exec, 0xffff
  buffer_load_dwordx4 v214, s[32:35], s26 offen offset:2048 lds
  s_mov_b64 exec, -1
  s_add_u32 s26, s26, 110592
  v_mfma_f32_16x16x32_bf16 v[44:47], v[152:155], v[192:195], v[44:47]
  ds_read_b64_tr_b16 v[152:153], v219 offset:64
  ds_read_b64_tr_b16 v[154:155], v219 offset:4672
  v_mfma_f32_16x16x32_bf16 v[12:15], v[156:159], v[188:191], v[12:15]
  s_add_u32 m0, s53, 52224
  s_nop 0
  buffer_load_dwordx4 v217, s[28:31], s44 offen offset:0 lds
  v_mfma_f32_16x16x32_bf16 v[48:51], v[156:159], v[192:195], v[48:51]
  ds_read_b64_tr_b16 v[156:157], v219 offset:96
  ds_read_b64_tr_b16 v[158:159], v219 offset:4704
  v_mfma_f32_16x16x32_bf16 v[16:19], v[160:163], v[188:191], v[16:19]
  buffer_load_dwordx4 v218, s[28:31], s44 offen offset:1024 lds
  s_add_u32 s44, s44, 64
  v_mfma_f32_16x16x32_bf16 v[52:55], v[160:163], v[192:195], v[52:55]
  ds_read_b64_tr_b16 v[160:161], v219 offset:128
  ds_read_b64_tr_b16 v[162:163], v219 offset:4736
  v_mfma_f32_16x16x32_bf16 v[20:23], v[164:167], v[188:191], v[20:23]
  v_mfma_f32_16x16x32_bf16 v[56:59], v[164:167], v[192:195], v[56:59]
  ds_read_b64_tr_b16 v[164:165], v219 offset:160
  ds_read_b64_tr_b16 v[166:167], v219 offset:4768
  v_mfma_f32_16x16x32_bf16 v[24:27], v[168:171], v[188:191], v[24:27]
  v_mfma_f32_16x16x32_bf16 v[60:63], v[168:171], v[192:195], v[60:63]
  ds_read_b64_tr_b16 v[168:169], v219 offset:192
  ds_read_b64_tr_b16 v[170:171], v219 offset:4800
  v_mfma_f32_16x16x32_bf16 v[28:31], v[172:175], v[188:191], v[28:31]
  v_mfma_f32_16x16x32_bf16 v[64:67], v[172:175], v[192:195], v[64:67]
  ds_read_b64_tr_b16 v[172:173], v219 offset:224
  ds_read_b64_tr_b16 v[174:175], v219 offset:4832
  v_mfma_f32_16x16x32_bf16 v[32:35], v[176:179], v[188:191], v[32:35]
  v_mfma_f32_16x16x32_bf16 v[68:71], v[176:179], v[192:195], v[68:71]
  ds_read_b64_tr_b16 v[176:177], v219 offset:256
  ds_read_b64_tr_b16 v[178:179], v219 offset:4864
  s_waitcnt vmcnt(10)
  s_waitcnt lgkmcnt(0)
  s_barrier
  ds_read_b128 v[188:191], v220 offset:17408
  ds_read_b128 v[192:195], v220 offset:18432
  v_mfma_f32_16x16x32_bf16 v[0:3], v[144:147], v[180:183], v[0:3]
  s_add_u32 m0, s52, 0
  s_nop 0
  buffer_load_dwordx4 v212, s[32:35], s26 offen offset:0 lds
  v_mfma_f32_16x16x32_bf16 v[36:39], v[144:147], v[184:187], v[36:39]
  ds_read_b64_tr_b16 v[144:145], v219 offset:17408
  ds_read_b64_tr_b16 v[146:147], v219 offset:22016
  v_mfma_f32_16x16x32_bf16 v[4:7], v[148:151], v[180:183], v[4:7]
  buffer_load_dwordx4 v213, s[32:35], s26 offen offset:1024 lds
  v_mfma_f32_16x16x32_bf16 v[40:43], v[148:151], v[184:187], v[40:43]
  ds_read_b64_tr_b16 v[148:149], v219 offset:17440
  ds_read_b64_tr_b16 v[150:151], v219 offset:22048
  v_mfma_f32_16x16x32_bf16 v[8:11], v[152:155], v[180:183], v[8:11]
  s_mov_b64 exec, 0xffff
  buffer_load_dwordx4 v214, s[32:35], s26 offen offset:2048 lds
  s_mov_b64 exec, -1
  s_add_u32 s26, s26, 110592
  v_mfma_f32_16x16x32_bf16 v[44:47], v[152:155], v[184:187], v[44:47]
  ds_read_b64_tr_b16 v[152:153], v219 offset:17472
  ds_read_b64_tr_b16 v[154:155], v219 offset:22080
  v_mfma_f32_16x16x32_bf16 v[12:15], v[156:159], v[180:183], v[12:15]
  s_add_u32 m0, s53, 0
  s_nop 0
  buffer_load_dwordx4 v217, s[28:31], s44 offen offset:0 lds
  v_mfma_f32_16x16x32_bf16 v[48:51], v[156:159], v[184:187], v[48:51]
  ds_read_b64_tr_b16 v[156:157], v219 offset:17504
  ds_read_b64_tr_b16 v[158:159], v219 offset:22112
  v_mfma_f32_16x16x32_bf16 v[16:19], v[160:163], v[180:183], v[16:19]
  buffer_load_dwordx4 v218, s[28:31], s44 offen offset:1024 lds
  s_add_u32 s44, s44, 64
  v_mfma_f32_16x16x32_bf16 v[52:55], v[160:163], v[184:187], v[52:55]
  ds_read_b64_tr_b16 v[160:161], v219 offset:17536
  ds_read_b64_tr_b16 v[162:163], v219 offset:22144
  v_mfma_f32_16x16x32_bf16 v[20:23], v[164:167], v[180:183], v[20:23]
  v_mfma_f32_16x16x32_bf16 v[56:59], v[164:167], v[184:187], v[56:59]
  ds_read_b64_tr_b16 v[164:165], v219 offset:17568
  ds_read_b64_tr_b16 v[166:167], v219 offset:22176
  v_mfma_f32_16x16x32_bf16 v[24:27], v[168:171], v[180:183], v[24:27]
  v_mfma_f32_16x16x32_bf16 v[60:63], v[168:171], v[184:187], v[60:63]
  ds_read_b64_tr_b16 v[168:169], v219 offset:17600
  ds_read_b64_tr_b16 v[170:171], v219 offset:22208
  v_mfma_f32_16x16x32_bf16 v[28:31], v[172:175], v[180:183], v[28:31]
  v_mfma_f32_16x16x32_bf16 v[64:67], v[172:175], v[184:187], v[64:67]
  ds_read_b64_tr_b16 v[172:173], v219 offset:17632
  ds_read_b64_tr_b16 v[174:175], v219 offset:22240
  v_mfma_f32_16x16x32_bf16 v[32:35], v[176:179], v[180:183], v[32:35]
  v_mfma_f32_16x16x32_bf16 v[68:71], v[176:179], v[184:187], v[68:71]
  ds_read_b64_tr_b16 v[176:177], v219 offset:17664
  ds_read_b64_tr_b16 v[178:179], v219 offset:22272
  s_waitcnt vmcnt(10)
  s_waitcnt lgkmcnt(0)
  s_barrier
  ds_read_b128 v[180:183], v220 offset:34816
  ds_read_b128 v[184:187], v220 offset:35840
  v_mfma_f32_16x16x32_bf16 v[0:3], v[144:147], v[188:191], v[0:3]
  s_add_u32 m0, s52, 17408
  s_nop 0
  buffer_load_dwordx4 v212, s[32:35], s26 offen offset:0 lds
  v_mfma_f32_16x16x32_bf16 v[36:39], v[144:147], v[192:195], v[36:39]
  ds_read_b64_tr_b16 v[144:145], v219 offset:34816
  ds_read_b64_tr_b16 v[146:147], v219 offset:39424
  v_mfma_f32_16x16x32_bf16 v[4:7], v[148:151], v[188:191], v[4:7]
  buffer_load_dwordx4 v213, s[32:35], s26 offen offset:1024 lds
  v_mfma_f32_16x16x32_bf16 v[40:43], v[148:151], v[192:195], v[40:43]
  ds_read_b64_tr_b16 v[148:149], v219 offset:34848
  ds_read_b64_tr_b16 v[150:151], v219 offset:39456
  v_mfma_f32_16x16x32_bf16 v[8:11], v[152:155], v[188:191], v[8:11]
  s_mov_b64 exec, 0xffff
  buffer_load_dwordx4 v214, s[32:35], s26 offen offset:2048 lds
  s_mov_b64 exec, -1
  s_add_u32 s26, s26, 110592
  v_mfma_f32_16x16x32_bf16 v[44:47], v[152:155], v[192:195], v[44:47]
  ds_read_b64_tr_b16 v[152:153], v219 offset:34880
  ds_read_b64_tr_b16 v[154:155], v219 offset:39488
  v_mfma_f32_16x16x32_bf16 v[12:15], v[156:159], v[188:191], v[12:15]
  s_add_u32 m0, s53, 17408
  s_nop 0
  buffer_load_dwordx4 v217, s[28:31], s44 offen offset:0 lds
  v_mfma_f32_16x16x32_bf16 v[48:51], v[156:159], v[192:195], v[48:51]
  ds_read_b64_tr_b16 v[156:157], v219 offset:34912
  ds_read_b64_tr_b16 v[158:159], v219 offset:39520
  v_mfma_f32_16x16x32_bf16 v[16:19], v[160:163], v[188:191], v[16:19]
  buffer_load_dwordx4 v218, s[28:31], s44 offen offset:1024 lds
  s_add_u32 s44, s44, 64
  v_mfma_f32_16x16x32_bf16 v[52:55], v[160:163], v[192:195], v[52:55]
  ds_read_b64_tr_b16 v[160:161], v219 offset:34944
  ds_read_b64_tr_b16 v[162:163], v219 offset:39552
  v_mfma_f32_16x16x32_bf16 v[20:23], v[164:167], v[188:191], v[20:23]
  v_mfma_f32_16x16x32_bf16 v[56:59], v[164:167], v[192:195], v[56:59]
  ds_read_b64_tr_b16 v[164:165], v219 offset:34976
  ds_read_b64_tr_b16 v[166:167], v219 offset:39584
  v_mfma_f32_16x16x32_bf16 v[24:27], v[168:171], v[188:191], v[24:27]
  v_mfma_f32_16x16x32_bf16 v[60:63], v[168:171], v[192:195], v[60:63]
  ds_read_b64_tr_b16 v[168:169], v219 offset:35008
  ds_read_b64_tr_b16 v[170:171], v219 offset:39616
  v_mfma_f32_16x16x32_bf16 v[28:31], v[172:175], v[188:191], v[28:31]
  v_mfma_f32_16x16x32_bf16 v[64:67], v[172:175], v[192:195], v[64:67]
  ds_read_b64_tr_b16 v[172:173], v219 offset:35040
  ds_read_b64_tr_b16 v[174:175], v219 offset:39648
  v_mfma_f32_16x16x32_bf16 v[32:35], v[176:179], v[188:191], v[32:35]
  v_mfma_f32_16x16x32_bf16 v[68:71], v[176:179], v[192:195], v[68:71]
  ds_read_b64_tr_b16 v[176:177], v219 offset:35072
  ds_read_b64_tr_b16 v[178:179], v219 offset:39680
  s_waitcnt vmcnt(10)
  s_waitcnt lgkmcnt(0)
  s_barrier
  ds_read_b128 v[188:191], v220 offset:52224
  ds_read_b128 v[192:195], v220 offset:53248
  v_mfma_f32_16x16x32_bf16 v[0:3], v[144:147], v[180:183], v[0:3]
  s_add_u32 m0, s52, 34816
  s_nop 0
  buffer_load_dwordx4 v212, s[32:35], s26 offen offset:0 lds
  v_mfma_f32_16x16x32_bf16 v[36:39], v[144:147], v[184:187], v[36:39]
  ds_read_b64_tr_b16 v[144:145], v219 offset:52224
  ds_read_b64_tr_b16 v[146:147], v219 offset:56832
  v_mfma_f32_16x16x32_bf16 v[4:7], v[148:151], v[180:183], v[4:7]
  buffer_load_dwordx4 v213, s[32:35], s26 offen offset:1024 lds
  v_mfma_f32_16x16x32_bf16 v[40:43], v[148:151], v[184:187], v[40:43]
  ds_read_b64_tr_b16 v[148:149], v219 offset:52256
  ds_read_b64_tr_b16 v[150:151], v219 offset:56864
  v_mfma_f32_16x16x32_bf16 v[8:11], v[152:155], v[180:183], v[8:11]
  s_mov_b64 exec, 0xffff
  buffer_load_dwordx4 v214, s[32:35], s26 offen offset:2048 lds
  s_mov_b64 exec, -1
  s_add_u32 s26, s26, 110592
  v_mfma_f32_16x16x32_bf16 v[44:47], v[152:155], v[184:187], v[44:47]
  ds_read_b64_tr_b16 v[152:153], v219 offset:52288
  ds_read_b64_tr_b16 v[154:155], v219 offset:56896
  v_mfma_f32_16x16x32_bf16 v[12:15], v[156:159], v[180:183], v[12:15]
  s_add_u32 m0, s53, 34816
  s_nop 0
  buffer_load_dwordx4 v217, s[28:31], s44 offen offset:0 lds
  v_mfma_f32_16x16x32_bf16 v[48:51], v[156:159], v[184:187], v[48:51]
  ds_read_b64_tr_b16 v[156:157], v219 offset:52320
  ds_read_b64_tr_b16 v[158:159], v219 offset:56928
  v_mfma_f32_16x16x32_bf16 v[16:19], v[160:163], v[180:183], v[16:19]
  buffer_load_dwordx4 v218, s[28:31], s44 offen offset:1024 lds
  s_add_u32 s44, s44, 64
  v_mfma_f32_16x16x32_bf16 v[52:55], v[160:163], v[184:187], v[52:55]
  ds_read_b64_tr_b16 v[160:161], v219 offset:52352
  ds_read_b64_tr_b16 v[162:163], v219 offset:56960
  v_mfma_f32_16x16x32_bf16 v[20:23], v[164:167], v[180:183], v[20:23]
  v_mfma_f32_16x16x32_bf16 v[56:59], v[164:167], v[184:187], v[56:59]
  ds_read_b64_tr_b16 v[164:165], v219 offset:52384
  ds_read_b64_tr_b16 v[166:167], v219 offset:56992
  v_mfma_f32_16x16x32_bf16 v[24:27], v[168:171], v[180:183], v[24:27]
  v_mfma_f32_16x16x32_bf16 v[60:63], v[168:171], v[184:187], v[60:63]
  ds_read_b64_tr_b16 v[168:169], v219 offset:52416
  ds_read_b64_tr_b16 v[170:171], v219 offset:57024
  v_mfma_f32_16x16x32_bf16 v[28:31], v[172:175], v[180:183], v[28:31]
  v_mfma_f32_16x16x32_bf16 v[64:67], v[172:175], v[184:187], v[64:67]
  ds_read_b64_tr_b16 v[172:173], v219 offset:52448
  ds_read_b64_tr_b16 v[174:175], v219 offset:57056
  v_mfma_f32_16x16x32_bf16 v[32:35], v[176:179], v[180:183], v[32:35]
  v_mfma_f32_16x16x32_bf16 v[68:71], v[176:179], v[184:187], v[68:71]
  ds_read_b64_tr_b16 v[176:177], v219 offset:52480
  ds_read_b64_tr_b16 v[178:179], v219 offset:57088
  s_waitcnt vmcnt(10)
  s_waitcnt lgkmcnt(0)
  s_barrier
  ds_read_b128 v[180:183], v220 offset:0
  ds_read_b128 v[184:187], v220 offset:1024
  v_mfma_f32_16x16x32_bf16 v[0:3], v[144:147], v[188:191], v[0:3]
  s_add_u32 m0, s52, 52224
  s_nop 0
  buffer_load_dwordx4 v212, s[32:35], s26 offen offset:0 lds
  v_mfma_f32_16x16x32_bf16 v[36:39], v[144:147], v[192:195], v[36:39]
  ds_read_b64_tr_b16 v[144:145], v219 offset:0
  ds_read_b64_tr_b16 v[146:147], v219 offset:4608
  v_mfma_f32_16x16x32_bf16 v[4:7], v[148:151], v[188:191], v[4:7]
  buffer_load_dwordx4 v213, s[32:35], s26 offen offset:1024 lds
  v_mfma_f32_16x16x32_bf16 v[40:43], v[148:151], v[192:195], v[40:43]
  ds_read_b64_tr_b16 v[148:149], v219 offset:32
  ds_read_b64_tr_b16 v[150:151], v219 offset:4640
  v_mfma_f32_16x16x32_bf16 v[8:11], v[152:155], v[188:191], v[8:11]
  s_mov_b64 exec, 0xffff
  buffer_load_dwordx4 v214, s[32:35], s26 offen offset:2048 lds
  s_mov_b64 exec, -1
  s_add_u32 s26, s26, 110592
  v_mfma_f32_16x16x32_bf16 v[44:47], v[152:155], v[192:195], v[44:47]
  ds_read_b64_tr_b16 v[152:153], v219 offset:64
  ds_read_b64_tr_b16 v[154:155], v219 offset:4672
  v_mfma_f32_16x16x32_bf16 v[12:15], v[156:159], v[188:191], v[12:15]
  s_add_u32 m0, s53, 52224
  s_nop 0
  buffer_load_dwordx4 v217, s[28:31], s44 offen offset:0 lds
  v_mfma_f32_16x16x32_bf16 v[48:51], v[156:159], v[192:195], v[48:51]
  ds_read_b64_tr_b16 v[156:157], v219 offset:96
  ds_read_b64_tr_b16 v[158:159], v219 offset:4704
  v_mfma_f32_16x16x32_bf16 v[16:19], v[160:163], v[188:191], v[16:19]
  buffer_load_dwordx4 v218, s[28:31], s44 offen offset:1024 lds
  s_add_u32 s44, s44, 64
  v_mfma_f32_16x16x32_bf16 v[52:55], v[160:163], v[192:195], v[52:55]
  ds_read_b64_tr_b16 v[160:161], v219 offset:128
  ds_read_b64_tr_b16 v[162:163], v219 offset:4736
  v_mfma_f32_16x16x32_bf16 v[20:23], v[164:167], v[188:191], v[20:23]
  v_mfma_f32_16x16x32_bf16 v[56:59], v[164:167], v[192:195], v[56:59]
  ds_read_b64_tr_b16 v[164:165], v219 offset:160
  ds_read_b64_tr_b16 v[166:167], v219 offset:4768
  v_mfma_f32_16x16x32_bf16 v[24:27], v[168:171], v[188:191], v[24:27]
  v_mfma_f32_16x16x32_bf16 v[60:63], v[168:171], v[192:195], v[60:63]
  ds_read_b64_tr_b16 v[168:169], v219 offset:192
  ds_read_b64_tr_b16 v[170:171], v219 offset:4800
  v_mfma_f32_16x16x32_bf16 v[28:31], v[172:175], v[188:191], v[28:31]
  v_mfma_f32_16x16x32_bf16 v[64:67], v[172:175], v[192:195], v[64:67]
  ds_read_b64_tr_b16 v[172:173], v219 offset:224
  ds_read_b64_tr_b16 v[174:175], v219 offset:4832
  v_mfma_f32_16x16x32_bf16 v[32:35], v[176:179], v[188:191], v[32:35]
  v_mfma_f32_16x16x32_bf16 v[68:71], v[176:179], v[192:195], v[68:71]
  ds_read_b64_tr_b16 v[176:177], v219 offset:256
  ds_read_b64_tr_b16 v[178:179], v219 offset:4864
  s_waitcnt vmcnt(10)
  s_waitcnt lgkmcnt(0)
  s_barrier
  ds_read_b128 v[188:191], v220 offset:17408
  ds_read_b128 v[192:195], v220 offset:18432
  v_mfma_f32_16x16x32_bf16 v[0:3], v[144:147], v[180:183], v[0:3]
  s_add_u32 m0, s52, 0
  s_nop 0
  buffer_load_dwordx4 v212, s[32:35], s26 offen offset:0 lds
  v_mfma_f32_16x16x32_bf16 v[36:39], v[144:147], v[184:187], v[36:39]
  ds_read_b64_tr_b16 v[144:145], v219 offset:17408
  ds_read_b64_tr_b16 v[146:147], v219 offset:22016
  v_mfma_f32_16x16x32_bf16 v[4:7], v[148:151], v[180:183], v[4:7]
  buffer_load_dwordx4 v213, s[32:35], s26 offen offset:1024 lds
  v_mfma_f32_16x16x32_bf16 v[40:43], v[148:151], v[184:187], v[40:43]
  ds_read_b64_tr_b16 v[148:149], v219 offset:17440
  ds_read_b64_tr_b16 v[150:151], v219 offset:22048
  v_mfma_f32_16x16x32_bf16 v[8:11], v[152:155], v[180:183], v[8:11]
  s_mov_b64 exec, 0xffff
  buffer_load_dwordx4 v214, s[32:35], s26 offen offset:2048 lds
  s_mov_b64 exec, -1
  s_add_u32 s26, s26, 110592
  v_mfma_f32_16x16x32_bf16 v[44:47], v[152:155], v[184:187], v[44:47]
  ds_read_b64_tr_b16 v[152:153], v219 offset:17472
  ds_read_b64_tr_b16 v[154:155], v219 offset:22080
  v_mfma_f32_16x16x32_bf16 v[12:15], v[156:159], v[180:183], v[12:15]
  s_add_u32 m0, s53, 0
  s_nop 0
  buffer_load_dwordx4 v217, s[28:31], s44 offen offset:0 lds
  v_mfma_f32_16x16x32_bf16 v[48:51], v[156:159], v[184:187], v[48:51]
  ds_read_b64_tr_b16 v[156:157], v219 offset:17504
  ds_read_b64_tr_b16 v[158:159], v219 offset:22112
  v_mfma_f32_16x16x32_bf16 v[16:19], v[160:163], v[180:183], v[16:19]
  buffer_load_dwordx4 v218, s[28:31], s44 offen offset:1024 lds
  s_add_u32 s44, s44, 64
  v_mfma_f32_16x16x32_bf16 v[52:55], v[160:163], v[184:187], v[52:55]
  ds_read_b64_tr_b16 v[160:161], v219 offset:17536
  ds_read_b64_tr_b16 v[162:163], v219 offset:22144
  v_mfma_f32_16x16x32_bf16 v[20:23], v[164:167], v[180:183], v[20:23]
  v_mfma_f32_16x16x32_bf16 v[56:59], v[164:167], v[184:187], v[56:59]
  ds_read_b64_tr_b16 v[164:165], v219 offset:17568
  ds_read_b64_tr_b16 v[166:167], v219 offset:22176
  v_mfma_f32_16x16x32_bf16 v[24:27], v[168:171], v[180:183], v[24:27]
  v_mfma_f32_16x16x32_bf16 v[60:63], v[168:171], v[184:187], v[60:63]
  ds_read_b64_tr_b16 v[168:169], v219 offset:17600
  ds_read_b64_tr_b16 v[170:171], v219 offset:22208
  v_mfma_f32_16x16x32_bf16 v[28:31], v[172:175], v[180:183], v[28:31]
  v_mfma_f32_16x16x32_bf16 v[64:67], v[172:175], v[184:187], v[64:67]
  ds_read_b64_tr_b16 v[172:173], v219 offset:17632
  ds_read_b64_tr_b16 v[174:175], v219 offset:22240
  v_mfma_f32_16x16x32_bf16 v[32:35], v[176:179], v[180:183], v[32:35]
  v_mfma_f32_16x16x32_bf16 v[68:71], v[176:179], v[184:187], v[68:71]
  ds_read_b64_tr_b16 v[176:177], v219 offset:17664
  ds_read_b64_tr_b16 v[178:179], v219 offset:22272
  s_waitcnt vmcnt(10)
  s_waitcnt lgkmcnt(0)
  s_barrier
  ds_read_b128 v[180:183], v220 offset:34816
  ds_read_b128 v[184:187], v220 offset:35840
  v_mfma_f32_16x16x32_bf16 v[0:3], v[144:147], v[188:191], v[0:3]
  s_add_u32 m0, s52, 17408
  s_nop 0
  buffer_load_dwordx4 v212, s[32:35], s26 offen offset:0 lds
  v_mfma_f32_16x16x32_bf16 v[36:39], v[144:147], v[192:195], v[36:39]
  ds_read_b64_tr_b16 v[144:145], v219 offset:34816
  ds_read_b64_tr_b16 v[146:147], v219 offset:39424
  v_mfma_f32_16x16x32_bf16 v[4:7], v[148:151], v[188:191], v[4:7]
  buffer_load_dwordx4 v213, s[32:35], s26 offen offset:1024 lds
  v_mfma_f32_16x16x32_bf16 v[40:43], v[148:151], v[192:195], v[40:43]
  ds_read_b64_tr_b16 v[148:149], v219 offset:34848
  ds_read_b64_tr_b16 v[150:151], v219 offset:39456
  v_mfma_f32_16x16x32_bf16 v[8:11], v[152:155], v[188:191], v[8:11]
  s_mov_b64 exec, 0xffff
  buffer_load_dwordx4 v214, s[32:35], s26 offen offset:2048 lds
  s_mov_b64 exec, -1
  s_add_u32 s26, s26, 110592
  v_mfma_f32_16x16x32_bf16 v[44:47], v[152:155], v[192:195], v[44:47]
  ds_read_b64_tr_b16 v[152:153], v219 offset:34880
  ds_read_b64_tr_b16 v[154:155], v219 offset:39488
  v_mfma_f32_16x16x32_bf16 v[12:15], v[156:159], v[188:191], v[12:15]
  s_add_u32 m0, s53, 17408
  s_nop 0
  buffer_load_dwordx4 v217, s[28:31], s44 offen offset:0 lds
  v_mfma_f32_16x16x32_bf16 v[48:51], v[156:159], v[192:195], v[48:51]
  ds_read_b64_tr_b16 v[156:157], v219 offset:34912
  ds_read_b64_tr_b16 v[158:159], v219 offset:39520
  v_mfma_f32_16x16x32_bf16 v[16:19], v[160:163], v[188:191], v[16:19]
  buffer_load_dwordx4 v218, s[28:31], s44 offen offset:1024 lds
  s_add_u32 s44, s44, 64
  v_mfma_f32_16x16x32_bf16 v[52:55], v[160:163], v[192:195], v[52:55]
  ds_read_b64_tr_b16 v[160:161], v219 offset:34944
  ds_read_b64_tr_b16 v[162:163], v219 offset:39552
  v_mfma_f32_16x16x32_bf16 v[20:23], v[164:167], v[188:191], v[20:23]
  v_mfma_f32_16x16x32_bf16 v[56:59], v[164:167], v[192:195], v[56:59]
  ds_read_b64_tr_b16 v[164:165], v219 offset:34976
  ds_read_b64_tr_b16 v[166:167], v219 offset:39584
  v_mfma_f32_16x16x32_bf16 v[24:27], v[168:171], v[188:191], v[24:27]
  v_mfma_f32_16x16x32_bf16 v[60:63], v[168:171], v[192:195], v[60:63]
  ds_read_b64_tr_b16 v[168:169], v219 offset:35008
  ds_read_b64_tr_b16 v[170:171], v219 offset:39616
  v_mfma_f32_16x16x32_bf16 v[28:31], v[172:175], v[188:191], v[28:31]
  v_mfma_f32_16x16x32_bf16 v[64:67], v[172:175], v[192:195], v[64:67]
  ds_read_b64_tr_b16 v[172:173], v219 offset:35040
  ds_read_b64_tr_b16 v[174:175], v219 offset:39648
  v_mfma_f32_16x16x32_bf16 v[32:35], v[176:179], v[188:191], v[32:35]
  v_mfma_f32_16x16x32_bf16 v[68:71], v[176:179], v[192:195], v[68:71]
  ds_read_b64_tr_b16 v[176:177], v219 offset:35072
  ds_read_b64_tr_b16 v[178:179], v219 offset:39680
  s_waitcnt vmcnt(10)
  s_waitcnt lgkmcnt(0)
  s_barrier
  ds_read_b128 v[188:191], v220 offset:52224
  ds_read_b128 v[192:195], v220 offset:53248
  v_mfma_f32_16x16x32_bf16 v[0:3], v[144:147], v[180:183], v[0:3]
  v_mfma_f32_16x16x32_bf16 v[36:39], v[144:147], v[184:187], v[36:39]
  ds_read_b64_tr_b16 v[144:145], v219 offset:52224
  ds_read_b64_tr_b16 v[146:147], v219 offset:56832
  v_mfma_f32_16x16x32_bf16 v[4:7], v[148:151], v[180:183], v[4:7]
  v_mfma_f32_16x16x32_bf16 v[40:43], v[148:151], v[184:187], v[40:43]
  ds_read_b64_tr_b16 v[148:149], v219 offset:52256
  ds_read_b64_tr_b16 v[150:151], v219 offset:56864
  v_mfma_f32_16x16x32_bf16 v[8:11], v[152:155], v[180:183], v[8:11]
  v_mfma_f32_16x16x32_bf16 v[44:47], v[152:155], v[184:187], v[44:47]
  ds_read_b64_tr_b16 v[152:153], v219 offset:52288
  ds_read_b64_tr_b16 v[154:155], v219 offset:56896
  v_mfma_f32_16x16x32_bf16 v[12:15], v[156:159], v[180:183], v[12:15]
  v_mfma_f32_16x16x32_bf16 v[48:51], v[156:159], v[184:187], v[48:51]
  ds_read_b64_tr_b16 v[156:157], v219 offset:52320
  ds_read_b64_tr_b16 v[158:159], v219 offset:56928
  v_mfma_f32_16x16x32_bf16 v[16:19], v[160:163], v[180:183], v[16:19]
  v_mfma_f32_16x16x32_bf16 v[52:55], v[160:163], v[184:187], v[52:55]
  ds_read_b64_tr_b16 v[160:161], v219 offset:52352
  ds_read_b64_tr_b16 v[162:163], v219 offset:56960
  v_mfma_f32_16x16x32_bf16 v[20:23], v[164:167], v[180:183], v[20:23]
  v_mfma_f32_16x16x32_bf16 v[56:59], v[164:167], v[184:187], v[56:59]
  ds_read_b64_tr_b16 v[164:165], v219 offset:52384
  ds_read_b64_tr_b16 v[166:167], v219 offset:56992
  v_mfma_f32_16x16x32_bf16 v[24:27], v[168:171], v[180:183], v[24:27]
  v_mfma_f32_16x16x32_bf16 v[60:63], v[168:171], v[184:187], v[60:63]
  ds_read_b64_tr_b16 v[168:169], v219 offset:52416
  ds_read_b64_tr_b16 v[170:171], v219 offset:57024
  v_mfma_f32_16x16x32_bf16 v[28:31], v[172:175], v[180:183], v[28:31]
  v_mfma_f32_16x16x32_bf16 v[64:67], v[172:175], v[184:187], v[64:67]
  ds_read_b64_tr_b16 v[172:173], v219 offset:52448
  ds_read_b64_tr_b16 v[174:175], v219 offset:57056
  v_mfma_f32_16x16x32_bf16 v[32:35], v[176:179], v[180:183], v[32:35]
  v_mfma_f32_16x16x32_bf16 v[68:71], v[176:179], v[184:187], v[68:71]
  ds_read_b64_tr_b16 v[176:177], v219 offset:52480
  ds_read_b64_tr_b16 v[178:179], v219 offset:57088
  s_waitcnt vmcnt(5)
  s_waitcnt lgkmcnt(0)
  s_barrier
  ds_read_b128 v[180:183], v220 offset:0
  ds_read_b128 v[184:187], v220 offset:1024
  v_mfma_f32_16x16x32_bf16 v[0:3], v[144:147], v[188:191], v[0:3]
  v_mfma_f32_16x16x32_bf16 v[36:39], v[144:147], v[192:195], v[36:39]
  ds_read_b64_tr_b16 v[144:145], v219 offset:0
  ds_read_b64_tr_b16 v[146:147], v219 offset:4608
  v_mfma_f32_16x16x32_bf16 v[4:7], v[148:151], v[188:191], v[4:7]
  v_mfma_f32_16x16x32_bf16 v[40:43], v[148:151], v[192:195], v[40:43]
  ds_read_b64_tr_b16 v[148:149], v219 offset:32
  ds_read_b64_tr_b16 v[150:151], v219 offset:4640
  v_mfma_f32_16x16x32_bf16 v[8:11], v[152:155], v[188:191], v[8:11]
  v_mfma_f32_16x16x32_bf16 v[44:47], v[152:155], v[192:195], v[44:47]
  ds_read_b64_tr_b16 v[152:153], v219 offset:64
  ds_read_b64_tr_b16 v[154:155], v219 offset:4672
  v_mfma_f32_16x16x32_bf16 v[12:15], v[156:159], v[188:191], v[12:15]
  v_mfma_f32_16x16x32_bf16 v[48:51], v[156:159], v[192:195], v[48:51]
  ds_read_b64_tr_b16 v[156:157], v219 offset:96
  ds_read_b64_tr_b16 v[158:159], v219 offset:4704
  v_mfma_f32_16x16x32_bf16 v[16:19], v[160:163], v[188:191], v[16:19]
  v_mfma_f32_16x16x32_bf16 v[52:55], v[160:163], v[192:195], v[52:55]
  ds_read_b64_tr_b16 v[160:161], v219 offset:128
  ds_read_b64_tr_b16 v[162:163], v219 offset:4736
  v_mfma_f32_16x16x32_bf16 v[20:23], v[164:167], v[188:191], v[20:23]
  v_mfma_f32_16x16x32_bf16 v[56:59], v[164:167], v[192:195], v[56:59]
  ds_read_b64_tr_b16 v[164:165], v219 offset:160
  ds_read_b64_tr_b16 v[166:167], v219 offset:4768
  v_mfma_f32_16x16x32_bf16 v[24:27], v[168:171], v[188:191], v[24:27]
  v_mfma_f32_16x16x32_bf16 v[60:63], v[168:171], v[192:195], v[60:63]
  ds_read_b64_tr_b16 v[168:169], v219 offset:192
  ds_read_b64_tr_b16 v[170:171], v219 offset:4800
  v_mfma_f32_16x16x32_bf16 v[28:31], v[172:175], v[188:191], v[28:31]
  v_mfma_f32_16x16x32_bf16 v[64:67], v[172:175], v[192:195], v[64:67]
  ds_read_b64_tr_b16 v[172:173], v219 offset:224
  ds_read_b64_tr_b16 v[174:175], v219 offset:4832
  v_mfma_f32_16x16x32_bf16 v[32:35], v[176:179], v[188:191], v[32:35]
  v_mfma_f32_16x16x32_bf16 v[68:71], v[176:179], v[192:195], v[68:71]
  ds_read_b64_tr_b16 v[176:177], v219 offset:256
  ds_read_b64_tr_b16 v[178:179], v219 offset:4864
  s_waitcnt vmcnt(0)
  s_waitcnt lgkmcnt(0)
  s_barrier
  ds_read_b128 v[188:191], v220 offset:17408
  ds_read_b128 v[192:195], v220 offset:18432
  v_mfma_f32_16x16x32_bf16 v[0:3], v[144:147], v[180:183], v[0:3]
  v_mfma_f32_16x16x32_bf16 v[36:39], v[144:147], v[184:187], v[36:39]
  ds_read_b64_tr_b16 v[144:145], v219 offset:17408
  ds_read_b64_tr_b16 v[146:147], v219 offset:22016
  v_mfma_f32_16x16x32_bf16 v[4:7], v[148:151], v[180:183], v[4:7]
  v_mfma_f32_16x16x32_bf16 v[40:43], v[148:151], v[184:187], v[40:43]
  ds_read_b64_tr_b16 v[148:149], v219 offset:17440
  ds_read_b64_tr_b16 v[150:151], v219 offset:22048
  v_mfma_f32_16x16x32_bf16 v[8:11], v[152:155], v[180:183], v[8:11]
  v_mfma_f32_16x16x32_bf16 v[44:47], v[152:155], v[184:187], v[44:47]
  ds_read_b64_tr_b16 v[152:153], v219 offset:17472
  ds_read_b64_tr_b16 v[154:155], v219 offset:22080
  v_mfma_f32_16x16x32_bf16 v[12:15], v[156:159], v[180:183], v[12:15]
  v_mfma_f32_16x16x32_bf16 v[48:51], v[156:159], v[184:187], v[48:51]
  ds_read_b64_tr_b16 v[156:157], v219 offset:17504
  ds_read_b64_tr_b16 v[158:159], v219 offset:22112
  v_mfma_f32_16x16x32_bf16 v[16:19], v[160:163], v[180:183], v[16:19]
  v_mfma_f32_16x16x32_bf16 v[52:55], v[160:163], v[184:187], v[52:55]
  ds_read_b64_tr_b16 v[160:161], v219 offset:17536
  ds_read_b64_tr_b16 v[162:163], v219 offset:22144
  v_mfma_f32_16x16x32_bf16 v[20:23], v[164:167], v[180:183], v[20:23]
  v_mfma_f32_16x16x32_bf16 v[56:59], v[164:167], v[184:187], v[56:59]
  ds_read_b64_tr_b16 v[164:165], v219 offset:17568
  ds_read_b64_tr_b16 v[166:167], v219 offset:22176
  v_mfma_f32_16x16x32_bf16 v[24:27], v[168:171], v[180:183], v[24:27]
  v_mfma_f32_16x16x32_bf16 v[60:63], v[168:171], v[184:187], v[60:63]
  ds_read_b64_tr_b16 v[168:169], v219 offset:17600
  ds_read_b64_tr_b16 v[170:171], v219 offset:22208
  v_mfma_f32_16x16x32_bf16 v[28:31], v[172:175], v[180:183], v[28:31]
  v_mfma_f32_16x16x32_bf16 v[64:67], v[172:175], v[184:187], v[64:67]
  ds_read_b64_tr_b16 v[172:173], v219 offset:17632
  ds_read_b64_tr_b16 v[174:175], v219 offset:22240
  v_mfma_f32_16x16x32_bf16 v[32:35], v[176:179], v[180:183], v[32:35]
  v_mfma_f32_16x16x32_bf16 v[68:71], v[176:179], v[184:187], v[68:71]
  ds_read_b64_tr_b16 v[176:177], v219 offset:17664
  ds_read_b64_tr_b16 v[178:179], v219 offset:22272
  s_waitcnt lgkmcnt(0)
  s_barrier
  v_mfma_f32_16x16x32_bf16 v[0:3], v[144:147], v[188:191], v[0:3]
  v_mfma_f32_16x16x32_bf16 v[36:39], v[144:147], v[192:195], v[36:39]
  v_mfma_f32_16x16x32_bf16 v[4:7], v[148:151], v[188:191], v[4:7]
  v_mfma_f32_16x16x32_bf16 v[40:43], v[148:151], v[192:195], v[40:43]
  v_mfma_f32_16x16x32_bf16 v[8:11], v[152:155], v[188:191], v[8:11]
  v_mfma_f32_16x16x32_bf16 v[44:47], v[152:155], v[192:195], v[44:47]
  v_mfma_f32_16x16x32_bf16 v[12:15], v[156:159], v[188:191], v[12:15]
  v_mfma_f32_16x16x32_bf16 v[48:51], v[156:159], v[192:195], v[48:51]
  v_mfma_f32_16x16x32_bf16 v[16:19], v[160:163], v[188:191], v[16:19]
  v_mfma_f32_16x16x32_bf16 v[52:55], v[160:163], v[192:195], v[52:55]
  v_mfma_f32_16x16x32_bf16 v[20:23], v[164:167], v[188:191], v[20:23]
  v_mfma_f32_16x16x32_bf16 v[56:59], v[164:167], v[192:195], v[56:59]
  v_mfma_f32_16x16x32_bf16 v[24:27], v[168:171], v[188:191], v[24:27]
  v_mfma_f32_16x16x32_bf16 v[60:63], v[168:171], v[192:195], v[60:63]
  v_mfma_f32_16x16x32_bf16 v[28:31], v[172:175], v[188:191], v[28:31]
  v_mfma_f32_16x16x32_bf16 v[64:67], v[172:175], v[192:195], v[64:67]
  v_mfma_f32_16x16x32_bf16 v[32:35], v[176:179], v[188:191], v[32:35]
  v_mfma_f32_16x16x32_bf16 v[68:71], v[176:179], v[192:195], v[68:71]
  s_nop 7
  s_nop 1
  s_lshr_b32 s27, s22, 5
  s_cmp_ge_u32 s23, 4
  s_cbranch_scc1 k1_kernel_KEPI
  s_mov_b32 s45, 0x3eae1a93
  v_mul_f32 v0, s45, v0
  v_mul_f32 v1, s45, v1
  v_mul_f32 v2, s45, v2
  v_mul_f32 v3, s45, v3
  v_mul_f32 v4, s45, v4
  v_mul_f32 v5, s45, v5
  v_mul_f32 v6, s45, v6
  v_mul_f32 v7, s45, v7
  v_mul_f32 v8, s45, v8
  v_mul_f32 v9, s45, v9
  v_mul_f32 v10, s45, v10
  v_mul_f32 v11, s45, v11
  v_mul_f32 v12, s45, v12
  v_mul_f32 v13, s45, v13
  v_mul_f32 v14, s45, v14
  v_mul_f32 v15, s45, v15
  v_mul_f32 v16, s45, v16
  v_mul_f32 v17, s45, v17
  v_mul_f32 v18, s45, v18
  v_mul_f32 v19, s45, v19
  v_mul_f32 v20, s45, v20
  v_mul_f32 v21, s45, v21
  v_mul_f32 v22, s45, v22
  v_mul_f32 v23, s45, v23
  v_mul_f32 v24, s45, v24
  v_mul_f32 v25, s45, v25
  v_mul_f32 v26, s45, v26
  v_mul_f32 v27, s45, v27
  v_mul_f32 v28, s45, v28
  v_mul_f32 v29, s45, v29
  v_mul_f32 v30, s45, v30
  v_mul_f32 v31, s45, v31
  v_mul_f32 v32, s45, v32
  v_mul_f32 v33, s45, v33
  v_mul_f32 v34, s45, v34
  v_mul_f32 v35, s45, v35
  v_mul_f32 v36, s45, v36
  v_mul_f32 v37, s45, v37
  v_mul_f32 v38, s45, v38
  v_mul_f32 v39, s45, v39
  v_mul_f32 v40, s45, v40
  v_mul_f32 v41, s45, v41
  v_mul_f32 v42, s45, v42
  v_mul_f32 v43, s45, v43
  v_mul_f32 v44, s45, v44
  v_mul_f32 v45, s45, v45
  v_mul_f32 v46, s45, v46
  v_mul_f32 v47, s45, v47
  v_mul_f32 v48, s45, v48
  v_mul_f32 v49, s45, v49
  v_mul_f32 v50, s45, v50
  v_mul_f32 v51, s45, v51
  v_mul_f32 v52, s45, v52
  v_mul_f32 v53, s45, v53
  v_mul_f32 v54, s45, v54
  v_mul_f32 v55, s45, v55
  v_mul_f32 v56, s45, v56
  v_mul_f32 v57, s45, v57
  v_mul_f32 v58, s45, v58
  v_mul_f32 v59, s45, v59
  v_mul_f32 v60, s45, v60
  v_mul_f32 v61, s45, v61
  v_mul_f32 v62, s45, v62
  v_mul_f32 v63, s45, v63
  v_mul_f32 v64, s45, v64
  v_mul_f32 v65, s45, v65
  v_mul_f32 v66, s45, v66
  v_mul_f32 v67, s45, v67
  v_mul_f32 v68, s45, v68
  v_mul_f32 v69, s45, v69
  v_mul_f32 v70, s45, v70
  v_mul_f32 v71, s45, v71
  s_and_b32 s46, s23, 3
  s_mul_i32 s46, s46, 589824
  s_mul_i32 s47, s27, 1152
  s_add_u32 s46, s46, s47
  v_and_b32 v146, 15, v230
  v_bfe_u32 v147, v230, 4, 2
  v_lshlrev_b32 v147, 2, v147
  s_mov_b32 s47, 73728
  v_add_u32 v148, 0, v147
  v_mul_u32_u24 v149, 57, v148
  v_lshrrev_b32 v149, 10, v149
  v_mul_u32_u24 v150, 18, v149
  v_sub_u32 v148, v148, v150
  v_mul_lo_u32 v149, v149, s47
  v_lshrrev_b32 v150, 3, v148
  v_lshlrev_b32 v150, 9, v150
  v_and_b32 v151, 7, v148
  v_lshl_add_u32 v150, v151, 1, v150
  v_cmp_gt_u32 vcc, 16, v148
  v_mov_b32 v151, 4
  v_mov_b32 v152, 16
  v_cndmask_b32 v151, v151, v152, vcc
  v_mad_u32_u24 v149, v146, v151, v149
  v_add_u32 v149, v149, v150
  v_lshl_add_u32 v150, v151, 4, v149
  v_cvt_pk_bf16_f32 v153, v0, v1
  buffer_store_dword v153, v149, s[36:39], s46 offen
  v_cvt_pk_bf16_f32 v154, v36, v37
  buffer_store_dword v154, v150, s[36:39], s46 offen
  v_add_u32 v148, 2, v147
  v_mul_u32_u24 v149, 57, v148
  v_lshrrev_b32 v149, 10, v149
  v_mul_u32_u24 v150, 18, v149
  v_sub_u32 v148, v148, v150
  v_mul_lo_u32 v149, v149, s47
  v_lshrrev_b32 v150, 3, v148
  v_lshlrev_b32 v150, 9, v150
  v_and_b32 v151, 7, v148
  v_lshl_add_u32 v150, v151, 1, v150
  v_cmp_gt_u32 vcc, 16, v148
  v_mov_b32 v151, 4
  v_mov_b32 v152, 16
  v_cndmask_b32 v151, v151, v152, vcc
  v_mad_u32_u24 v149, v146, v151, v149
  v_add_u32 v149, v149, v150
  v_lshl_add_u32 v150, v151, 4, v149
  v_cvt_pk_bf16_f32 v153, v2, v3
  buffer_store_dword v153, v149, s[36:39], s46 offen
  v_cvt_pk_bf16_f32 v154, v38, v39
  buffer_store_dword v154, v150, s[36:39], s46 offen
  v_add_u32 v148, 16, v147
  v_mul_u32_u24 v149, 57, v148
  v_lshrrev_b32 v149, 10, v149
  v_mul_u32_u24 v150, 18, v149
  v_sub_u32 v148, v148, v150
  v_mul_lo_u32 v149, v149, s47
  v_lshrrev_b32 v150, 3, v148
  v_lshlrev_b32 v150, 9, v150
  v_and_b32 v151, 7, v148
  v_lshl_add_u32 v150, v151, 1, v150
  v_cmp_gt_u32 vcc, 16, v148
  v_mov_b32 v151, 4
  v_mov_b32 v152, 16
  v_cndmask_b32 v151, v151, v152, vcc
  v_mad_u32_u24 v149, v146, v151, v149
  v_add_u32 v149, v149, v150
  v_lshl_add_u32 v150, v151, 4, v149
  v_cvt_pk_bf16_f32 v153, v4, v5
  buffer_store_dword v153, v149, s[36:39], s46 offen
  v_cvt_pk_bf16_f32 v154, v40, v41
  buffer_store_dword v154, v150, s[36:39], s46 offen
  v_add_u32 v148, 18, v147
  v_mul_u32_u24 v149, 57, v148
  v_lshrrev_b32 v149, 10, v149
  v_mul_u32_u24 v150, 18, v149
  v_sub_u32 v148, v148, v150
  v_mul_lo_u32 v149, v149, s47
  v_lshrrev_b32 v150, 3, v148
  v_lshlrev_b32 v150, 9, v150
  v_and_b32 v151, 7, v148
  v_lshl_add_u32 v150, v151, 1, v150
  v_cmp_gt_u32 vcc, 16, v148
  v_mov_b32 v151, 4
  v_mov_b32 v152, 16
  v_cndmask_b32 v151, v151, v152, vcc
  v_mad_u32_u24 v149, v146, v151, v149
  v_add_u32 v149, v149, v150
  v_lshl_add_u32 v150, v151, 4, v149
  v_cvt_pk_bf16_f32 v153, v6, v7
  buffer_store_dword v153, v149, s[36:39], s46 offen
  v_cvt_pk_bf16_f32 v154, v42, v43
  buffer_store_dword v154, v150, s[36:39], s46 offen
  v_add_u32 v148, 32, v147
  v_mul_u32_u24 v149, 57, v148
  v_lshrrev_b32 v149, 10, v149
  v_mul_u32_u24 v150, 18, v149
  v_sub_u32 v148, v148, v150
  v_mul_lo_u32 v149, v149, s47
  v_lshrrev_b32 v150, 3, v148
  v_lshlrev_b32 v150, 9, v150
  v_and_b32 v151, 7, v148
  v_lshl_add_u32 v150, v151, 1, v150
  v_cmp_gt_u32 vcc, 16, v148
  v_mov_b32 v151, 4
  v_mov_b32 v152, 16
  v_cndmask_b32 v151, v151, v152, vcc
  v_mad_u32_u24 v149, v146, v151, v149
  v_add_u32 v149, v149, v150
  v_lshl_add_u32 v150, v151, 4, v149
  v_cvt_pk_bf16_f32 v153, v8, v9
  buffer_store_dword v153, v149, s[36:39], s46 offen
  v_cvt_pk_bf16_f32 v154, v44, v45
  buffer_store_dword v154, v150, s[36:39], s46 offen
  v_add_u32 v148, 34, v147
  v_mul_u32_u24 v149, 57, v148
  v_lshrrev_b32 v149, 10, v149
  v_mul_u32_u24 v150, 18, v149
  v_sub_u32 v148, v148, v150
  v_mul_lo_u32 v149, v149, s47
  v_lshrrev_b32 v150, 3, v148
  v_lshlrev_b32 v150, 9, v150
  v_and_b32 v151, 7, v148
  v_lshl_add_u32 v150, v151, 1, v150
  v_cmp_gt_u32 vcc, 16, v148
  v_mov_b32 v151, 4
  v_mov_b32 v152, 16
  v_cndmask_b32 v151, v151, v152, vcc
  v_mad_u32_u24 v149, v146, v151, v149
  v_add_u32 v149, v149, v150
  v_lshl_add_u32 v150, v151, 4, v149
  v_cvt_pk_bf16_f32 v153, v10, v11
  buffer_store_dword v153, v149, s[36:39], s46 offen
  v_cvt_pk_bf16_f32 v154, v46, v47
  buffer_store_dword v154, v150, s[36:39], s46 offen
  v_add_u32 v148, 48, v147
  v_mul_u32_u24 v149, 57, v148
  v_lshrrev_b32 v149, 10, v149
  v_mul_u32_u24 v150, 18, v149
  v_sub_u32 v148, v148, v150
  v_mul_lo_u32 v149, v149, s47
  v_lshrrev_b32 v150, 3, v148
  v_lshlrev_b32 v150, 9, v150
  v_and_b32 v151, 7, v148
  v_lshl_add_u32 v150, v151, 1, v150
  v_cmp_gt_u32 vcc, 16, v148
  v_mov_b32 v151, 4
  v_mov_b32 v152, 16
  v_cndmask_b32 v151, v151, v152, vcc
  v_mad_u32_u24 v149, v146, v151, v149
  v_add_u32 v149, v149, v150
  v_lshl_add_u32 v150, v151, 4, v149
  v_cvt_pk_bf16_f32 v153, v12, v13
  buffer_store_dword v153, v149, s[36:39], s46 offen
  v_cvt_pk_bf16_f32 v154, v48, v49
  buffer_store_dword v154, v150, s[36:39], s46 offen
  v_add_u32 v148, 50, v147
  v_mul_u32_u24 v149, 57, v148
  v_lshrrev_b32 v149, 10, v149
  v_mul_u32_u24 v150, 18, v149
  v_sub_u32 v148, v148, v150
  v_mul_lo_u32 v149, v149, s47
  v_lshrrev_b32 v150, 3, v148
  v_lshlrev_b32 v150, 9, v150
  v_and_b32 v151, 7, v148
  v_lshl_add_u32 v150, v151, 1, v150
  v_cmp_gt_u32 vcc, 16, v148
  v_mov_b32 v151, 4
  v_mov_b32 v152, 16
  v_cndmask_b32 v151, v151, v152, vcc
  v_mad_u32_u24 v149, v146, v151, v149
  v_add_u32 v149, v149, v150
  v_lshl_add_u32 v150, v151, 4, v149
  v_cvt_pk_bf16_f32 v153, v14, v15
  buffer_store_dword v153, v149, s[36:39], s46 offen
  v_cvt_pk_bf16_f32 v154, v50, v51
  buffer_store_dword v154, v150, s[36:39], s46 offen
  v_add_u32 v148, 64, v147
  v_mul_u32_u24 v149, 57, v148
  v_lshrrev_b32 v149, 10, v149
  v_mul_u32_u24 v150, 18, v149
  v_sub_u32 v148, v148, v150
  v_mul_lo_u32 v149, v149, s47
  v_lshrrev_b32 v150, 3, v148
  v_lshlrev_b32 v150, 9, v150
  v_and_b32 v151, 7, v148
  v_lshl_add_u32 v150, v151, 1, v150
  v_cmp_gt_u32 vcc, 16, v148
  v_mov_b32 v151, 4
  v_mov_b32 v152, 16
  v_cndmask_b32 v151, v151, v152, vcc
  v_mad_u32_u24 v149, v146, v151, v149
  v_add_u32 v149, v149, v150
  v_lshl_add_u32 v150, v151, 4, v149
  v_cvt_pk_bf16_f32 v153, v16, v17
  buffer_store_dword v153, v149, s[36:39], s46 offen
  v_cvt_pk_bf16_f32 v154, v52, v53
  buffer_store_dword v154, v150, s[36:39], s46 offen
  v_add_u32 v148, 66, v147
  v_mul_u32_u24 v149, 57, v148
  v_lshrrev_b32 v149, 10, v149
  v_mul_u32_u24 v150, 18, v149
  v_sub_u32 v148, v148, v150
  v_mul_lo_u32 v149, v149, s47
  v_lshrrev_b32 v150, 3, v148
  v_lshlrev_b32 v150, 9, v150
  v_and_b32 v151, 7, v148
  v_lshl_add_u32 v150, v151, 1, v150
  v_cmp_gt_u32 vcc, 16, v148
  v_mov_b32 v151, 4
  v_mov_b32 v152, 16
  v_cndmask_b32 v151, v151, v152, vcc
  v_mad_u32_u24 v149, v146, v151, v149
  v_add_u32 v149, v149, v150
  v_lshl_add_u32 v150, v151, 4, v149
  v_cvt_pk_bf16_f32 v153, v18, v19
  buffer_store_dword v153, v149, s[36:39], s46 offen
  v_cvt_pk_bf16_f32 v154, v54, v55
  buffer_store_dword v154, v150, s[36:39], s46 offen
  v_add_u32 v148, 80, v147
  v_mul_u32_u24 v149, 57, v148
  v_lshrrev_b32 v149, 10, v149
  v_mul_u32_u24 v150, 18, v149
  v_sub_u32 v148, v148, v150
  v_mul_lo_u32 v149, v149, s47
  v_lshrrev_b32 v150, 3, v148
  v_lshlrev_b32 v150, 9, v150
  v_and_b32 v151, 7, v148
  v_lshl_add_u32 v150, v151, 1, v150
  v_cmp_gt_u32 vcc, 16, v148
  v_mov_b32 v151, 4
  v_mov_b32 v152, 16
  v_cndmask_b32 v151, v151, v152, vcc
  v_mad_u32_u24 v149, v146, v151, v149
  v_add_u32 v149, v149, v150
  v_lshl_add_u32 v150, v151, 4, v149
  v_cvt_pk_bf16_f32 v153, v20, v21
  buffer_store_dword v153, v149, s[36:39], s46 offen
  v_cvt_pk_bf16_f32 v154, v56, v57
  buffer_store_dword v154, v150, s[36:39], s46 offen
  v_add_u32 v148, 82, v147
  v_mul_u32_u24 v149, 57, v148
  v_lshrrev_b32 v149, 10, v149
  v_mul_u32_u24 v150, 18, v149
  v_sub_u32 v148, v148, v150
  v_mul_lo_u32 v149, v149, s47
  v_lshrrev_b32 v150, 3, v148
  v_lshlrev_b32 v150, 9, v150
  v_and_b32 v151, 7, v148
  v_lshl_add_u32 v150, v151, 1, v150
  v_cmp_gt_u32 vcc, 16, v148
  v_mov_b32 v151, 4
  v_mov_b32 v152, 16
  v_cndmask_b32 v151, v151, v152, vcc
  v_mad_u32_u24 v149, v146, v151, v149
  v_add_u32 v149, v149, v150
  v_lshl_add_u32 v150, v151, 4, v149
  v_cvt_pk_bf16_f32 v153, v22, v23
  buffer_store_dword v153, v149, s[36:39], s46 offen
  v_cvt_pk_bf16_f32 v154, v58, v59
  buffer_store_dword v154, v150, s[36:39], s46 offen
  v_add_u32 v148, 96, v147
  v_mul_u32_u24 v149, 57, v148
  v_lshrrev_b32 v149, 10, v149
  v_mul_u32_u24 v150, 18, v149
  v_sub_u32 v148, v148, v150
  v_mul_lo_u32 v149, v149, s47
  v_lshrrev_b32 v150, 3, v148
  v_lshlrev_b32 v150, 9, v150
  v_and_b32 v151, 7, v148
  v_lshl_add_u32 v150, v151, 1, v150
  v_cmp_gt_u32 vcc, 16, v148
  v_mov_b32 v151, 4
  v_mov_b32 v152, 16
  v_cndmask_b32 v151, v151, v152, vcc
  v_mad_u32_u24 v149, v146, v151, v149
  v_add_u32 v149, v149, v150
  v_lshl_add_u32 v150, v151, 4, v149
  v_cvt_pk_bf16_f32 v153, v24, v25
  buffer_store_dword v153, v149, s[36:39], s46 offen
  v_cvt_pk_bf16_f32 v154, v60, v61
  buffer_store_dword v154, v150, s[36:39], s46 offen
  v_add_u32 v148, 98, v147
  v_mul_u32_u24 v149, 57, v148
  v_lshrrev_b32 v149, 10, v149
  v_mul_u32_u24 v150, 18, v149
  v_sub_u32 v148, v148, v150
  v_mul_lo_u32 v149, v149, s47
  v_lshrrev_b32 v150, 3, v148
  v_lshlrev_b32 v150, 9, v150
  v_and_b32 v151, 7, v148
  v_lshl_add_u32 v150, v151, 1, v150
  v_cmp_gt_u32 vcc, 16, v148
  v_mov_b32 v151, 4
  v_mov_b32 v152, 16
  v_cndmask_b32 v151, v151, v152, vcc
  v_mad_u32_u24 v149, v146, v151, v149
  v_add_u32 v149, v149, v150
  v_lshl_add_u32 v150, v151, 4, v149
  v_cvt_pk_bf16_f32 v153, v26, v27
  buffer_store_dword v153, v149, s[36:39], s46 offen
  v_cvt_pk_bf16_f32 v154, v62, v63
  buffer_store_dword v154, v150, s[36:39], s46 offen
  v_add_u32 v148, 112, v147
  v_mul_u32_u24 v149, 57, v148
  v_lshrrev_b32 v149, 10, v149
  v_mul_u32_u24 v150, 18, v149
  v_sub_u32 v148, v148, v150
  v_mul_lo_u32 v149, v149, s47
  v_lshrrev_b32 v150, 3, v148
  v_lshlrev_b32 v150, 9, v150
  v_and_b32 v151, 7, v148
  v_lshl_add_u32 v150, v151, 1, v150
  v_cmp_gt_u32 vcc, 16, v148
  v_mov_b32 v151, 4
  v_mov_b32 v152, 16
  v_cndmask_b32 v151, v151, v152, vcc
  v_mad_u32_u24 v149, v146, v151, v149
  v_add_u32 v149, v149, v150
  v_lshl_add_u32 v150, v151, 4, v149
  v_cvt_pk_bf16_f32 v153, v28, v29
  buffer_store_dword v153, v149, s[36:39], s46 offen
  v_cvt_pk_bf16_f32 v154, v64, v65
  buffer_store_dword v154, v150, s[36:39], s46 offen
  v_add_u32 v148, 114, v147
  v_mul_u32_u24 v149, 57, v148
  v_lshrrev_b32 v149, 10, v149
  v_mul_u32_u24 v150, 18, v149
  v_sub_u32 v148, v148, v150
  v_mul_lo_u32 v149, v149, s47
  v_lshrrev_b32 v150, 3, v148
  v_lshlrev_b32 v150, 9, v150
  v_and_b32 v151, 7, v148
  v_lshl_add_u32 v150, v151, 1, v150
  v_cmp_gt_u32 vcc, 16, v148
  v_mov_b32 v151, 4
  v_mov_b32 v152, 16
  v_cndmask_b32 v151, v151, v152, vcc
  v_mad_u32_u24 v149, v146, v151, v149
  v_add_u32 v149, v149, v150
  v_lshl_add_u32 v150, v151, 4, v149
  v_cvt_pk_bf16_f32 v153, v30, v31
  buffer_store_dword v153, v149, s[36:39], s46 offen
  v_cvt_pk_bf16_f32 v154, v66, v67
  buffer_store_dword v154, v150, s[36:39], s46 offen
  v_add_u32 v148, 128, v147
  v_mul_u32_u24 v149, 57, v148
  v_lshrrev_b32 v149, 10, v149
  v_mul_u32_u24 v150, 18, v149
  v_sub_u32 v148, v148, v150
  v_mul_lo_u32 v149, v149, s47
  v_lshrrev_b32 v150, 3, v148
  v_lshlrev_b32 v150, 9, v150
  v_and_b32 v151, 7, v148
  v_lshl_add_u32 v150, v151, 1, v150
  v_cmp_gt_u32 vcc, 16, v148
  v_mov_b32 v151, 4
  v_mov_b32 v152, 16
  v_cndmask_b32 v151, v151, v152, vcc
  v_mad_u32_u24 v149, v146, v151, v149
  v_add_u32 v149, v149, v150
  v_lshl_add_u32 v150, v151, 4, v149
  v_cvt_pk_bf16_f32 v153, v32, v33
  buffer_store_dword v153, v149, s[36:39], s46 offen
  v_cvt_pk_bf16_f32 v154, v68, v69
  buffer_store_dword v154, v150, s[36:39], s46 offen
  v_add_u32 v148, 130, v147
  v_mul_u32_u24 v149, 57, v148
  v_lshrrev_b32 v149, 10, v149
  v_mul_u32_u24 v150, 18, v149
  v_sub_u32 v148, v148, v150
  v_mul_lo_u32 v149, v149, s47
  v_lshrrev_b32 v150, 3, v148
  v_lshlrev_b32 v150, 9, v150
  v_and_b32 v151, 7, v148
  v_lshl_add_u32 v150, v151, 1, v150
  v_cmp_gt_u32 vcc, 16, v148
  v_mov_b32 v151, 4
  v_mov_b32 v152, 16
  v_cndmask_b32 v151, v151, v152, vcc
  v_mad_u32_u24 v149, v146, v151, v149
  v_add_u32 v149, v149, v150
  v_lshl_add_u32 v150, v151, 4, v149
  v_cvt_pk_bf16_f32 v153, v34, v35
  buffer_store_dword v153, v149, s[36:39], s46 offen
  v_cvt_pk_bf16_f32 v154, v70, v71
  buffer_store_dword v154, v150, s[36:39], s46 offen
  s_endpgm
k1_kernel_KEPI:
  v_mov_b32 v160, 0
  v_max3_f32 v160, |v0|, |v1|, v160
  v_max3_f32 v160, |v2|, |v3|, v160
  v_max3_f32 v160, |v4|, |v5|, v160
  v_max3_f32 v160, |v6|, |v7|, v160
  v_max3_f32 v160, |v8|, |v9|, v160
  v_max3_f32 v160, |v10|, |v11|, v160
  v_max3_f32 v160, |v12|, |v13|, v160
  v_max3_f32 v160, |v14|, |v15|, v160
  v_max3_f32 v160, |v16|, |v17|, v160
  v_max3_f32 v160, |v18|, |v19|, v160
  v_max3_f32 v160, |v20|, |v21|, v160
  v_max3_f32 v160, |v22|, |v23|, v160
  v_max3_f32 v160, |v24|, |v25|, v160
  v_max3_f32 v160, |v26|, |v27|, v160
  v_max3_f32 v160, |v28|, |v29|, v160
  v_max3_f32 v160, |v30|, |v31|, v160
  v_max3_f32 v160, |v32|, |v33|, v160
  v_max3_f32 v160, |v34|, |v35|, v160
  v_max3_f32 v160, |v36|, |v37|, v160
  v_max3_f32 v160, |v38|, |v39|, v160
  v_max3_f32 v160, |v40|, |v41|, v160
  v_max3_f32 v160, |v42|, |v43|, v160
  v_max3_f32 v160, |v44|, |v45|, v160
  v_max3_f32 v160, |v46|, |v47|, v160
  v_max3_f32 v160, |v48|, |v49|, v160
  v_max3_f32 v160, |v50|, |v51|, v160
  v_max3_f32 v160, |v52|, |v53|, v160
  v_max3_f32 v160, |v54|, |v55|, v160
  v_max3_f32 v160, |v56|, |v57|, v160
  v_max3_f32 v160, |v58|, |v59|, v160
  v_max3_f32 v160, |v60|, |v61|, v160
  v_max3_f32 v160, |v62|, |v63|, v160
  v_max3_f32 v160, |v64|, |v65|, v160
  v_max3_f32 v160, |v66|, |v67|, v160
  v_max3_f32 v160, |v68|, |v69|, v160
  v_max3_f32 v160, |v70|, |v71|, v160
  s_and_b32 s46, s23, 3
  s_mul_i32 s46, s46, 1310720
  s_mul_i32 s47, s27, 2560
  s_add_u32 s46, s46, s47
  v_and_b32 v146, 15, v230
  v_bfe_u32 v147, v230, 4, 2
  v_lshlrev_b32 v147, 2, v147
  s_mov_b32 s47, 163840
  v_add_u32 v148, 0, v147
  v_mul_u32_u24 v149, 57, v148
  v_lshrrev_b32 v149, 10, v149
  v_mul_u32_u24 v150, 18, v149
  v_sub_u32 v148, v148, v150
  v_mul_lo_u32 v149, v149, s47
  v_lshrrev_b32 v150, 3, v148
  v_lshlrev_b32 v150, 9, v150
  v_and_b32 v151, 7, v148
  v_lshl_add_u32 v150, v151, 1, v150
  v_cmp_gt_u32 vcc, 16, v148
  v_mov_b32 v151, 4
  v_mov_b32 v152, 16
  v_cndmask_b32 v151, v151, v152, vcc
  v_mad_u32_u24 v149, v146, v151, v149
  v_add_u32 v149, v149, v150
  v_lshl_add_u32 v150, v151, 4, v149
  v_cvt_pk_bf16_f32 v153, v0, v1
  buffer_store_dword v153, v149, s[40:43], s46 offen
  v_cvt_pk_bf16_f32 v154, v36, v37
  buffer_store_dword v154, v150, s[40:43], s46 offen
  v_add_u32 v148, 2, v147
  v_mul_u32_u24 v149, 57, v148
  v_lshrrev_b32 v149, 10, v149
  v_mul_u32_u24 v150, 18, v149
  v_sub_u32 v148, v148, v150
  v_mul_lo_u32 v149, v149, s47
  v_lshrrev_b32 v150, 3, v148
  v_lshlrev_b32 v150, 9, v150
  v_and_b32 v151, 7, v148
  v_lshl_add_u32 v150, v151, 1, v150
  v_cmp_gt_u32 vcc, 16, v148
  v_mov_b32 v151, 4
  v_mov_b32 v152, 16
  v_cndmask_b32 v151, v151, v152, vcc
  v_mad_u32_u24 v149, v146, v151, v149
  v_add_u32 v149, v149, v150
  v_lshl_add_u32 v150, v151, 4, v149
  v_cvt_pk_bf16_f32 v153, v2, v3
  buffer_store_dword v153, v149, s[40:43], s46 offen
  v_cvt_pk_bf16_f32 v154, v38, v39
  buffer_store_dword v154, v150, s[40:43], s46 offen
  v_add_u32 v148, 16, v147
  v_mul_u32_u24 v149, 57, v148
  v_lshrrev_b32 v149, 10, v149
  v_mul_u32_u24 v150, 18, v149
  v_sub_u32 v148, v148, v150
  v_mul_lo_u32 v149, v149, s47
  v_lshrrev_b32 v150, 3, v148
  v_lshlrev_b32 v150, 9, v150
  v_and_b32 v151, 7, v148
  v_lshl_add_u32 v150, v151, 1, v150
  v_cmp_gt_u32 vcc, 16, v148
  v_mov_b32 v151, 4
  v_mov_b32 v152, 16
  v_cndmask_b32 v151, v151, v152, vcc
  v_mad_u32_u24 v149, v146, v151, v149
  v_add_u32 v149, v149, v150
  v_lshl_add_u32 v150, v151, 4, v149
  v_cvt_pk_bf16_f32 v153, v4, v5
  buffer_store_dword v153, v149, s[40:43], s46 offen
  v_cvt_pk_bf16_f32 v154, v40, v41
  buffer_store_dword v154, v150, s[40:43], s46 offen
  v_add_u32 v148, 18, v147
  v_mul_u32_u24 v149, 57, v148
  v_lshrrev_b32 v149, 10, v149
  v_mul_u32_u24 v150, 18, v149
  v_sub_u32 v148, v148, v150
  v_mul_lo_u32 v149, v149, s47
  v_lshrrev_b32 v150, 3, v148
  v_lshlrev_b32 v150, 9, v150
  v_and_b32 v151, 7, v148
  v_lshl_add_u32 v150, v151, 1, v150
  v_cmp_gt_u32 vcc, 16, v148
  v_mov_b32 v151, 4
  v_mov_b32 v152, 16
  v_cndmask_b32 v151, v151, v152, vcc
  v_mad_u32_u24 v149, v146, v151, v149
  v_add_u32 v149, v149, v150
  v_lshl_add_u32 v150, v151, 4, v149
  v_cvt_pk_bf16_f32 v153, v6, v7
  buffer_store_dword v153, v149, s[40:43], s46 offen
  v_cvt_pk_bf16_f32 v154, v42, v43
  buffer_store_dword v154, v150, s[40:43], s46 offen
  v_add_u32 v148, 32, v147
  v_mul_u32_u24 v149, 57, v148
  v_lshrrev_b32 v149, 10, v149
  v_mul_u32_u24 v150, 18, v149
  v_sub_u32 v148, v148, v150
  v_mul_lo_u32 v149, v149, s47
  v_lshrrev_b32 v150, 3, v148
  v_lshlrev_b32 v150, 9, v150
  v_and_b32 v151, 7, v148
  v_lshl_add_u32 v150, v151, 1, v150
  v_cmp_gt_u32 vcc, 16, v148
  v_mov_b32 v151, 4
  v_mov_b32 v152, 16
  v_cndmask_b32 v151, v151, v152, vcc
  v_mad_u32_u24 v149, v146, v151, v149
  v_add_u32 v149, v149, v150
  v_lshl_add_u32 v150, v151, 4, v149
  v_cvt_pk_bf16_f32 v153, v8, v9
  buffer_store_dword v153, v149, s[40:43], s46 offen
  v_cvt_pk_bf16_f32 v154, v44, v45
  buffer_store_dword v154, v150, s[40:43], s46 offen
  v_add_u32 v148, 34, v147
  v_mul_u32_u24 v149, 57, v148
  v_lshrrev_b32 v149, 10, v149
  v_mul_u32_u24 v150, 18, v149
  v_sub_u32 v148, v148, v150
  v_mul_lo_u32 v149, v149, s47
  v_lshrrev_b32 v150, 3, v148
  v_lshlrev_b32 v150, 9, v150
  v_and_b32 v151, 7, v148
  v_lshl_add_u32 v150, v151, 1, v150
  v_cmp_gt_u32 vcc, 16, v148
  v_mov_b32 v151, 4
  v_mov_b32 v152, 16
  v_cndmask_b32 v151, v151, v152, vcc
  v_mad_u32_u24 v149, v146, v151, v149
  v_add_u32 v149, v149, v150
  v_lshl_add_u32 v150, v151, 4, v149
  v_cvt_pk_bf16_f32 v153, v10, v11
  buffer_store_dword v153, v149, s[40:43], s46 offen
  v_cvt_pk_bf16_f32 v154, v46, v47
  buffer_store_dword v154, v150, s[40:43], s46 offen
  v_add_u32 v148, 48, v147
  v_mul_u32_u24 v149, 57, v148
  v_lshrrev_b32 v149, 10, v149
  v_mul_u32_u24 v150, 18, v149
  v_sub_u32 v148, v148, v150
  v_mul_lo_u32 v149, v149, s47
  v_lshrrev_b32 v150, 3, v148
  v_lshlrev_b32 v150, 9, v150
  v_and_b32 v151, 7, v148
  v_lshl_add_u32 v150, v151, 1, v150
  v_cmp_gt_u32 vcc, 16, v148
  v_mov_b32 v151, 4
  v_mov_b32 v152, 16
  v_cndmask_b32 v151, v151, v152, vcc
  v_mad_u32_u24 v149, v146, v151, v149
  v_add_u32 v149, v149, v150
  v_lshl_add_u32 v150, v151, 4, v149
  v_cvt_pk_bf16_f32 v153, v12, v13
  buffer_store_dword v153, v149, s[40:43], s46 offen
  v_cvt_pk_bf16_f32 v154, v48, v49
  buffer_store_dword v154, v150, s[40:43], s46 offen
  v_add_u32 v148, 50, v147
  v_mul_u32_u24 v149, 57, v148
  v_lshrrev_b32 v149, 10, v149
  v_mul_u32_u24 v150, 18, v149
  v_sub_u32 v148, v148, v150
  v_mul_lo_u32 v149, v149, s47
  v_lshrrev_b32 v150, 3, v148
  v_lshlrev_b32 v150, 9, v150
  v_and_b32 v151, 7, v148
  v_lshl_add_u32 v150, v151, 1, v150
  v_cmp_gt_u32 vcc, 16, v148
  v_mov_b32 v151, 4
  v_mov_b32 v152, 16
  v_cndmask_b32 v151, v151, v152, vcc
  v_mad_u32_u24 v149, v146, v151, v149
  v_add_u32 v149, v149, v150
  v_lshl_add_u32 v150, v151, 4, v149
  v_cvt_pk_bf16_f32 v153, v14, v15
  buffer_store_dword v153, v149, s[40:43], s46 offen
  v_cvt_pk_bf16_f32 v154, v50, v51
  buffer_store_dword v154, v150, s[40:43], s46 offen
  v_add_u32 v148, 64, v147
  v_mul_u32_u24 v149, 57, v148
  v_lshrrev_b32 v149, 10, v149
  v_mul_u32_u24 v150, 18, v149
  v_sub_u32 v148, v148, v150
  v_mul_lo_u32 v149, v149, s47
  v_lshrrev_b32 v150, 3, v148
  v_lshlrev_b32 v150, 9, v150
  v_and_b32 v151, 7, v148
  v_lshl_add_u32 v150, v151, 1, v150
  v_cmp_gt_u32 vcc, 16, v148
  v_mov_b32 v151, 4
  v_mov_b32 v152, 16
  v_cndmask_b32 v151, v151, v152, vcc
  v_mad_u32_u24 v149, v146, v151, v149
  v_add_u32 v149, v149, v150
  v_lshl_add_u32 v150, v151, 4, v149
  v_cvt_pk_bf16_f32 v153, v16, v17
  buffer_store_dword v153, v149, s[40:43], s46 offen
  v_cvt_pk_bf16_f32 v154, v52, v53
  buffer_store_dword v154, v150, s[40:43], s46 offen
  v_add_u32 v148, 66, v147
  v_mul_u32_u24 v149, 57, v148
  v_lshrrev_b32 v149, 10, v149
  v_mul_u32_u24 v150, 18, v149
  v_sub_u32 v148, v148, v150
  v_mul_lo_u32 v149, v149, s47
  v_lshrrev_b32 v150, 3, v148
  v_lshlrev_b32 v150, 9, v150
  v_and_b32 v151, 7, v148
  v_lshl_add_u32 v150, v151, 1, v150
  v_cmp_gt_u32 vcc, 16, v148
  v_mov_b32 v151, 4
  v_mov_b32 v152, 16
  v_cndmask_b32 v151, v151, v152, vcc
  v_mad_u32_u24 v149, v146, v151, v149
  v_add_u32 v149, v149, v150
  v_lshl_add_u32 v150, v151, 4, v149
  v_cvt_pk_bf16_f32 v153, v18, v19
  buffer_store_dword v153, v149, s[40:43], s46 offen
  v_cvt_pk_bf16_f32 v154, v54, v55
  buffer_store_dword v154, v150, s[40:43], s46 offen
  v_add_u32 v148, 80, v147
  v_mul_u32_u24 v149, 57, v148
  v_lshrrev_b32 v149, 10, v149
  v_mul_u32_u24 v150, 18, v149
  v_sub_u32 v148, v148, v150
  v_mul_lo_u32 v149, v149, s47
  v_lshrrev_b32 v150, 3, v148
  v_lshlrev_b32 v150, 9, v150
  v_and_b32 v151, 7, v148
  v_lshl_add_u32 v150, v151, 1, v150
  v_cmp_gt_u32 vcc, 16, v148
  v_mov_b32 v151, 4
  v_mov_b32 v152, 16
  v_cndmask_b32 v151, v151, v152, vcc
  v_mad_u32_u24 v149, v146, v151, v149
  v_add_u32 v149, v149, v150
  v_lshl_add_u32 v150, v151, 4, v149
  v_cvt_pk_bf16_f32 v153, v20, v21
  buffer_store_dword v153, v149, s[40:43], s46 offen
  v_cvt_pk_bf16_f32 v154, v56, v57
  buffer_store_dword v154, v150, s[40:43], s46 offen
  v_add_u32 v148, 82, v147
  v_mul_u32_u24 v149, 57, v148
  v_lshrrev_b32 v149, 10, v149
  v_mul_u32_u24 v150, 18, v149
  v_sub_u32 v148, v148, v150
  v_mul_lo_u32 v149, v149, s47
  v_lshrrev_b32 v150, 3, v148
  v_lshlrev_b32 v150, 9, v150
  v_and_b32 v151, 7, v148
  v_lshl_add_u32 v150, v151, 1, v150
  v_cmp_gt_u32 vcc, 16, v148
  v_mov_b32 v151, 4
  v_mov_b32 v152, 16
  v_cndmask_b32 v151, v151, v152, vcc
  v_mad_u32_u24 v149, v146, v151, v149
  v_add_u32 v149, v149, v150
  v_lshl_add_u32 v150, v151, 4, v149
  v_cvt_pk_bf16_f32 v153, v22, v23
  buffer_store_dword v153, v149, s[40:43], s46 offen
  v_cvt_pk_bf16_f32 v154, v58, v59
  buffer_store_dword v154, v150, s[40:43], s46 offen
  v_add_u32 v148, 96, v147
  v_mul_u32_u24 v149, 57, v148
  v_lshrrev_b32 v149, 10, v149
  v_mul_u32_u24 v150, 18, v149
  v_sub_u32 v148, v148, v150
  v_mul_lo_u32 v149, v149, s47
  v_lshrrev_b32 v150, 3, v148
  v_lshlrev_b32 v150, 9, v150
  v_and_b32 v151, 7, v148
  v_lshl_add_u32 v150, v151, 1, v150
  v_cmp_gt_u32 vcc, 16, v148
  v_mov_b32 v151, 4
  v_mov_b32 v152, 16
  v_cndmask_b32 v151, v151, v152, vcc
  v_mad_u32_u24 v149, v146, v151, v149
  v_add_u32 v149, v149, v150
  v_lshl_add_u32 v150, v151, 4, v149
  v_cvt_pk_bf16_f32 v153, v24, v25
  buffer_store_dword v153, v149, s[40:43], s46 offen
  v_cvt_pk_bf16_f32 v154, v60, v61
  buffer_store_dword v154, v150, s[40:43], s46 offen
  v_add_u32 v148, 98, v147
  v_mul_u32_u24 v149, 57, v148
  v_lshrrev_b32 v149, 10, v149
  v_mul_u32_u24 v150, 18, v149
  v_sub_u32 v148, v148, v150
  v_mul_lo_u32 v149, v149, s47
  v_lshrrev_b32 v150, 3, v148
  v_lshlrev_b32 v150, 9, v150
  v_and_b32 v151, 7, v148
  v_lshl_add_u32 v150, v151, 1, v150
  v_cmp_gt_u32 vcc, 16, v148
  v_mov_b32 v151, 4
  v_mov_b32 v152, 16
  v_cndmask_b32 v151, v151, v152, vcc
  v_mad_u32_u24 v149, v146, v151, v149
  v_add_u32 v149, v149, v150
  v_lshl_add_u32 v150, v151, 4, v149
  v_cvt_pk_bf16_f32 v153, v26, v27
  buffer_store_dword v153, v149, s[40:43], s46 offen
  v_cvt_pk_bf16_f32 v154, v62, v63
  buffer_store_dword v154, v150, s[40:43], s46 offen
  v_add_u32 v148, 112, v147
  v_mul_u32_u24 v149, 57, v148
  v_lshrrev_b32 v149, 10, v149
  v_mul_u32_u24 v150, 18, v149
  v_sub_u32 v148, v148, v150
  v_mul_lo_u32 v149, v149, s47
  v_lshrrev_b32 v150, 3, v148
  v_lshlrev_b32 v150, 9, v150
  v_and_b32 v151, 7, v148
  v_lshl_add_u32 v150, v151, 1, v150
  v_cmp_gt_u32 vcc, 16, v148
  v_mov_b32 v151, 4
  v_mov_b32 v152, 16
  v_cndmask_b32 v151, v151, v152, vcc
  v_mad_u32_u24 v149, v146, v151, v149
  v_add_u32 v149, v149, v150
  v_lshl_add_u32 v150, v151, 4, v149
  v_cvt_pk_bf16_f32 v153, v28, v29
  buffer_store_dword v153, v149, s[40:43], s46 offen
  v_cvt_pk_bf16_f32 v154, v64, v65
  buffer_store_dword v154, v150, s[40:43], s46 offen
  v_add_u32 v148, 114, v147
  v_mul_u32_u24 v149, 57, v148
  v_lshrrev_b32 v149, 10, v149
  v_mul_u32_u24 v150, 18, v149
  v_sub_u32 v148, v148, v150
  v_mul_lo_u32 v149, v149, s47
  v_lshrrev_b32 v150, 3, v148
  v_lshlrev_b32 v150, 9, v150
  v_and_b32 v151, 7, v148
  v_lshl_add_u32 v150, v151, 1, v150
  v_cmp_gt_u32 vcc, 16, v148
  v_mov_b32 v151, 4
  v_mov_b32 v152, 16
  v_cndmask_b32 v151, v151, v152, vcc
  v_mad_u32_u24 v149, v146, v151, v149
  v_add_u32 v149, v149, v150
  v_lshl_add_u32 v150, v151, 4, v149
  v_cvt_pk_bf16_f32 v153, v30, v31
  buffer_store_dword v153, v149, s[40:43], s46 offen
  v_cvt_pk_bf16_f32 v154, v66, v67
  buffer_store_dword v154, v150, s[40:43], s46 offen
  v_add_u32 v148, 128, v147
  v_mul_u32_u24 v149, 57, v148
  v_lshrrev_b32 v149, 10, v149
  v_mul_u32_u24 v150, 18, v149
  v_sub_u32 v148, v148, v150
  v_mul_lo_u32 v149, v149, s47
  v_lshrrev_b32 v150, 3, v148
  v_lshlrev_b32 v150, 9, v150
  v_and_b32 v151, 7, v148
  v_lshl_add_u32 v150, v151, 1, v150
  v_cmp_gt_u32 vcc, 16, v148
  v_mov_b32 v151, 4
  v_mov_b32 v152, 16
  v_cndmask_b32 v151, v151, v152, vcc
  v_mad_u32_u24 v149, v146, v151, v149
  v_add_u32 v149, v149, v150
  v_lshl_add_u32 v150, v151, 4, v149
  v_cvt_pk_bf16_f32 v153, v32, v33
  buffer_store_dword v153, v149, s[40:43], s46 offen
  v_cvt_pk_bf16_f32 v154, v68, v69
  buffer_store_dword v154, v150, s[40:43], s46 offen
  v_add_u32 v148, 130, v147
  v_mul_u32_u24 v149, 57, v148
  v_lshrrev_b32 v149, 10, v149
  v_mul_u32_u24 v150, 18, v149
  v_sub_u32 v148, v148, v150
  v_mul_lo_u32 v149, v149, s47
  v_lshrrev_b32 v150, 3, v148
  v_lshlrev_b32 v150, 9, v150
  v_and_b32 v151, 7, v148
  v_lshl_add_u32 v150, v151, 1, v150
  v_cmp_gt_u32 vcc, 16, v148
  v_mov_b32 v151, 4
  v_mov_b32 v152, 16
  v_cndmask_b32 v151, v151, v152, vcc
  v_mad_u32_u24 v149, v146, v151, v149
  v_add_u32 v149, v149, v150
  v_lshl_add_u32 v150, v151, 4, v149
  v_cvt_pk_bf16_f32 v153, v34, v35
  buffer_store_dword v153, v149, s[40:43], s46 offen
  v_cvt_pk_bf16_f32 v154, v70, v71
  buffer_store_dword v154, v150, s[40:43], s46 offen
  s_nop 1
  v_max_f32_dpp v160, v160, v160 row_ror:8 row_mask:0xf bank_mask:0xf
  s_nop 1
  v_max_f32_dpp v160, v160, v160 row_ror:4 row_mask:0xf bank_mask:0xf
  s_nop 1
  v_max_f32_dpp v160, v160, v160 row_ror:2 row_mask:0xf bank_mask:0xf
  s_nop 1
  v_max_f32_dpp v160, v160, v160 row_ror:1 row_mask:0xf bank_mask:0xf
  v_mov_b32 v161, v160
  s_nop 1
  v_permlane16_swap_b32 v161, v160
  s_nop 1
  v_max_f32 v160, v160, v161
  v_mov_b32 v161, v160
  s_nop 1
  v_permlane32_swap_b32 v161, v160
  s_nop 1
  v_max_f32 v160, v160, v161
  s_lshl_b32 s46, s23, 8
  s_lshl_b32 s47, s27, 2
  s_add_u32 s46, s46, s47
  s_sub_u32 s46, s46, 1024
  v_mov_b32 v146, 0
  buffer_store_dword v160, v146, s[48:51], s46 offen
  s_endpgm
k1_kernel_V:
  v_and_b32 v221, 63, v230
  s_mul_i32 s52, s21, 144
  v_add_u32 v222, s52, v221
  v_min_u32 v222, 575, v222
  v_mul_u32_u24 v223, 3641, v222
  v_lshrrev_b32 v223, 16, v223
  v_mul_u32_u24 v224, 18, v223
  v_sub_u32 v224, v222, v224
  v_bfe_u32 v225, v223, 2, 2
  v_lshlrev_b32 v225, 3, v225
  v_and_b32 v222, 3, v223
  v_add_u32 v225, v225, v222
  v_lshrrev_b32 v222, 4, v223
  v_lshl_add_u32 v225, v222, 2, v225
  v_mul_u32_u24 v225, 3456, v225
  v_lshl_add_u32 v225, v224, 4, v225
  v_mov_b32 v212, v225
  v_add_u32 v222, s52, v221
  v_add_u32 v222, 64, v222
  v_min_u32 v222, 575, v222
  v_mul_u32_u24 v223, 3641, v222
  v_lshrrev_b32 v223, 16, v223
  v_mul_u32_u24 v224, 18, v223
  v_sub_u32 v224, v222, v224
  v_bfe_u32 v225, v223, 2, 2
  v_lshlrev_b32 v225, 3, v225
  v_and_b32 v222, 3, v223
  v_add_u32 v225, v225, v222
  v_lshrrev_b32 v222, 4, v223
  v_lshl_add_u32 v225, v222, 2, v225
  v_mul_u32_u24 v225, 3456, v225
  v_lshl_add_u32 v225, v224, 4, v225
  v_subrev_u32 v213, 1024, v225
  v_add_u32 v222, s52, v221
  v_add_u32 v222, 128, v222
  v_min_u32 v222, 575, v222
  v_mul_u32_u24 v223, 3641, v222
  v_lshrrev_b32 v223, 16, v223
  v_mul_u32_u24 v224, 18, v223
  v_sub_u32 v224, v222, v224
  v_bfe_u32 v225, v223, 2, 2
  v_lshlrev_b32 v225, 3, v225
  v_and_b32 v222, 3, v223
  v_add_u32 v225, v225, v222
  v_lshrrev_b32 v222, 4, v223
  v_lshl_add_u32 v225, v222, 2, v225
  v_mul_u32_u24 v225, 3456, v225
  v_lshl_add_u32 v225, v224, 4, v225
  v_subrev_u32 v214, 2048, v225
  s_lshl_b32 s52, s52, 4
  s_add_u32 s52, s52, 8192
  v_lshrrev_b32 v222, 2, v221
  v_mul_u32_u24 v222, 288, v222
  v_and_b32 v223, 3, v221
  v_lshl_add_u32 v219, v223, 3, v222
  s_mov_b32 s54, 8192
  v_add_u32 v219, s54, v219
  s_mul_i32 s53, s21, 128
  v_add_u32 v222, s53, v221
  v_lshrrev_b32 v223, 2, v222
  v_bfe_u32 v224, v223, 3, 1
  v_mul_u32_u24 v224, 3, v224
  v_and_b32 v222, 3, v222
  v_xor_b32 v222, v222, v224
  v_mul_u32_u24 v223, 1152, v223
  v_lshl_add_u32 v223, v222, 4, v223
  v_mov_b32 v217, v223
  v_add_u32 v222, s53, v221
  v_add_u32 v222, 64, v222
  v_lshrrev_b32 v223, 2, v222
  v_bfe_u32 v224, v223, 3, 1
  v_mul_u32_u24 v224, 3, v224
  v_and_b32 v222, 3, v222
  v_xor_b32 v222, v222, v224
  v_mul_u32_u24 v223, 1152, v223
  v_lshl_add_u32 v223, v222, 4, v223
  v_subrev_u32 v218, 1024, v223
  s_lshl_b32 s53, s53, 4
  v_and_b32 v222, 15, v221
  v_bfe_u32 v223, v221, 3, 1
  v_mul_u32_u24 v223, 3, v223
  v_lshrrev_b32 v224, 4, v221
  v_xor_b32 v223, v223, v224
  v_lshlrev_b32 v223, 4, v223
  v_lshl_add_u32 v220, v222, 6, v223
  s_lshr_b32 s54, s21, 0
  s_mul_i32 s54, s54, 2048
  v_add_u32 v220, s54, v220
  s_add_u32 m0, s52, 0
  s_nop 0
  buffer_load_dwordx4 v212, s[32:35], s26 offen offset:0 lds
  buffer_load_dwordx4 v213, s[32:35], s26 offen offset:1024 lds
  s_mov_b64 exec, 0xffff
  buffer_load_dwordx4 v214, s[32:35], s26 offen offset:2048 lds
  s_mov_b64 exec, -1
  s_add_u32 s26, s26, 110592
  s_add_u32 m0, s53, 0
  s_nop 0
  buffer_load_dwordx4 v217, s[28:31], s44 offen offset:0 lds
  buffer_load_dwordx4 v218, s[28:31], s44 offen offset:1024 lds
  s_add_u32 s44, s44, 64
  s_add_u32 m0, s52, 17408
  s_nop 0
  buffer_load_dwordx4 v212, s[32:35], s26 offen offset:0 lds
  buffer_load_dwordx4 v213, s[32:35], s26 offen offset:1024 lds
  s_mov_b64 exec, 0xffff
  buffer_load_dwordx4 v214, s[32:35], s26 offen offset:2048 lds
  s_mov_b64 exec, -1
  s_add_u32 s26, s26, 110592
  s_add_u32 m0, s53, 17408
  s_nop 0
  buffer_load_dwordx4 v217, s[28:31], s44 offen offset:0 lds
  buffer_load_dwordx4 v218, s[28:31], s44 offen offset:1024 lds
  s_add_u32 s44, s44, 64
  s_add_u32 m0, s52, 34816
  s_nop 0
  buffer_load_dwordx4 v212, s[32:35], s26 offen offset:0 lds
  buffer_load_dwordx4 v213, s[32:35], s26 offen offset:1024 lds
  s_mov_b64 exec, 0xffff
  buffer_load_dwordx4 v214, s[32:35], s26 offen offset:2048 lds
  s_mov_b64 exec, -1
  s_add_u32 s26, s26, 110592
  s_add_u32 m0, s53, 34816
  s_nop 0
  buffer_load_dwordx4 v217, s[28:31], s44 offen offset:0 lds
  buffer_load_dwordx4 v218, s[28:31], s44 offen offset:1024 lds
  s_add_u32 s44, s44, 64
  s_add_u32 m0, s52, 52224
  s_nop 0
  buffer_load_dwordx4 v212, s[32:35], s26 offen offset:0 lds
  buffer_load_dwordx4 v213, s[32:35], s26 offen offset:1024 lds
  s_mov_b64 exec, 0xffff
  buffer_load_dwordx4 v214, s[32:35], s26 offen offset:2048 lds
  s_mov_b64 exec, -1
  s_add_u32 s26, s26, 110592
  s_add_u32 m0, s53, 52224
  s_nop 0
  buffer_load_dwordx4 v217, s[28:31], s44 offen offset:0 lds
  buffer_load_dwordx4 v218, s[28:31], s44 offen offset:1024 lds
  s_add_u32 s44, s44, 64
  v_mov_b32 v0, 0
  v_mov_b32 v1, 0
  v_mov_b32 v2, 0
  v_mov_b32 v3, 0
  v_mov_b32 v4, 0
  v_mov_b32 v5, 0
  v_mov_b32 v6, 0
  v_mov_b32 v7, 0
  v_mov_b32 v8, 0
  v_mov_b32 v9, 0
  v_mov_b32 v10, 0
  v_mov_b32 v11, 0
  v_mov_b32 v12, 0
  v_mov_b32 v13, 0
  v_mov_b32 v14, 0
  v_mov_b32 v15, 0
  v_mov_b32 v16, 0
  v_mov_b32 v17, 0
  v_mov_b32 v18, 0
  v_mov_b32 v19, 0
  v_mov_b32 v20, 0
  v_mov_b32 v21, 0
  v_mov_b32 v22, 0
  v_mov_b32 v23, 0
  v_mov_b32 v24, 0
  v_mov_b32 v25, 0
  v_mov_b32 v26, 0
  v_mov_b32 v27, 0
  v_mov_b32 v28, 0
  v_mov_b32 v29, 0
  v_mov_b32 v30, 0
  v_mov_b32 v31, 0
  v_mov_b32 v32, 0
  v_mov_b32 v33, 0
  v_mov_b32 v34, 0
  v_mov_b32 v35, 0
  v_mov_b32 v36, 0
  v_mov_b32 v37, 0
  v_mov_b32 v38, 0
  v_mov_b32 v39, 0
  v_mov_b32 v40, 0
  v_mov_b32 v41, 0
  v_mov_b32 v42, 0
  v_mov_b32 v43, 0
  v_mov_b32 v44, 0
  v_mov_b32 v45, 0
  v_mov_b32 v46, 0
  v_mov_b32 v47, 0
  v_mov_b32 v48, 0
  v_mov_b32 v49, 0
  v_mov_b32 v50, 0
  v_mov_b32 v51, 0
  v_mov_b32 v52, 0
  v_mov_b32 v53, 0
  v_mov_b32 v54, 0
  v_mov_b32 v55, 0
  v_mov_b32 v56, 0
  v_mov_b32 v57, 0
  v_mov_b32 v58, 0
  v_mov_b32 v59, 0
  v_mov_b32 v60, 0
  v_mov_b32 v61, 0
  v_mov_b32 v62, 0
  v_mov_b32 v63, 0
  v_mov_b32 v64, 0
  v_mov_b32 v65, 0
  v_mov_b32 v66, 0
  v_mov_b32 v67, 0
  v_mov_b32 v68, 0
  v_mov_b32 v69, 0
  v_mov_b32 v70, 0
  v_mov_b32 v71, 0
  s_waitcnt vmcnt(15)
  s_barrier
  ds_read_b128 v[180:183], v220 offset:0
  ds_read_b128 v[184:187], v220 offset:1024
  ds_read_b64_tr_b16 v[144:145], v219 offset:0
  ds_read_b64_tr_b16 v[146:147], v219 offset:4608
  ds_read_b64_tr_b16 v[148:149], v219 offset:32
  ds_read_b64_tr_b16 v[150:151], v219 offset:4640
  ds_read_b64_tr_b16 v[152:153], v219 offset:64
  ds_read_b64_tr_b16 v[154:155], v219 offset:4672
  ds_read_b64_tr_b16 v[156:157], v219 offset:96
  ds_read_b64_tr_b16 v[158:159], v219 offset:4704
  ds_read_b64_tr_b16 v[160:161], v219 offset:128
  ds_read_b64_tr_b16 v[162:163], v219 offset:4736
  ds_read_b64_tr_b16 v[164:165], v219 offset:160
  ds_read_b64_tr_b16 v[166:167], v219 offset:4768
  ds_read_b64_tr_b16 v[168:169], v219 offset:192
  ds_read_b64_tr_b16 v[170:171], v219 offset:4800
  ds_read_b64_tr_b16 v[172:173], v219 offset:224
  ds_read_b64_tr_b16 v[174:175], v219 offset:4832
  ds_read_b64_tr_b16 v[176:177], v219 offset:256
  ds_read_b64_tr_b16 v[178:179], v219 offset:4864
  s_waitcnt vmcnt(10)
  s_waitcnt lgkmcnt(0)
  s_barrier
  ds_read_b128 v[188:191], v220 offset:17408
  ds_read_b128 v[192:195], v220 offset:18432
  v_mfma_f32_16x16x32_bf16 v[0:3], v[180:183], v[144:147], v[0:3]
  s_add_u32 m0, s52, 0
  s_nop 0
  buffer_load_dwordx4 v212, s[32:35], s26 offen offset:0 lds
  v_mfma_f32_16x16x32_bf16 v[36:39], v[184:187], v[144:147], v[36:39]
  ds_read_b64_tr_b16 v[144:145], v219 offset:17408
  ds_read_b64_tr_b16 v[146:147], v219 offset:22016
  v_mfma_f32_16x16x32_bf16 v[4:7], v[180:183], v[148:151], v[4:7]
  buffer_load_dwordx4 v213, s[32:35], s26 offen offset:1024 lds
  v_mfma_f32_16x16x32_bf16 v[40:43], v[184:187], v[148:151], v[40:43]
  ds_read_b64_tr_b16 v[148:149], v219 offset:17440
  ds_read_b64_tr_b16 v[150:151], v219 offset:22048
  v_mfma_f32_16x16x32_bf16 v[8:11], v[180:183], v[152:155], v[8:11]
  s_mov_b64 exec, 0xffff
  buffer_load_dwordx4 v214, s[32:35], s26 offen offset:2048 lds
  s_mov_b64 exec, -1
  s_add_u32 s26, s26, 110592
  v_mfma_f32_16x16x32_bf16 v[44:47], v[184:187], v[152:155], v[44:47]
  ds_read_b64_tr_b16 v[152:153], v219 offset:17472
  ds_read_b64_tr_b16 v[154:155], v219 offset:22080
  v_mfma_f32_16x16x32_bf16 v[12:15], v[180:183], v[156:159], v[12:15]
  s_add_u32 m0, s53, 0
  s_nop 0
  buffer_load_dwordx4 v217, s[28:31], s44 offen offset:0 lds
  v_mfma_f32_16x16x32_bf16 v[48:51], v[184:187], v[156:159], v[48:51]
  ds_read_b64_tr_b16 v[156:157], v219 offset:17504
  ds_read_b64_tr_b16 v[158:159], v219 offset:22112
  v_mfma_f32_16x16x32_bf16 v[16:19], v[180:183], v[160:163], v[16:19]
  buffer_load_dwordx4 v218, s[28:31], s44 offen offset:1024 lds
  s_add_u32 s44, s44, 64
  v_mfma_f32_16x16x32_bf16 v[52:55], v[184:187], v[160:163], v[52:55]
  ds_read_b64_tr_b16 v[160:161], v219 offset:17536
  ds_read_b64_tr_b16 v[162:163], v219 offset:22144
  v_mfma_f32_16x16x32_bf16 v[20:23], v[180:183], v[164:167], v[20:23]
  v_mfma_f32_16x16x32_bf16 v[56:59], v[184:187], v[164:167], v[56:59]
  ds_read_b64_tr_b16 v[164:165], v219 offset:17568
  ds_read_b64_tr_b16 v[166:167], v219 offset:22176
  v_mfma_f32_16x16x32_bf16 v[24:27], v[180:183], v[168:171], v[24:27]
  v_mfma_f32_16x16x32_bf16 v[60:63], v[184:187], v[168:171], v[60:63]
  ds_read_b64_tr_b16 v[168:169], v219 offset:17600
  ds_read_b64_tr_b16 v[170:171], v219 offset:22208
  v_mfma_f32_16x16x32_bf16 v[28:31], v[180:183], v[172:175], v[28:31]
  v_mfma_f32_16x16x32_bf16 v[64:67], v[184:187], v[172:175], v[64:67]
  ds_read_b64_tr_b16 v[172:173], v219 offset:17632
  ds_read_b64_tr_b16 v[174:175], v219 offset:22240
  v_mfma_f32_16x16x32_bf16 v[32:35], v[180:183], v[176:179], v[32:35]
  v_mfma_f32_16x16x32_bf16 v[68:71], v[184:187], v[176:179], v[68:71]
  ds_read_b64_tr_b16 v[176:177], v219 offset:17664
  ds_read_b64_tr_b16 v[178:179], v219 offset:22272
  s_waitcnt vmcnt(10)
  s_waitcnt lgkmcnt(0)
  s_barrier
  ds_read_b128 v[180:183], v220 offset:34816
  ds_read_b128 v[184:187], v220 offset:35840
  v_mfma_f32_16x16x32_bf16 v[0:3], v[188:191], v[144:147], v[0:3]
  s_add_u32 m0, s52, 17408
  s_nop 0
  buffer_load_dwordx4 v212, s[32:35], s26 offen offset:0 lds
  v_mfma_f32_16x16x32_bf16 v[36:39], v[192:195], v[144:147], v[36:39]
  ds_read_b64_tr_b16 v[144:145], v219 offset:34816
  ds_read_b64_tr_b16 v[146:147], v219 offset:39424
  v_mfma_f32_16x16x32_bf16 v[4:7], v[188:191], v[148:151], v[4:7]
  buffer_load_dwordx4 v213, s[32:35], s26 offen offset:1024 lds
  v_mfma_f32_16x16x32_bf16 v[40:43], v[192:195], v[148:151], v[40:43]
  ds_read_b64_tr_b16 v[148:149], v219 offset:34848
  ds_read_b64_tr_b16 v[150:151], v219 offset:39456
  v_mfma_f32_16x16x32_bf16 v[8:11], v[188:191], v[152:155], v[8:11]
  s_mov_b64 exec, 0xffff
  buffer_load_dwordx4 v214, s[32:35], s26 offen offset:2048 lds
  s_mov_b64 exec, -1
  s_add_u32 s26, s26, 110592
  v_mfma_f32_16x16x32_bf16 v[44:47], v[192:195], v[152:155], v[44:47]
  ds_read_b64_tr_b16 v[152:153], v219 offset:34880
  ds_read_b64_tr_b16 v[154:155], v219 offset:39488
  v_mfma_f32_16x16x32_bf16 v[12:15], v[188:191], v[156:159], v[12:15]
  s_add_u32 m0, s53, 17408
  s_nop 0
  buffer_load_dwordx4 v217, s[28:31], s44 offen offset:0 lds
  v_mfma_f32_16x16x32_bf16 v[48:51], v[192:195], v[156:159], v[48:51]
  ds_read_b64_tr_b16 v[156:157], v219 offset:34912
  ds_read_b64_tr_b16 v[158:159], v219 offset:39520
  v_mfma_f32_16x16x32_bf16 v[16:19], v[188:191], v[160:163], v[16:19]
  buffer_load_dwordx4 v218, s[28:31], s44 offen offset:1024 lds
  s_add_u32 s44, s44, 64
  v_mfma_f32_16x16x32_bf16 v[52:55], v[192:195], v[160:163], v[52:55]
  ds_read_b64_tr_b16 v[160:161], v219 offset:34944
  ds_read_b64_tr_b16 v[162:163], v219 offset:39552
  v_mfma_f32_16x16x32_bf16 v[20:23], v[188:191], v[164:167], v[20:23]
  v_mfma_f32_16x16x32_bf16 v[56:59], v[192:195], v[164:167], v[56:59]
  ds_read_b64_tr_b16 v[164:165], v219 offset:34976
  ds_read_b64_tr_b16 v[166:167], v219 offset:39584
  v_mfma_f32_16x16x32_bf16 v[24:27], v[188:191], v[168:171], v[24:27]
  v_mfma_f32_16x16x32_bf16 v[60:63], v[192:195], v[168:171], v[60:63]
  ds_read_b64_tr_b16 v[168:169], v219 offset:35008
  ds_read_b64_tr_b16 v[170:171], v219 offset:39616
  v_mfma_f32_16x16x32_bf16 v[28:31], v[188:191], v[172:175], v[28:31]
  v_mfma_f32_16x16x32_bf16 v[64:67], v[192:195], v[172:175], v[64:67]
  ds_read_b64_tr_b16 v[172:173], v219 offset:35040
  ds_read_b64_tr_b16 v[174:175], v219 offset:39648
  v_mfma_f32_16x16x32_bf16 v[32:35], v[188:191], v[176:179], v[32:35]
  v_mfma_f32_16x16x32_bf16 v[68:71], v[192:195], v[176:179], v[68:71]
  ds_read_b64_tr_b16 v[176:177], v219 offset:35072
  ds_read_b64_tr_b16 v[178:179], v219 offset:39680
  s_waitcnt vmcnt(10)
  s_waitcnt lgkmcnt(0)
  s_barrier
  ds_read_b128 v[188:191], v220 offset:52224
  ds_read_b128 v[192:195], v220 offset:53248
  v_mfma_f32_16x16x32_bf16 v[0:3], v[180:183], v[144:147], v[0:3]
  s_add_u32 m0, s52, 34816
  s_nop 0
  buffer_load_dwordx4 v212, s[32:35], s26 offen offset:0 lds
  v_mfma_f32_16x16x32_bf16 v[36:39], v[184:187], v[144:147], v[36:39]
  ds_read_b64_tr_b16 v[144:145], v219 offset:52224
  ds_read_b64_tr_b16 v[146:147], v219 offset:56832
  v_mfma_f32_16x16x32_bf16 v[4:7], v[180:183], v[148:151], v[4:7]
  buffer_load_dwordx4 v213, s[32:35], s26 offen offset:1024 lds
  v_mfma_f32_16x16x32_bf16 v[40:43], v[184:187], v[148:151], v[40:43]
  ds_read_b64_tr_b16 v[148:149], v219 offset:52256
  ds_read_b64_tr_b16 v[150:151], v219 offset:56864
  v_mfma_f32_16x16x32_bf16 v[8:11], v[180:183], v[152:155], v[8:11]
  s_mov_b64 exec, 0xffff
  buffer_load_dwordx4 v214, s[32:35], s26 offen offset:2048 lds
  s_mov_b64 exec, -1
  s_add_u32 s26, s26, 110592
  v_mfma_f32_16x16x32_bf16 v[44:47], v[184:187], v[152:155], v[44:47]
  ds_read_b64_tr_b16 v[152:153], v219 offset:52288
  ds_read_b64_tr_b16 v[154:155], v219 offset:56896
  v_mfma_f32_16x16x32_bf16 v[12:15], v[180:183], v[156:159], v[12:15]
  s_add_u32 m0, s53, 34816
  s_nop 0
  buffer_load_dwordx4 v217, s[28:31], s44 offen offset:0 lds
  v_mfma_f32_16x16x32_bf16 v[48:51], v[184:187], v[156:159], v[48:51]
  ds_read_b64_tr_b16 v[156:157], v219 offset:52320
  ds_read_b64_tr_b16 v[158:159], v219 offset:56928
  v_mfma_f32_16x16x32_bf16 v[16:19], v[180:183], v[160:163], v[16:19]
  buffer_load_dwordx4 v218, s[28:31], s44 offen offset:1024 lds
  s_add_u32 s44, s44, 64
  v_mfma_f32_16x16x32_bf16 v[52:55], v[184:187], v[160:163], v[52:55]
  ds_read_b64_tr_b16 v[160:161], v219 offset:52352
  ds_read_b64_tr_b16 v[162:163], v219 offset:56960
  v_mfma_f32_16x16x32_bf16 v[20:23], v[180:183], v[164:167], v[20:23]
  v_mfma_f32_16x16x32_bf16 v[56:59], v[184:187], v[164:167], v[56:59]
  ds_read_b64_tr_b16 v[164:165], v219 offset:52384
  ds_read_b64_tr_b16 v[166:167], v219 offset:56992
  v_mfma_f32_16x16x32_bf16 v[24:27], v[180:183], v[168:171], v[24:27]
  v_mfma_f32_16x16x32_bf16 v[60:63], v[184:187], v[168:171], v[60:63]
  ds_read_b64_tr_b16 v[168:169], v219 offset:52416
  ds_read_b64_tr_b16 v[170:171], v219 offset:57024
  v_mfma_f32_16x16x32_bf16 v[28:31], v[180:183], v[172:175], v[28:31]
  v_mfma_f32_16x16x32_bf16 v[64:67], v[184:187], v[172:175], v[64:67]
  ds_read_b64_tr_b16 v[172:173], v219 offset:52448
  ds_read_b64_tr_b16 v[174:175], v219 offset:57056
  v_mfma_f32_16x16x32_bf16 v[32:35], v[180:183], v[176:179], v[32:35]
  v_mfma_f32_16x16x32_bf16 v[68:71], v[184:187], v[176:179], v[68:71]
  ds_read_b64_tr_b16 v[176:177], v219 offset:52480
  ds_read_b64_tr_b16 v[178:179], v219 offset:57088
  s_waitcnt vmcnt(10)
  s_waitcnt lgkmcnt(0)
  s_barrier
  ds_read_b128 v[180:183], v220 offset:0
  ds_read_b128 v[184:187], v220 offset:1024
  v_mfma_f32_16x16x32_bf16 v[0:3], v[188:191], v[144:147], v[0:3]
  s_add_u32 m0, s52, 52224
  s_nop 0
  buffer_load_dwordx4 v212, s[32:35], s26 offen offset:0 lds
  v_mfma_f32_16x16x32_bf16 v[36:39], v[192:195], v[144:147], v[36:39]
  ds_read_b64_tr_b16 v[144:145], v219 offset:0
  ds_read_b64_tr_b16 v[146:147], v219 offset:4608
  v_mfma_f32_16x16x32_bf16 v[4:7], v[188:191], v[148:151], v[4:7]
  buffer_load_dwordx4 v213, s[32:35], s26 offen offset:1024 lds
  v_mfma_f32_16x16x32_bf16 v[40:43], v[192:195], v[148:151], v[40:43]
  ds_read_b64_tr_b16 v[148:149], v219 offset:32
  ds_read_b64_tr_b16 v[150:151], v219 offset:4640
  v_mfma_f32_16x16x32_bf16 v[8:11], v[188:191], v[152:155], v[8:11]
  s_mov_b64 exec, 0xffff
  buffer_load_dwordx4 v214, s[32:35], s26 offen offset:2048 lds
  s_mov_b64 exec, -1
  s_add_u32 s26, s26, 110592
  v_mfma_f32_16x16x32_bf16 v[44:47], v[192:195], v[152:155], v[44:47]
  ds_read_b64_tr_b16 v[152:153], v219 offset:64
  ds_read_b64_tr_b16 v[154:155], v219 offset:4672
  v_mfma_f32_16x16x32_bf16 v[12:15], v[188:191], v[156:159], v[12:15]
  s_add_u32 m0, s53, 52224
  s_nop 0
  buffer_load_dwordx4 v217, s[28:31], s44 offen offset:0 lds
  v_mfma_f32_16x16x32_bf16 v[48:51], v[192:195], v[156:159], v[48:51]
  ds_read_b64_tr_b16 v[156:157], v219 offset:96
  ds_read_b64_tr_b16 v[158:159], v219 offset:4704
  v_mfma_f32_16x16x32_bf16 v[16:19], v[188:191], v[160:163], v[16:19]
  buffer_load_dwordx4 v218, s[28:31], s44 offen offset:1024 lds
  s_add_u32 s44, s44, 64
  v_mfma_f32_16x16x32_bf16 v[52:55], v[192:195], v[160:163], v[52:55]
  ds_read_b64_tr_b16 v[160:161], v219 offset:128
  ds_read_b64_tr_b16 v[162:163], v219 offset:4736
  v_mfma_f32_16x16x32_bf16 v[20:23], v[188:191], v[164:167], v[20:23]
  v_mfma_f32_16x16x32_bf16 v[56:59], v[192:195], v[164:167], v[56:59]
  ds_read_b64_tr_b16 v[164:165], v219 offset:160
  ds_read_b64_tr_b16 v[166:167], v219 offset:4768
  v_mfma_f32_16x16x32_bf16 v[24:27], v[188:191], v[168:171], v[24:27]
  v_mfma_f32_16x16x32_bf16 v[60:63], v[192:195], v[168:171], v[60:63]
  ds_read_b64_tr_b16 v[168:169], v219 offset:192
  ds_read_b64_tr_b16 v[170:171], v219 offset:4800
  v_mfma_f32_16x16x32_bf16 v[28:31], v[188:191], v[172:175], v[28:31]
  v_mfma_f32_16x16x32_bf16 v[64:67], v[192:195], v[172:175], v[64:67]
  ds_read_b64_tr_b16 v[172:173], v219 offset:224
  ds_read_b64_tr_b16 v[174:175], v219 offset:4832
  v_mfma_f32_16x16x32_bf16 v[32:35], v[188:191], v[176:179], v[32:35]
  v_mfma_f32_16x16x32_bf16 v[68:71], v[192:195], v[176:179], v[68:71]
  ds_read_b64_tr_b16 v[176:177], v219 offset:256
  ds_read_b64_tr_b16 v[178:179], v219 offset:4864
  s_waitcnt vmcnt(10)
  s_waitcnt lgkmcnt(0)
  s_barrier
  ds_read_b128 v[188:191], v220 offset:17408
  ds_read_b128 v[192:195], v220 offset:18432
  v_mfma_f32_16x16x32_bf16 v[0:3], v[180:183], v[144:147], v[0:3]
  s_add_u32 m0, s52, 0
  s_nop 0
  buffer_load_dwordx4 v212, s[32:35], s26 offen offset:0 lds
  v_mfma_f32_16x16x32_bf16 v[36:39], v[184:187], v[144:147], v[36:39]
  ds_read_b64_tr_b16 v[144:145], v219 offset:17408
  ds_read_b64_tr_b16 v[146:147], v219 offset:22016
  v_mfma_f32_16x16x32_bf16 v[4:7], v[180:183], v[148:151], v[4:7]
  buffer_load_dwordx4 v213, s[32:35], s26 offen offset:1024 lds
  v_mfma_f32_16x16x32_bf16 v[40:43], v[184:187], v[148:151], v[40:43]
  ds_read_b64_tr_b16 v[148:149], v219 offset:17440
  ds_read_b64_tr_b16 v[150:151], v219 offset:22048
  v_mfma_f32_16x16x32_bf16 v[8:11], v[180:183], v[152:155], v[8:11]
  s_mov_b64 exec, 0xffff
  buffer_load_dwordx4 v214, s[32:35], s26 offen offset:2048 lds
  s_mov_b64 exec, -1
  s_add_u32 s26, s26, 110592
  v_mfma_f32_16x16x32_bf16 v[44:47], v[184:187], v[152:155], v[44:47]
  ds_read_b64_tr_b16 v[152:153], v219 offset:17472
  ds_read_b64_tr_b16 v[154:155], v219 offset:22080
  v_mfma_f32_16x16x32_bf16 v[12:15], v[180:183], v[156:159], v[12:15]
  s_add_u32 m0, s53, 0
  s_nop 0
  buffer_load_dwordx4 v217, s[28:31], s44 offen offset:0 lds
  v_mfma_f32_16x16x32_bf16 v[48:51], v[184:187], v[156:159], v[48:51]
  ds_read_b64_tr_b16 v[156:157], v219 offset:17504
  ds_read_b64_tr_b16 v[158:159], v219 offset:22112
  v_mfma_f32_16x16x32_bf16 v[16:19], v[180:183], v[160:163], v[16:19]
  buffer_load_dwordx4 v218, s[28:31], s44 offen offset:1024 lds
  s_add_u32 s44, s44, 64
  v_mfma_f32_16x16x32_bf16 v[52:55], v[184:187], v[160:163], v[52:55]
  ds_read_b64_tr_b16 v[160:161], v219 offset:17536
  ds_read_b64_tr_b16 v[162:163], v219 offset:22144
  v_mfma_f32_16x16x32_bf16 v[20:23], v[180:183], v[164:167], v[20:23]
  v_mfma_f32_16x16x32_bf16 v[56:59], v[184:187], v[164:167], v[56:59]
  ds_read_b64_tr_b16 v[164:165], v219 offset:17568
  ds_read_b64_tr_b16 v[166:167], v219 offset:22176
  v_mfma_f32_16x16x32_bf16 v[24:27], v[180:183], v[168:171], v[24:27]
  v_mfma_f32_16x16x32_bf16 v[60:63], v[184:187], v[168:171], v[60:63]
  ds_read_b64_tr_b16 v[168:169], v219 offset:17600
  ds_read_b64_tr_b16 v[170:171], v219 offset:22208
  v_mfma_f32_16x16x32_bf16 v[28:31], v[180:183], v[172:175], v[28:31]
  v_mfma_f32_16x16x32_bf16 v[64:67], v[184:187], v[172:175], v[64:67]
  ds_read_b64_tr_b16 v[172:173], v219 offset:17632
  ds_read_b64_tr_b16 v[174:175], v219 offset:22240
  v_mfma_f32_16x16x32_bf16 v[32:35], v[180:183], v[176:179], v[32:35]
  v_mfma_f32_16x16x32_bf16 v[68:71], v[184:187], v[176:179], v[68:71]
  ds_read_b64_tr_b16 v[176:177], v219 offset:17664
  ds_read_b64_tr_b16 v[178:179], v219 offset:22272
  s_waitcnt vmcnt(10)
  s_waitcnt lgkmcnt(0)
  s_barrier
  ds_read_b128 v[180:183], v220 offset:34816
  ds_read_b128 v[184:187], v220 offset:35840
  v_mfma_f32_16x16x32_bf16 v[0:3], v[188:191], v[144:147], v[0:3]
  s_add_u32 m0, s52, 17408
  s_nop 0
  buffer_load_dwordx4 v212, s[32:35], s26 offen offset:0 lds
  v_mfma_f32_16x16x32_bf16 v[36:39], v[192:195], v[144:147], v[36:39]
  ds_read_b64_tr_b16 v[144:145], v219 offset:34816
  ds_read_b64_tr_b16 v[146:147], v219 offset:39424
  v_mfma_f32_16x16x32_bf16 v[4:7], v[188:191], v[148:151], v[4:7]
  buffer_load_dwordx4 v213, s[32:35], s26 offen offset:1024 lds
  v_mfma_f32_16x16x32_bf16 v[40:43], v[192:195], v[148:151], v[40:43]
  ds_read_b64_tr_b16 v[148:149], v219 offset:34848
  ds_read_b64_tr_b16 v[150:151], v219 offset:39456
  v_mfma_f32_16x16x32_bf16 v[8:11], v[188:191], v[152:155], v[8:11]
  s_mov_b64 exec, 0xffff
  buffer_load_dwordx4 v214, s[32:35], s26 offen offset:2048 lds
  s_mov_b64 exec, -1
  s_add_u32 s26, s26, 110592
  v_mfma_f32_16x16x32_bf16 v[44:47], v[192:195], v[152:155], v[44:47]
  ds_read_b64_tr_b16 v[152:153], v219 offset:34880
  ds_read_b64_tr_b16 v[154:155], v219 offset:39488
  v_mfma_f32_16x16x32_bf16 v[12:15], v[188:191], v[156:159], v[12:15]
  s_add_u32 m0, s53, 17408
  s_nop 0
  buffer_load_dwordx4 v217, s[28:31], s44 offen offset:0 lds
  v_mfma_f32_16x16x32_bf16 v[48:51], v[192:195], v[156:159], v[48:51]
  ds_read_b64_tr_b16 v[156:157], v219 offset:34912
  ds_read_b64_tr_b16 v[158:159], v219 offset:39520
  v_mfma_f32_16x16x32_bf16 v[16:19], v[188:191], v[160:163], v[16:19]
  buffer_load_dwordx4 v218, s[28:31], s44 offen offset:1024 lds
  s_add_u32 s44, s44, 64
  v_mfma_f32_16x16x32_bf16 v[52:55], v[192:195], v[160:163], v[52:55]
  ds_read_b64_tr_b16 v[160:161], v219 offset:34944
  ds_read_b64_tr_b16 v[162:163], v219 offset:39552
  v_mfma_f32_16x16x32_bf16 v[20:23], v[188:191], v[164:167], v[20:23]
  v_mfma_f32_16x16x32_bf16 v[56:59], v[192:195], v[164:167], v[56:59]
  ds_read_b64_tr_b16 v[164:165], v219 offset:34976
  ds_read_b64_tr_b16 v[166:167], v219 offset:39584
  v_mfma_f32_16x16x32_bf16 v[24:27], v[188:191], v[168:171], v[24:27]
  v_mfma_f32_16x16x32_bf16 v[60:63], v[192:195], v[168:171], v[60:63]
  ds_read_b64_tr_b16 v[168:169], v219 offset:35008
  ds_read_b64_tr_b16 v[170:171], v219 offset:39616
  v_mfma_f32_16x16x32_bf16 v[28:31], v[188:191], v[172:175], v[28:31]
  v_mfma_f32_16x16x32_bf16 v[64:67], v[192:195], v[172:175], v[64:67]
  ds_read_b64_tr_b16 v[172:173], v219 offset:35040
  ds_read_b64_tr_b16 v[174:175], v219 offset:39648
  v_mfma_f32_16x16x32_bf16 v[32:35], v[188:191], v[176:179], v[32:35]
  v_mfma_f32_16x16x32_bf16 v[68:71], v[192:195], v[176:179], v[68:71]
  ds_read_b64_tr_b16 v[176:177], v219 offset:35072
  ds_read_b64_tr_b16 v[178:179], v219 offset:39680
  s_waitcnt vmcnt(10)
  s_waitcnt lgkmcnt(0)
  s_barrier
  ds_read_b128 v[188:191], v220 offset:52224
  ds_read_b128 v[192:195], v220 offset:53248
  v_mfma_f32_16x16x32_bf16 v[0:3], v[180:183], v[144:147], v[0:3]
  s_add_u32 m0, s52, 34816
  s_nop 0
  buffer_load_dwordx4 v212, s[32:35], s26 offen offset:0 lds
  v_mfma_f32_16x16x32_bf16 v[36:39], v[184:187], v[144:147], v[36:39]
  ds_read_b64_tr_b16 v[144:145], v219 offset:52224
  ds_read_b64_tr_b16 v[146:147], v219 offset:56832
  v_mfma_f32_16x16x32_bf16 v[4:7], v[180:183], v[148:151], v[4:7]
  buffer_load_dwordx4 v213, s[32:35], s26 offen offset:1024 lds
  v_mfma_f32_16x16x32_bf16 v[40:43], v[184:187], v[148:151], v[40:43]
  ds_read_b64_tr_b16 v[148:149], v219 offset:52256
  ds_read_b64_tr_b16 v[150:151], v219 offset:56864
  v_mfma_f32_16x16x32_bf16 v[8:11], v[180:183], v[152:155], v[8:11]
  s_mov_b64 exec, 0xffff
  buffer_load_dwordx4 v214, s[32:35], s26 offen offset:2048 lds
  s_mov_b64 exec, -1
  s_add_u32 s26, s26, 110592
  v_mfma_f32_16x16x32_bf16 v[44:47], v[184:187], v[152:155], v[44:47]
  ds_read_b64_tr_b16 v[152:153], v219 offset:52288
  ds_read_b64_tr_b16 v[154:155], v219 offset:56896
  v_mfma_f32_16x16x32_bf16 v[12:15], v[180:183], v[156:159], v[12:15]
  s_add_u32 m0, s53, 34816
  s_nop 0
  buffer_load_dwordx4 v217, s[28:31], s44 offen offset:0 lds
  v_mfma_f32_16x16x32_bf16 v[48:51], v[184:187], v[156:159], v[48:51]
  ds_read_b64_tr_b16 v[156:157], v219 offset:52320
  ds_read_b64_tr_b16 v[158:159], v219 offset:56928
  v_mfma_f32_16x16x32_bf16 v[16:19], v[180:183], v[160:163], v[16:19]
  buffer_load_dwordx4 v218, s[28:31], s44 offen offset:1024 lds
  s_add_u32 s44, s44, 64
  v_mfma_f32_16x16x32_bf16 v[52:55], v[184:187], v[160:163], v[52:55]
  ds_read_b64_tr_b16 v[160:161], v219 offset:52352
  ds_read_b64_tr_b16 v[162:163], v219 offset:56960
  v_mfma_f32_16x16x32_bf16 v[20:23], v[180:183], v[164:167], v[20:23]
  v_mfma_f32_16x16x32_bf16 v[56:59], v[184:187], v[164:167], v[56:59]
  ds_read_b64_tr_b16 v[164:165], v219 offset:52384
  ds_read_b64_tr_b16 v[166:167], v219 offset:56992
  v_mfma_f32_16x16x32_bf16 v[24:27], v[180:183], v[168:171], v[24:27]
  v_mfma_f32_16x16x32_bf16 v[60:63], v[184:187], v[168:171], v[60:63]
  ds_read_b64_tr_b16 v[168:169], v219 offset:52416
  ds_read_b64_tr_b16 v[170:171], v219 offset:57024
  v_mfma_f32_16x16x32_bf16 v[28:31], v[180:183], v[172:175], v[28:31]
  v_mfma_f32_16x16x32_bf16 v[64:67], v[184:187], v[172:175], v[64:67]
  ds_read_b64_tr_b16 v[172:173], v219 offset:52448
  ds_read_b64_tr_b16 v[174:175], v219 offset:57056
  v_mfma_f32_16x16x32_bf16 v[32:35], v[180:183], v[176:179], v[32:35]
  v_mfma_f32_16x16x32_bf16 v[68:71], v[184:187], v[176:179], v[68:71]
  ds_read_b64_tr_b16 v[176:177], v219 offset:52480
  ds_read_b64_tr_b16 v[178:179], v219 offset:57088
  s_waitcnt vmcnt(10)
  s_waitcnt lgkmcnt(0)
  s_barrier
  ds_read_b128 v[180:183], v220 offset:0
  ds_read_b128 v[184:187], v220 offset:1024
  v_mfma_f32_16x16x32_bf16 v[0:3], v[188:191], v[144:147], v[0:3]
  s_add_u32 m0, s52, 52224
  s_nop 0
  buffer_load_dwordx4 v212, s[32:35], s26 offen offset:0 lds
  v_mfma_f32_16x16x32_bf16 v[36:39], v[192:195], v[144:147], v[36:39]
  ds_read_b64_tr_b16 v[144:145], v219 offset:0
  ds_read_b64_tr_b16 v[146:147], v219 offset:4608
  v_mfma_f32_16x16x32_bf16 v[4:7], v[188:191], v[148:151], v[4:7]
  buffer_load_dwordx4 v213, s[32:35], s26 offen offset:1024 lds
  v_mfma_f32_16x16x32_bf16 v[40:43], v[192:195], v[148:151], v[40:43]
  ds_read_b64_tr_b16 v[148:149], v219 offset:32
  ds_read_b64_tr_b16 v[150:151], v219 offset:4640
  v_mfma_f32_16x16x32_bf16 v[8:11], v[188:191], v[152:155], v[8:11]
  s_mov_b64 exec, 0xffff
  buffer_load_dwordx4 v214, s[32:35], s26 offen offset:2048 lds
  s_mov_b64 exec, -1
  s_add_u32 s26, s26, 110592
  v_mfma_f32_16x16x32_bf16 v[44:47], v[192:195], v[152:155], v[44:47]
  ds_read_b64_tr_b16 v[152:153], v219 offset:64
  ds_read_b64_tr_b16 v[154:155], v219 offset:4672
  v_mfma_f32_16x16x32_bf16 v[12:15], v[188:191], v[156:159], v[12:15]
  s_add_u32 m0, s53, 52224
  s_nop 0
  buffer_load_dwordx4 v217, s[28:31], s44 offen offset:0 lds
  v_mfma_f32_16x16x32_bf16 v[48:51], v[192:195], v[156:159], v[48:51]
  ds_read_b64_tr_b16 v[156:157], v219 offset:96
  ds_read_b64_tr_b16 v[158:159], v219 offset:4704
  v_mfma_f32_16x16x32_bf16 v[16:19], v[188:191], v[160:163], v[16:19]
  buffer_load_dwordx4 v218, s[28:31], s44 offen offset:1024 lds
  s_add_u32 s44, s44, 64
  v_mfma_f32_16x16x32_bf16 v[52:55], v[192:195], v[160:163], v[52:55]
  ds_read_b64_tr_b16 v[160:161], v219 offset:128
  ds_read_b64_tr_b16 v[162:163], v219 offset:4736
  v_mfma_f32_16x16x32_bf16 v[20:23], v[188:191], v[164:167], v[20:23]
  v_mfma_f32_16x16x32_bf16 v[56:59], v[192:195], v[164:167], v[56:59]
  ds_read_b64_tr_b16 v[164:165], v219 offset:160
  ds_read_b64_tr_b16 v[166:167], v219 offset:4768
  v_mfma_f32_16x16x32_bf16 v[24:27], v[188:191], v[168:171], v[24:27]
  v_mfma_f32_16x16x32_bf16 v[60:63], v[192:195], v[168:171], v[60:63]
  ds_read_b64_tr_b16 v[168:169], v219 offset:192
  ds_read_b64_tr_b16 v[170:171], v219 offset:4800
  v_mfma_f32_16x16x32_bf16 v[28:31], v[188:191], v[172:175], v[28:31]
  v_mfma_f32_16x16x32_bf16 v[64:67], v[192:195], v[172:175], v[64:67]
  ds_read_b64_tr_b16 v[172:173], v219 offset:224
  ds_read_b64_tr_b16 v[174:175], v219 offset:4832
  v_mfma_f32_16x16x32_bf16 v[32:35], v[188:191], v[176:179], v[32:35]
  v_mfma_f32_16x16x32_bf16 v[68:71], v[192:195], v[176:179], v[68:71]
  ds_read_b64_tr_b16 v[176:177], v219 offset:256
  ds_read_b64_tr_b16 v[178:179], v219 offset:4864
  s_waitcnt vmcnt(10)
  s_waitcnt lgkmcnt(0)
  s_barrier
  ds_read_b128 v[188:191], v220 offset:17408
  ds_read_b128 v[192:195], v220 offset:18432
  v_mfma_f32_16x16x32_bf16 v[0:3], v[180:183], v[144:147], v[0:3]
  s_add_u32 m0, s52, 0
  s_nop 0
  buffer_load_dwordx4 v212, s[32:35], s26 offen offset:0 lds
  v_mfma_f32_16x16x32_bf16 v[36:39], v[184:187], v[144:147], v[36:39]
  ds_read_b64_tr_b16 v[144:145], v219 offset:17408
  ds_read_b64_tr_b16 v[146:147], v219 offset:22016
  v_mfma_f32_16x16x32_bf16 v[4:7], v[180:183], v[148:151], v[4:7]
  buffer_load_dwordx4 v213, s[32:35], s26 offen offset:1024 lds
  v_mfma_f32_16x16x32_bf16 v[40:43], v[184:187], v[148:151], v[40:43]
  ds_read_b64_tr_b16 v[148:149], v219 offset:17440
  ds_read_b64_tr_b16 v[150:151], v219 offset:22048
  v_mfma_f32_16x16x32_bf16 v[8:11], v[180:183], v[152:155], v[8:11]
  s_mov_b64 exec, 0xffff
  buffer_load_dwordx4 v214, s[32:35], s26 offen offset:2048 lds
  s_mov_b64 exec, -1
  s_add_u32 s26, s26, 110592
  v_mfma_f32_16x16x32_bf16 v[44:47], v[184:187], v[152:155], v[44:47]
  ds_read_b64_tr_b16 v[152:153], v219 offset:17472
  ds_read_b64_tr_b16 v[154:155], v219 offset:22080
  v_mfma_f32_16x16x32_bf16 v[12:15], v[180:183], v[156:159], v[12:15]
  s_add_u32 m0, s53, 0
  s_nop 0
  buffer_load_dwordx4 v217, s[28:31], s44 offen offset:0 lds
  v_mfma_f32_16x16x32_bf16 v[48:51], v[184:187], v[156:159], v[48:51]
  ds_read_b64_tr_b16 v[156:157], v219 offset:17504
  ds_read_b64_tr_b16 v[158:159], v219 offset:22112
  v_mfma_f32_16x16x32_bf16 v[16:19], v[180:183], v[160:163], v[16:19]
  buffer_load_dwordx4 v218, s[28:31], s44 offen offset:1024 lds
  s_add_u32 s44, s44, 64
  v_mfma_f32_16x16x32_bf16 v[52:55], v[184:187], v[160:163], v[52:55]
  ds_read_b64_tr_b16 v[160:161], v219 offset:17536
  ds_read_b64_tr_b16 v[162:163], v219 offset:22144
  v_mfma_f32_16x16x32_bf16 v[20:23], v[180:183], v[164:167], v[20:23]
  v_mfma_f32_16x16x32_bf16 v[56:59], v[184:187], v[164:167], v[56:59]
  ds_read_b64_tr_b16 v[164:165], v219 offset:17568
  ds_read_b64_tr_b16 v[166:167], v219 offset:22176
  v_mfma_f32_16x16x32_bf16 v[24:27], v[180:183], v[168:171], v[24:27]
  v_mfma_f32_16x16x32_bf16 v[60:63], v[184:187], v[168:171], v[60:63]
  ds_read_b64_tr_b16 v[168:169], v219 offset:17600
  ds_read_b64_tr_b16 v[170:171], v219 offset:22208
  v_mfma_f32_16x16x32_bf16 v[28:31], v[180:183], v[172:175], v[28:31]
  v_mfma_f32_16x16x32_bf16 v[64:67], v[184:187], v[172:175], v[64:67]
  ds_read_b64_tr_b16 v[172:173], v219 offset:17632
  ds_read_b64_tr_b16 v[174:175], v219 offset:22240
  v_mfma_f32_16x16x32_bf16 v[32:35], v[180:183], v[176:179], v[32:35]
  v_mfma_f32_16x16x32_bf16 v[68:71], v[184:187], v[176:179], v[68:71]
  ds_read_b64_tr_b16 v[176:177], v219 offset:17664
  ds_read_b64_tr_b16 v[178:179], v219 offset:22272
  s_waitcnt vmcnt(10)
  s_waitcnt lgkmcnt(0)
  s_barrier
  ds_read_b128 v[180:183], v220 offset:34816
  ds_read_b128 v[184:187], v220 offset:35840
  v_mfma_f32_16x16x32_bf16 v[0:3], v[188:191], v[144:147], v[0:3]
  s_add_u32 m0, s52, 17408
  s_nop 0
  buffer_load_dwordx4 v212, s[32:35], s26 offen offset:0 lds
  v_mfma_f32_16x16x32_bf16 v[36:39], v[192:195], v[144:147], v[36:39]
  ds_read_b64_tr_b16 v[144:145], v219 offset:34816
  ds_read_b64_tr_b16 v[146:147], v219 offset:39424
  v_mfma_f32_16x16x32_bf16 v[4:7], v[188:191], v[148:151], v[4:7]
  buffer_load_dwordx4 v213, s[32:35], s26 offen offset:1024 lds
  v_mfma_f32_16x16x32_bf16 v[40:43], v[192:195], v[148:151], v[40:43]
  ds_read_b64_tr_b16 v[148:149], v219 offset:34848
  ds_read_b64_tr_b16 v[150:151], v219 offset:39456
  v_mfma_f32_16x16x32_bf16 v[8:11], v[188:191], v[152:155], v[8:11]
  s_mov_b64 exec, 0xffff
  buffer_load_dwordx4 v214, s[32:35], s26 offen offset:2048 lds
  s_mov_b64 exec, -1
  s_add_u32 s26, s26, 110592
  v_mfma_f32_16x16x32_bf16 v[44:47], v[192:195], v[152:155], v[44:47]
  ds_read_b64_tr_b16 v[152:153], v219 offset:34880
  ds_read_b64_tr_b16 v[154:155], v219 offset:39488
  v_mfma_f32_16x16x32_bf16 v[12:15], v[188:191], v[156:159], v[12:15]
  s_add_u32 m0, s53, 17408
  s_nop 0
  buffer_load_dwordx4 v217, s[28:31], s44 offen offset:0 lds
  v_mfma_f32_16x16x32_bf16 v[48:51], v[192:195], v[156:159], v[48:51]
  ds_read_b64_tr_b16 v[156:157], v219 offset:34912
  ds_read_b64_tr_b16 v[158:159], v219 offset:39520
  v_mfma_f32_16x16x32_bf16 v[16:19], v[188:191], v[160:163], v[16:19]
  buffer_load_dwordx4 v218, s[28:31], s44 offen offset:1024 lds
  s_add_u32 s44, s44, 64
  v_mfma_f32_16x16x32_bf16 v[52:55], v[192:195], v[160:163], v[52:55]
  ds_read_b64_tr_b16 v[160:161], v219 offset:34944
  ds_read_b64_tr_b16 v[162:163], v219 offset:39552
  v_mfma_f32_16x16x32_bf16 v[20:23], v[188:191], v[164:167], v[20:23]
  v_mfma_f32_16x16x32_bf16 v[56:59], v[192:195], v[164:167], v[56:59]
  ds_read_b64_tr_b16 v[164:165], v219 offset:34976
  ds_read_b64_tr_b16 v[166:167], v219 offset:39584
  v_mfma_f32_16x16x32_bf16 v[24:27], v[188:191], v[168:171], v[24:27]
  v_mfma_f32_16x16x32_bf16 v[60:63], v[192:195], v[168:171], v[60:63]
  ds_read_b64_tr_b16 v[168:169], v219 offset:35008
  ds_read_b64_tr_b16 v[170:171], v219 offset:39616
  v_mfma_f32_16x16x32_bf16 v[28:31], v[188:191], v[172:175], v[28:31]
  v_mfma_f32_16x16x32_bf16 v[64:67], v[192:195], v[172:175], v[64:67]
  ds_read_b64_tr_b16 v[172:173], v219 offset:35040
  ds_read_b64_tr_b16 v[174:175], v219 offset:39648
  v_mfma_f32_16x16x32_bf16 v[32:35], v[188:191], v[176:179], v[32:35]
  v_mfma_f32_16x16x32_bf16 v[68:71], v[192:195], v[176:179], v[68:71]
  ds_read_b64_tr_b16 v[176:177], v219 offset:35072
  ds_read_b64_tr_b16 v[178:179], v219 offset:39680
  s_waitcnt vmcnt(10)
  s_waitcnt lgkmcnt(0)
  s_barrier
  ds_read_b128 v[188:191], v220 offset:52224
  ds_read_b128 v[192:195], v220 offset:53248
  v_mfma_f32_16x16x32_bf16 v[0:3], v[180:183], v[144:147], v[0:3]
  s_add_u32 m0, s52, 34816
  s_nop 0
  buffer_load_dwordx4 v212, s[32:35], s26 offen offset:0 lds
  v_mfma_f32_16x16x32_bf16 v[36:39], v[184:187], v[144:147], v[36:39]
  ds_read_b64_tr_b16 v[144:145], v219 offset:52224
  ds_read_b64_tr_b16 v[146:147], v219 offset:56832
  v_mfma_f32_16x16x32_bf16 v[4:7], v[180:183], v[148:151], v[4:7]
  buffer_load_dwordx4 v213, s[32:35], s26 offen offset:1024 lds
  v_mfma_f32_16x16x32_bf16 v[40:43], v[184:187], v[148:151], v[40:43]
  ds_read_b64_tr_b16 v[148:149], v219 offset:52256
  ds_read_b64_tr_b16 v[150:151], v219 offset:56864
  v_mfma_f32_16x16x32_bf16 v[8:11], v[180:183], v[152:155], v[8:11]
  s_mov_b64 exec, 0xffff
  buffer_load_dwordx4 v214, s[32:35], s26 offen offset:2048 lds
  s_mov_b64 exec, -1
  s_add_u32 s26, s26, 110592
  v_mfma_f32_16x16x32_bf16 v[44:47], v[184:187], v[152:155], v[44:47]
  ds_read_b64_tr_b16 v[152:153], v219 offset:52288
  ds_read_b64_tr_b16 v[154:155], v219 offset:56896
  v_mfma_f32_16x16x32_bf16 v[12:15], v[180:183], v[156:159], v[12:15]
  s_add_u32 m0, s53, 34816
  s_nop 0
  buffer_load_dwordx4 v217, s[28:31], s44 offen offset:0 lds
  v_mfma_f32_16x16x32_bf16 v[48:51], v[184:187], v[156:159], v[48:51]
  ds_read_b64_tr_b16 v[156:157], v219 offset:52320
  ds_read_b64_tr_b16 v[158:159], v219 offset:56928
  v_mfma_f32_16x16x32_bf16 v[16:19], v[180:183], v[160:163], v[16:19]
  buffer_load_dwordx4 v218, s[28:31], s44 offen offset:1024 lds
  s_add_u32 s44, s44, 64
  v_mfma_f32_16x16x32_bf16 v[52:55], v[184:187], v[160:163], v[52:55]
  ds_read_b64_tr_b16 v[160:161], v219 offset:52352
  ds_read_b64_tr_b16 v[162:163], v219 offset:56960
  v_mfma_f32_16x16x32_bf16 v[20:23], v[180:183], v[164:167], v[20:23]
  v_mfma_f32_16x16x32_bf16 v[56:59], v[184:187], v[164:167], v[56:59]
  ds_read_b64_tr_b16 v[164:165], v219 offset:52384
  ds_read_b64_tr_b16 v[166:167], v219 offset:56992
  v_mfma_f32_16x16x32_bf16 v[24:27], v[180:183], v[168:171], v[24:27]
  v_mfma_f32_16x16x32_bf16 v[60:63], v[184:187], v[168:171], v[60:63]
  ds_read_b64_tr_b16 v[168:169], v219 offset:52416
  ds_read_b64_tr_b16 v[170:171], v219 offset:57024
  v_mfma_f32_16x16x32_bf16 v[28:31], v[180:183], v[172:175], v[28:31]
  v_mfma_f32_16x16x32_bf16 v[64:67], v[184:187], v[172:175], v[64:67]
  ds_read_b64_tr_b16 v[172:173], v219 offset:52448
  ds_read_b64_tr_b16 v[174:175], v219 offset:57056
  v_mfma_f32_16x16x32_bf16 v[32:35], v[180:183], v[176:179], v[32:35]
  v_mfma_f32_16x16x32_bf16 v[68:71], v[184:187], v[176:179], v[68:71]
  ds_read_b64_tr_b16 v[176:177], v219 offset:52480
  ds_read_b64_tr_b16 v[178:179], v219 offset:57088
  s_waitcnt vmcnt(10)
  s_waitcnt lgkmcnt(0)
  s_barrier
  ds_read_b128 v[180:183], v220 offset:0
  ds_read_b128 v[184:187], v220 offset:1024
  v_mfma_f32_16x16x32_bf16 v[0:3], v[188:191], v[144:147], v[0:3]
  s_add_u32 m0, s52, 52224
  s_nop 0
  buffer_load_dwordx4 v212, s[32:35], s26 offen offset:0 lds
  v_mfma_f32_16x16x32_bf16 v[36:39], v[192:195], v[144:147], v[36:39]
  ds_read_b64_tr_b16 v[144:145], v219 offset:0
  ds_read_b64_tr_b16 v[146:147], v219 offset:4608
  v_mfma_f32_16x16x32_bf16 v[4:7], v[188:191], v[148:151], v[4:7]
  buffer_load_dwordx4 v213, s[32:35], s26 offen offset:1024 lds
  v_mfma_f32_16x16x32_bf16 v[40:43], v[192:195], v[148:151], v[40:43]
  ds_read_b64_tr_b16 v[148:149], v219 offset:32
  ds_read_b64_tr_b16 v[150:151], v219 offset:4640
  v_mfma_f32_16x16x32_bf16 v[8:11], v[188:191], v[152:155], v[8:11]
  s_mov_b64 exec, 0xffff
  buffer_load_dwordx4 v214, s[32:35], s26 offen offset:2048 lds
  s_mov_b64 exec, -1
  s_add_u32 s26, s26, 110592
  v_mfma_f32_16x16x32_bf16 v[44:47], v[192:195], v[152:155], v[44:47]
  ds_read_b64_tr_b16 v[152:153], v219 offset:64
  ds_read_b64_tr_b16 v[154:155], v219 offset:4672
  v_mfma_f32_16x16x32_bf16 v[12:15], v[188:191], v[156:159], v[12:15]
  s_add_u32 m0, s53, 52224
  s_nop 0
  buffer_load_dwordx4 v217, s[28:31], s44 offen offset:0 lds
  v_mfma_f32_16x16x32_bf16 v[48:51], v[192:195], v[156:159], v[48:51]
  ds_read_b64_tr_b16 v[156:157], v219 offset:96
  ds_read_b64_tr_b16 v[158:159], v219 offset:4704
  v_mfma_f32_16x16x32_bf16 v[16:19], v[188:191], v[160:163], v[16:19]
  buffer_load_dwordx4 v218, s[28:31], s44 offen offset:1024 lds
  s_add_u32 s44, s44, 64
  v_mfma_f32_16x16x32_bf16 v[52:55], v[192:195], v[160:163], v[52:55]
  ds_read_b64_tr_b16 v[160:161], v219 offset:128
  ds_read_b64_tr_b16 v[162:163], v219 offset:4736
  v_mfma_f32_16x16x32_bf16 v[20:23], v[188:191], v[164:167], v[20:23]
  v_mfma_f32_16x16x32_bf16 v[56:59], v[192:195], v[164:167], v[56:59]
  ds_read_b64_tr_b16 v[164:165], v219 offset:160
  ds_read_b64_tr_b16 v[166:167], v219 offset:4768
  v_mfma_f32_16x16x32_bf16 v[24:27], v[188:191], v[168:171], v[24:27]
  v_mfma_f32_16x16x32_bf16 v[60:63], v[192:195], v[168:171], v[60:63]
  ds_read_b64_tr_b16 v[168:169], v219 offset:192
  ds_read_b64_tr_b16 v[170:171], v219 offset:4800
  v_mfma_f32_16x16x32_bf16 v[28:31], v[188:191], v[172:175], v[28:31]
  v_mfma_f32_16x16x32_bf16 v[64:67], v[192:195], v[172:175], v[64:67]
  ds_read_b64_tr_b16 v[172:173], v219 offset:224
  ds_read_b64_tr_b16 v[174:175], v219 offset:4832
  v_mfma_f32_16x16x32_bf16 v[32:35], v[188:191], v[176:179], v[32:35]
  v_mfma_f32_16x16x32_bf16 v[68:71], v[192:195], v[176:179], v[68:71]
  ds_read_b64_tr_b16 v[176:177], v219 offset:256
  ds_read_b64_tr_b16 v[178:179], v219 offset:4864
  s_waitcnt vmcnt(10)
  s_waitcnt lgkmcnt(0)
  s_barrier
  ds_read_b128 v[188:191], v220 offset:17408
  ds_read_b128 v[192:195], v220 offset:18432
  v_mfma_f32_16x16x32_bf16 v[0:3], v[180:183], v[144:147], v[0:3]
  s_add_u32 m0, s52, 0
  s_nop 0
  buffer_load_dwordx4 v212, s[32:35], s26 offen offset:0 lds
  v_mfma_f32_16x16x32_bf16 v[36:39], v[184:187], v[144:147], v[36:39]
  ds_read_b64_tr_b16 v[144:145], v219 offset:17408
  ds_read_b64_tr_b16 v[146:147], v219 offset:22016
  v_mfma_f32_16x16x32_bf16 v[4:7], v[180:183], v[148:151], v[4:7]
  buffer_load_dwordx4 v213, s[32:35], s26 offen offset:1024 lds
  v_mfma_f32_16x16x32_bf16 v[40:43], v[184:187], v[148:151], v[40:43]
  ds_read_b64_tr_b16 v[148:149], v219 offset:17440
  ds_read_b64_tr_b16 v[150:151], v219 offset:22048
  v_mfma_f32_16x16x32_bf16 v[8:11], v[180:183], v[152:155], v[8:11]
  s_mov_b64 exec, 0xffff
  buffer_load_dwordx4 v214, s[32:35], s26 offen offset:2048 lds
  s_mov_b64 exec, -1
  s_add_u32 s26, s26, 110592
  v_mfma_f32_16x16x32_bf16 v[44:47], v[184:187], v[152:155], v[44:47]
  ds_read_b64_tr_b16 v[152:153], v219 offset:17472
  ds_read_b64_tr_b16 v[154:155], v219 offset:22080
  v_mfma_f32_16x16x32_bf16 v[12:15], v[180:183], v[156:159], v[12:15]
  s_add_u32 m0, s53, 0
  s_nop 0
  buffer_load_dwordx4 v217, s[28:31], s44 offen offset:0 lds
  v_mfma_f32_16x16x32_bf16 v[48:51], v[184:187], v[156:159], v[48:51]
  ds_read_b64_tr_b16 v[156:157], v219 offset:17504
  ds_read_b64_tr_b16 v[158:159], v219 offset:22112
  v_mfma_f32_16x16x32_bf16 v[16:19], v[180:183], v[160:163], v[16:19]
  buffer_load_dwordx4 v218, s[28:31], s44 offen offset:1024 lds
  s_add_u32 s44, s44, 64
  v_mfma_f32_16x16x32_bf16 v[52:55], v[184:187], v[160:163], v[52:55]
  ds_read_b64_tr_b16 v[160:161], v219 offset:17536
  ds_read_b64_tr_b16 v[162:163], v219 offset:22144
  v_mfma_f32_16x16x32_bf16 v[20:23], v[180:183], v[164:167], v[20:23]
  v_mfma_f32_16x16x32_bf16 v[56:59], v[184:187], v[164:167], v[56:59]
  ds_read_b64_tr_b16 v[164:165], v219 offset:17568
  ds_read_b64_tr_b16 v[166:167], v219 offset:22176
  v_mfma_f32_16x16x32_bf16 v[24:27], v[180:183], v[168:171], v[24:27]
  v_mfma_f32_16x16x32_bf16 v[60:63], v[184:187], v[168:171], v[60:63]
  ds_read_b64_tr_b16 v[168:169], v219 offset:17600
  ds_read_b64_tr_b16 v[170:171], v219 offset:22208
  v_mfma_f32_16x16x32_bf16 v[28:31], v[180:183], v[172:175], v[28:31]
  v_mfma_f32_16x16x32_bf16 v[64:67], v[184:187], v[172:175], v[64:67]
  ds_read_b64_tr_b16 v[172:173], v219 offset:17632
  ds_read_b64_tr_b16 v[174:175], v219 offset:22240
  v_mfma_f32_16x16x32_bf16 v[32:35], v[180:183], v[176:179], v[32:35]
  v_mfma_f32_16x16x32_bf16 v[68:71], v[184:187], v[176:179], v[68:71]
  ds_read_b64_tr_b16 v[176:177], v219 offset:17664
  ds_read_b64_tr_b16 v[178:179], v219 offset:22272
  s_waitcnt vmcnt(10)
  s_waitcnt lgkmcnt(0)
  s_barrier
  ds_read_b128 v[180:183], v220 offset:34816
  ds_read_b128 v[184:187], v220 offset:35840
  v_mfma_f32_16x16x32_bf16 v[0:3], v[188:191], v[144:147], v[0:3]
  s_add_u32 m0, s52, 17408
  s_nop 0
  buffer_load_dwordx4 v212, s[32:35], s26 offen offset:0 lds
  v_mfma_f32_16x16x32_bf16 v[36:39], v[192:195], v[144:147], v[36:39]
  ds_read_b64_tr_b16 v[144:145], v219 offset:34816
  ds_read_b64_tr_b16 v[146:147], v219 offset:39424
  v_mfma_f32_16x16x32_bf16 v[4:7], v[188:191], v[148:151], v[4:7]
  buffer_load_dwordx4 v213, s[32:35], s26 offen offset:1024 lds
  v_mfma_f32_16x16x32_bf16 v[40:43], v[192:195], v[148:151], v[40:43]
  ds_read_b64_tr_b16 v[148:149], v219 offset:34848
  ds_read_b64_tr_b16 v[150:151], v219 offset:39456
  v_mfma_f32_16x16x32_bf16 v[8:11], v[188:191], v[152:155], v[8:11]
  s_mov_b64 exec, 0xffff
  buffer_load_dwordx4 v214, s[32:35], s26 offen offset:2048 lds
  s_mov_b64 exec, -1
  s_add_u32 s26, s26, 110592
  v_mfma_f32_16x16x32_bf16 v[44:47], v[192:195], v[152:155], v[44:47]
  ds_read_b64_tr_b16 v[152:153], v219 offset:34880
  ds_read_b64_tr_b16 v[154:155], v219 offset:39488
  v_mfma_f32_16x16x32_bf16 v[12:15], v[188:191], v[156:159], v[12:15]
  s_add_u32 m0, s53, 17408
  s_nop 0
  buffer_load_dwordx4 v217, s[28:31], s44 offen offset:0 lds
  v_mfma_f32_16x16x32_bf16 v[48:51], v[192:195], v[156:159], v[48:51]
  ds_read_b64_tr_b16 v[156:157], v219 offset:34912
  ds_read_b64_tr_b16 v[158:159], v219 offset:39520
  v_mfma_f32_16x16x32_bf16 v[16:19], v[188:191], v[160:163], v[16:19]
  buffer_load_dwordx4 v218, s[28:31], s44 offen offset:1024 lds
  s_add_u32 s44, s44, 64
  v_mfma_f32_16x16x32_bf16 v[52:55], v[192:195], v[160:163], v[52:55]
  ds_read_b64_tr_b16 v[160:161], v219 offset:34944
  ds_read_b64_tr_b16 v[162:163], v219 offset:39552
  v_mfma_f32_16x16x32_bf16 v[20:23], v[188:191], v[164:167], v[20:23]
  v_mfma_f32_16x16x32_bf16 v[56:59], v[192:195], v[164:167], v[56:59]
  ds_read_b64_tr_b16 v[164:165], v219 offset:34976
  ds_read_b64_tr_b16 v[166:167], v219 offset:39584
  v_mfma_f32_16x16x32_bf16 v[24:27], v[188:191], v[168:171], v[24:27]
  v_mfma_f32_16x16x32_bf16 v[60:63], v[192:195], v[168:171], v[60:63]
  ds_read_b64_tr_b16 v[168:169], v219 offset:35008
  ds_read_b64_tr_b16 v[170:171], v219 offset:39616
  v_mfma_f32_16x16x32_bf16 v[28:31], v[188:191], v[172:175], v[28:31]
  v_mfma_f32_16x16x32_bf16 v[64:67], v[192:195], v[172:175], v[64:67]
  ds_read_b64_tr_b16 v[172:173], v219 offset:35040
  ds_read_b64_tr_b16 v[174:175], v219 offset:39648
  v_mfma_f32_16x16x32_bf16 v[32:35], v[188:191], v[176:179], v[32:35]
  v_mfma_f32_16x16x32_bf16 v[68:71], v[192:195], v[176:179], v[68:71]
  ds_read_b64_tr_b16 v[176:177], v219 offset:35072
  ds_read_b64_tr_b16 v[178:179], v219 offset:39680
  s_waitcnt vmcnt(10)
  s_waitcnt lgkmcnt(0)
  s_barrier
  ds_read_b128 v[188:191], v220 offset:52224
  ds_read_b128 v[192:195], v220 offset:53248
  v_mfma_f32_16x16x32_bf16 v[0:3], v[180:183], v[144:147], v[0:3]
  v_mfma_f32_16x16x32_bf16 v[36:39], v[184:187], v[144:147], v[36:39]
  ds_read_b64_tr_b16 v[144:145], v219 offset:52224
  ds_read_b64_tr_b16 v[146:147], v219 offset:56832
  v_mfma_f32_16x16x32_bf16 v[4:7], v[180:183], v[148:151], v[4:7]
  v_mfma_f32_16x16x32_bf16 v[40:43], v[184:187], v[148:151], v[40:43]
  ds_read_b64_tr_b16 v[148:149], v219 offset:52256
  ds_read_b64_tr_b16 v[150:151], v219 offset:56864
  v_mfma_f32_16x16x32_bf16 v[8:11], v[180:183], v[152:155], v[8:11]
  v_mfma_f32_16x16x32_bf16 v[44:47], v[184:187], v[152:155], v[44:47]
  ds_read_b64_tr_b16 v[152:153], v219 offset:52288
  ds_read_b64_tr_b16 v[154:155], v219 offset:56896
  v_mfma_f32_16x16x32_bf16 v[12:15], v[180:183], v[156:159], v[12:15]
  v_mfma_f32_16x16x32_bf16 v[48:51], v[184:187], v[156:159], v[48:51]
  ds_read_b64_tr_b16 v[156:157], v219 offset:52320
  ds_read_b64_tr_b16 v[158:159], v219 offset:56928
  v_mfma_f32_16x16x32_bf16 v[16:19], v[180:183], v[160:163], v[16:19]
  v_mfma_f32_16x16x32_bf16 v[52:55], v[184:187], v[160:163], v[52:55]
  ds_read_b64_tr_b16 v[160:161], v219 offset:52352
  ds_read_b64_tr_b16 v[162:163], v219 offset:56960
  v_mfma_f32_16x16x32_bf16 v[20:23], v[180:183], v[164:167], v[20:23]
  v_mfma_f32_16x16x32_bf16 v[56:59], v[184:187], v[164:167], v[56:59]
  ds_read_b64_tr_b16 v[164:165], v219 offset:52384
  ds_read_b64_tr_b16 v[166:167], v219 offset:56992
  v_mfma_f32_16x16x32_bf16 v[24:27], v[180:183], v[168:171], v[24:27]
  v_mfma_f32_16x16x32_bf16 v[60:63], v[184:187], v[168:171], v[60:63]
  ds_read_b64_tr_b16 v[168:169], v219 offset:52416
  ds_read_b64_tr_b16 v[170:171], v219 offset:57024
  v_mfma_f32_16x16x32_bf16 v[28:31], v[180:183], v[172:175], v[28:31]
  v_mfma_f32_16x16x32_bf16 v[64:67], v[184:187], v[172:175], v[64:67]
  ds_read_b64_tr_b16 v[172:173], v219 offset:52448
  ds_read_b64_tr_b16 v[174:175], v219 offset:57056
  v_mfma_f32_16x16x32_bf16 v[32:35], v[180:183], v[176:179], v[32:35]
  v_mfma_f32_16x16x32_bf16 v[68:71], v[184:187], v[176:179], v[68:71]
  ds_read_b64_tr_b16 v[176:177], v219 offset:52480
  ds_read_b64_tr_b16 v[178:179], v219 offset:57088
  s_waitcnt vmcnt(5)
  s_waitcnt lgkmcnt(0)
  s_barrier
  ds_read_b128 v[180:183], v220 offset:0
  ds_read_b128 v[184:187], v220 offset:1024
  v_mfma_f32_16x16x32_bf16 v[0:3], v[188:191], v[144:147], v[0:3]
  v_mfma_f32_16x16x32_bf16 v[36:39], v[192:195], v[144:147], v[36:39]
  ds_read_b64_tr_b16 v[144:145], v219 offset:0
  ds_read_b64_tr_b16 v[146:147], v219 offset:4608
  v_mfma_f32_16x16x32_bf16 v[4:7], v[188:191], v[148:151], v[4:7]
  v_mfma_f32_16x16x32_bf16 v[40:43], v[192:195], v[148:151], v[40:43]
  ds_read_b64_tr_b16 v[148:149], v219 offset:32
  ds_read_b64_tr_b16 v[150:151], v219 offset:4640
  v_mfma_f32_16x16x32_bf16 v[8:11], v[188:191], v[152:155], v[8:11]
  v_mfma_f32_16x16x32_bf16 v[44:47], v[192:195], v[152:155], v[44:47]
  ds_read_b64_tr_b16 v[152:153], v219 offset:64
  ds_read_b64_tr_b16 v[154:155], v219 offset:4672
  v_mfma_f32_16x16x32_bf16 v[12:15], v[188:191], v[156:159], v[12:15]
  v_mfma_f32_16x16x32_bf16 v[48:51], v[192:195], v[156:159], v[48:51]
  ds_read_b64_tr_b16 v[156:157], v219 offset:96
  ds_read_b64_tr_b16 v[158:159], v219 offset:4704
  v_mfma_f32_16x16x32_bf16 v[16:19], v[188:191], v[160:163], v[16:19]
  v_mfma_f32_16x16x32_bf16 v[52:55], v[192:195], v[160:163], v[52:55]
  ds_read_b64_tr_b16 v[160:161], v219 offset:128
  ds_read_b64_tr_b16 v[162:163], v219 offset:4736
  v_mfma_f32_16x16x32_bf16 v[20:23], v[188:191], v[164:167], v[20:23]
  v_mfma_f32_16x16x32_bf16 v[56:59], v[192:195], v[164:167], v[56:59]
  ds_read_b64_tr_b16 v[164:165], v219 offset:160
  ds_read_b64_tr_b16 v[166:167], v219 offset:4768
  v_mfma_f32_16x16x32_bf16 v[24:27], v[188:191], v[168:171], v[24:27]
  v_mfma_f32_16x16x32_bf16 v[60:63], v[192:195], v[168:171], v[60:63]
  ds_read_b64_tr_b16 v[168:169], v219 offset:192
  ds_read_b64_tr_b16 v[170:171], v219 offset:4800
  v_mfma_f32_16x16x32_bf16 v[28:31], v[188:191], v[172:175], v[28:31]
  v_mfma_f32_16x16x32_bf16 v[64:67], v[192:195], v[172:175], v[64:67]
  ds_read_b64_tr_b16 v[172:173], v219 offset:224
  ds_read_b64_tr_b16 v[174:175], v219 offset:4832
  v_mfma_f32_16x16x32_bf16 v[32:35], v[188:191], v[176:179], v[32:35]
  v_mfma_f32_16x16x32_bf16 v[68:71], v[192:195], v[176:179], v[68:71]
  ds_read_b64_tr_b16 v[176:177], v219 offset:256
  ds_read_b64_tr_b16 v[178:179], v219 offset:4864
  s_waitcnt vmcnt(0)
  s_waitcnt lgkmcnt(0)
  s_barrier
  ds_read_b128 v[188:191], v220 offset:17408
  ds_read_b128 v[192:195], v220 offset:18432
  v_mfma_f32_16x16x32_bf16 v[0:3], v[180:183], v[144:147], v[0:3]
  v_mfma_f32_16x16x32_bf16 v[36:39], v[184:187], v[144:147], v[36:39]
  ds_read_b64_tr_b16 v[144:145], v219 offset:17408
  ds_read_b64_tr_b16 v[146:147], v219 offset:22016
  v_mfma_f32_16x16x32_bf16 v[4:7], v[180:183], v[148:151], v[4:7]
  v_mfma_f32_16x16x32_bf16 v[40:43], v[184:187], v[148:151], v[40:43]
  ds_read_b64_tr_b16 v[148:149], v219 offset:17440
  ds_read_b64_tr_b16 v[150:151], v219 offset:22048
  v_mfma_f32_16x16x32_bf16 v[8:11], v[180:183], v[152:155], v[8:11]
  v_mfma_f32_16x16x32_bf16 v[44:47], v[184:187], v[152:155], v[44:47]
  ds_read_b64_tr_b16 v[152:153], v219 offset:17472
  ds_read_b64_tr_b16 v[154:155], v219 offset:22080
  v_mfma_f32_16x16x32_bf16 v[12:15], v[180:183], v[156:159], v[12:15]
  v_mfma_f32_16x16x32_bf16 v[48:51], v[184:187], v[156:159], v[48:51]
  ds_read_b64_tr_b16 v[156:157], v219 offset:17504
  ds_read_b64_tr_b16 v[158:159], v219 offset:22112
  v_mfma_f32_16x16x32_bf16 v[16:19], v[180:183], v[160:163], v[16:19]
  v_mfma_f32_16x16x32_bf16 v[52:55], v[184:187], v[160:163], v[52:55]
  ds_read_b64_tr_b16 v[160:161], v219 offset:17536
  ds_read_b64_tr_b16 v[162:163], v219 offset:22144
  v_mfma_f32_16x16x32_bf16 v[20:23], v[180:183], v[164:167], v[20:23]
  v_mfma_f32_16x16x32_bf16 v[56:59], v[184:187], v[164:167], v[56:59]
  ds_read_b64_tr_b16 v[164:165], v219 offset:17568
  ds_read_b64_tr_b16 v[166:167], v219 offset:22176
  v_mfma_f32_16x16x32_bf16 v[24:27], v[180:183], v[168:171], v[24:27]
  v_mfma_f32_16x16x32_bf16 v[60:63], v[184:187], v[168:171], v[60:63]
  ds_read_b64_tr_b16 v[168:169], v219 offset:17600
  ds_read_b64_tr_b16 v[170:171], v219 offset:22208
  v_mfma_f32_16x16x32_bf16 v[28:31], v[180:183], v[172:175], v[28:31]
  v_mfma_f32_16x16x32_bf16 v[64:67], v[184:187], v[172:175], v[64:67]
  ds_read_b64_tr_b16 v[172:173], v219 offset:17632
  ds_read_b64_tr_b16 v[174:175], v219 offset:22240
  v_mfma_f32_16x16x32_bf16 v[32:35], v[180:183], v[176:179], v[32:35]
  v_mfma_f32_16x16x32_bf16 v[68:71], v[184:187], v[176:179], v[68:71]
  ds_read_b64_tr_b16 v[176:177], v219 offset:17664
  ds_read_b64_tr_b16 v[178:179], v219 offset:22272
  s_waitcnt lgkmcnt(0)
  s_barrier
  v_mfma_f32_16x16x32_bf16 v[0:3], v[188:191], v[144:147], v[0:3]
  v_mfma_f32_16x16x32_bf16 v[36:39], v[192:195], v[144:147], v[36:39]
  v_mfma_f32_16x16x32_bf16 v[4:7], v[188:191], v[148:151], v[4:7]
  v_mfma_f32_16x16x32_bf16 v[40:43], v[192:195], v[148:151], v[40:43]
  v_mfma_f32_16x16x32_bf16 v[8:11], v[188:191], v[152:155], v[8:11]
  v_mfma_f32_16x16x32_bf16 v[44:47], v[192:195], v[152:155], v[44:47]
  v_mfma_f32_16x16x32_bf16 v[12:15], v[188:191], v[156:159], v[12:15]
  v_mfma_f32_16x16x32_bf16 v[48:51], v[192:195], v[156:159], v[48:51]
  v_mfma_f32_16x16x32_bf16 v[16:19], v[188:191], v[160:163], v[16:19]
  v_mfma_f32_16x16x32_bf16 v[52:55], v[192:195], v[160:163], v[52:55]
  v_mfma_f32_16x16x32_bf16 v[20:23], v[188:191], v[164:167], v[20:23]
  v_mfma_f32_16x16x32_bf16 v[56:59], v[192:195], v[164:167], v[56:59]
  v_mfma_f32_16x16x32_bf16 v[24:27], v[188:191], v[168:171], v[24:27]
  v_mfma_f32_16x16x32_bf16 v[60:63], v[192:195], v[168:171], v[60:63]
  v_mfma_f32_16x16x32_bf16 v[28:31], v[188:191], v[172:175], v[28:31]
  v_mfma_f32_16x16x32_bf16 v[64:67], v[192:195], v[172:175], v[64:67]
  v_mfma_f32_16x16x32_bf16 v[32:35], v[188:191], v[176:179], v[32:35]
  v_mfma_f32_16x16x32_bf16 v[68:71], v[192:195], v[176:179], v[68:71]
  s_nop 7
  s_nop 1
  s_lshr_b32 s27, s22, 5
  v_mov_b32 v160, 0
  v_max3_f32 v160, |v0|, |v1|, v160
  v_max3_f32 v160, |v2|, |v3|, v160
  v_max3_f32 v160, |v4|, |v5|, v160
  v_max3_f32 v160, |v6|, |v7|, v160
  v_max3_f32 v160, |v8|, |v9|, v160
  v_max3_f32 v160, |v10|, |v11|, v160
  v_max3_f32 v160, |v12|, |v13|, v160
  v_max3_f32 v160, |v14|, |v15|, v160
  v_max3_f32 v160, |v16|, |v17|, v160
  v_max3_f32 v160, |v18|, |v19|, v160
  v_max3_f32 v160, |v20|, |v21|, v160
  v_max3_f32 v160, |v22|, |v23|, v160
  v_max3_f32 v160, |v24|, |v25|, v160
  v_max3_f32 v160, |v26|, |v27|, v160
  v_max3_f32 v160, |v28|, |v29|, v160
  v_max3_f32 v160, |v30|, |v31|, v160
  v_max3_f32 v160, |v32|, |v33|, v160
  v_max3_f32 v160, |v34|, |v35|, v160
  v_max3_f32 v160, |v36|, |v37|, v160
  v_max3_f32 v160, |v38|, |v39|, v160
  v_max3_f32 v160, |v40|, |v41|, v160
  v_max3_f32 v160, |v42|, |v43|, v160
  v_max3_f32 v160, |v44|, |v45|, v160
  v_max3_f32 v160, |v46|, |v47|, v160
  v_max3_f32 v160, |v48|, |v49|, v160
  v_max3_f32 v160, |v50|, |v51|, v160
  v_max3_f32 v160, |v52|, |v53|, v160
  v_max3_f32 v160, |v54|, |v55|, v160
  v_max3_f32 v160, |v56|, |v57|, v160
  v_max3_f32 v160, |v58|, |v59|, v160
  v_max3_f32 v160, |v60|, |v61|, v160
  v_max3_f32 v160, |v62|, |v63|, v160
  v_max3_f32 v160, |v64|, |v65|, v160
  v_max3_f32 v160, |v66|, |v67|, v160
  v_max3_f32 v160, |v68|, |v69|, v160
  v_max3_f32 v160, |v70|, |v71|, v160
  s_and_b32 s46, s23, 3
  s_mul_i32 s46, s46, 1310720
  s_mul_i32 s47, s27, 2560
  s_add_u32 s46, s46, s47
  s_add_u32 s46, s46, 1152
  v_and_b32 v146, 15, v230
  v_bfe_u32 v147, v230, 4, 1
  v_bfe_u32 v148, v230, 5, 1
  v_mul_u32_u24 v147, 304, v147
  v_lshl_add_u32 v147, v148, 3, v147
  s_mov_b32 s47, 163840
  v_add_u32 v148, 0, v146
  v_mul_u32_u24 v149, 57, v148
  v_lshrrev_b32 v149, 10, v149
  v_mul_u32_u24 v150, 18, v149
  v_sub_u32 v148, v148, v150
  v_mul_lo_u32 v149, v149, s47
  v_lshl_add_u32 v149, v148, 4, v149
  v_add_u32 v149, v149, v147
  v_cvt_pk_bf16_f32 v152, v0, v1
  v_cvt_pk_bf16_f32 v153, v2, v3
  buffer_store_dwordx2 v[152:153], v149, s[40:43], s46 offen offset:0
  v_cvt_pk_bf16_f32 v154, v36, v37
  v_cvt_pk_bf16_f32 v155, v38, v39
  buffer_store_dwordx2 v[154:155], v149, s[40:43], s46 offen offset:608
  s_nop 0
  v_add_u32 v148, 16, v146
  v_mul_u32_u24 v149, 57, v148
  v_lshrrev_b32 v149, 10, v149
  v_mul_u32_u24 v150, 18, v149
  v_sub_u32 v148, v148, v150
  v_mul_lo_u32 v149, v149, s47
  v_lshl_add_u32 v149, v148, 4, v149
  v_add_u32 v149, v149, v147
  v_cvt_pk_bf16_f32 v152, v4, v5
  v_cvt_pk_bf16_f32 v153, v6, v7
  buffer_store_dwordx2 v[152:153], v149, s[40:43], s46 offen offset:0
  v_cvt_pk_bf16_f32 v154, v40, v41
  v_cvt_pk_bf16_f32 v155, v42, v43
  buffer_store_dwordx2 v[154:155], v149, s[40:43], s46 offen offset:608
  s_nop 0
  v_add_u32 v148, 32, v146
  v_mul_u32_u24 v149, 57, v148
  v_lshrrev_b32 v149, 10, v149
  v_mul_u32_u24 v150, 18, v149
  v_sub_u32 v148, v148, v150
  v_mul_lo_u32 v149, v149, s47
  v_lshl_add_u32 v149, v148, 4, v149
  v_add_u32 v149, v149, v147
  v_cvt_pk_bf16_f32 v152, v8, v9
  v_cvt_pk_bf16_f32 v153, v10, v11
  buffer_store_dwordx2 v[152:153], v149, s[40:43], s46 offen offset:0
  v_cvt_pk_bf16_f32 v154, v44, v45
  v_cvt_pk_bf16_f32 v155, v46, v47
  buffer_store_dwordx2 v[154:155], v149, s[40:43], s46 offen offset:608
  s_nop 0
  v_add_u32 v148, 48, v146
  v_mul_u32_u24 v149, 57, v148
  v_lshrrev_b32 v149, 10, v149
  v_mul_u32_u24 v150, 18, v149
  v_sub_u32 v148, v148, v150
  v_mul_lo_u32 v149, v149, s47
  v_lshl_add_u32 v149, v148, 4, v149
  v_add_u32 v149, v149, v147
  v_cvt_pk_bf16_f32 v152, v12, v13
  v_cvt_pk_bf16_f32 v153, v14, v15
  buffer_store_dwordx2 v[152:153], v149, s[40:43], s46 offen offset:0
  v_cvt_pk_bf16_f32 v154, v48, v49
  v_cvt_pk_bf16_f32 v155, v50, v51
  buffer_store_dwordx2 v[154:155], v149, s[40:43], s46 offen offset:608
  s_nop 0
  v_add_u32 v148, 64, v146
  v_mul_u32_u24 v149, 57, v148
  v_lshrrev_b32 v149, 10, v149
  v_mul_u32_u24 v150, 18, v149
  v_sub_u32 v148, v148, v150
  v_mul_lo_u32 v149, v149, s47
  v_lshl_add_u32 v149, v148, 4, v149
  v_add_u32 v149, v149, v147
  v_cvt_pk_bf16_f32 v152, v16, v17
  v_cvt_pk_bf16_f32 v153, v18, v19
  buffer_store_dwordx2 v[152:153], v149, s[40:43], s46 offen offset:0
  v_cvt_pk_bf16_f32 v154, v52, v53
  v_cvt_pk_bf16_f32 v155, v54, v55
  buffer_store_dwordx2 v[154:155], v149, s[40:43], s46 offen offset:608
  s_nop 0
  v_add_u32 v148, 80, v146
  v_mul_u32_u24 v149, 57, v148
  v_lshrrev_b32 v149, 10, v149
  v_mul_u32_u24 v150, 18, v149
  v_sub_u32 v148, v148, v150
  v_mul_lo_u32 v149, v149, s47
  v_lshl_add_u32 v149, v148, 4, v149
  v_add_u32 v149, v149, v147
  v_cvt_pk_bf16_f32 v152, v20, v21
  v_cvt_pk_bf16_f32 v153, v22, v23
  buffer_store_dwordx2 v[152:153], v149, s[40:43], s46 offen offset:0
  v_cvt_pk_bf16_f32 v154, v56, v57
  v_cvt_pk_bf16_f32 v155, v58, v59
  buffer_store_dwordx2 v[154:155], v149, s[40:43], s46 offen offset:608
  s_nop 0
  v_add_u32 v148, 96, v146
  v_mul_u32_u24 v149, 57, v148
  v_lshrrev_b32 v149, 10, v149
  v_mul_u32_u24 v150, 18, v149
  v_sub_u32 v148, v148, v150
  v_mul_lo_u32 v149, v149, s47
  v_lshl_add_u32 v149, v148, 4, v149
  v_add_u32 v149, v149, v147
  v_cvt_pk_bf16_f32 v152, v24, v25
  v_cvt_pk_bf16_f32 v153, v26, v27
  buffer_store_dwordx2 v[152:153], v149, s[40:43], s46 offen offset:0
  v_cvt_pk_bf16_f32 v154, v60, v61
  v_cvt_pk_bf16_f32 v155, v62, v63
  buffer_store_dwordx2 v[154:155], v149, s[40:43], s46 offen offset:608
  s_nop 0
  v_add_u32 v148, 112, v146
  v_mul_u32_u24 v149, 57, v148
  v_lshrrev_b32 v149, 10, v149
  v_mul_u32_u24 v150, 18, v149
  v_sub_u32 v148, v148, v150
  v_mul_lo_u32 v149, v149, s47
  v_lshl_add_u32 v149, v148, 4, v149
  v_add_u32 v149, v149, v147
  v_cvt_pk_bf16_f32 v152, v28, v29
  v_cvt_pk_bf16_f32 v153, v30, v31
  buffer_store_dwordx2 v[152:153], v149, s[40:43], s46 offen offset:0
  v_cvt_pk_bf16_f32 v154, v64, v65
  v_cvt_pk_bf16_f32 v155, v66, v67
  buffer_store_dwordx2 v[154:155], v149, s[40:43], s46 offen offset:608
  s_nop 0
  v_add_u32 v148, 128, v146
  v_mul_u32_u24 v149, 57, v148
  v_lshrrev_b32 v149, 10, v149
  v_mul_u32_u24 v150, 18, v149
  v_sub_u32 v148, v148, v150
  v_mul_lo_u32 v149, v149, s47
  v_lshl_add_u32 v149, v148, 4, v149
  v_add_u32 v149, v149, v147
  v_cvt_pk_bf16_f32 v152, v32, v33
  v_cvt_pk_bf16_f32 v153, v34, v35
  buffer_store_dwordx2 v[152:153], v149, s[40:43], s46 offen offset:0
  v_cvt_pk_bf16_f32 v154, v68, v69
  v_cvt_pk_bf16_f32 v155, v70, v71
  buffer_store_dwordx2 v[154:155], v149, s[40:43], s46 offen offset:608
  s_nop 0
  v_and_b32 v146, 63, v230
  v_bfe_u32 v147, v146, 2, 3
  v_mul_lo_u32 v147, v147, s47
  v_and_b32 v148, 3, v146
  v_mul_u32_u24 v148, 304, v148
  v_add_u32 v147, v147, v148
  v_add_u32 v147, 288, v147
  v_mov_b32 v152, 0x3f803f80
  v_mov_b32 v153, 0x3f803f80
  v_mov_b32 v154, 0x3f803f80
  v_mov_b32 v155, 0x3f803f80
  buffer_store_dwordx4 v[152:155], v147, s[40:43], s46 offen
  s_nop 1
  v_max_f32_dpp v160, v160, v160 row_ror:8 row_mask:0xf bank_mask:0xf
  s_nop 1
  v_max_f32_dpp v160, v160, v160 row_ror:4 row_mask:0xf bank_mask:0xf
  s_nop 1
  v_max_f32_dpp v160, v160, v160 row_ror:2 row_mask:0xf bank_mask:0xf
  s_nop 1
  v_max_f32_dpp v160, v160, v160 row_ror:1 row_mask:0xf bank_mask:0xf
  v_mov_b32 v161, v160
  s_nop 1
  v_permlane16_swap_b32 v161, v160
  s_nop 1
  v_max_f32 v160, v160, v161
  v_mov_b32 v161, v160
  s_nop 1
  v_permlane32_swap_b32 v161, v160
  s_nop 1
  v_max_f32 v160, v160, v161
  s_lshl_b32 s46, s23, 8
  s_lshl_b32 s47, s27, 2
  s_add_u32 s46, s46, s47
  s_sub_u32 s46, s46, 1024
  v_mov_b32 v146, 0
  buffer_store_dword v160, v146, s[48:51], s46 offen
  s_endpgm
k1_kernel_GATE:
  s_sub_u32 s18, s2, 448
  s_lshl_b32 s18, s18, 5
  s_waitcnt lgkmcnt(0)
  s_mov_b32 s28, s4
  s_mov_b32 s29, s5
  s_mov_b32 s30, 2359296
  s_mov_b32 s31, 0x20000
  s_mov_b32 s32, s14
  s_mov_b32 s33, s15
  s_mov_b32 s34, 1152
  s_mov_b32 s35, 0x20000
  s_add_u32 s36, s16, 26480640
  s_addc_u32 s37, s17, 0
  s_mov_b32 s38, 8192
  s_mov_b32 s39, 0x20000
  v_lshrrev_b32 v146, 3, v230
  v_add_u32 v146, s18, v146
  v_and_b32 v147, 7, v230
  v_lshlrev_b32 v147, 4, v147
  v_mul_u32_u24 v148, 1152, v146
  v_add_u32 v148, v148, v147
  buffer_load_dwordx4 v[0:3], v148, s[28:31], 0 offen offset:0
  buffer_load_dwordx4 v[36:39], v147, s[32:35], 0 offen offset:0
  buffer_load_dwordx4 v[4:7], v148, s[28:31], 0 offen offset:128
  buffer_load_dwordx4 v[40:43], v147, s[32:35], 0 offen offset:128
  buffer_load_dwordx4 v[8:11], v148, s[28:31], 0 offen offset:256
  buffer_load_dwordx4 v[44:47], v147, s[32:35], 0 offen offset:256
  buffer_load_dwordx4 v[12:15], v148, s[28:31], 0 offen offset:384
  buffer_load_dwordx4 v[48:51], v147, s[32:35], 0 offen offset:384
  buffer_load_dwordx4 v[16:19], v148, s[28:31], 0 offen offset:512
  buffer_load_dwordx4 v[52:55], v147, s[32:35], 0 offen offset:512
  buffer_load_dwordx4 v[20:23], v148, s[28:31], 0 offen offset:640
  buffer_load_dwordx4 v[56:59], v147, s[32:35], 0 offen offset:640
  buffer_load_dwordx4 v[24:27], v148, s[28:31], 0 offen offset:768
  buffer_load_dwordx4 v[60:63], v147, s[32:35], 0 offen offset:768
  buffer_load_dwordx4 v[28:31], v148, s[28:31], 0 offen offset:896
  buffer_load_dwordx4 v[64:67], v147, s[32:35], 0 offen offset:896
  buffer_load_dwordx4 v[32:35], v148, s[28:31], 0 offen offset:1024
  buffer_load_dwordx4 v[68:71], v147, s[32:35], 0 offen offset:1024
  s_load_dwordx2 s[60:61], s[0:1], 48
  s_load_dwordx2 s[62:63], s[0:1], 16
  s_mov_b32 s48, s10
  s_mov_b32 s49, s11
  s_mov_b32 s50, 5308416
  s_mov_b32 s51, 0x20000
  s_mov_b32 s52, s6
  s_mov_b32 s53, s7
  s_mov_b32 s54, 1990656
  s_mov_b32 s55, 0x20000
  v_lshlrev_b32 v82, 7, v230
  s_lshl_b32 s19, s18, 10
  v_add_u32 v82, s19, v82
  buffer_load_dword v100, v82, s[48:51], 0 offen
  v_add_u32 v82, 2097152, v82
  buffer_load_dword v101, v82, s[48:51], 0 offen
  v_add_u32 v82, 2097152, v82
  buffer_load_dword v102, v82, s[48:51], 0 offen
  v_lshlrev_b32 v82, 7, v230
  s_lshl_b32 s19, s18, 10
  v_add_u32 v82, s19, v82
  buffer_load_dword v108, v82, s[52:55], 0 offen
  s_waitcnt vmcnt(4)
  v_mov_b32 v80, 0
  v_mov_b32 v81, 0
  v_lshlrev_b32 v72, 16, v0
  v_lshlrev_b32 v73, 16, v36
  v_fmac_f32 v80, v72, v73
  v_and_b32 v74, 0xffff0000, v0
  v_and_b32 v75, 0xffff0000, v36
  v_fmac_f32 v81, v74, v75
  v_lshlrev_b32 v72, 16, v1
  v_lshlrev_b32 v73, 16, v37
  v_fmac_f32 v80, v72, v73
  v_and_b32 v74, 0xffff0000, v1
  v_and_b32 v75, 0xffff0000, v37
  v_fmac_f32 v81, v74, v75
  v_lshlrev_b32 v72, 16, v2
  v_lshlrev_b32 v73, 16, v38
  v_fmac_f32 v80, v72, v73
  v_and_b32 v74, 0xffff0000, v2
  v_and_b32 v75, 0xffff0000, v38
  v_fmac_f32 v81, v74, v75
  v_lshlrev_b32 v72, 16, v3
  v_lshlrev_b32 v73, 16, v39
  v_fmac_f32 v80, v72, v73
  v_and_b32 v74, 0xffff0000, v3
  v_and_b32 v75, 0xffff0000, v39
  v_fmac_f32 v81, v74, v75
  v_lshlrev_b32 v72, 16, v4
  v_lshlrev_b32 v73, 16, v40
  v_fmac_f32 v80, v72, v73
  v_and_b32 v74, 0xffff0000, v4
  v_and_b32 v75, 0xffff0000, v40
  v_fmac_f32 v81, v74, v75
  v_lshlrev_b32 v72, 16, v5
  v_lshlrev_b32 v73, 16, v41
  v_fmac_f32 v80, v72, v73
  v_and_b32 v74, 0xffff0000, v5
  v_and_b32 v75, 0xffff0000, v41
  v_fmac_f32 v81, v74, v75
  v_lshlrev_b32 v72, 16, v6
  v_lshlrev_b32 v73, 16, v42
  v_fmac_f32 v80, v72, v73
  v_and_b32 v74, 0xffff0000, v6
  v_and_b32 v75, 0xffff0000, v42
  v_fmac_f32 v81, v74, v75
  v_lshlrev_b32 v72, 16, v7
  v_lshlrev_b32 v73, 16, v43
  v_fmac_f32 v80, v72, v73
  v_and_b32 v74, 0xffff0000, v7
  v_and_b32 v75, 0xffff0000, v43
  v_fmac_f32 v81, v74, v75
  v_lshlrev_b32 v72, 16, v8
  v_lshlrev_b32 v73, 16, v44
  v_fmac_f32 v80, v72, v73
  v_and_b32 v74, 0xffff0000, v8
  v_and_b32 v75, 0xffff0000, v44
  v_fmac_f32 v81, v74, v75
  v_lshlrev_b32 v72, 16, v9
  v_lshlrev_b32 v73, 16, v45
  v_fmac_f32 v80, v72, v73
  v_and_b32 v74, 0xffff0000, v9
  v_and_b32 v75, 0xffff0000, v45
  v_fmac_f32 v81, v74, v75
  v_lshlrev_b32 v72, 16, v10
  v_lshlrev_b32 v73, 16, v46
  v_fmac_f32 v80, v72, v73
  v_and_b32 v74, 0xffff0000, v10
  v_and_b32 v75, 0xffff0000, v46
  v_fmac_f32 v81, v74, v75
  v_lshlrev_b32 v72, 16, v11
  v_lshlrev_b32 v73, 16, v47
  v_fmac_f32 v80, v72, v73
  v_and_b32 v74, 0xffff0000, v11
  v_and_b32 v75, 0xffff0000, v47
  v_fmac_f32 v81, v74, v75
  v_lshlrev_b32 v72, 16, v12
  v_lshlrev_b32 v73, 16, v48
  v_fmac_f32 v80, v72, v73
  v_and_b32 v74, 0xffff0000, v12
  v_and_b32 v75, 0xffff0000, v48
  v_fmac_f32 v81, v74, v75
  v_lshlrev_b32 v72, 16, v13
  v_lshlrev_b32 v73, 16, v49
  v_fmac_f32 v80, v72, v73
  v_and_b32 v74, 0xffff0000, v13
  v_and_b32 v75, 0xffff0000, v49
  v_fmac_f32 v81, v74, v75
  v_lshlrev_b32 v72, 16, v14
  v_lshlrev_b32 v73, 16, v50
  v_fmac_f32 v80, v72, v73
  v_and_b32 v74, 0xffff0000, v14
  v_and_b32 v75, 0xffff0000, v50
  v_fmac_f32 v81, v74, v75
  v_lshlrev_b32 v72, 16, v15
  v_lshlrev_b32 v73, 16, v51
  v_fmac_f32 v80, v72, v73
  v_and_b32 v74, 0xffff0000, v15
  v_and_b32 v75, 0xffff0000, v51
  v_fmac_f32 v81, v74, v75
  v_lshlrev_b32 v72, 16, v16
  v_lshlrev_b32 v73, 16, v52
  v_fmac_f32 v80, v72, v73
  v_and_b32 v74, 0xffff0000, v16
  v_and_b32 v75, 0xffff0000, v52
  v_fmac_f32 v81, v74, v75
  v_lshlrev_b32 v72, 16, v17
  v_lshlrev_b32 v73, 16, v53
  v_fmac_f32 v80, v72, v73
  v_and_b32 v74, 0xffff0000, v17
  v_and_b32 v75, 0xffff0000, v53
  v_fmac_f32 v81, v74, v75
  v_lshlrev_b32 v72, 16, v18
  v_lshlrev_b32 v73, 16, v54
  v_fmac_f32 v80, v72, v73
  v_and_b32 v74, 0xffff0000, v18
  v_and_b32 v75, 0xffff0000, v54
  v_fmac_f32 v81, v74, v75
  v_lshlrev_b32 v72, 16, v19
  v_lshlrev_b32 v73, 16, v55
  v_fmac_f32 v80, v72, v73
  v_and_b32 v74, 0xffff0000, v19
  v_and_b32 v75, 0xffff0000, v55
  v_fmac_f32 v81, v74, v75
  v_lshlrev_b32 v72, 16, v20
  v_lshlrev_b32 v73, 16, v56
  v_fmac_f32 v80, v72, v73
  v_and_b32 v74, 0xffff0000, v20
  v_and_b32 v75, 0xffff0000, v56
  v_fmac_f32 v81, v74, v75
  v_lshlrev_b32 v72, 16, v21
  v_lshlrev_b32 v73, 16, v57
  v_fmac_f32 v80, v72, v73
  v_and_b32 v74, 0xffff0000, v21
  v_and_b32 v75, 0xffff0000, v57
  v_fmac_f32 v81, v74, v75
  v_lshlrev_b32 v72, 16, v22
  v_lshlrev_b32 v73, 16, v58
  v_fmac_f32 v80, v72, v73
  v_and_b32 v74, 0xffff0000, v22
  v_and_b32 v75, 0xffff0000, v58
  v_fmac_f32 v81, v74, v75
  v_lshlrev_b32 v72, 16, v23
  v_lshlrev_b32 v73, 16, v59
  v_fmac_f32 v80, v72, v73
  v_and_b32 v74, 0xffff0000, v23
  v_and_b32 v75, 0xffff0000, v59
  v_fmac_f32 v81, v74, v75
  v_lshlrev_b32 v72, 16, v24
  v_lshlrev_b32 v73, 16, v60
  v_fmac_f32 v80, v72, v73
  v_and_b32 v74, 0xffff0000, v24
  v_and_b32 v75, 0xffff0000, v60
  v_fmac_f32 v81, v74, v75
  v_lshlrev_b32 v72, 16, v25
  v_lshlrev_b32 v73, 16, v61
  v_fmac_f32 v80, v72, v73
  v_and_b32 v74, 0xffff0000, v25
  v_and_b32 v75, 0xffff0000, v61
  v_fmac_f32 v81, v74, v75
  v_lshlrev_b32 v72, 16, v26
  v_lshlrev_b32 v73, 16, v62
  v_fmac_f32 v80, v72, v73
  v_and_b32 v74, 0xffff0000, v26
  v_and_b32 v75, 0xffff0000, v62
  v_fmac_f32 v81, v74, v75
  v_lshlrev_b32 v72, 16, v27
  v_lshlrev_b32 v73, 16, v63
  v_fmac_f32 v80, v72, v73
  v_and_b32 v74, 0xffff0000, v27
  v_and_b32 v75, 0xffff0000, v63
  v_fmac_f32 v81, v74, v75
  v_lshlrev_b32 v72, 16, v28
  v_lshlrev_b32 v73, 16, v64
  v_fmac_f32 v80, v72, v73
  v_and_b32 v74, 0xffff0000, v28
  v_and_b32 v75, 0xffff0000, v64
  v_fmac_f32 v81, v74, v75
  v_lshlrev_b32 v72, 16, v29
  v_lshlrev_b32 v73, 16, v65
  v_fmac_f32 v80, v72, v73
  v_and_b32 v74, 0xffff0000, v29
  v_and_b32 v75, 0xffff0000, v65
  v_fmac_f32 v81, v74, v75
  v_lshlrev_b32 v72, 16, v30
  v_lshlrev_b32 v73, 16, v66
  v_fmac_f32 v80, v72, v73
  v_and_b32 v74, 0xffff0000, v30
  v_and_b32 v75, 0xffff0000, v66
  v_fmac_f32 v81, v74, v75
  v_lshlrev_b32 v72, 16, v31
  v_lshlrev_b32 v73, 16, v67
  v_fmac_f32 v80, v72, v73
  v_and_b32 v74, 0xffff0000, v31
  v_and_b32 v75, 0xffff0000, v67
  v_fmac_f32 v81, v74, v75
  v_lshlrev_b32 v72, 16, v32
  v_lshlrev_b32 v73, 16, v68
  v_fmac_f32 v80, v72, v73
  v_and_b32 v74, 0xffff0000, v32
  v_and_b32 v75, 0xffff0000, v68
  v_fmac_f32 v81, v74, v75
  v_lshlrev_b32 v72, 16, v33
  v_lshlrev_b32 v73, 16, v69
  v_fmac_f32 v80, v72, v73
  v_and_b32 v74, 0xffff0000, v33
  v_and_b32 v75, 0xffff0000, v69
  v_fmac_f32 v81, v74, v75
  v_lshlrev_b32 v72, 16, v34
  v_lshlrev_b32 v73, 16, v70
  v_fmac_f32 v80, v72, v73
  v_and_b32 v74, 0xffff0000, v34
  v_and_b32 v75, 0xffff0000, v70
  v_fmac_f32 v81, v74, v75
  v_lshlrev_b32 v72, 16, v35
  v_lshlrev_b32 v73, 16, v71
  v_fmac_f32 v80, v72, v73
  v_and_b32 v74, 0xffff0000, v35
  v_and_b32 v75, 0xffff0000, v71
  v_fmac_f32 v81, v74, v75
  v_add_f32 v80, v80, v81
  s_nop 1
  v_add_f32_dpp v80, v80, v80 quad_perm:[1,0,3,2] row_mask:0xf bank_mask:0xf
  s_nop 1
  v_add_f32_dpp v80, v80, v80 quad_perm:[2,3,0,1] row_mask:0xf bank_mask:0xf
  s_nop 1
  v_add_f32_dpp v80, v80, v80 row_half_mirror row_mask:0xf bank_mask:0xf
  v_mul_f32 v80, 0xbfb8aa3b, v80
  v_exp_f32 v80, v80
  s_nop 0
  v_add_f32 v80, 1.0, v80
  v_rcp_f32 v80, v80
  v_lshlrev_b32 v146, 2, v146
  s_nop 0
  buffer_store_dword v80, v146, s[36:39], 0 offen
  s_waitcnt lgkmcnt(0)
  s_mov_b32 s40, s60
  s_mov_b32 s41, s61
  s_mov_b32 s42, 5308416
  s_mov_b32 s43, 0x20000
  s_mov_b32 s44, s62
  s_mov_b32 s45, s63
  s_mov_b32 s46, 663552
  s_mov_b32 s47, 0x20000
  v_lshlrev_b32 v82, 7, v230
  s_lshl_b32 s19, s18, 10
  v_add_u32 v82, s19, v82
  buffer_load_dword v84, v82, s[40:43], 0 offen
  v_add_u32 v82, 2097152, v82
  buffer_load_dword v85, v82, s[40:43], 0 offen
  v_add_u32 v82, 2097152, v82
  buffer_load_dword v86, v82, s[40:43], 0 offen
  v_lshlrev_b32 v82, 7, v230
  s_lshl_b32 s19, s18, 10
  v_add_u32 v82, s19, v82
  buffer_load_dword v92, v82, s[44:47], 0 offen
  s_waitcnt vmcnt(0)
k1_kernel_END:
  s_endpgm
.globl k2_kernel
.p2align 8
.type k2_kernel,@function
k2_kernel:
  s_cmp_ge_u32 s2, 768
  s_cbranch_scc1 k2_kernel_END
  s_nop 0
  s_load_dwordx2 s[8:9], s[0:1], 48
  s_load_dwordx2 s[16:17], s[0:1], 88
  v_lshrrev_b32 v1, 6, v0
  s_nop 0
  v_readfirstlane_b32 s21, v1
  s_cmp_ge_u32 s2, 256
  s_cbranch_scc1 k2_kernel_ATT
  v_mov_b32 v70, v0
  s_and_b32 s25, s2, 7
  s_lshr_b32 s19, s2, 3
  s_lshr_b32 s18, s25, 1
  s_and_b32 s23, s19, 3
  s_lshr_b32 s24, s19, 2
  s_and_b32 s25, s25, 1
  s_lshl_b32 s25, s25, 3
  s_add_u32 s24, s24, s25
  s_mul_i32 s44, s24, 144
  s_mul_i32 s25, s18, 36
  s_add_u32 s44, s44, s25
  s_lshl_b32 s44, s44, 13
  s_mul_i32 s26, s18, 1327104
  s_mul_i32 s25, s23, 288
  s_add_u32 s26, s26, s25
  s_waitcnt lgkmcnt(0)
  s_mov_b32 s28, s16
  s_mov_b32 s29, s17
  s_mov_b32 s30, 18874368
  s_mov_b32 s31, 0x20000
  s_mov_b32 s32, s8
  s_mov_b32 s33, s9
  s_mov_b32 s34, 5308416
  s_mov_b32 s35, 0x20000
  s_add_u32 s40, s16, 28848128
  s_addc_u32 s41, s17, 0
  s_mov_b32 s42, 9437184
  s_mov_b32 s43, 0x20000
  s_mov_b32 s56, s44
  v_and_b32 v61, 63, v70
  s_mul_i32 s52, s21, 144
  v_add_u32 v62, s52, v61
  v_min_u32 v62, 575, v62
  v_mul_u32_u24 v63, 3641, v62
  v_lshrrev_b32 v63, 16, v63
  v_mul_u32_u24 v64, 18, v63
  v_sub_u32 v64, v62, v64
  v_bfe_u32 v65, v63, 2, 2
  v_lshlrev_b32 v65, 3, v65
  v_and_b32 v62, 3, v63
  v_add_u32 v65, v65, v62
  v_lshrrev_b32 v62, 4, v63
  v_lshl_add_u32 v65, v62, 2, v65
  v_mul_u32_u24 v65, 1152, v65
  v_lshl_add_u32 v65, v64, 4, v65
  v_mov_b32 v52, v65
  v_add_u32 v62, s52, v61
  v_add_u32 v62, 64, v62
  v_min_u32 v62, 575, v62
  v_mul_u32_u24 v63, 3641, v62
  v_lshrrev_b32 v63, 16, v63
  v_mul_u32_u24 v64, 18, v63
  v_sub_u32 v64, v62, v64
  v_bfe_u32 v65, v63, 2, 2
  v_lshlrev_b32 v65, 3, v65
  v_and_b32 v62, 3, v63
  v_add_u32 v65, v65, v62
  v_lshrrev_b32 v62, 4, v63
  v_lshl_add_u32 v65, v62, 2, v65
  v_mul_u32_u24 v65, 1152, v65
  v_lshl_add_u32 v65, v64, 4, v65
  v_subrev_u32 v53, 1024, v65
  v_add_u32 v62, s52, v61
  v_add_u32 v62, 128, v62
  v_min_u32 v62, 575, v62
  v_mul_u32_u24 v63, 3641, v62
  v_lshrrev_b32 v63, 16, v63
  v_mul_u32_u24 v64, 18, v63
  v_sub_u32 v64, v62, v64
  v_bfe_u32 v65, v63, 2, 2
  v_lshlrev_b32 v65, 3, v65
  v_and_b32 v62, 3, v63
  v_add_u32 v65, v65, v62
  v_lshrrev_b32 v62, 4, v63
  v_lshl_add_u32 v65, v62, 2, v65
  v_mul_u32_u24 v65, 1152, v65
  v_lshl_add_u32 v65, v64, 4, v65
  v_subrev_u32 v54, 2048, v65
  s_lshl_b32 s52, s52, 4
  s_add_u32 s52, s52, 8192
  v_lshrrev_b32 v62, 2, v61
  v_mul_u32_u24 v62, 288, v62
  v_and_b32 v63, 3, v61
  v_lshl_add_u32 v59, v63, 3, v62
  s_mov_b32 s54, 8192
  v_add_u32 v59, s54, v59
  s_mul_i32 s53, s21, 128
  v_add_u32 v62, s53, v61
  v_lshlrev_b32 v63, 4, v62
  v_mov_b32 v57, v63
  v_add_u32 v62, s53, v61
  v_add_u32 v62, 64, v62
  v_lshlrev_b32 v63, 4, v62
  v_subrev_u32 v58, 1024, v63
  s_lshl_b32 s53, s53, 4
  v_and_b32 v62, 15, v61
  v_bfe_u32 v63, v61, 3, 1
  v_mul_u32_u24 v63, 3, v63
  v_lshrrev_b32 v64, 4, v61
  v_xor_b32 v63, v63, v64
  v_lshlrev_b32 v63, 4, v63
  v_lshl_add_u32 v60, v62, 6, v63
  s_lshr_b32 s54, s21, 0
  s_mul_i32 s54, s54, 2048
  v_add_u32 v60, s54, v60
  s_add_u32 m0, s52, 0
  s_nop 0
  buffer_load_dwordx4 v52, s[32:35], s26 offen offset:0 lds
  buffer_load_dwordx4 v53, s[32:35], s26 offen offset:1024 lds
  s_mov_b64 exec, 0xffff
  buffer_load_dwordx4 v54, s[32:35], s26 offen offset:2048 lds
  s_mov_b64 exec, -1
  s_add_u32 s26, s26, 36864
  s_add_u32 m0, s53, 0
  s_nop 0
  buffer_load_dwordx4 v57, s[28:31], s44 offen offset:0 lds
  buffer_load_dwordx4 v58, s[28:31], s44 offen offset:1024 lds
  s_add_u32 s44, s44, 8192
  s_add_u32 m0, s52, 17408
  s_nop 0
  buffer_load_dwordx4 v52, s[32:35], s26 offen offset:0 lds
  buffer_load_dwordx4 v53, s[32:35], s26 offen offset:1024 lds
  s_mov_b64 exec, 0xffff
  buffer_load_dwordx4 v54, s[32:35], s26 offen offset:2048 lds
  s_mov_b64 exec, -1
  s_add_u32 s26, s26, 36864
  s_add_u32 m0, s53, 17408
  s_nop 0
  buffer_load_dwordx4 v57, s[28:31], s44 offen offset:0 lds
  buffer_load_dwordx4 v58, s[28:31], s44 offen offset:1024 lds
  s_add_u32 s44, s44, 8192
  s_add_u32 m0, s52, 34816
  s_nop 0
  buffer_load_dwordx4 v52, s[32:35], s26 offen offset:0 lds
  buffer_load_dwordx4 v53, s[32:35], s26 offen offset:1024 lds
  s_mov_b64 exec, 0xffff
  buffer_load_dwordx4 v54, s[32:35], s26 offen offset:2048 lds
  s_mov_b64 exec, -1
  s_add_u32 s26, s26, 36864
  s_add_u32 m0, s53, 34816
  s_nop 0
  buffer_load_dwordx4 v57, s[28:31], s44 offen offset:0 lds
  buffer_load_dwordx4 v58, s[28:31], s44 offen offset:1024 lds
  s_add_u32 s44, s44, 8192
  v_accvgpr_write_b32 a0, 0
  v_accvgpr_write_b32 a1, 0
  v_accvgpr_write_b32 a2, 0
  v_accvgpr_write_b32 a3, 0
  v_accvgpr_write_b32 a4, 0
  v_accvgpr_write_b32 a5, 0
  v_accvgpr_write_b32 a6, 0
  v_accvgpr_write_b32 a7, 0
  v_accvgpr_write_b32 a8, 0
  v_accvgpr_write_b32 a9, 0
  v_accvgpr_write_b32 a10, 0
  v_accvgpr_write_b32 a11, 0
  v_accvgpr_write_b32 a12, 0
  v_accvgpr_write_b32 a13, 0
  v_accvgpr_write_b32 a14, 0
  v_accvgpr_write_b32 a15, 0
  v_accvgpr_write_b32 a16, 0
  v_accvgpr_write_b32 a17, 0
  v_accvgpr_write_b32 a18, 0
  v_accvgpr_write_b32 a19, 0
  v_accvgpr_write_b32 a20, 0
  v_accvgpr_write_b32 a21, 0
  v_accvgpr_write_b32 a22, 0
  v_accvgpr_write_b32 a23, 0
  v_accvgpr_write_b32 a24, 0
  v_accvgpr_write_b32 a25, 0
  v_accvgpr_write_b32 a26, 0
  v_accvgpr_write_b32 a27, 0
  v_accvgpr_write_b32 a28, 0
  v_accvgpr_write_b32 a29, 0
  v_accvgpr_write_b32 a30, 0
  v_accvgpr_write_b32 a31, 0
  v_accvgpr_write_b32 a32, 0
  v_accvgpr_write_b32 a33, 0
  v_accvgpr_write_b32 a34, 0
  v_accvgpr_write_b32 a35, 0
  v_accvgpr_write_b32 a36, 0
  v_accvgpr_write_b32 a37, 0
  v_accvgpr_write_b32 a38, 0
  v_accvgpr_write_b32 a39, 0
  v_accvgpr_write_b32 a40, 0
  v_accvgpr_write_b32 a41, 0
  v_accvgpr_write_b32 a42, 0
  v_accvgpr_write_b32 a43, 0
  v_accvgpr_write_b32 a44, 0
  v_accvgpr_write_b32 a45, 0
  v_accvgpr_write_b32 a46, 0
  v_accvgpr_write_b32 a47, 0
  v_accvgpr_write_b32 a48, 0
  v_accvgpr_write_b32 a49, 0
  v_accvgpr_write_b32 a50, 0
  v_accvgpr_write_b32 a51, 0
  v_accvgpr_write_b32 a52, 0
  v_accvgpr_write_b32 a53, 0
  v_accvgpr_write_b32 a54, 0
  v_accvgpr_write_b32 a55, 0
  v_accvgpr_write_b32 a56, 0
  v_accvgpr_write_b32 a57, 0
  v_accvgpr_write_b32 a58, 0
  v_accvgpr_write_b32 a59, 0
  v_accvgpr_write_b32 a60, 0
  v_accvgpr_write_b32 a61, 0
  v_accvgpr_write_b32 a62, 0
  v_accvgpr_write_b32 a63, 0
  v_accvgpr_write_b32 a64, 0
  v_accvgpr_write_b32 a65, 0
  v_accvgpr_write_b32 a66, 0
  v_accvgpr_write_b32 a67, 0
  v_accvgpr_write_b32 a68, 0
  v_accvgpr_write_b32 a69, 0
  v_accvgpr_write_b32 a70, 0
  v_accvgpr_write_b32 a71, 0
  s_waitcnt vmcnt(10)
  s_barrier
  ds_read_b128 v[36:39], v60 offset:0
  ds_read_b128 v[40:43], v60 offset:1024
  ds_read_b64_tr_b16 v[0:1], v59 offset:0
  ds_read_b64_tr_b16 v[2:3], v59 offset:4608
  ds_read_b64_tr_b16 v[4:5], v59 offset:32
  ds_read_b64_tr_b16 v[6:7], v59 offset:4640
  ds_read_b64_tr_b16 v[8:9], v59 offset:64
  ds_read_b64_tr_b16 v[10:11], v59 offset:4672
  ds_read_b64_tr_b16 v[12:13], v59 offset:96
  ds_read_b64_tr_b16 v[14:15], v59 offset:4704
  ds_read_b64_tr_b16 v[16:17], v59 offset:128
  ds_read_b64_tr_b16 v[18:19], v59 offset:4736
  ds_read_b64_tr_b16 v[20:21], v59 offset:160
  ds_read_b64_tr_b16 v[22:23], v59 offset:4768
  ds_read_b64_tr_b16 v[24:25], v59 offset:192
  ds_read_b64_tr_b16 v[26:27], v59 offset:4800
  ds_read_b64_tr_b16 v[28:29], v59 offset:224
  ds_read_b64_tr_b16 v[30:31], v59 offset:4832
  ds_read_b64_tr_b16 v[32:33], v59 offset:256
  ds_read_b64_tr_b16 v[34:35], v59 offset:4864
  s_waitcnt vmcnt(5)
  s_waitcnt lgkmcnt(0)
  s_barrier
  ds_read_b128 v[44:47], v60 offset:17408
  ds_read_b128 v[48:51], v60 offset:18432
  v_mfma_f32_16x16x32_bf16 a[0:3], v[0:3], v[36:39], a[0:3]
  s_add_u32 m0, s52, 0
  s_nop 0
  buffer_load_dwordx4 v52, s[32:35], s26 offen offset:0 lds
  v_mfma_f32_16x16x32_bf16 a[36:39], v[0:3], v[40:43], a[36:39]
  ds_read_b64_tr_b16 v[0:1], v59 offset:17408
  ds_read_b64_tr_b16 v[2:3], v59 offset:22016
  v_mfma_f32_16x16x32_bf16 a[4:7], v[4:7], v[36:39], a[4:7]
  buffer_load_dwordx4 v53, s[32:35], s26 offen offset:1024 lds
  v_mfma_f32_16x16x32_bf16 a[40:43], v[4:7], v[40:43], a[40:43]
  ds_read_b64_tr_b16 v[4:5], v59 offset:17440
  ds_read_b64_tr_b16 v[6:7], v59 offset:22048
  v_mfma_f32_16x16x32_bf16 a[8:11], v[8:11], v[36:39], a[8:11]
  s_mov_b64 exec, 0xffff
  buffer_load_dwordx4 v54, s[32:35], s26 offen offset:2048 lds
  s_mov_b64 exec, -1
  s_add_u32 s26, s26, 36864
  v_mfma_f32_16x16x32_bf16 a[44:47], v[8:11], v[40:43], a[44:47]
  ds_read_b64_tr_b16 v[8:9], v59 offset:17472
  ds_read_b64_tr_b16 v[10:11], v59 offset:22080
  v_mfma_f32_16x16x32_bf16 a[12:15], v[12:15], v[36:39], a[12:15]
  s_add_u32 m0, s53, 0
  s_nop 0
  buffer_load_dwordx4 v57, s[28:31], s44 offen offset:0 lds
  v_mfma_f32_16x16x32_bf16 a[48:51], v[12:15], v[40:43], a[48:51]
  ds_read_b64_tr_b16 v[12:13], v59 offset:17504
  ds_read_b64_tr_b16 v[14:15], v59 offset:22112
  v_mfma_f32_16x16x32_bf16 a[16:19], v[16:19], v[36:39], a[16:19]
  buffer_load_dwordx4 v58, s[28:31], s44 offen offset:1024 lds
  s_add_u32 s44, s44, 8192
  v_mfma_f32_16x16x32_bf16 a[52:55], v[16:19], v[40:43], a[52:55]
  ds_read_b64_tr_b16 v[16:17], v59 offset:17536
  ds_read_b64_tr_b16 v[18:19], v59 offset:22144
  v_mfma_f32_16x16x32_bf16 a[20:23], v[20:23], v[36:39], a[20:23]
  v_mfma_f32_16x16x32_bf16 a[56:59], v[20:23], v[40:43], a[56:59]
  ds_read_b64_tr_b16 v[20:21], v59 offset:17568
  ds_read_b64_tr_b16 v[22:23], v59 offset:22176
  v_mfma_f32_16x16x32_bf16 a[24:27], v[24:27], v[36:39], a[24:27]
  v_mfma_f32_16x16x32_bf16 a[60:63], v[24:27], v[40:43], a[60:63]
  ds_read_b64_tr_b16 v[24:25], v59 offset:17600
  ds_read_b64_tr_b16 v[26:27], v59 offset:22208
  v_mfma_f32_16x16x32_bf16 a[28:31], v[28:31], v[36:39], a[28:31]
  v_mfma_f32_16x16x32_bf16 a[64:67], v[28:31], v[40:43], a[64:67]
  ds_read_b64_tr_b16 v[28:29], v59 offset:17632
  ds_read_b64_tr_b16 v[30:31], v59 offset:22240
  v_mfma_f32_16x16x32_bf16 a[32:35], v[32:35], v[36:39], a[32:35]
  v_mfma_f32_16x16x32_bf16 a[68:71], v[32:35], v[40:43], a[68:71]
  ds_read_b64_tr_b16 v[32:33], v59 offset:17664
  ds_read_b64_tr_b16 v[34:35], v59 offset:22272
  s_waitcnt vmcnt(5)
  s_waitcnt lgkmcnt(0)
  s_barrier
  ds_read_b128 v[36:39], v60 offset:34816
  ds_read_b128 v[40:43], v60 offset:35840
  v_mfma_f32_16x16x32_bf16 a[0:3], v[0:3], v[44:47], a[0:3]
  s_add_u32 m0, s52, 17408
  s_nop 0
  buffer_load_dwordx4 v52, s[32:35], s26 offen offset:0 lds
  v_mfma_f32_16x16x32_bf16 a[36:39], v[0:3], v[48:51], a[36:39]
  ds_read_b64_tr_b16 v[0:1], v59 offset:34816
  ds_read_b64_tr_b16 v[2:3], v59 offset:39424
  v_mfma_f32_16x16x32_bf16 a[4:7], v[4:7], v[44:47], a[4:7]
  buffer_load_dwordx4 v53, s[32:35], s26 offen offset:1024 lds
  v_mfma_f32_16x16x32_bf16 a[40:43], v[4:7], v[48:51], a[40:43]
  ds_read_b64_tr_b16 v[4:5], v59 offset:34848
  ds_read_b64_tr_b16 v[6:7], v59 offset:39456
  v_mfma_f32_16x16x32_bf16 a[8:11], v[8:11], v[44:47], a[8:11]
  s_mov_b64 exec, 0xffff
  buffer_load_dwordx4 v54, s[32:35], s26 offen offset:2048 lds
  s_mov_b64 exec, -1
  s_add_u32 s26, s26, 36864
  v_mfma_f32_16x16x32_bf16 a[44:47], v[8:11], v[48:51], a[44:47]
  ds_read_b64_tr_b16 v[8:9], v59 offset:34880
  ds_read_b64_tr_b16 v[10:11], v59 offset:39488
  v_mfma_f32_16x16x32_bf16 a[12:15], v[12:15], v[44:47], a[12:15]
  s_add_u32 m0, s53, 17408
  s_nop 0
  buffer_load_dwordx4 v57, s[28:31], s44 offen offset:0 lds
  v_mfma_f32_16x16x32_bf16 a[48:51], v[12:15], v[48:51], a[48:51]
  ds_read_b64_tr_b16 v[12:13], v59 offset:34912
  ds_read_b64_tr_b16 v[14:15], v59 offset:39520
  v_mfma_f32_16x16x32_bf16 a[16:19], v[16:19], v[44:47], a[16:19]
  buffer_load_dwordx4 v58, s[28:31], s44 offen offset:1024 lds
  s_add_u32 s44, s44, 8192
  v_mfma_f32_16x16x32_bf16 a[52:55], v[16:19], v[48:51], a[52:55]
  ds_read_b64_tr_b16 v[16:17], v59 offset:34944
  ds_read_b64_tr_b16 v[18:19], v59 offset:39552
  v_mfma_f32_16x16x32_bf16 a[20:23], v[20:23], v[44:47], a[20:23]
  v_mfma_f32_16x16x32_bf16 a[56:59], v[20:23], v[48:51], a[56:59]
  ds_read_b64_tr_b16 v[20:21], v59 offset:34976
  ds_read_b64_tr_b16 v[22:23], v59 offset:39584
  v_mfma_f32_16x16x32_bf16 a[24:27], v[24:27], v[44:47], a[24:27]
  v_mfma_f32_16x16x32_bf16 a[60:63], v[24:27], v[48:51], a[60:63]
  ds_read_b64_tr_b16 v[24:25], v59 offset:35008
  ds_read_b64_tr_b16 v[26:27], v59 offset:39616
  v_mfma_f32_16x16x32_bf16 a[28:31], v[28:31], v[44:47], a[28:31]
  v_mfma_f32_16x16x32_bf16 a[64:67], v[28:31], v[48:51], a[64:67]
  ds_read_b64_tr_b16 v[28:29], v59 offset:35040
  ds_read_b64_tr_b16 v[30:31], v59 offset:39648
  v_mfma_f32_16x16x32_bf16 a[32:35], v[32:35], v[44:47], a[32:35]
  v_mfma_f32_16x16x32_bf16 a[68:71], v[32:35], v[48:51], a[68:71]
  ds_read_b64_tr_b16 v[32:33], v59 offset:35072
  ds_read_b64_tr_b16 v[34:35], v59 offset:39680
  s_waitcnt vmcnt(5)
  s_waitcnt lgkmcnt(0)
  s_barrier
  ds_read_b128 v[44:47], v60 offset:0
  ds_read_b128 v[48:51], v60 offset:1024
  v_mfma_f32_16x16x32_bf16 a[0:3], v[0:3], v[36:39], a[0:3]
  s_add_u32 m0, s52, 34816
  s_nop 0
  buffer_load_dwordx4 v52, s[32:35], s26 offen offset:0 lds
  v_mfma_f32_16x16x32_bf16 a[36:39], v[0:3], v[40:43], a[36:39]
  ds_read_b64_tr_b16 v[0:1], v59 offset:0
  ds_read_b64_tr_b16 v[2:3], v59 offset:4608
  v_mfma_f32_16x16x32_bf16 a[4:7], v[4:7], v[36:39], a[4:7]
  buffer_load_dwordx4 v53, s[32:35], s26 offen offset:1024 lds
  v_mfma_f32_16x16x32_bf16 a[40:43], v[4:7], v[40:43], a[40:43]
  ds_read_b64_tr_b16 v[4:5], v59 offset:32
  ds_read_b64_tr_b16 v[6:7], v59 offset:4640
  v_mfma_f32_16x16x32_bf16 a[8:11], v[8:11], v[36:39], a[8:11]
  s_mov_b64 exec, 0xffff
  buffer_load_dwordx4 v54, s[32:35], s26 offen offset:2048 lds
  s_mov_b64 exec, -1
  s_add_u32 s26, s26, 36864
  v_mfma_f32_16x16x32_bf16 a[44:47], v[8:11], v[40:43], a[44:47]
  ds_read_b64_tr_b16 v[8:9], v59 offset:64
  ds_read_b64_tr_b16 v[10:11], v59 offset:4672
  v_mfma_f32_16x16x32_bf16 a[12:15], v[12:15], v[36:39], a[12:15]
  s_add_u32 m0, s53, 34816
  s_nop 0
  buffer_load_dwordx4 v57, s[28:31], s44 offen offset:0 lds
  v_mfma_f32_16x16x32_bf16 a[48:51], v[12:15], v[40:43], a[48:51]
  ds_read_b64_tr_b16 v[12:13], v59 offset:96
  ds_read_b64_tr_b16 v[14:15], v59 offset:4704
  v_mfma_f32_16x16x32_bf16 a[16:19], v[16:19], v[36:39], a[16:19]
  buffer_load_dwordx4 v58, s[28:31], s44 offen offset:1024 lds
  s_add_u32 s44, s44, 8192
  v_mfma_f32_16x16x32_bf16 a[52:55], v[16:19], v[40:43], a[52:55]
  ds_read_b64_tr_b16 v[16:17], v59 offset:128
  ds_read_b64_tr_b16 v[18:19], v59 offset:4736
  v_mfma_f32_16x16x32_bf16 a[20:23], v[20:23], v[36:39], a[20:23]
  v_mfma_f32_16x16x32_bf16 a[56:59], v[20:23], v[40:43], a[56:59]
  ds_read_b64_tr_b16 v[20:21], v59 offset:160
  ds_read_b64_tr_b16 v[22:23], v59 offset:4768
  v_mfma_f32_16x16x32_bf16 a[24:27], v[24:27], v[36:39], a[24:27]
  v_mfma_f32_16x16x32_bf16 a[60:63], v[24:27], v[40:43], a[60:63]
  ds_read_b64_tr_b16 v[24:25], v59 offset:192
  ds_read_b64_tr_b16 v[26:27], v59 offset:4800
  v_mfma_f32_16x16x32_bf16 a[28:31], v[28:31], v[36:39], a[28:31]
  v_mfma_f32_16x16x32_bf16 a[64:67], v[28:31], v[40:43], a[64:67]
  ds_read_b64_tr_b16 v[28:29], v59 offset:224
  ds_read_b64_tr_b16 v[30:31], v59 offset:4832
  v_mfma_f32_16x16x32_bf16 a[32:35], v[32:35], v[36:39], a[32:35]
  v_mfma_f32_16x16x32_bf16 a[68:71], v[32:35], v[40:43], a[68:71]
  ds_read_b64_tr_b16 v[32:33], v59 offset:256
  ds_read_b64_tr_b16 v[34:35], v59 offset:4864
  s_waitcnt vmcnt(5)
  s_waitcnt lgkmcnt(0)
  s_barrier
  ds_read_b128 v[36:39], v60 offset:17408
  ds_read_b128 v[40:43], v60 offset:18432
  v_mfma_f32_16x16x32_bf16 a[0:3], v[0:3], v[44:47], a[0:3]
  s_add_u32 m0, s52, 0
  s_nop 0
  buffer_load_dwordx4 v52, s[32:35], s26 offen offset:0 lds
  v_mfma_f32_16x16x32_bf16 a[36:39], v[0:3], v[48:51], a[36:39]
  ds_read_b64_tr_b16 v[0:1], v59 offset:17408
  ds_read_b64_tr_b16 v[2:3], v59 offset:22016
  v_mfma_f32_16x16x32_bf16 a[4:7], v[4:7], v[44:47], a[4:7]
  buffer_load_dwordx4 v53, s[32:35], s26 offen offset:1024 lds
  v_mfma_f32_16x16x32_bf16 a[40:43], v[4:7], v[48:51], a[40:43]
  ds_read_b64_tr_b16 v[4:5], v59 offset:17440
  ds_read_b64_tr_b16 v[6:7], v59 offset:22048
  v_mfma_f32_16x16x32_bf16 a[8:11], v[8:11], v[44:47], a[8:11]
  s_mov_b64 exec, 0xffff
  buffer_load_dwordx4 v54, s[32:35], s26 offen offset:2048 lds
  s_mov_b64 exec, -1
  s_add_u32 s26, s26, 36864
  v_mfma_f32_16x16x32_bf16 a[44:47], v[8:11], v[48:51], a[44:47]
  ds_read_b64_tr_b16 v[8:9], v59 offset:17472
  ds_read_b64_tr_b16 v[10:11], v59 offset:22080
  v_mfma_f32_16x16x32_bf16 a[12:15], v[12:15], v[44:47], a[12:15]
  s_add_u32 m0, s53, 0
  s_nop 0
  buffer_load_dwordx4 v57, s[28:31], s44 offen offset:0 lds
  v_mfma_f32_16x16x32_bf16 a[48:51], v[12:15], v[48:51], a[48:51]
  ds_read_b64_tr_b16 v[12:13], v59 offset:17504
  ds_read_b64_tr_b16 v[14:15], v59 offset:22112
  v_mfma_f32_16x16x32_bf16 a[16:19], v[16:19], v[44:47], a[16:19]
  buffer_load_dwordx4 v58, s[28:31], s44 offen offset:1024 lds
  s_add_u32 s44, s44, 8192
  v_mfma_f32_16x16x32_bf16 a[52:55], v[16:19], v[48:51], a[52:55]
  ds_read_b64_tr_b16 v[16:17], v59 offset:17536
  ds_read_b64_tr_b16 v[18:19], v59 offset:22144
  v_mfma_f32_16x16x32_bf16 a[20:23], v[20:23], v[44:47], a[20:23]
  v_mfma_f32_16x16x32_bf16 a[56:59], v[20:23], v[48:51], a[56:59]
  ds_read_b64_tr_b16 v[20:21], v59 offset:17568
  ds_read_b64_tr_b16 v[22:23], v59 offset:22176
  v_mfma_f32_16x16x32_bf16 a[24:27], v[24:27], v[44:47], a[24:27]
  v_mfma_f32_16x16x32_bf16 a[60:63], v[24:27], v[48:51], a[60:63]
  ds_read_b64_tr_b16 v[24:25], v59 offset:17600
  ds_read_b64_tr_b16 v[26:27], v59 offset:22208
  v_mfma_f32_16x16x32_bf16 a[28:31], v[28:31], v[44:47], a[28:31]
  v_mfma_f32_16x16x32_bf16 a[64:67], v[28:31], v[48:51], a[64:67]
  ds_read_b64_tr_b16 v[28:29], v59 offset:17632
  ds_read_b64_tr_b16 v[30:31], v59 offset:22240
  v_mfma_f32_16x16x32_bf16 a[32:35], v[32:35], v[44:47], a[32:35]
  v_mfma_f32_16x16x32_bf16 a[68:71], v[32:35], v[48:51], a[68:71]
  ds_read_b64_tr_b16 v[32:33], v59 offset:17664
  ds_read_b64_tr_b16 v[34:35], v59 offset:22272
  s_waitcnt vmcnt(5)
  s_waitcnt lgkmcnt(0)
  s_barrier
  ds_read_b128 v[44:47], v60 offset:34816
  ds_read_b128 v[48:51], v60 offset:35840
  v_mfma_f32_16x16x32_bf16 a[0:3], v[0:3], v[36:39], a[0:3]
  s_add_u32 m0, s52, 17408
  s_nop 0
  buffer_load_dwordx4 v52, s[32:35], s26 offen offset:0 lds
  v_mfma_f32_16x16x32_bf16 a[36:39], v[0:3], v[40:43], a[36:39]
  ds_read_b64_tr_b16 v[0:1], v59 offset:34816
  ds_read_b64_tr_b16 v[2:3], v59 offset:39424
  v_mfma_f32_16x16x32_bf16 a[4:7], v[4:7], v[36:39], a[4:7]
  buffer_load_dwordx4 v53, s[32:35], s26 offen offset:1024 lds
  v_mfma_f32_16x16x32_bf16 a[40:43], v[4:7], v[40:43], a[40:43]
  ds_read_b64_tr_b16 v[4:5], v59 offset:34848
  ds_read_b64_tr_b16 v[6:7], v59 offset:39456
  v_mfma_f32_16x16x32_bf16 a[8:11], v[8:11], v[36:39], a[8:11]
  s_mov_b64 exec, 0xffff
  buffer_load_dwordx4 v54, s[32:35], s26 offen offset:2048 lds
  s_mov_b64 exec, -1
  s_add_u32 s26, s26, 36864
  v_mfma_f32_16x16x32_bf16 a[44:47], v[8:11], v[40:43], a[44:47]
  ds_read_b64_tr_b16 v[8:9], v59 offset:34880
  ds_read_b64_tr_b16 v[10:11], v59 offset:39488
  v_mfma_f32_16x16x32_bf16 a[12:15], v[12:15], v[36:39], a[12:15]
  s_add_u32 m0, s53, 17408
  s_nop 0
  buffer_load_dwordx4 v57, s[28:31], s44 offen offset:0 lds
  v_mfma_f32_16x16x32_bf16 a[48:51], v[12:15], v[40:43], a[48:51]
  ds_read_b64_tr_b16 v[12:13], v59 offset:34912
  ds_read_b64_tr_b16 v[14:15], v59 offset:39520
  v_mfma_f32_16x16x32_bf16 a[16:19], v[16:19], v[36:39], a[16:19]
  buffer_load_dwordx4 v58, s[28:31], s44 offen offset:1024 lds
  s_add_u32 s44, s44, 8192
  v_mfma_f32_16x16x32_bf16 a[52:55], v[16:19], v[40:43], a[52:55]
  ds_read_b64_tr_b16 v[16:17], v59 offset:34944
  ds_read_b64_tr_b16 v[18:19], v59 offset:39552
  v_mfma_f32_16x16x32_bf16 a[20:23], v[20:23], v[36:39], a[20:23]
  v_mfma_f32_16x16x32_bf16 a[56:59], v[20:23], v[40:43], a[56:59]
  ds_read_b64_tr_b16 v[20:21], v59 offset:34976
  ds_read_b64_tr_b16 v[22:23], v59 offset:39584
  v_mfma_f32_16x16x32_bf16 a[24:27], v[24:27], v[36:39], a[24:27]
  v_mfma_f32_16x16x32_bf16 a[60:63], v[24:27], v[40:43], a[60:63]
  ds_read_b64_tr_b16 v[24:25], v59 offset:35008
  ds_read_b64_tr_b16 v[26:27], v59 offset:39616
  v_mfma_f32_16x16x32_bf16 a[28:31], v[28:31], v[36:39], a[28:31]
  v_mfma_f32_16x16x32_bf16 a[64:67], v[28:31], v[40:43], a[64:67]
  ds_read_b64_tr_b16 v[28:29], v59 offset:35040
  ds_read_b64_tr_b16 v[30:31], v59 offset:39648
  v_mfma_f32_16x16x32_bf16 a[32:35], v[32:35], v[36:39], a[32:35]
  v_mfma_f32_16x16x32_bf16 a[68:71], v[32:35], v[40:43], a[68:71]
  ds_read_b64_tr_b16 v[32:33], v59 offset:35072
  ds_read_b64_tr_b16 v[34:35], v59 offset:39680
  s_waitcnt vmcnt(5)
  s_waitcnt lgkmcnt(0)
  s_barrier
  ds_read_b128 v[36:39], v60 offset:0
  ds_read_b128 v[40:43], v60 offset:1024
  v_mfma_f32_16x16x32_bf16 a[0:3], v[0:3], v[44:47], a[0:3]
  s_add_u32 m0, s52, 34816
  s_nop 0
  buffer_load_dwordx4 v52, s[32:35], s26 offen offset:0 lds
  v_mfma_f32_16x16x32_bf16 a[36:39], v[0:3], v[48:51], a[36:39]
  ds_read_b64_tr_b16 v[0:1], v59 offset:0
  ds_read_b64_tr_b16 v[2:3], v59 offset:4608
  v_mfma_f32_16x16x32_bf16 a[4:7], v[4:7], v[44:47], a[4:7]
  buffer_load_dwordx4 v53, s[32:35], s26 offen offset:1024 lds
  v_mfma_f32_16x16x32_bf16 a[40:43], v[4:7], v[48:51], a[40:43]
  ds_read_b64_tr_b16 v[4:5], v59 offset:32
  ds_read_b64_tr_b16 v[6:7], v59 offset:4640
  v_mfma_f32_16x16x32_bf16 a[8:11], v[8:11], v[44:47], a[8:11]
  s_mov_b64 exec, 0xffff
  buffer_load_dwordx4 v54, s[32:35], s26 offen offset:2048 lds
  s_mov_b64 exec, -1
  s_add_u32 s26, s26, 36864
  v_mfma_f32_16x16x32_bf16 a[44:47], v[8:11], v[48:51], a[44:47]
  ds_read_b64_tr_b16 v[8:9], v59 offset:64
  ds_read_b64_tr_b16 v[10:11], v59 offset:4672
  v_mfma_f32_16x16x32_bf16 a[12:15], v[12:15], v[44:47], a[12:15]
  s_add_u32 m0, s53, 34816
  s_nop 0
  buffer_load_dwordx4 v57, s[28:31], s44 offen offset:0 lds
  v_mfma_f32_16x16x32_bf16 a[48:51], v[12:15], v[48:51], a[48:51]
  ds_read_b64_tr_b16 v[12:13], v59 offset:96
  ds_read_b64_tr_b16 v[14:15], v59 offset:4704
  v_mfma_f32_16x16x32_bf16 a[16:19], v[16:19], v[44:47], a[16:19]
  buffer_load_dwordx4 v58, s[28:31], s44 offen offset:1024 lds
  s_add_u32 s44, s44, 8192
  v_mfma_f32_16x16x32_bf16 a[52:55], v[16:19], v[48:51], a[52:55]
  ds_read_b64_tr_b16 v[16:17], v59 offset:128
  ds_read_b64_tr_b16 v[18:19], v59 offset:4736
  v_mfma_f32_16x16x32_bf16 a[20:23], v[20:23], v[44:47], a[20:23]
  v_mfma_f32_16x16x32_bf16 a[56:59], v[20:23], v[48:51], a[56:59]
  ds_read_b64_tr_b16 v[20:21], v59 offset:160
  ds_read_b64_tr_b16 v[22:23], v59 offset:4768
  v_mfma_f32_16x16x32_bf16 a[24:27], v[24:27], v[44:47], a[24:27]
  v_mfma_f32_16x16x32_bf16 a[60:63], v[24:27], v[48:51], a[60:63]
  ds_read_b64_tr_b16 v[24:25], v59 offset:192
  ds_read_b64_tr_b16 v[26:27], v59 offset:4800
  v_mfma_f32_16x16x32_bf16 a[28:31], v[28:31], v[44:47], a[28:31]
  v_mfma_f32_16x16x32_bf16 a[64:67], v[28:31], v[48:51], a[64:67]
  ds_read_b64_tr_b16 v[28:29], v59 offset:224
  ds_read_b64_tr_b16 v[30:31], v59 offset:4832
  v_mfma_f32_16x16x32_bf16 a[32:35], v[32:35], v[44:47], a[32:35]
  v_mfma_f32_16x16x32_bf16 a[68:71], v[32:35], v[48:51], a[68:71]
  ds_read_b64_tr_b16 v[32:33], v59 offset:256
  ds_read_b64_tr_b16 v[34:35], v59 offset:4864
  s_waitcnt vmcnt(5)
  s_waitcnt lgkmcnt(0)
  s_barrier
  ds_read_b128 v[44:47], v60 offset:17408
  ds_read_b128 v[48:51], v60 offset:18432
  v_mfma_f32_16x16x32_bf16 a[0:3], v[0:3], v[36:39], a[0:3]
  s_add_u32 m0, s52, 0
  s_nop 0
  buffer_load_dwordx4 v52, s[32:35], s26 offen offset:0 lds
  v_mfma_f32_16x16x32_bf16 a[36:39], v[0:3], v[40:43], a[36:39]
  ds_read_b64_tr_b16 v[0:1], v59 offset:17408
  ds_read_b64_tr_b16 v[2:3], v59 offset:22016
  v_mfma_f32_16x16x32_bf16 a[4:7], v[4:7], v[36:39], a[4:7]
  buffer_load_dwordx4 v53, s[32:35], s26 offen offset:1024 lds
  v_mfma_f32_16x16x32_bf16 a[40:43], v[4:7], v[40:43], a[40:43]
  ds_read_b64_tr_b16 v[4:5], v59 offset:17440
  ds_read_b64_tr_b16 v[6:7], v59 offset:22048
  v_mfma_f32_16x16x32_bf16 a[8:11], v[8:11], v[36:39], a[8:11]
  s_mov_b64 exec, 0xffff
  buffer_load_dwordx4 v54, s[32:35], s26 offen offset:2048 lds
  s_mov_b64 exec, -1
  s_add_u32 s26, s26, 36864
  v_mfma_f32_16x16x32_bf16 a[44:47], v[8:11], v[40:43], a[44:47]
  ds_read_b64_tr_b16 v[8:9], v59 offset:17472
  ds_read_b64_tr_b16 v[10:11], v59 offset:22080
  v_mfma_f32_16x16x32_bf16 a[12:15], v[12:15], v[36:39], a[12:15]
  s_add_u32 m0, s53, 0
  s_nop 0
  buffer_load_dwordx4 v57, s[28:31], s44 offen offset:0 lds
  v_mfma_f32_16x16x32_bf16 a[48:51], v[12:15], v[40:43], a[48:51]
  ds_read_b64_tr_b16 v[12:13], v59 offset:17504
  ds_read_b64_tr_b16 v[14:15], v59 offset:22112
  v_mfma_f32_16x16x32_bf16 a[16:19], v[16:19], v[36:39], a[16:19]
  buffer_load_dwordx4 v58, s[28:31], s44 offen offset:1024 lds
  s_add_u32 s44, s44, 8192
  v_mfma_f32_16x16x32_bf16 a[52:55], v[16:19], v[40:43], a[52:55]
  ds_read_b64_tr_b16 v[16:17], v59 offset:17536
  ds_read_b64_tr_b16 v[18:19], v59 offset:22144
  v_mfma_f32_16x16x32_bf16 a[20:23], v[20:23], v[36:39], a[20:23]
  v_mfma_f32_16x16x32_bf16 a[56:59], v[20:23], v[40:43], a[56:59]
  ds_read_b64_tr_b16 v[20:21], v59 offset:17568
  ds_read_b64_tr_b16 v[22:23], v59 offset:22176
  v_mfma_f32_16x16x32_bf16 a[24:27], v[24:27], v[36:39], a[24:27]
  v_mfma_f32_16x16x32_bf16 a[60:63], v[24:27], v[40:43], a[60:63]
  ds_read_b64_tr_b16 v[24:25], v59 offset:17600
  ds_read_b64_tr_b16 v[26:27], v59 offset:22208
  v_mfma_f32_16x16x32_bf16 a[28:31], v[28:31], v[36:39], a[28:31]
  v_mfma_f32_16x16x32_bf16 a[64:67], v[28:31], v[40:43], a[64:67]
  ds_read_b64_tr_b16 v[28:29], v59 offset:17632
  ds_read_b64_tr_b16 v[30:31], v59 offset:22240
  v_mfma_f32_16x16x32_bf16 a[32:35], v[32:35], v[36:39], a[32:35]
  v_mfma_f32_16x16x32_bf16 a[68:71], v[32:35], v[40:43], a[68:71]
  ds_read_b64_tr_b16 v[32:33], v59 offset:17664
  ds_read_b64_tr_b16 v[34:35], v59 offset:22272
  s_waitcnt vmcnt(5)
  s_waitcnt lgkmcnt(0)
  s_barrier
  ds_read_b128 v[36:39], v60 offset:34816
  ds_read_b128 v[40:43], v60 offset:35840
  v_mfma_f32_16x16x32_bf16 a[0:3], v[0:3], v[44:47], a[0:3]
  s_add_u32 m0, s52, 17408
  s_nop 0
  buffer_load_dwordx4 v52, s[32:35], s26 offen offset:0 lds
  v_mfma_f32_16x16x32_bf16 a[36:39], v[0:3], v[48:51], a[36:39]
  ds_read_b64_tr_b16 v[0:1], v59 offset:34816
  ds_read_b64_tr_b16 v[2:3], v59 offset:39424
  v_mfma_f32_16x16x32_bf16 a[4:7], v[4:7], v[44:47], a[4:7]
  buffer_load_dwordx4 v53, s[32:35], s26 offen offset:1024 lds
  v_mfma_f32_16x16x32_bf16 a[40:43], v[4:7], v[48:51], a[40:43]
  ds_read_b64_tr_b16 v[4:5], v59 offset:34848
  ds_read_b64_tr_b16 v[6:7], v59 offset:39456
  v_mfma_f32_16x16x32_bf16 a[8:11], v[8:11], v[44:47], a[8:11]
  s_mov_b64 exec, 0xffff
  buffer_load_dwordx4 v54, s[32:35], s26 offen offset:2048 lds
  s_mov_b64 exec, -1
  s_add_u32 s26, s26, 36864
  v_mfma_f32_16x16x32_bf16 a[44:47], v[8:11], v[48:51], a[44:47]
  ds_read_b64_tr_b16 v[8:9], v59 offset:34880
  ds_read_b64_tr_b16 v[10:11], v59 offset:39488
  v_mfma_f32_16x16x32_bf16 a[12:15], v[12:15], v[44:47], a[12:15]
  s_add_u32 m0, s53, 17408
  s_nop 0
  buffer_load_dwordx4 v57, s[28:31], s44 offen offset:0 lds
  v_mfma_f32_16x16x32_bf16 a[48:51], v[12:15], v[48:51], a[48:51]
  ds_read_b64_tr_b16 v[12:13], v59 offset:34912
  ds_read_b64_tr_b16 v[14:15], v59 offset:39520
  v_mfma_f32_16x16x32_bf16 a[16:19], v[16:19], v[44:47], a[16:19]
  buffer_load_dwordx4 v58, s[28:31], s44 offen offset:1024 lds
  s_add_u32 s44, s44, 8192
  v_mfma_f32_16x16x32_bf16 a[52:55], v[16:19], v[48:51], a[52:55]
  ds_read_b64_tr_b16 v[16:17], v59 offset:34944
  ds_read_b64_tr_b16 v[18:19], v59 offset:39552
  v_mfma_f32_16x16x32_bf16 a[20:23], v[20:23], v[44:47], a[20:23]
  v_mfma_f32_16x16x32_bf16 a[56:59], v[20:23], v[48:51], a[56:59]
  ds_read_b64_tr_b16 v[20:21], v59 offset:34976
  ds_read_b64_tr_b16 v[22:23], v59 offset:39584
  v_mfma_f32_16x16x32_bf16 a[24:27], v[24:27], v[44:47], a[24:27]
  v_mfma_f32_16x16x32_bf16 a[60:63], v[24:27], v[48:51], a[60:63]
  ds_read_b64_tr_b16 v[24:25], v59 offset:35008
  ds_read_b64_tr_b16 v[26:27], v59 offset:39616
  v_mfma_f32_16x16x32_bf16 a[28:31], v[28:31], v[44:47], a[28:31]
  v_mfma_f32_16x16x32_bf16 a[64:67], v[28:31], v[48:51], a[64:67]
  ds_read_b64_tr_b16 v[28:29], v59 offset:35040
  ds_read_b64_tr_b16 v[30:31], v59 offset:39648
  v_mfma_f32_16x16x32_bf16 a[32:35], v[32:35], v[44:47], a[32:35]
  v_mfma_f32_16x16x32_bf16 a[68:71], v[32:35], v[48:51], a[68:71]
  ds_read_b64_tr_b16 v[32:33], v59 offset:35072
  ds_read_b64_tr_b16 v[34:35], v59 offset:39680
  s_waitcnt vmcnt(5)
  s_waitcnt lgkmcnt(0)
  s_barrier
  ds_read_b128 v[44:47], v60 offset:0
  ds_read_b128 v[48:51], v60 offset:1024
  v_mfma_f32_16x16x32_bf16 a[0:3], v[0:3], v[36:39], a[0:3]
  s_add_u32 m0, s52, 34816
  s_nop 0
  buffer_load_dwordx4 v52, s[32:35], s26 offen offset:0 lds
  v_mfma_f32_16x16x32_bf16 a[36:39], v[0:3], v[40:43], a[36:39]
  ds_read_b64_tr_b16 v[0:1], v59 offset:0
  ds_read_b64_tr_b16 v[2:3], v59 offset:4608
  v_mfma_f32_16x16x32_bf16 a[4:7], v[4:7], v[36:39], a[4:7]
  buffer_load_dwordx4 v53, s[32:35], s26 offen offset:1024 lds
  v_mfma_f32_16x16x32_bf16 a[40:43], v[4:7], v[40:43], a[40:43]
  ds_read_b64_tr_b16 v[4:5], v59 offset:32
  ds_read_b64_tr_b16 v[6:7], v59 offset:4640
  v_mfma_f32_16x16x32_bf16 a[8:11], v[8:11], v[36:39], a[8:11]
  s_mov_b64 exec, 0xffff
  buffer_load_dwordx4 v54, s[32:35], s26 offen offset:2048 lds
  s_mov_b64 exec, -1
  s_add_u32 s26, s26, 36864
  v_mfma_f32_16x16x32_bf16 a[44:47], v[8:11], v[40:43], a[44:47]
  ds_read_b64_tr_b16 v[8:9], v59 offset:64
  ds_read_b64_tr_b16 v[10:11], v59 offset:4672
  v_mfma_f32_16x16x32_bf16 a[12:15], v[12:15], v[36:39], a[12:15]
  s_add_u32 m0, s53, 34816
  s_nop 0
  buffer_load_dwordx4 v57, s[28:31], s44 offen offset:0 lds
  v_mfma_f32_16x16x32_bf16 a[48:51], v[12:15], v[40:43], a[48:51]
  ds_read_b64_tr_b16 v[12:13], v59 offset:96
  ds_read_b64_tr_b16 v[14:15], v59 offset:4704
  v_mfma_f32_16x16x32_bf16 a[16:19], v[16:19], v[36:39], a[16:19]
  buffer_load_dwordx4 v58, s[28:31], s44 offen offset:1024 lds
  s_add_u32 s44, s44, 8192
  v_mfma_f32_16x16x32_bf16 a[52:55], v[16:19], v[40:43], a[52:55]
  ds_read_b64_tr_b16 v[16:17], v59 offset:128
  ds_read_b64_tr_b16 v[18:19], v59 offset:4736
  v_mfma_f32_16x16x32_bf16 a[20:23], v[20:23], v[36:39], a[20:23]
  v_mfma_f32_16x16x32_bf16 a[56:59], v[20:23], v[40:43], a[56:59]
  ds_read_b64_tr_b16 v[20:21], v59 offset:160
  ds_read_b64_tr_b16 v[22:23], v59 offset:4768
  v_mfma_f32_16x16x32_bf16 a[24:27], v[24:27], v[36:39], a[24:27]
  v_mfma_f32_16x16x32_bf16 a[60:63], v[24:27], v[40:43], a[60:63]
  ds_read_b64_tr_b16 v[24:25], v59 offset:192
  ds_read_b64_tr_b16 v[26:27], v59 offset:4800
  v_mfma_f32_16x16x32_bf16 a[28:31], v[28:31], v[36:39], a[28:31]
  v_mfma_f32_16x16x32_bf16 a[64:67], v[28:31], v[40:43], a[64:67]
  ds_read_b64_tr_b16 v[28:29], v59 offset:224
  ds_read_b64_tr_b16 v[30:31], v59 offset:4832
  v_mfma_f32_16x16x32_bf16 a[32:35], v[32:35], v[36:39], a[32:35]
  v_mfma_f32_16x16x32_bf16 a[68:71], v[32:35], v[40:43], a[68:71]
  ds_read_b64_tr_b16 v[32:33], v59 offset:256
  ds_read_b64_tr_b16 v[34:35], v59 offset:4864
  s_waitcnt vmcnt(5)
  s_waitcnt lgkmcnt(0)
  s_barrier
  ds_read_b128 v[36:39], v60 offset:17408
  ds_read_b128 v[40:43], v60 offset:18432
  v_mfma_f32_16x16x32_bf16 a[0:3], v[0:3], v[44:47], a[0:3]
  s_add_u32 m0, s52, 0
  s_nop 0
  buffer_load_dwordx4 v52, s[32:35], s26 offen offset:0 lds
  v_mfma_f32_16x16x32_bf16 a[36:39], v[0:3], v[48:51], a[36:39]
  ds_read_b64_tr_b16 v[0:1], v59 offset:17408
  ds_read_b64_tr_b16 v[2:3], v59 offset:22016
  v_mfma_f32_16x16x32_bf16 a[4:7], v[4:7], v[44:47], a[4:7]
  buffer_load_dwordx4 v53, s[32:35], s26 offen offset:1024 lds
  v_mfma_f32_16x16x32_bf16 a[40:43], v[4:7], v[48:51], a[40:43]
  ds_read_b64_tr_b16 v[4:5], v59 offset:17440
  ds_read_b64_tr_b16 v[6:7], v59 offset:22048
  v_mfma_f32_16x16x32_bf16 a[8:11], v[8:11], v[44:47], a[8:11]
  s_mov_b64 exec, 0xffff
  buffer_load_dwordx4 v54, s[32:35], s26 offen offset:2048 lds
  s_mov_b64 exec, -1
  s_add_u32 s26, s26, 36864
  v_mfma_f32_16x16x32_bf16 a[44:47], v[8:11], v[48:51], a[44:47]
  ds_read_b64_tr_b16 v[8:9], v59 offset:17472
  ds_read_b64_tr_b16 v[10:11], v59 offset:22080
  v_mfma_f32_16x16x32_bf16 a[12:15], v[12:15], v[44:47], a[12:15]
  s_add_u32 m0, s53, 0
  s_nop 0
  buffer_load_dwordx4 v57, s[28:31], s44 offen offset:0 lds
  v_mfma_f32_16x16x32_bf16 a[48:51], v[12:15], v[48:51], a[48:51]
  ds_read_b64_tr_b16 v[12:13], v59 offset:17504
  ds_read_b64_tr_b16 v[14:15], v59 offset:22112
  v_mfma_f32_16x16x32_bf16 a[16:19], v[16:19], v[44:47], a[16:19]
  buffer_load_dwordx4 v58, s[28:31], s44 offen offset:1024 lds
  s_add_u32 s44, s44, 8192
  v_mfma_f32_16x16x32_bf16 a[52:55], v[16:19], v[48:51], a[52:55]
  ds_read_b64_tr_b16 v[16:17], v59 offset:17536
  ds_read_b64_tr_b16 v[18:19], v59 offset:22144
  v_mfma_f32_16x16x32_bf16 a[20:23], v[20:23], v[44:47], a[20:23]
  v_mfma_f32_16x16x32_bf16 a[56:59], v[20:23], v[48:51], a[56:59]
  ds_read_b64_tr_b16 v[20:21], v59 offset:17568
  ds_read_b64_tr_b16 v[22:23], v59 offset:22176
  v_mfma_f32_16x16x32_bf16 a[24:27], v[24:27], v[44:47], a[24:27]
  v_mfma_f32_16x16x32_bf16 a[60:63], v[24:27], v[48:51], a[60:63]
  ds_read_b64_tr_b16 v[24:25], v59 offset:17600
  ds_read_b64_tr_b16 v[26:27], v59 offset:22208
  v_mfma_f32_16x16x32_bf16 a[28:31], v[28:31], v[44:47], a[28:31]
  v_mfma_f32_16x16x32_bf16 a[64:67], v[28:31], v[48:51], a[64:67]
  ds_read_b64_tr_b16 v[28:29], v59 offset:17632
  ds_read_b64_tr_b16 v[30:31], v59 offset:22240
  v_mfma_f32_16x16x32_bf16 a[32:35], v[32:35], v[44:47], a[32:35]
  v_mfma_f32_16x16x32_bf16 a[68:71], v[32:35], v[48:51], a[68:71]
  ds_read_b64_tr_b16 v[32:33], v59 offset:17664
  ds_read_b64_tr_b16 v[34:35], v59 offset:22272
  s_waitcnt vmcnt(5)
  s_waitcnt lgkmcnt(0)
  s_barrier
  ds_read_b128 v[44:47], v60 offset:34816
  ds_read_b128 v[48:51], v60 offset:35840
  v_mfma_f32_16x16x32_bf16 a[0:3], v[0:3], v[36:39], a[0:3]
  s_add_u32 m0, s52, 17408
  s_nop 0
  buffer_load_dwordx4 v52, s[32:35], s26 offen offset:0 lds
  v_mfma_f32_16x16x32_bf16 a[36:39], v[0:3], v[40:43], a[36:39]
  ds_read_b64_tr_b16 v[0:1], v59 offset:34816
  ds_read_b64_tr_b16 v[2:3], v59 offset:39424
  v_mfma_f32_16x16x32_bf16 a[4:7], v[4:7], v[36:39], a[4:7]
  buffer_load_dwordx4 v53, s[32:35], s26 offen offset:1024 lds
  v_mfma_f32_16x16x32_bf16 a[40:43], v[4:7], v[40:43], a[40:43]
  ds_read_b64_tr_b16 v[4:5], v59 offset:34848
  ds_read_b64_tr_b16 v[6:7], v59 offset:39456
  v_mfma_f32_16x16x32_bf16 a[8:11], v[8:11], v[36:39], a[8:11]
  s_mov_b64 exec, 0xffff
  buffer_load_dwordx4 v54, s[32:35], s26 offen offset:2048 lds
  s_mov_b64 exec, -1
  s_add_u32 s26, s26, 36864
  v_mfma_f32_16x16x32_bf16 a[44:47], v[8:11], v[40:43], a[44:47]
  ds_read_b64_tr_b16 v[8:9], v59 offset:34880
  ds_read_b64_tr_b16 v[10:11], v59 offset:39488
  v_mfma_f32_16x16x32_bf16 a[12:15], v[12:15], v[36:39], a[12:15]
  s_add_u32 m0, s53, 17408
  s_nop 0
  buffer_load_dwordx4 v57, s[28:31], s44 offen offset:0 lds
  v_mfma_f32_16x16x32_bf16 a[48:51], v[12:15], v[40:43], a[48:51]
  ds_read_b64_tr_b16 v[12:13], v59 offset:34912
  ds_read_b64_tr_b16 v[14:15], v59 offset:39520
  v_mfma_f32_16x16x32_bf16 a[16:19], v[16:19], v[36:39], a[16:19]
  buffer_load_dwordx4 v58, s[28:31], s44 offen offset:1024 lds
  s_add_u32 s44, s44, 8192
  v_mfma_f32_16x16x32_bf16 a[52:55], v[16:19], v[40:43], a[52:55]
  ds_read_b64_tr_b16 v[16:17], v59 offset:34944
  ds_read_b64_tr_b16 v[18:19], v59 offset:39552
  v_mfma_f32_16x16x32_bf16 a[20:23], v[20:23], v[36:39], a[20:23]
  v_mfma_f32_16x16x32_bf16 a[56:59], v[20:23], v[40:43], a[56:59]
  ds_read_b64_tr_b16 v[20:21], v59 offset:34976
  ds_read_b64_tr_b16 v[22:23], v59 offset:39584
  v_mfma_f32_16x16x32_bf16 a[24:27], v[24:27], v[36:39], a[24:27]
  v_mfma_f32_16x16x32_bf16 a[60:63], v[24:27], v[40:43], a[60:63]
  ds_read_b64_tr_b16 v[24:25], v59 offset:35008
  ds_read_b64_tr_b16 v[26:27], v59 offset:39616
  v_mfma_f32_16x16x32_bf16 a[28:31], v[28:31], v[36:39], a[28:31]
  v_mfma_f32_16x16x32_bf16 a[64:67], v[28:31], v[40:43], a[64:67]
  ds_read_b64_tr_b16 v[28:29], v59 offset:35040
  ds_read_b64_tr_b16 v[30:31], v59 offset:39648
  v_mfma_f32_16x16x32_bf16 a[32:35], v[32:35], v[36:39], a[32:35]
  v_mfma_f32_16x16x32_bf16 a[68:71], v[32:35], v[40:43], a[68:71]
  ds_read_b64_tr_b16 v[32:33], v59 offset:35072
  ds_read_b64_tr_b16 v[34:35], v59 offset:39680
  s_waitcnt vmcnt(5)
  s_waitcnt lgkmcnt(0)
  s_barrier
  ds_read_b128 v[36:39], v60 offset:0
  ds_read_b128 v[40:43], v60 offset:1024
  v_mfma_f32_16x16x32_bf16 a[0:3], v[0:3], v[44:47], a[0:3]
  s_add_u32 m0, s52, 34816
  s_nop 0
  buffer_load_dwordx4 v52, s[32:35], s26 offen offset:0 lds
  v_mfma_f32_16x16x32_bf16 a[36:39], v[0:3], v[48:51], a[36:39]
  ds_read_b64_tr_b16 v[0:1], v59 offset:0
  ds_read_b64_tr_b16 v[2:3], v59 offset:4608
  v_mfma_f32_16x16x32_bf16 a[4:7], v[4:7], v[44:47], a[4:7]
  buffer_load_dwordx4 v53, s[32:35], s26 offen offset:1024 lds
  v_mfma_f32_16x16x32_bf16 a[40:43], v[4:7], v[48:51], a[40:43]
  ds_read_b64_tr_b16 v[4:5], v59 offset:32
  ds_read_b64_tr_b16 v[6:7], v59 offset:4640
  v_mfma_f32_16x16x32_bf16 a[8:11], v[8:11], v[44:47], a[8:11]
  s_mov_b64 exec, 0xffff
  buffer_load_dwordx4 v54, s[32:35], s26 offen offset:2048 lds
  s_mov_b64 exec, -1
  s_add_u32 s26, s26, 36864
  v_mfma_f32_16x16x32_bf16 a[44:47], v[8:11], v[48:51], a[44:47]
  ds_read_b64_tr_b16 v[8:9], v59 offset:64
  ds_read_b64_tr_b16 v[10:11], v59 offset:4672
  v_mfma_f32_16x16x32_bf16 a[12:15], v[12:15], v[44:47], a[12:15]
  s_add_u32 m0, s53, 34816
  s_nop 0
  buffer_load_dwordx4 v57, s[28:31], s44 offen offset:0 lds
  v_mfma_f32_16x16x32_bf16 a[48:51], v[12:15], v[48:51], a[48:51]
  ds_read_b64_tr_b16 v[12:13], v59 offset:96
  ds_read_b64_tr_b16 v[14:15], v59 offset:4704
  v_mfma_f32_16x16x32_bf16 a[16:19], v[16:19], v[44:47], a[16:19]
  buffer_load_dwordx4 v58, s[28:31], s44 offen offset:1024 lds
  s_add_u32 s44, s44, 8192
  v_mfma_f32_16x16x32_bf16 a[52:55], v[16:19], v[48:51], a[52:55]
  ds_read_b64_tr_b16 v[16:17], v59 offset:128
  ds_read_b64_tr_b16 v[18:19], v59 offset:4736
  v_mfma_f32_16x16x32_bf16 a[20:23], v[20:23], v[44:47], a[20:23]
  v_mfma_f32_16x16x32_bf16 a[56:59], v[20:23], v[48:51], a[56:59]
  ds_read_b64_tr_b16 v[20:21], v59 offset:160
  ds_read_b64_tr_b16 v[22:23], v59 offset:4768
  v_mfma_f32_16x16x32_bf16 a[24:27], v[24:27], v[44:47], a[24:27]
  v_mfma_f32_16x16x32_bf16 a[60:63], v[24:27], v[48:51], a[60:63]
  ds_read_b64_tr_b16 v[24:25], v59 offset:192
  ds_read_b64_tr_b16 v[26:27], v59 offset:4800
  v_mfma_f32_16x16x32_bf16 a[28:31], v[28:31], v[44:47], a[28:31]
  v_mfma_f32_16x16x32_bf16 a[64:67], v[28:31], v[48:51], a[64:67]
  ds_read_b64_tr_b16 v[28:29], v59 offset:224
  ds_read_b64_tr_b16 v[30:31], v59 offset:4832
  v_mfma_f32_16x16x32_bf16 a[32:35], v[32:35], v[44:47], a[32:35]
  v_mfma_f32_16x16x32_bf16 a[68:71], v[32:35], v[48:51], a[68:71]
  ds_read_b64_tr_b16 v[32:33], v59 offset:256
  ds_read_b64_tr_b16 v[34:35], v59 offset:4864
  s_waitcnt vmcnt(5)
  s_waitcnt lgkmcnt(0)
  s_barrier
  ds_read_b128 v[44:47], v60 offset:17408
  ds_read_b128 v[48:51], v60 offset:18432
  v_mfma_f32_16x16x32_bf16 a[0:3], v[0:3], v[36:39], a[0:3]
  s_add_u32 m0, s52, 0
  s_nop 0
  buffer_load_dwordx4 v52, s[32:35], s26 offen offset:0 lds
  v_mfma_f32_16x16x32_bf16 a[36:39], v[0:3], v[40:43], a[36:39]
  ds_read_b64_tr_b16 v[0:1], v59 offset:17408
  ds_read_b64_tr_b16 v[2:3], v59 offset:22016
  v_mfma_f32_16x16x32_bf16 a[4:7], v[4:7], v[36:39], a[4:7]
  buffer_load_dwordx4 v53, s[32:35], s26 offen offset:1024 lds
  v_mfma_f32_16x16x32_bf16 a[40:43], v[4:7], v[40:43], a[40:43]
  ds_read_b64_tr_b16 v[4:5], v59 offset:17440
  ds_read_b64_tr_b16 v[6:7], v59 offset:22048
  v_mfma_f32_16x16x32_bf16 a[8:11], v[8:11], v[36:39], a[8:11]
  s_mov_b64 exec, 0xffff
  buffer_load_dwordx4 v54, s[32:35], s26 offen offset:2048 lds
  s_mov_b64 exec, -1
  s_add_u32 s26, s26, 36864
  v_mfma_f32_16x16x32_bf16 a[44:47], v[8:11], v[40:43], a[44:47]
  ds_read_b64_tr_b16 v[8:9], v59 offset:17472
  ds_read_b64_tr_b16 v[10:11], v59 offset:22080
  v_mfma_f32_16x16x32_bf16 a[12:15], v[12:15], v[36:39], a[12:15]
  s_add_u32 m0, s53, 0
  s_nop 0
  buffer_load_dwordx4 v57, s[28:31], s44 offen offset:0 lds
  v_mfma_f32_16x16x32_bf16 a[48:51], v[12:15], v[40:43], a[48:51]
  ds_read_b64_tr_b16 v[12:13], v59 offset:17504
  ds_read_b64_tr_b16 v[14:15], v59 offset:22112
  v_mfma_f32_16x16x32_bf16 a[16:19], v[16:19], v[36:39], a[16:19]
  buffer_load_dwordx4 v58, s[28:31], s44 offen offset:1024 lds
  s_add_u32 s44, s44, 8192
  v_mfma_f32_16x16x32_bf16 a[52:55], v[16:19], v[40:43], a[52:55]
  ds_read_b64_tr_b16 v[16:17], v59 offset:17536
  ds_read_b64_tr_b16 v[18:19], v59 offset:22144
  v_mfma_f32_16x16x32_bf16 a[20:23], v[20:23], v[36:39], a[20:23]
  v_mfma_f32_16x16x32_bf16 a[56:59], v[20:23], v[40:43], a[56:59]
  ds_read_b64_tr_b16 v[20:21], v59 offset:17568
  ds_read_b64_tr_b16 v[22:23], v59 offset:22176
  v_mfma_f32_16x16x32_bf16 a[24:27], v[24:27], v[36:39], a[24:27]
  v_mfma_f32_16x16x32_bf16 a[60:63], v[24:27], v[40:43], a[60:63]
  ds_read_b64_tr_b16 v[24:25], v59 offset:17600
  ds_read_b64_tr_b16 v[26:27], v59 offset:22208
  v_mfma_f32_16x16x32_bf16 a[28:31], v[28:31], v[36:39], a[28:31]
  v_mfma_f32_16x16x32_bf16 a[64:67], v[28:31], v[40:43], a[64:67]
  ds_read_b64_tr_b16 v[28:29], v59 offset:17632
  ds_read_b64_tr_b16 v[30:31], v59 offset:22240
  v_mfma_f32_16x16x32_bf16 a[32:35], v[32:35], v[36:39], a[32:35]
  v_mfma_f32_16x16x32_bf16 a[68:71], v[32:35], v[40:43], a[68:71]
  ds_read_b64_tr_b16 v[32:33], v59 offset:17664
  ds_read_b64_tr_b16 v[34:35], v59 offset:22272
  s_waitcnt vmcnt(5)
  s_waitcnt lgkmcnt(0)
  s_barrier
  ds_read_b128 v[36:39], v60 offset:34816
  ds_read_b128 v[40:43], v60 offset:35840
  v_mfma_f32_16x16x32_bf16 a[0:3], v[0:3], v[44:47], a[0:3]
  s_add_u32 m0, s52, 17408
  s_nop 0
  buffer_load_dwordx4 v52, s[32:35], s26 offen offset:0 lds
  v_mfma_f32_16x16x32_bf16 a[36:39], v[0:3], v[48:51], a[36:39]
  ds_read_b64_tr_b16 v[0:1], v59 offset:34816
  ds_read_b64_tr_b16 v[2:3], v59 offset:39424
  v_mfma_f32_16x16x32_bf16 a[4:7], v[4:7], v[44:47], a[4:7]
  buffer_load_dwordx4 v53, s[32:35], s26 offen offset:1024 lds
  v_mfma_f32_16x16x32_bf16 a[40:43], v[4:7], v[48:51], a[40:43]
  ds_read_b64_tr_b16 v[4:5], v59 offset:34848
  ds_read_b64_tr_b16 v[6:7], v59 offset:39456
  v_mfma_f32_16x16x32_bf16 a[8:11], v[8:11], v[44:47], a[8:11]
  s_mov_b64 exec, 0xffff
  buffer_load_dwordx4 v54, s[32:35], s26 offen offset:2048 lds
  s_mov_b64 exec, -1
  s_add_u32 s26, s26, 36864
  v_mfma_f32_16x16x32_bf16 a[44:47], v[8:11], v[48:51], a[44:47]
  ds_read_b64_tr_b16 v[8:9], v59 offset:34880
  ds_read_b64_tr_b16 v[10:11], v59 offset:39488
  v_mfma_f32_16x16x32_bf16 a[12:15], v[12:15], v[44:47], a[12:15]
  s_add_u32 m0, s53, 17408
  s_nop 0
  buffer_load_dwordx4 v57, s[28:31], s44 offen offset:0 lds
  v_mfma_f32_16x16x32_bf16 a[48:51], v[12:15], v[48:51], a[48:51]
  ds_read_b64_tr_b16 v[12:13], v59 offset:34912
  ds_read_b64_tr_b16 v[14:15], v59 offset:39520
  v_mfma_f32_16x16x32_bf16 a[16:19], v[16:19], v[44:47], a[16:19]
  buffer_load_dwordx4 v58, s[28:31], s44 offen offset:1024 lds
  s_add_u32 s44, s44, 8192
  v_mfma_f32_16x16x32_bf16 a[52:55], v[16:19], v[48:51], a[52:55]
  ds_read_b64_tr_b16 v[16:17], v59 offset:34944
  ds_read_b64_tr_b16 v[18:19], v59 offset:39552
  v_mfma_f32_16x16x32_bf16 a[20:23], v[20:23], v[44:47], a[20:23]
  v_mfma_f32_16x16x32_bf16 a[56:59], v[20:23], v[48:51], a[56:59]
  ds_read_b64_tr_b16 v[20:21], v59 offset:34976
  ds_read_b64_tr_b16 v[22:23], v59 offset:39584
  v_mfma_f32_16x16x32_bf16 a[24:27], v[24:27], v[44:47], a[24:27]
  v_mfma_f32_16x16x32_bf16 a[60:63], v[24:27], v[48:51], a[60:63]
  ds_read_b64_tr_b16 v[24:25], v59 offset:35008
  ds_read_b64_tr_b16 v[26:27], v59 offset:39616
  v_mfma_f32_16x16x32_bf16 a[28:31], v[28:31], v[44:47], a[28:31]
  v_mfma_f32_16x16x32_bf16 a[64:67], v[28:31], v[48:51], a[64:67]
  ds_read_b64_tr_b16 v[28:29], v59 offset:35040
  ds_read_b64_tr_b16 v[30:31], v59 offset:39648
  v_mfma_f32_16x16x32_bf16 a[32:35], v[32:35], v[44:47], a[32:35]
  v_mfma_f32_16x16x32_bf16 a[68:71], v[32:35], v[48:51], a[68:71]
  ds_read_b64_tr_b16 v[32:33], v59 offset:35072
  ds_read_b64_tr_b16 v[34:35], v59 offset:39680
  s_waitcnt vmcnt(5)
  s_waitcnt lgkmcnt(0)
  s_barrier
  ds_read_b128 v[44:47], v60 offset:0
  ds_read_b128 v[48:51], v60 offset:1024
  v_mfma_f32_16x16x32_bf16 a[0:3], v[0:3], v[36:39], a[0:3]
  s_add_u32 m0, s52, 34816
  s_nop 0
  buffer_load_dwordx4 v52, s[32:35], s26 offen offset:0 lds
  v_mfma_f32_16x16x32_bf16 a[36:39], v[0:3], v[40:43], a[36:39]
  ds_read_b64_tr_b16 v[0:1], v59 offset:0
  ds_read_b64_tr_b16 v[2:3], v59 offset:4608
  v_mfma_f32_16x16x32_bf16 a[4:7], v[4:7], v[36:39], a[4:7]
  buffer_load_dwordx4 v53, s[32:35], s26 offen offset:1024 lds
  v_mfma_f32_16x16x32_bf16 a[40:43], v[4:7], v[40:43], a[40:43]
  ds_read_b64_tr_b16 v[4:5], v59 offset:32
  ds_read_b64_tr_b16 v[6:7], v59 offset:4640
  v_mfma_f32_16x16x32_bf16 a[8:11], v[8:11], v[36:39], a[8:11]
  s_mov_b64 exec, 0xffff
  buffer_load_dwordx4 v54, s[32:35], s26 offen offset:2048 lds
  s_mov_b64 exec, -1
  s_add_u32 s26, s26, 36864
  v_mfma_f32_16x16x32_bf16 a[44:47], v[8:11], v[40:43], a[44:47]
  ds_read_b64_tr_b16 v[8:9], v59 offset:64
  ds_read_b64_tr_b16 v[10:11], v59 offset:4672
  v_mfma_f32_16x16x32_bf16 a[12:15], v[12:15], v[36:39], a[12:15]
  s_add_u32 m0, s53, 34816
  s_nop 0
  buffer_load_dwordx4 v57, s[28:31], s44 offen offset:0 lds
  v_mfma_f32_16x16x32_bf16 a[48:51], v[12:15], v[40:43], a[48:51]
  ds_read_b64_tr_b16 v[12:13], v59 offset:96
  ds_read_b64_tr_b16 v[14:15], v59 offset:4704
  v_mfma_f32_16x16x32_bf16 a[16:19], v[16:19], v[36:39], a[16:19]
  buffer_load_dwordx4 v58, s[28:31], s44 offen offset:1024 lds
  s_add_u32 s44, s44, 8192
  v_mfma_f32_16x16x32_bf16 a[52:55], v[16:19], v[40:43], a[52:55]
  ds_read_b64_tr_b16 v[16:17], v59 offset:128
  ds_read_b64_tr_b16 v[18:19], v59 offset:4736
  v_mfma_f32_16x16x32_bf16 a[20:23], v[20:23], v[36:39], a[20:23]
  v_mfma_f32_16x16x32_bf16 a[56:59], v[20:23], v[40:43], a[56:59]
  ds_read_b64_tr_b16 v[20:21], v59 offset:160
  ds_read_b64_tr_b16 v[22:23], v59 offset:4768
  v_mfma_f32_16x16x32_bf16 a[24:27], v[24:27], v[36:39], a[24:27]
  v_mfma_f32_16x16x32_bf16 a[60:63], v[24:27], v[40:43], a[60:63]
  ds_read_b64_tr_b16 v[24:25], v59 offset:192
  ds_read_b64_tr_b16 v[26:27], v59 offset:4800
  v_mfma_f32_16x16x32_bf16 a[28:31], v[28:31], v[36:39], a[28:31]
  v_mfma_f32_16x16x32_bf16 a[64:67], v[28:31], v[40:43], a[64:67]
  ds_read_b64_tr_b16 v[28:29], v59 offset:224
  ds_read_b64_tr_b16 v[30:31], v59 offset:4832
  v_mfma_f32_16x16x32_bf16 a[32:35], v[32:35], v[36:39], a[32:35]
  v_mfma_f32_16x16x32_bf16 a[68:71], v[32:35], v[40:43], a[68:71]
  ds_read_b64_tr_b16 v[32:33], v59 offset:256
  ds_read_b64_tr_b16 v[34:35], v59 offset:4864
  s_waitcnt vmcnt(5)
  s_waitcnt lgkmcnt(0)
  s_barrier
  ds_read_b128 v[36:39], v60 offset:17408
  ds_read_b128 v[40:43], v60 offset:18432
  v_mfma_f32_16x16x32_bf16 a[0:3], v[0:3], v[44:47], a[0:3]
  s_add_u32 m0, s52, 0
  s_nop 0
  buffer_load_dwordx4 v52, s[32:35], s26 offen offset:0 lds
  v_mfma_f32_16x16x32_bf16 a[36:39], v[0:3], v[48:51], a[36:39]
  ds_read_b64_tr_b16 v[0:1], v59 offset:17408
  ds_read_b64_tr_b16 v[2:3], v59 offset:22016
  v_mfma_f32_16x16x32_bf16 a[4:7], v[4:7], v[44:47], a[4:7]
  buffer_load_dwordx4 v53, s[32:35], s26 offen offset:1024 lds
  v_mfma_f32_16x16x32_bf16 a[40:43], v[4:7], v[48:51], a[40:43]
  ds_read_b64_tr_b16 v[4:5], v59 offset:17440
  ds_read_b64_tr_b16 v[6:7], v59 offset:22048
  v_mfma_f32_16x16x32_bf16 a[8:11], v[8:11], v[44:47], a[8:11]
  s_mov_b64 exec, 0xffff
  buffer_load_dwordx4 v54, s[32:35], s26 offen offset:2048 lds
  s_mov_b64 exec, -1
  s_add_u32 s26, s26, 36864
  v_mfma_f32_16x16x32_bf16 a[44:47], v[8:11], v[48:51], a[44:47]
  ds_read_b64_tr_b16 v[8:9], v59 offset:17472
  ds_read_b64_tr_b16 v[10:11], v59 offset:22080
  v_mfma_f32_16x16x32_bf16 a[12:15], v[12:15], v[44:47], a[12:15]
  s_add_u32 m0, s53, 0
  s_nop 0
  buffer_load_dwordx4 v57, s[28:31], s44 offen offset:0 lds
  v_mfma_f32_16x16x32_bf16 a[48:51], v[12:15], v[48:51], a[48:51]
  ds_read_b64_tr_b16 v[12:13], v59 offset:17504
  ds_read_b64_tr_b16 v[14:15], v59 offset:22112
  v_mfma_f32_16x16x32_bf16 a[16:19], v[16:19], v[44:47], a[16:19]
  buffer_load_dwordx4 v58, s[28:31], s44 offen offset:1024 lds
  s_add_u32 s44, s44, 8192
  v_mfma_f32_16x16x32_bf16 a[52:55], v[16:19], v[48:51], a[52:55]
  ds_read_b64_tr_b16 v[16:17], v59 offset:17536
  ds_read_b64_tr_b16 v[18:19], v59 offset:22144
  v_mfma_f32_16x16x32_bf16 a[20:23], v[20:23], v[44:47], a[20:23]
  v_mfma_f32_16x16x32_bf16 a[56:59], v[20:23], v[48:51], a[56:59]
  ds_read_b64_tr_b16 v[20:21], v59 offset:17568
  ds_read_b64_tr_b16 v[22:23], v59 offset:22176
  v_mfma_f32_16x16x32_bf16 a[24:27], v[24:27], v[44:47], a[24:27]
  v_mfma_f32_16x16x32_bf16 a[60:63], v[24:27], v[48:51], a[60:63]
  ds_read_b64_tr_b16 v[24:25], v59 offset:17600
  ds_read_b64_tr_b16 v[26:27], v59 offset:22208
  v_mfma_f32_16x16x32_bf16 a[28:31], v[28:31], v[44:47], a[28:31]
  v_mfma_f32_16x16x32_bf16 a[64:67], v[28:31], v[48:51], a[64:67]
  ds_read_b64_tr_b16 v[28:29], v59 offset:17632
  ds_read_b64_tr_b16 v[30:31], v59 offset:22240
  v_mfma_f32_16x16x32_bf16 a[32:35], v[32:35], v[44:47], a[32:35]
  v_mfma_f32_16x16x32_bf16 a[68:71], v[32:35], v[48:51], a[68:71]
  ds_read_b64_tr_b16 v[32:33], v59 offset:17664
  ds_read_b64_tr_b16 v[34:35], v59 offset:22272
  s_waitcnt vmcnt(5)
  s_waitcnt lgkmcnt(0)
  s_barrier
  ds_read_b128 v[44:47], v60 offset:34816
  ds_read_b128 v[48:51], v60 offset:35840
  v_mfma_f32_16x16x32_bf16 a[0:3], v[0:3], v[36:39], a[0:3]
  s_add_u32 m0, s52, 17408
  s_nop 0
  buffer_load_dwordx4 v52, s[32:35], s26 offen offset:0 lds
  v_mfma_f32_16x16x32_bf16 a[36:39], v[0:3], v[40:43], a[36:39]
  ds_read_b64_tr_b16 v[0:1], v59 offset:34816
  ds_read_b64_tr_b16 v[2:3], v59 offset:39424
  v_mfma_f32_16x16x32_bf16 a[4:7], v[4:7], v[36:39], a[4:7]
  buffer_load_dwordx4 v53, s[32:35], s26 offen offset:1024 lds
  v_mfma_f32_16x16x32_bf16 a[40:43], v[4:7], v[40:43], a[40:43]
  ds_read_b64_tr_b16 v[4:5], v59 offset:34848
  ds_read_b64_tr_b16 v[6:7], v59 offset:39456
  v_mfma_f32_16x16x32_bf16 a[8:11], v[8:11], v[36:39], a[8:11]
  s_mov_b64 exec, 0xffff
  buffer_load_dwordx4 v54, s[32:35], s26 offen offset:2048 lds
  s_mov_b64 exec, -1
  s_add_u32 s26, s26, 36864
  v_mfma_f32_16x16x32_bf16 a[44:47], v[8:11], v[40:43], a[44:47]
  ds_read_b64_tr_b16 v[8:9], v59 offset:34880
  ds_read_b64_tr_b16 v[10:11], v59 offset:39488
  v_mfma_f32_16x16x32_bf16 a[12:15], v[12:15], v[36:39], a[12:15]
  s_add_u32 m0, s53, 17408
  s_nop 0
  buffer_load_dwordx4 v57, s[28:31], s44 offen offset:0 lds
  v_mfma_f32_16x16x32_bf16 a[48:51], v[12:15], v[40:43], a[48:51]
  ds_read_b64_tr_b16 v[12:13], v59 offset:34912
  ds_read_b64_tr_b16 v[14:15], v59 offset:39520
  v_mfma_f32_16x16x32_bf16 a[16:19], v[16:19], v[36:39], a[16:19]
  buffer_load_dwordx4 v58, s[28:31], s44 offen offset:1024 lds
  s_add_u32 s44, s44, 8192
  v_mfma_f32_16x16x32_bf16 a[52:55], v[16:19], v[40:43], a[52:55]
  ds_read_b64_tr_b16 v[16:17], v59 offset:34944
  ds_read_b64_tr_b16 v[18:19], v59 offset:39552
  v_mfma_f32_16x16x32_bf16 a[20:23], v[20:23], v[36:39], a[20:23]
  v_mfma_f32_16x16x32_bf16 a[56:59], v[20:23], v[40:43], a[56:59]
  ds_read_b64_tr_b16 v[20:21], v59 offset:34976
  ds_read_b64_tr_b16 v[22:23], v59 offset:39584
  v_mfma_f32_16x16x32_bf16 a[24:27], v[24:27], v[36:39], a[24:27]
  v_mfma_f32_16x16x32_bf16 a[60:63], v[24:27], v[40:43], a[60:63]
  ds_read_b64_tr_b16 v[24:25], v59 offset:35008
  ds_read_b64_tr_b16 v[26:27], v59 offset:39616
  v_mfma_f32_16x16x32_bf16 a[28:31], v[28:31], v[36:39], a[28:31]
  v_mfma_f32_16x16x32_bf16 a[64:67], v[28:31], v[40:43], a[64:67]
  ds_read_b64_tr_b16 v[28:29], v59 offset:35040
  ds_read_b64_tr_b16 v[30:31], v59 offset:39648
  v_mfma_f32_16x16x32_bf16 a[32:35], v[32:35], v[36:39], a[32:35]
  v_mfma_f32_16x16x32_bf16 a[68:71], v[32:35], v[40:43], a[68:71]
  ds_read_b64_tr_b16 v[32:33], v59 offset:35072
  ds_read_b64_tr_b16 v[34:35], v59 offset:39680
  s_waitcnt vmcnt(5)
  s_waitcnt lgkmcnt(0)
  s_barrier
  ds_read_b128 v[36:39], v60 offset:0
  ds_read_b128 v[40:43], v60 offset:1024
  v_mfma_f32_16x16x32_bf16 a[0:3], v[0:3], v[44:47], a[0:3]
  s_add_u32 m0, s52, 34816
  s_nop 0
  buffer_load_dwordx4 v52, s[32:35], s26 offen offset:0 lds
  v_mfma_f32_16x16x32_bf16 a[36:39], v[0:3], v[48:51], a[36:39]
  ds_read_b64_tr_b16 v[0:1], v59 offset:0
  ds_read_b64_tr_b16 v[2:3], v59 offset:4608
  v_mfma_f32_16x16x32_bf16 a[4:7], v[4:7], v[44:47], a[4:7]
  buffer_load_dwordx4 v53, s[32:35], s26 offen offset:1024 lds
  v_mfma_f32_16x16x32_bf16 a[40:43], v[4:7], v[48:51], a[40:43]
  ds_read_b64_tr_b16 v[4:5], v59 offset:32
  ds_read_b64_tr_b16 v[6:7], v59 offset:4640
  v_mfma_f32_16x16x32_bf16 a[8:11], v[8:11], v[44:47], a[8:11]
  s_mov_b64 exec, 0xffff
  buffer_load_dwordx4 v54, s[32:35], s26 offen offset:2048 lds
  s_mov_b64 exec, -1
  s_add_u32 s26, s26, 36864
  v_mfma_f32_16x16x32_bf16 a[44:47], v[8:11], v[48:51], a[44:47]
  ds_read_b64_tr_b16 v[8:9], v59 offset:64
  ds_read_b64_tr_b16 v[10:11], v59 offset:4672
  v_mfma_f32_16x16x32_bf16 a[12:15], v[12:15], v[44:47], a[12:15]
  s_add_u32 m0, s53, 34816
  s_nop 0
  buffer_load_dwordx4 v57, s[28:31], s44 offen offset:0 lds
  v_mfma_f32_16x16x32_bf16 a[48:51], v[12:15], v[48:51], a[48:51]
  ds_read_b64_tr_b16 v[12:13], v59 offset:96
  ds_read_b64_tr_b16 v[14:15], v59 offset:4704
  v_mfma_f32_16x16x32_bf16 a[16:19], v[16:19], v[44:47], a[16:19]
  buffer_load_dwordx4 v58, s[28:31], s44 offen offset:1024 lds
  s_add_u32 s44, s44, 8192
  v_mfma_f32_16x16x32_bf16 a[52:55], v[16:19], v[48:51], a[52:55]
  ds_read_b64_tr_b16 v[16:17], v59 offset:128
  ds_read_b64_tr_b16 v[18:19], v59 offset:4736
  v_mfma_f32_16x16x32_bf16 a[20:23], v[20:23], v[44:47], a[20:23]
  v_mfma_f32_16x16x32_bf16 a[56:59], v[20:23], v[48:51], a[56:59]
  ds_read_b64_tr_b16 v[20:21], v59 offset:160
  ds_read_b64_tr_b16 v[22:23], v59 offset:4768
  v_mfma_f32_16x16x32_bf16 a[24:27], v[24:27], v[44:47], a[24:27]
  v_mfma_f32_16x16x32_bf16 a[60:63], v[24:27], v[48:51], a[60:63]
  ds_read_b64_tr_b16 v[24:25], v59 offset:192
  ds_read_b64_tr_b16 v[26:27], v59 offset:4800
  v_mfma_f32_16x16x32_bf16 a[28:31], v[28:31], v[44:47], a[28:31]
  v_mfma_f32_16x16x32_bf16 a[64:67], v[28:31], v[48:51], a[64:67]
  ds_read_b64_tr_b16 v[28:29], v59 offset:224
  ds_read_b64_tr_b16 v[30:31], v59 offset:4832
  v_mfma_f32_16x16x32_bf16 a[32:35], v[32:35], v[44:47], a[32:35]
  v_mfma_f32_16x16x32_bf16 a[68:71], v[32:35], v[48:51], a[68:71]
  ds_read_b64_tr_b16 v[32:33], v59 offset:256
  ds_read_b64_tr_b16 v[34:35], v59 offset:4864
  s_waitcnt vmcnt(5)
  s_waitcnt lgkmcnt(0)
  s_barrier
  ds_read_b128 v[44:47], v60 offset:17408
  ds_read_b128 v[48:51], v60 offset:18432
  v_mfma_f32_16x16x32_bf16 a[0:3], v[0:3], v[36:39], a[0:3]
  s_add_u32 m0, s52, 0
  s_nop 0
  buffer_load_dwordx4 v52, s[32:35], s26 offen offset:0 lds
  v_mfma_f32_16x16x32_bf16 a[36:39], v[0:3], v[40:43], a[36:39]
  ds_read_b64_tr_b16 v[0:1], v59 offset:17408
  ds_read_b64_tr_b16 v[2:3], v59 offset:22016
  v_mfma_f32_16x16x32_bf16 a[4:7], v[4:7], v[36:39], a[4:7]
  buffer_load_dwordx4 v53, s[32:35], s26 offen offset:1024 lds
  v_mfma_f32_16x16x32_bf16 a[40:43], v[4:7], v[40:43], a[40:43]
  ds_read_b64_tr_b16 v[4:5], v59 offset:17440
  ds_read_b64_tr_b16 v[6:7], v59 offset:22048
  v_mfma_f32_16x16x32_bf16 a[8:11], v[8:11], v[36:39], a[8:11]
  s_mov_b64 exec, 0xffff
  buffer_load_dwordx4 v54, s[32:35], s26 offen offset:2048 lds
  s_mov_b64 exec, -1
  s_add_u32 s26, s26, 36864
  v_mfma_f32_16x16x32_bf16 a[44:47], v[8:11], v[40:43], a[44:47]
  ds_read_b64_tr_b16 v[8:9], v59 offset:17472
  ds_read_b64_tr_b16 v[10:11], v59 offset:22080
  v_mfma_f32_16x16x32_bf16 a[12:15], v[12:15], v[36:39], a[12:15]
  s_add_u32 m0, s53, 0
  s_nop 0
  buffer_load_dwordx4 v57, s[28:31], s44 offen offset:0 lds
  v_mfma_f32_16x16x32_bf16 a[48:51], v[12:15], v[40:43], a[48:51]
  ds_read_b64_tr_b16 v[12:13], v59 offset:17504
  ds_read_b64_tr_b16 v[14:15], v59 offset:22112
  v_mfma_f32_16x16x32_bf16 a[16:19], v[16:19], v[36:39], a[16:19]
  buffer_load_dwordx4 v58, s[28:31], s44 offen offset:1024 lds
  s_add_u32 s44, s44, 8192
  v_mfma_f32_16x16x32_bf16 a[52:55], v[16:19], v[40:43], a[52:55]
  ds_read_b64_tr_b16 v[16:17], v59 offset:17536
  ds_read_b64_tr_b16 v[18:19], v59 offset:22144
  v_mfma_f32_16x16x32_bf16 a[20:23], v[20:23], v[36:39], a[20:23]
  v_mfma_f32_16x16x32_bf16 a[56:59], v[20:23], v[40:43], a[56:59]
  ds_read_b64_tr_b16 v[20:21], v59 offset:17568
  ds_read_b64_tr_b16 v[22:23], v59 offset:22176
  v_mfma_f32_16x16x32_bf16 a[24:27], v[24:27], v[36:39], a[24:27]
  v_mfma_f32_16x16x32_bf16 a[60:63], v[24:27], v[40:43], a[60:63]
  ds_read_b64_tr_b16 v[24:25], v59 offset:17600
  ds_read_b64_tr_b16 v[26:27], v59 offset:22208
  v_mfma_f32_16x16x32_bf16 a[28:31], v[28:31], v[36:39], a[28:31]
  v_mfma_f32_16x16x32_bf16 a[64:67], v[28:31], v[40:43], a[64:67]
  ds_read_b64_tr_b16 v[28:29], v59 offset:17632
  ds_read_b64_tr_b16 v[30:31], v59 offset:22240
  v_mfma_f32_16x16x32_bf16 a[32:35], v[32:35], v[36:39], a[32:35]
  v_mfma_f32_16x16x32_bf16 a[68:71], v[32:35], v[40:43], a[68:71]
  ds_read_b64_tr_b16 v[32:33], v59 offset:17664
  ds_read_b64_tr_b16 v[34:35], v59 offset:22272
  s_waitcnt vmcnt(5)
  s_waitcnt lgkmcnt(0)
  s_barrier
  ds_read_b128 v[36:39], v60 offset:34816
  ds_read_b128 v[40:43], v60 offset:35840
  v_mfma_f32_16x16x32_bf16 a[0:3], v[0:3], v[44:47], a[0:3]
  s_add_u32 m0, s52, 17408
  s_nop 0
  buffer_load_dwordx4 v52, s[32:35], s26 offen offset:0 lds
  v_mfma_f32_16x16x32_bf16 a[36:39], v[0:3], v[48:51], a[36:39]
  ds_read_b64_tr_b16 v[0:1], v59 offset:34816
  ds_read_b64_tr_b16 v[2:3], v59 offset:39424
  v_mfma_f32_16x16x32_bf16 a[4:7], v[4:7], v[44:47], a[4:7]
  buffer_load_dwordx4 v53, s[32:35], s26 offen offset:1024 lds
  v_mfma_f32_16x16x32_bf16 a[40:43], v[4:7], v[48:51], a[40:43]
  ds_read_b64_tr_b16 v[4:5], v59 offset:34848
  ds_read_b64_tr_b16 v[6:7], v59 offset:39456
  v_mfma_f32_16x16x32_bf16 a[8:11], v[8:11], v[44:47], a[8:11]
  s_mov_b64 exec, 0xffff
  buffer_load_dwordx4 v54, s[32:35], s26 offen offset:2048 lds
  s_mov_b64 exec, -1
  s_add_u32 s26, s26, 36864
  v_mfma_f32_16x16x32_bf16 a[44:47], v[8:11], v[48:51], a[44:47]
  ds_read_b64_tr_b16 v[8:9], v59 offset:34880
  ds_read_b64_tr_b16 v[10:11], v59 offset:39488
  v_mfma_f32_16x16x32_bf16 a[12:15], v[12:15], v[44:47], a[12:15]
  s_add_u32 m0, s53, 17408
  s_nop 0
  buffer_load_dwordx4 v57, s[28:31], s44 offen offset:0 lds
  v_mfma_f32_16x16x32_bf16 a[48:51], v[12:15], v[48:51], a[48:51]
  ds_read_b64_tr_b16 v[12:13], v59 offset:34912
  ds_read_b64_tr_b16 v[14:15], v59 offset:39520
  v_mfma_f32_16x16x32_bf16 a[16:19], v[16:19], v[44:47], a[16:19]
  buffer_load_dwordx4 v58, s[28:31], s44 offen offset:1024 lds
  s_add_u32 s44, s44, 8192
  v_mfma_f32_16x16x32_bf16 a[52:55], v[16:19], v[48:51], a[52:55]
  ds_read_b64_tr_b16 v[16:17], v59 offset:34944
  ds_read_b64_tr_b16 v[18:19], v59 offset:39552
  v_mfma_f32_16x16x32_bf16 a[20:23], v[20:23], v[44:47], a[20:23]
  v_mfma_f32_16x16x32_bf16 a[56:59], v[20:23], v[48:51], a[56:59]
  ds_read_b64_tr_b16 v[20:21], v59 offset:34976
  ds_read_b64_tr_b16 v[22:23], v59 offset:39584
  v_mfma_f32_16x16x32_bf16 a[24:27], v[24:27], v[44:47], a[24:27]
  v_mfma_f32_16x16x32_bf16 a[60:63], v[24:27], v[48:51], a[60:63]
  ds_read_b64_tr_b16 v[24:25], v59 offset:35008
  ds_read_b64_tr_b16 v[26:27], v59 offset:39616
  v_mfma_f32_16x16x32_bf16 a[28:31], v[28:31], v[44:47], a[28:31]
  v_mfma_f32_16x16x32_bf16 a[64:67], v[28:31], v[48:51], a[64:67]
  ds_read_b64_tr_b16 v[28:29], v59 offset:35040
  ds_read_b64_tr_b16 v[30:31], v59 offset:39648
  v_mfma_f32_16x16x32_bf16 a[32:35], v[32:35], v[44:47], a[32:35]
  v_mfma_f32_16x16x32_bf16 a[68:71], v[32:35], v[48:51], a[68:71]
  ds_read_b64_tr_b16 v[32:33], v59 offset:35072
  ds_read_b64_tr_b16 v[34:35], v59 offset:39680
  s_waitcnt vmcnt(5)
  s_waitcnt lgkmcnt(0)
  s_barrier
  ds_read_b128 v[44:47], v60 offset:0
  ds_read_b128 v[48:51], v60 offset:1024
  v_mfma_f32_16x16x32_bf16 a[0:3], v[0:3], v[36:39], a[0:3]
  s_add_u32 m0, s52, 34816
  s_nop 0
  buffer_load_dwordx4 v52, s[32:35], s26 offen offset:0 lds
  v_mfma_f32_16x16x32_bf16 a[36:39], v[0:3], v[40:43], a[36:39]
  ds_read_b64_tr_b16 v[0:1], v59 offset:0
  ds_read_b64_tr_b16 v[2:3], v59 offset:4608
  v_mfma_f32_16x16x32_bf16 a[4:7], v[4:7], v[36:39], a[4:7]
  buffer_load_dwordx4 v53, s[32:35], s26 offen offset:1024 lds
  v_mfma_f32_16x16x32_bf16 a[40:43], v[4:7], v[40:43], a[40:43]
  ds_read_b64_tr_b16 v[4:5], v59 offset:32
  ds_read_b64_tr_b16 v[6:7], v59 offset:4640
  v_mfma_f32_16x16x32_bf16 a[8:11], v[8:11], v[36:39], a[8:11]
  s_mov_b64 exec, 0xffff
  buffer_load_dwordx4 v54, s[32:35], s26 offen offset:2048 lds
  s_mov_b64 exec, -1
  s_add_u32 s26, s26, 36864
  v_mfma_f32_16x16x32_bf16 a[44:47], v[8:11], v[40:43], a[44:47]
  ds_read_b64_tr_b16 v[8:9], v59 offset:64
  ds_read_b64_tr_b16 v[10:11], v59 offset:4672
  v_mfma_f32_16x16x32_bf16 a[12:15], v[12:15], v[36:39], a[12:15]
  s_add_u32 m0, s53, 34816
  s_nop 0
  buffer_load_dwordx4 v57, s[28:31], s44 offen offset:0 lds
  v_mfma_f32_16x16x32_bf16 a[48:51], v[12:15], v[40:43], a[48:51]
  ds_read_b64_tr_b16 v[12:13], v59 offset:96
  ds_read_b64_tr_b16 v[14:15], v59 offset:4704
  v_mfma_f32_16x16x32_bf16 a[16:19], v[16:19], v[36:39], a[16:19]
  buffer_load_dwordx4 v58, s[28:31], s44 offen offset:1024 lds
  s_add_u32 s44, s44, 8192
  v_mfma_f32_16x16x32_bf16 a[52:55], v[16:19], v[40:43], a[52:55]
  ds_read_b64_tr_b16 v[16:17], v59 offset:128
  ds_read_b64_tr_b16 v[18:19], v59 offset:4736
  v_mfma_f32_16x16x32_bf16 a[20:23], v[20:23], v[36:39], a[20:23]
  v_mfma_f32_16x16x32_bf16 a[56:59], v[20:23], v[40:43], a[56:59]
  ds_read_b64_tr_b16 v[20:21], v59 offset:160
  ds_read_b64_tr_b16 v[22:23], v59 offset:4768
  v_mfma_f32_16x16x32_bf16 a[24:27], v[24:27], v[36:39], a[24:27]
  v_mfma_f32_16x16x32_bf16 a[60:63], v[24:27], v[40:43], a[60:63]
  ds_read_b64_tr_b16 v[24:25], v59 offset:192
  ds_read_b64_tr_b16 v[26:27], v59 offset:4800
  v_mfma_f32_16x16x32_bf16 a[28:31], v[28:31], v[36:39], a[28:31]
  v_mfma_f32_16x16x32_bf16 a[64:67], v[28:31], v[40:43], a[64:67]
  ds_read_b64_tr_b16 v[28:29], v59 offset:224
  ds_read_b64_tr_b16 v[30:31], v59 offset:4832
  v_mfma_f32_16x16x32_bf16 a[32:35], v[32:35], v[36:39], a[32:35]
  v_mfma_f32_16x16x32_bf16 a[68:71], v[32:35], v[40:43], a[68:71]
  ds_read_b64_tr_b16 v[32:33], v59 offset:256
  ds_read_b64_tr_b16 v[34:35], v59 offset:4864
  s_waitcnt vmcnt(5)
  s_waitcnt lgkmcnt(0)
  s_barrier
  ds_read_b128 v[36:39], v60 offset:17408
  ds_read_b128 v[40:43], v60 offset:18432
  v_mfma_f32_16x16x32_bf16 a[0:3], v[0:3], v[44:47], a[0:3]
  s_add_u32 m0, s52, 0
  s_nop 0
  buffer_load_dwordx4 v52, s[32:35], s26 offen offset:0 lds
  v_mfma_f32_16x16x32_bf16 a[36:39], v[0:3], v[48:51], a[36:39]
  ds_read_b64_tr_b16 v[0:1], v59 offset:17408
  ds_read_b64_tr_b16 v[2:3], v59 offset:22016
  v_mfma_f32_16x16x32_bf16 a[4:7], v[4:7], v[44:47], a[4:7]
  buffer_load_dwordx4 v53, s[32:35], s26 offen offset:1024 lds
  v_mfma_f32_16x16x32_bf16 a[40:43], v[4:7], v[48:51], a[40:43]
  ds_read_b64_tr_b16 v[4:5], v59 offset:17440
  ds_read_b64_tr_b16 v[6:7], v59 offset:22048
  v_mfma_f32_16x16x32_bf16 a[8:11], v[8:11], v[44:47], a[8:11]
  s_mov_b64 exec, 0xffff
  buffer_load_dwordx4 v54, s[32:35], s26 offen offset:2048 lds
  s_mov_b64 exec, -1
  s_add_u32 s26, s26, 36864
  v_mfma_f32_16x16x32_bf16 a[44:47], v[8:11], v[48:51], a[44:47]
  ds_read_b64_tr_b16 v[8:9], v59 offset:17472
  ds_read_b64_tr_b16 v[10:11], v59 offset:22080
  v_mfma_f32_16x16x32_bf16 a[12:15], v[12:15], v[44:47], a[12:15]
  s_add_u32 m0, s53, 0
  s_nop 0
  buffer_load_dwordx4 v57, s[28:31], s44 offen offset:0 lds
  v_mfma_f32_16x16x32_bf16 a[48:51], v[12:15], v[48:51], a[48:51]
  ds_read_b64_tr_b16 v[12:13], v59 offset:17504
  ds_read_b64_tr_b16 v[14:15], v59 offset:22112
  v_mfma_f32_16x16x32_bf16 a[16:19], v[16:19], v[44:47], a[16:19]
  buffer_load_dwordx4 v58, s[28:31], s44 offen offset:1024 lds
  s_add_u32 s44, s44, 8192
  v_mfma_f32_16x16x32_bf16 a[52:55], v[16:19], v[48:51], a[52:55]
  ds_read_b64_tr_b16 v[16:17], v59 offset:17536
  ds_read_b64_tr_b16 v[18:19], v59 offset:22144
  v_mfma_f32_16x16x32_bf16 a[20:23], v[20:23], v[44:47], a[20:23]
  v_mfma_f32_16x16x32_bf16 a[56:59], v[20:23], v[48:51], a[56:59]
  ds_read_b64_tr_b16 v[20:21], v59 offset:17568
  ds_read_b64_tr_b16 v[22:23], v59 offset:22176
  v_mfma_f32_16x16x32_bf16 a[24:27], v[24:27], v[44:47], a[24:27]
  v_mfma_f32_16x16x32_bf16 a[60:63], v[24:27], v[48:51], a[60:63]
  ds_read_b64_tr_b16 v[24:25], v59 offset:17600
  ds_read_b64_tr_b16 v[26:27], v59 offset:22208
  v_mfma_f32_16x16x32_bf16 a[28:31], v[28:31], v[44:47], a[28:31]
  v_mfma_f32_16x16x32_bf16 a[64:67], v[28:31], v[48:51], a[64:67]
  ds_read_b64_tr_b16 v[28:29], v59 offset:17632
  ds_read_b64_tr_b16 v[30:31], v59 offset:22240
  v_mfma_f32_16x16x32_bf16 a[32:35], v[32:35], v[44:47], a[32:35]
  v_mfma_f32_16x16x32_bf16 a[68:71], v[32:35], v[48:51], a[68:71]
  ds_read_b64_tr_b16 v[32:33], v59 offset:17664
  ds_read_b64_tr_b16 v[34:35], v59 offset:22272
  s_waitcnt vmcnt(5)
  s_waitcnt lgkmcnt(0)
  s_barrier
  ds_read_b128 v[44:47], v60 offset:34816
  ds_read_b128 v[48:51], v60 offset:35840
  v_mfma_f32_16x16x32_bf16 a[0:3], v[0:3], v[36:39], a[0:3]
  s_add_u32 m0, s52, 17408
  s_nop 0
  buffer_load_dwordx4 v52, s[32:35], s26 offen offset:0 lds
  v_mfma_f32_16x16x32_bf16 a[36:39], v[0:3], v[40:43], a[36:39]
  ds_read_b64_tr_b16 v[0:1], v59 offset:34816
  ds_read_b64_tr_b16 v[2:3], v59 offset:39424
  v_mfma_f32_16x16x32_bf16 a[4:7], v[4:7], v[36:39], a[4:7]
  buffer_load_dwordx4 v53, s[32:35], s26 offen offset:1024 lds
  v_mfma_f32_16x16x32_bf16 a[40:43], v[4:7], v[40:43], a[40:43]
  ds_read_b64_tr_b16 v[4:5], v59 offset:34848
  ds_read_b64_tr_b16 v[6:7], v59 offset:39456
  v_mfma_f32_16x16x32_bf16 a[8:11], v[8:11], v[36:39], a[8:11]
  s_mov_b64 exec, 0xffff
  buffer_load_dwordx4 v54, s[32:35], s26 offen offset:2048 lds
  s_mov_b64 exec, -1
  s_add_u32 s26, s26, 36864
  v_mfma_f32_16x16x32_bf16 a[44:47], v[8:11], v[40:43], a[44:47]
  ds_read_b64_tr_b16 v[8:9], v59 offset:34880
  ds_read_b64_tr_b16 v[10:11], v59 offset:39488
  v_mfma_f32_16x16x32_bf16 a[12:15], v[12:15], v[36:39], a[12:15]
  s_add_u32 m0, s53, 17408
  s_nop 0
  buffer_load_dwordx4 v57, s[28:31], s44 offen offset:0 lds
  v_mfma_f32_16x16x32_bf16 a[48:51], v[12:15], v[40:43], a[48:51]
  ds_read_b64_tr_b16 v[12:13], v59 offset:34912
  ds_read_b64_tr_b16 v[14:15], v59 offset:39520
  v_mfma_f32_16x16x32_bf16 a[16:19], v[16:19], v[36:39], a[16:19]
  buffer_load_dwordx4 v58, s[28:31], s44 offen offset:1024 lds
  s_add_u32 s44, s44, 8192
  v_mfma_f32_16x16x32_bf16 a[52:55], v[16:19], v[40:43], a[52:55]
  ds_read_b64_tr_b16 v[16:17], v59 offset:34944
  ds_read_b64_tr_b16 v[18:19], v59 offset:39552
  v_mfma_f32_16x16x32_bf16 a[20:23], v[20:23], v[36:39], a[20:23]
  v_mfma_f32_16x16x32_bf16 a[56:59], v[20:23], v[40:43], a[56:59]
  ds_read_b64_tr_b16 v[20:21], v59 offset:34976
  ds_read_b64_tr_b16 v[22:23], v59 offset:39584
  v_mfma_f32_16x16x32_bf16 a[24:27], v[24:27], v[36:39], a[24:27]
  v_mfma_f32_16x16x32_bf16 a[60:63], v[24:27], v[40:43], a[60:63]
  ds_read_b64_tr_b16 v[24:25], v59 offset:35008
  ds_read_b64_tr_b16 v[26:27], v59 offset:39616
  v_mfma_f32_16x16x32_bf16 a[28:31], v[28:31], v[36:39], a[28:31]
  v_mfma_f32_16x16x32_bf16 a[64:67], v[28:31], v[40:43], a[64:67]
  ds_read_b64_tr_b16 v[28:29], v59 offset:35040
  ds_read_b64_tr_b16 v[30:31], v59 offset:39648
  v_mfma_f32_16x16x32_bf16 a[32:35], v[32:35], v[36:39], a[32:35]
  v_mfma_f32_16x16x32_bf16 a[68:71], v[32:35], v[40:43], a[68:71]
  ds_read_b64_tr_b16 v[32:33], v59 offset:35072
  ds_read_b64_tr_b16 v[34:35], v59 offset:39680
  s_waitcnt vmcnt(5)
  s_waitcnt lgkmcnt(0)
  s_barrier
  ds_read_b128 v[36:39], v60 offset:0
  ds_read_b128 v[40:43], v60 offset:1024
  v_mfma_f32_16x16x32_bf16 a[0:3], v[0:3], v[44:47], a[0:3]
  s_add_u32 m0, s52, 34816
  s_nop 0
  buffer_load_dwordx4 v52, s[32:35], s26 offen offset:0 lds
  v_mfma_f32_16x16x32_bf16 a[36:39], v[0:3], v[48:51], a[36:39]
  ds_read_b64_tr_b16 v[0:1], v59 offset:0
  ds_read_b64_tr_b16 v[2:3], v59 offset:4608
  v_mfma_f32_16x16x32_bf16 a[4:7], v[4:7], v[44:47], a[4:7]
  buffer_load_dwordx4 v53, s[32:35], s26 offen offset:1024 lds
  v_mfma_f32_16x16x32_bf16 a[40:43], v[4:7], v[48:51], a[40:43]
  ds_read_b64_tr_b16 v[4:5], v59 offset:32
  ds_read_b64_tr_b16 v[6:7], v59 offset:4640
  v_mfma_f32_16x16x32_bf16 a[8:11], v[8:11], v[44:47], a[8:11]
  s_mov_b64 exec, 0xffff
  buffer_load_dwordx4 v54, s[32:35], s26 offen offset:2048 lds
  s_mov_b64 exec, -1
  s_add_u32 s26, s26, 36864
  v_mfma_f32_16x16x32_bf16 a[44:47], v[8:11], v[48:51], a[44:47]
  ds_read_b64_tr_b16 v[8:9], v59 offset:64
  ds_read_b64_tr_b16 v[10:11], v59 offset:4672
  v_mfma_f32_16x16x32_bf16 a[12:15], v[12:15], v[44:47], a[12:15]
  s_add_u32 m0, s53, 34816
  s_nop 0
  buffer_load_dwordx4 v57, s[28:31], s44 offen offset:0 lds
  v_mfma_f32_16x16x32_bf16 a[48:51], v[12:15], v[48:51], a[48:51]
  ds_read_b64_tr_b16 v[12:13], v59 offset:96
  ds_read_b64_tr_b16 v[14:15], v59 offset:4704
  v_mfma_f32_16x16x32_bf16 a[16:19], v[16:19], v[44:47], a[16:19]
  buffer_load_dwordx4 v58, s[28:31], s44 offen offset:1024 lds
  s_add_u32 s44, s44, 8192
  v_mfma_f32_16x16x32_bf16 a[52:55], v[16:19], v[48:51], a[52:55]
  ds_read_b64_tr_b16 v[16:17], v59 offset:128
  ds_read_b64_tr_b16 v[18:19], v59 offset:4736
  v_mfma_f32_16x16x32_bf16 a[20:23], v[20:23], v[44:47], a[20:23]
  v_mfma_f32_16x16x32_bf16 a[56:59], v[20:23], v[48:51], a[56:59]
  ds_read_b64_tr_b16 v[20:21], v59 offset:160
  ds_read_b64_tr_b16 v[22:23], v59 offset:4768
  v_mfma_f32_16x16x32_bf16 a[24:27], v[24:27], v[44:47], a[24:27]
  v_mfma_f32_16x16x32_bf16 a[60:63], v[24:27], v[48:51], a[60:63]
  ds_read_b64_tr_b16 v[24:25], v59 offset:192
  ds_read_b64_tr_b16 v[26:27], v59 offset:4800
  v_mfma_f32_16x16x32_bf16 a[28:31], v[28:31], v[44:47], a[28:31]
  v_mfma_f32_16x16x32_bf16 a[64:67], v[28:31], v[48:51], a[64:67]
  ds_read_b64_tr_b16 v[28:29], v59 offset:224
  ds_read_b64_tr_b16 v[30:31], v59 offset:4832
  v_mfma_f32_16x16x32_bf16 a[32:35], v[32:35], v[44:47], a[32:35]
  v_mfma_f32_16x16x32_bf16 a[68:71], v[32:35], v[48:51], a[68:71]
  ds_read_b64_tr_b16 v[32:33], v59 offset:256
  ds_read_b64_tr_b16 v[34:35], v59 offset:4864
  s_waitcnt vmcnt(5)
  s_waitcnt lgkmcnt(0)
  s_barrier
  ds_read_b128 v[44:47], v60 offset:17408
  ds_read_b128 v[48:51], v60 offset:18432
  v_mfma_f32_16x16x32_bf16 a[0:3], v[0:3], v[36:39], a[0:3]
  s_add_u32 m0, s52, 0
  s_nop 0
  buffer_load_dwordx4 v52, s[32:35], s26 offen offset:0 lds
  v_mfma_f32_16x16x32_bf16 a[36:39], v[0:3], v[40:43], a[36:39]
  ds_read_b64_tr_b16 v[0:1], v59 offset:17408
  ds_read_b64_tr_b16 v[2:3], v59 offset:22016
  v_mfma_f32_16x16x32_bf16 a[4:7], v[4:7], v[36:39], a[4:7]
  buffer_load_dwordx4 v53, s[32:35], s26 offen offset:1024 lds
  v_mfma_f32_16x16x32_bf16 a[40:43], v[4:7], v[40:43], a[40:43]
  ds_read_b64_tr_b16 v[4:5], v59 offset:17440
  ds_read_b64_tr_b16 v[6:7], v59 offset:22048
  v_mfma_f32_16x16x32_bf16 a[8:11], v[8:11], v[36:39], a[8:11]
  s_mov_b64 exec, 0xffff
  buffer_load_dwordx4 v54, s[32:35], s26 offen offset:2048 lds
  s_mov_b64 exec, -1
  s_add_u32 s26, s26, 36864
  v_mfma_f32_16x16x32_bf16 a[44:47], v[8:11], v[40:43], a[44:47]
  ds_read_b64_tr_b16 v[8:9], v59 offset:17472
  ds_read_b64_tr_b16 v[10:11], v59 offset:22080
  v_mfma_f32_16x16x32_bf16 a[12:15], v[12:15], v[36:39], a[12:15]
  s_add_u32 m0, s53, 0
  s_nop 0
  buffer_load_dwordx4 v57, s[28:31], s44 offen offset:0 lds
  v_mfma_f32_16x16x32_bf16 a[48:51], v[12:15], v[40:43], a[48:51]
  ds_read_b64_tr_b16 v[12:13], v59 offset:17504
  ds_read_b64_tr_b16 v[14:15], v59 offset:22112
  v_mfma_f32_16x16x32_bf16 a[16:19], v[16:19], v[36:39], a[16:19]
  buffer_load_dwordx4 v58, s[28:31], s44 offen offset:1024 lds
  s_add_u32 s44, s44, 8192
  v_mfma_f32_16x16x32_bf16 a[52:55], v[16:19], v[40:43], a[52:55]
  ds_read_b64_tr_b16 v[16:17], v59 offset:17536
  ds_read_b64_tr_b16 v[18:19], v59 offset:22144
  v_mfma_f32_16x16x32_bf16 a[20:23], v[20:23], v[36:39], a[20:23]
  v_mfma_f32_16x16x32_bf16 a[56:59], v[20:23], v[40:43], a[56:59]
  ds_read_b64_tr_b16 v[20:21], v59 offset:17568
  ds_read_b64_tr_b16 v[22:23], v59 offset:22176
  v_mfma_f32_16x16x32_bf16 a[24:27], v[24:27], v[36:39], a[24:27]
  v_mfma_f32_16x16x32_bf16 a[60:63], v[24:27], v[40:43], a[60:63]
  ds_read_b64_tr_b16 v[24:25], v59 offset:17600
  ds_read_b64_tr_b16 v[26:27], v59 offset:22208
  v_mfma_f32_16x16x32_bf16 a[28:31], v[28:31], v[36:39], a[28:31]
  v_mfma_f32_16x16x32_bf16 a[64:67], v[28:31], v[40:43], a[64:67]
  ds_read_b64_tr_b16 v[28:29], v59 offset:17632
  ds_read_b64_tr_b16 v[30:31], v59 offset:22240
  v_mfma_f32_16x16x32_bf16 a[32:35], v[32:35], v[36:39], a[32:35]
  v_mfma_f32_16x16x32_bf16 a[68:71], v[32:35], v[40:43], a[68:71]
  ds_read_b64_tr_b16 v[32:33], v59 offset:17664
  ds_read_b64_tr_b16 v[34:35], v59 offset:22272
  s_waitcnt vmcnt(5)
  s_waitcnt lgkmcnt(0)
  s_barrier
  ds_read_b128 v[36:39], v60 offset:34816
  ds_read_b128 v[40:43], v60 offset:35840
  v_mfma_f32_16x16x32_bf16 a[0:3], v[0:3], v[44:47], a[0:3]
  s_add_u32 m0, s52, 17408
  s_nop 0
  buffer_load_dwordx4 v52, s[32:35], s26 offen offset:0 lds
  v_mfma_f32_16x16x32_bf16 a[36:39], v[0:3], v[48:51], a[36:39]
  ds_read_b64_tr_b16 v[0:1], v59 offset:34816
  ds_read_b64_tr_b16 v[2:3], v59 offset:39424
  v_mfma_f32_16x16x32_bf16 a[4:7], v[4:7], v[44:47], a[4:7]
  buffer_load_dwordx4 v53, s[32:35], s26 offen offset:1024 lds
  v_mfma_f32_16x16x32_bf16 a[40:43], v[4:7], v[48:51], a[40:43]
  ds_read_b64_tr_b16 v[4:5], v59 offset:34848
  ds_read_b64_tr_b16 v[6:7], v59 offset:39456
  v_mfma_f32_16x16x32_bf16 a[8:11], v[8:11], v[44:47], a[8:11]
  s_mov_b64 exec, 0xffff
  buffer_load_dwordx4 v54, s[32:35], s26 offen offset:2048 lds
  s_mov_b64 exec, -1
  s_add_u32 s26, s26, 36864
  v_mfma_f32_16x16x32_bf16 a[44:47], v[8:11], v[48:51], a[44:47]
  ds_read_b64_tr_b16 v[8:9], v59 offset:34880
  ds_read_b64_tr_b16 v[10:11], v59 offset:39488
  v_mfma_f32_16x16x32_bf16 a[12:15], v[12:15], v[44:47], a[12:15]
  s_add_u32 m0, s53, 17408
  s_nop 0
  buffer_load_dwordx4 v57, s[28:31], s44 offen offset:0 lds
  v_mfma_f32_16x16x32_bf16 a[48:51], v[12:15], v[48:51], a[48:51]
  ds_read_b64_tr_b16 v[12:13], v59 offset:34912
  ds_read_b64_tr_b16 v[14:15], v59 offset:39520
  v_mfma_f32_16x16x32_bf16 a[16:19], v[16:19], v[44:47], a[16:19]
  buffer_load_dwordx4 v58, s[28:31], s44 offen offset:1024 lds
  s_add_u32 s44, s44, 8192
  v_mfma_f32_16x16x32_bf16 a[52:55], v[16:19], v[48:51], a[52:55]
  ds_read_b64_tr_b16 v[16:17], v59 offset:34944
  ds_read_b64_tr_b16 v[18:19], v59 offset:39552
  v_mfma_f32_16x16x32_bf16 a[20:23], v[20:23], v[44:47], a[20:23]
  v_mfma_f32_16x16x32_bf16 a[56:59], v[20:23], v[48:51], a[56:59]
  ds_read_b64_tr_b16 v[20:21], v59 offset:34976
  ds_read_b64_tr_b16 v[22:23], v59 offset:39584
  v_mfma_f32_16x16x32_bf16 a[24:27], v[24:27], v[44:47], a[24:27]
  v_mfma_f32_16x16x32_bf16 a[60:63], v[24:27], v[48:51], a[60:63]
  ds_read_b64_tr_b16 v[24:25], v59 offset:35008
  ds_read_b64_tr_b16 v[26:27], v59 offset:39616
  v_mfma_f32_16x16x32_bf16 a[28:31], v[28:31], v[44:47], a[28:31]
  v_mfma_f32_16x16x32_bf16 a[64:67], v[28:31], v[48:51], a[64:67]
  ds_read_b64_tr_b16 v[28:29], v59 offset:35040
  ds_read_b64_tr_b16 v[30:31], v59 offset:39648
  v_mfma_f32_16x16x32_bf16 a[32:35], v[32:35], v[44:47], a[32:35]
  v_mfma_f32_16x16x32_bf16 a[68:71], v[32:35], v[48:51], a[68:71]
  ds_read_b64_tr_b16 v[32:33], v59 offset:35072
  ds_read_b64_tr_b16 v[34:35], v59 offset:39680
  s_waitcnt vmcnt(5)
  s_waitcnt lgkmcnt(0)
  s_barrier
  ds_read_b128 v[44:47], v60 offset:0
  ds_read_b128 v[48:51], v60 offset:1024
  v_mfma_f32_16x16x32_bf16 a[0:3], v[0:3], v[36:39], a[0:3]
  s_add_u32 m0, s52, 34816
  s_nop 0
  buffer_load_dwordx4 v52, s[32:35], s26 offen offset:0 lds
  v_mfma_f32_16x16x32_bf16 a[36:39], v[0:3], v[40:43], a[36:39]
  ds_read_b64_tr_b16 v[0:1], v59 offset:0
  ds_read_b64_tr_b16 v[2:3], v59 offset:4608
  v_mfma_f32_16x16x32_bf16 a[4:7], v[4:7], v[36:39], a[4:7]
  buffer_load_dwordx4 v53, s[32:35], s26 offen offset:1024 lds
  v_mfma_f32_16x16x32_bf16 a[40:43], v[4:7], v[40:43], a[40:43]
  ds_read_b64_tr_b16 v[4:5], v59 offset:32
  ds_read_b64_tr_b16 v[6:7], v59 offset:4640
  v_mfma_f32_16x16x32_bf16 a[8:11], v[8:11], v[36:39], a[8:11]
  s_mov_b64 exec, 0xffff
  buffer_load_dwordx4 v54, s[32:35], s26 offen offset:2048 lds
  s_mov_b64 exec, -1
  s_add_u32 s26, s26, 36864
  v_mfma_f32_16x16x32_bf16 a[44:47], v[8:11], v[40:43], a[44:47]
  ds_read_b64_tr_b16 v[8:9], v59 offset:64
  ds_read_b64_tr_b16 v[10:11], v59 offset:4672
  v_mfma_f32_16x16x32_bf16 a[12:15], v[12:15], v[36:39], a[12:15]
  s_add_u32 m0, s53, 34816
  s_nop 0
  buffer_load_dwordx4 v57, s[28:31], s44 offen offset:0 lds
  v_mfma_f32_16x16x32_bf16 a[48:51], v[12:15], v[40:43], a[48:51]
  ds_read_b64_tr_b16 v[12:13], v59 offset:96
  ds_read_b64_tr_b16 v[14:15], v59 offset:4704
  v_mfma_f32_16x16x32_bf16 a[16:19], v[16:19], v[36:39], a[16:19]
  buffer_load_dwordx4 v58, s[28:31], s44 offen offset:1024 lds
  s_add_u32 s44, s44, 8192
  v_mfma_f32_16x16x32_bf16 a[52:55], v[16:19], v[40:43], a[52:55]
  ds_read_b64_tr_b16 v[16:17], v59 offset:128
  ds_read_b64_tr_b16 v[18:19], v59 offset:4736
  v_mfma_f32_16x16x32_bf16 a[20:23], v[20:23], v[36:39], a[20:23]
  v_mfma_f32_16x16x32_bf16 a[56:59], v[20:23], v[40:43], a[56:59]
  ds_read_b64_tr_b16 v[20:21], v59 offset:160
  ds_read_b64_tr_b16 v[22:23], v59 offset:4768
  v_mfma_f32_16x16x32_bf16 a[24:27], v[24:27], v[36:39], a[24:27]
  v_mfma_f32_16x16x32_bf16 a[60:63], v[24:27], v[40:43], a[60:63]
  ds_read_b64_tr_b16 v[24:25], v59 offset:192
  ds_read_b64_tr_b16 v[26:27], v59 offset:4800
  v_mfma_f32_16x16x32_bf16 a[28:31], v[28:31], v[36:39], a[28:31]
  v_mfma_f32_16x16x32_bf16 a[64:67], v[28:31], v[40:43], a[64:67]
  ds_read_b64_tr_b16 v[28:29], v59 offset:224
  ds_read_b64_tr_b16 v[30:31], v59 offset:4832
  v_mfma_f32_16x16x32_bf16 a[32:35], v[32:35], v[36:39], a[32:35]
  v_mfma_f32_16x16x32_bf16 a[68:71], v[32:35], v[40:43], a[68:71]
  ds_read_b64_tr_b16 v[32:33], v59 offset:256
  ds_read_b64_tr_b16 v[34:35], v59 offset:4864
  s_waitcnt vmcnt(5)
  s_waitcnt lgkmcnt(0)
  s_barrier
  ds_read_b128 v[36:39], v60 offset:17408
  ds_read_b128 v[40:43], v60 offset:18432
  v_mfma_f32_16x16x32_bf16 a[0:3], v[0:3], v[44:47], a[0:3]
  s_add_u32 m0, s52, 0
  s_nop 0
  buffer_load_dwordx4 v52, s[32:35], s26 offen offset:0 lds
  v_mfma_f32_16x16x32_bf16 a[36:39], v[0:3], v[48:51], a[36:39]
  ds_read_b64_tr_b16 v[0:1], v59 offset:17408
  ds_read_b64_tr_b16 v[2:3], v59 offset:22016
  v_mfma_f32_16x16x32_bf16 a[4:7], v[4:7], v[44:47], a[4:7]
  buffer_load_dwordx4 v53, s[32:35], s26 offen offset:1024 lds
  v_mfma_f32_16x16x32_bf16 a[40:43], v[4:7], v[48:51], a[40:43]
  ds_read_b64_tr_b16 v[4:5], v59 offset:17440
  ds_read_b64_tr_b16 v[6:7], v59 offset:22048
  v_mfma_f32_16x16x32_bf16 a[8:11], v[8:11], v[44:47], a[8:11]
  s_mov_b64 exec, 0xffff
  buffer_load_dwordx4 v54, s[32:35], s26 offen offset:2048 lds
  s_mov_b64 exec, -1
  s_add_u32 s26, s26, 36864
  v_mfma_f32_16x16x32_bf16 a[44:47], v[8:11], v[48:51], a[44:47]
  ds_read_b64_tr_b16 v[8:9], v59 offset:17472
  ds_read_b64_tr_b16 v[10:11], v59 offset:22080
  v_mfma_f32_16x16x32_bf16 a[12:15], v[12:15], v[44:47], a[12:15]
  s_add_u32 m0, s53, 0
  s_nop 0
  buffer_load_dwordx4 v57, s[28:31], s44 offen offset:0 lds
  v_mfma_f32_16x16x32_bf16 a[48:51], v[12:15], v[48:51], a[48:51]
  ds_read_b64_tr_b16 v[12:13], v59 offset:17504
  ds_read_b64_tr_b16 v[14:15], v59 offset:22112
  v_mfma_f32_16x16x32_bf16 a[16:19], v[16:19], v[44:47], a[16:19]
  buffer_load_dwordx4 v58, s[28:31], s44 offen offset:1024 lds
  s_add_u32 s44, s44, 8192
  v_mfma_f32_16x16x32_bf16 a[52:55], v[16:19], v[48:51], a[52:55]
  ds_read_b64_tr_b16 v[16:17], v59 offset:17536
  ds_read_b64_tr_b16 v[18:19], v59 offset:22144
  v_mfma_f32_16x16x32_bf16 a[20:23], v[20:23], v[44:47], a[20:23]
  v_mfma_f32_16x16x32_bf16 a[56:59], v[20:23], v[48:51], a[56:59]
  ds_read_b64_tr_b16 v[20:21], v59 offset:17568
  ds_read_b64_tr_b16 v[22:23], v59 offset:22176
  v_mfma_f32_16x16x32_bf16 a[24:27], v[24:27], v[44:47], a[24:27]
  v_mfma_f32_16x16x32_bf16 a[60:63], v[24:27], v[48:51], a[60:63]
  ds_read_b64_tr_b16 v[24:25], v59 offset:17600
  ds_read_b64_tr_b16 v[26:27], v59 offset:22208
  v_mfma_f32_16x16x32_bf16 a[28:31], v[28:31], v[44:47], a[28:31]
  v_mfma_f32_16x16x32_bf16 a[64:67], v[28:31], v[48:51], a[64:67]
  ds_read_b64_tr_b16 v[28:29], v59 offset:17632
  ds_read_b64_tr_b16 v[30:31], v59 offset:22240
  v_mfma_f32_16x16x32_bf16 a[32:35], v[32:35], v[44:47], a[32:35]
  v_mfma_f32_16x16x32_bf16 a[68:71], v[32:35], v[48:51], a[68:71]
  ds_read_b64_tr_b16 v[32:33], v59 offset:17664
  ds_read_b64_tr_b16 v[34:35], v59 offset:22272
  s_waitcnt vmcnt(5)
  s_waitcnt lgkmcnt(0)
  s_barrier
  ds_read_b128 v[44:47], v60 offset:34816
  ds_read_b128 v[48:51], v60 offset:35840
  v_mfma_f32_16x16x32_bf16 a[0:3], v[0:3], v[36:39], a[0:3]
  s_add_u32 m0, s52, 17408
  s_nop 0
  buffer_load_dwordx4 v52, s[32:35], s26 offen offset:0 lds
  v_mfma_f32_16x16x32_bf16 a[36:39], v[0:3], v[40:43], a[36:39]
  ds_read_b64_tr_b16 v[0:1], v59 offset:34816
  ds_read_b64_tr_b16 v[2:3], v59 offset:39424
  v_mfma_f32_16x16x32_bf16 a[4:7], v[4:7], v[36:39], a[4:7]
  buffer_load_dwordx4 v53, s[32:35], s26 offen offset:1024 lds
  v_mfma_f32_16x16x32_bf16 a[40:43], v[4:7], v[40:43], a[40:43]
  ds_read_b64_tr_b16 v[4:5], v59 offset:34848
  ds_read_b64_tr_b16 v[6:7], v59 offset:39456
  v_mfma_f32_16x16x32_bf16 a[8:11], v[8:11], v[36:39], a[8:11]
  s_mov_b64 exec, 0xffff
  buffer_load_dwordx4 v54, s[32:35], s26 offen offset:2048 lds
  s_mov_b64 exec, -1
  s_add_u32 s26, s26, 36864
  v_mfma_f32_16x16x32_bf16 a[44:47], v[8:11], v[40:43], a[44:47]
  ds_read_b64_tr_b16 v[8:9], v59 offset:34880
  ds_read_b64_tr_b16 v[10:11], v59 offset:39488
  v_mfma_f32_16x16x32_bf16 a[12:15], v[12:15], v[36:39], a[12:15]
  s_add_u32 m0, s53, 17408
  s_nop 0
  buffer_load_dwordx4 v57, s[28:31], s44 offen offset:0 lds
  v_mfma_f32_16x16x32_bf16 a[48:51], v[12:15], v[40:43], a[48:51]
  ds_read_b64_tr_b16 v[12:13], v59 offset:34912
  ds_read_b64_tr_b16 v[14:15], v59 offset:39520
  v_mfma_f32_16x16x32_bf16 a[16:19], v[16:19], v[36:39], a[16:19]
  buffer_load_dwordx4 v58, s[28:31], s44 offen offset:1024 lds
  s_add_u32 s44, s44, 8192
  v_mfma_f32_16x16x32_bf16 a[52:55], v[16:19], v[40:43], a[52:55]
  ds_read_b64_tr_b16 v[16:17], v59 offset:34944
  ds_read_b64_tr_b16 v[18:19], v59 offset:39552
  v_mfma_f32_16x16x32_bf16 a[20:23], v[20:23], v[36:39], a[20:23]
  v_mfma_f32_16x16x32_bf16 a[56:59], v[20:23], v[40:43], a[56:59]
  ds_read_b64_tr_b16 v[20:21], v59 offset:34976
  ds_read_b64_tr_b16 v[22:23], v59 offset:39584
  v_mfma_f32_16x16x32_bf16 a[24:27], v[24:27], v[36:39], a[24:27]
  v_mfma_f32_16x16x32_bf16 a[60:63], v[24:27], v[40:43], a[60:63]
  ds_read_b64_tr_b16 v[24:25], v59 offset:35008
  ds_read_b64_tr_b16 v[26:27], v59 offset:39616
  v_mfma_f32_16x16x32_bf16 a[28:31], v[28:31], v[36:39], a[28:31]
  v_mfma_f32_16x16x32_bf16 a[64:67], v[28:31], v[40:43], a[64:67]
  ds_read_b64_tr_b16 v[28:29], v59 offset:35040
  ds_read_b64_tr_b16 v[30:31], v59 offset:39648
  v_mfma_f32_16x16x32_bf16 a[32:35], v[32:35], v[36:39], a[32:35]
  v_mfma_f32_16x16x32_bf16 a[68:71], v[32:35], v[40:43], a[68:71]
  ds_read_b64_tr_b16 v[32:33], v59 offset:35072
  ds_read_b64_tr_b16 v[34:35], v59 offset:39680
  s_waitcnt vmcnt(5)
  s_waitcnt lgkmcnt(0)
  s_barrier
  ds_read_b128 v[36:39], v60 offset:0
  ds_read_b128 v[40:43], v60 offset:1024
  v_mfma_f32_16x16x32_bf16 a[0:3], v[0:3], v[44:47], a[0:3]
  s_add_u32 m0, s52, 34816
  s_nop 0
  buffer_load_dwordx4 v52, s[32:35], s26 offen offset:0 lds
  v_mfma_f32_16x16x32_bf16 a[36:39], v[0:3], v[48:51], a[36:39]
  ds_read_b64_tr_b16 v[0:1], v59 offset:0
  ds_read_b64_tr_b16 v[2:3], v59 offset:4608
  v_mfma_f32_16x16x32_bf16 a[4:7], v[4:7], v[44:47], a[4:7]
  buffer_load_dwordx4 v53, s[32:35], s26 offen offset:1024 lds
  v_mfma_f32_16x16x32_bf16 a[40:43], v[4:7], v[48:51], a[40:43]
  ds_read_b64_tr_b16 v[4:5], v59 offset:32
  ds_read_b64_tr_b16 v[6:7], v59 offset:4640
  v_mfma_f32_16x16x32_bf16 a[8:11], v[8:11], v[44:47], a[8:11]
  s_mov_b64 exec, 0xffff
  buffer_load_dwordx4 v54, s[32:35], s26 offen offset:2048 lds
  s_mov_b64 exec, -1
  s_add_u32 s26, s26, 36864
  v_mfma_f32_16x16x32_bf16 a[44:47], v[8:11], v[48:51], a[44:47]
  ds_read_b64_tr_b16 v[8:9], v59 offset:64
  ds_read_b64_tr_b16 v[10:11], v59 offset:4672
  v_mfma_f32_16x16x32_bf16 a[12:15], v[12:15], v[44:47], a[12:15]
  s_add_u32 m0, s53, 34816
  s_nop 0
  buffer_load_dwordx4 v57, s[28:31], s44 offen offset:0 lds
  v_mfma_f32_16x16x32_bf16 a[48:51], v[12:15], v[48:51], a[48:51]
  ds_read_b64_tr_b16 v[12:13], v59 offset:96
  ds_read_b64_tr_b16 v[14:15], v59 offset:4704
  v_mfma_f32_16x16x32_bf16 a[16:19], v[16:19], v[44:47], a[16:19]
  buffer_load_dwordx4 v58, s[28:31], s44 offen offset:1024 lds
  s_add_u32 s44, s44, 8192
  v_mfma_f32_16x16x32_bf16 a[52:55], v[16:19], v[48:51], a[52:55]
  ds_read_b64_tr_b16 v[16:17], v59 offset:128
  ds_read_b64_tr_b16 v[18:19], v59 offset:4736
  v_mfma_f32_16x16x32_bf16 a[20:23], v[20:23], v[44:47], a[20:23]
  v_mfma_f32_16x16x32_bf16 a[56:59], v[20:23], v[48:51], a[56:59]
  ds_read_b64_tr_b16 v[20:21], v59 offset:160
  ds_read_b64_tr_b16 v[22:23], v59 offset:4768
  v_mfma_f32_16x16x32_bf16 a[24:27], v[24:27], v[44:47], a[24:27]
  v_mfma_f32_16x16x32_bf16 a[60:63], v[24:27], v[48:51], a[60:63]
  ds_read_b64_tr_b16 v[24:25], v59 offset:192
  ds_read_b64_tr_b16 v[26:27], v59 offset:4800
  v_mfma_f32_16x16x32_bf16 a[28:31], v[28:31], v[44:47], a[28:31]
  v_mfma_f32_16x16x32_bf16 a[64:67], v[28:31], v[48:51], a[64:67]
  ds_read_b64_tr_b16 v[28:29], v59 offset:224
  ds_read_b64_tr_b16 v[30:31], v59 offset:4832
  v_mfma_f32_16x16x32_bf16 a[32:35], v[32:35], v[44:47], a[32:35]
  v_mfma_f32_16x16x32_bf16 a[68:71], v[32:35], v[48:51], a[68:71]
  ds_read_b64_tr_b16 v[32:33], v59 offset:256
  ds_read_b64_tr_b16 v[34:35], v59 offset:4864
  s_waitcnt vmcnt(5)
  s_waitcnt lgkmcnt(0)
  s_barrier
  ds_read_b128 v[44:47], v60 offset:17408
  ds_read_b128 v[48:51], v60 offset:18432
  v_mfma_f32_16x16x32_bf16 a[0:3], v[0:3], v[36:39], a[0:3]
  s_add_u32 m0, s52, 0
  s_nop 0
  buffer_load_dwordx4 v52, s[32:35], s26 offen offset:0 lds
  v_mfma_f32_16x16x32_bf16 a[36:39], v[0:3], v[40:43], a[36:39]
  ds_read_b64_tr_b16 v[0:1], v59 offset:17408
  ds_read_b64_tr_b16 v[2:3], v59 offset:22016
  v_mfma_f32_16x16x32_bf16 a[4:7], v[4:7], v[36:39], a[4:7]
  buffer_load_dwordx4 v53, s[32:35], s26 offen offset:1024 lds
  v_mfma_f32_16x16x32_bf16 a[40:43], v[4:7], v[40:43], a[40:43]
  ds_read_b64_tr_b16 v[4:5], v59 offset:17440
  ds_read_b64_tr_b16 v[6:7], v59 offset:22048
  v_mfma_f32_16x16x32_bf16 a[8:11], v[8:11], v[36:39], a[8:11]
  s_mov_b64 exec, 0xffff
  buffer_load_dwordx4 v54, s[32:35], s26 offen offset:2048 lds
  s_mov_b64 exec, -1
  s_add_u32 s26, s26, 36864
  v_mfma_f32_16x16x32_bf16 a[44:47], v[8:11], v[40:43], a[44:47]
  ds_read_b64_tr_b16 v[8:9], v59 offset:17472
  ds_read_b64_tr_b16 v[10:11], v59 offset:22080
  v_mfma_f32_16x16x32_bf16 a[12:15], v[12:15], v[36:39], a[12:15]
  s_add_u32 m0, s53, 0
  s_nop 0
  buffer_load_dwordx4 v57, s[28:31], s44 offen offset:0 lds
  v_mfma_f32_16x16x32_bf16 a[48:51], v[12:15], v[40:43], a[48:51]
  ds_read_b64_tr_b16 v[12:13], v59 offset:17504
  ds_read_b64_tr_b16 v[14:15], v59 offset:22112
  v_mfma_f32_16x16x32_bf16 a[16:19], v[16:19], v[36:39], a[16:19]
  buffer_load_dwordx4 v58, s[28:31], s44 offen offset:1024 lds
  s_add_u32 s44, s44, 8192
  v_mfma_f32_16x16x32_bf16 a[52:55], v[16:19], v[40:43], a[52:55]
  ds_read_b64_tr_b16 v[16:17], v59 offset:17536
  ds_read_b64_tr_b16 v[18:19], v59 offset:22144
  v_mfma_f32_16x16x32_bf16 a[20:23], v[20:23], v[36:39], a[20:23]
  v_mfma_f32_16x16x32_bf16 a[56:59], v[20:23], v[40:43], a[56:59]
  ds_read_b64_tr_b16 v[20:21], v59 offset:17568
  ds_read_b64_tr_b16 v[22:23], v59 offset:22176
  v_mfma_f32_16x16x32_bf16 a[24:27], v[24:27], v[36:39], a[24:27]
  v_mfma_f32_16x16x32_bf16 a[60:63], v[24:27], v[40:43], a[60:63]
  ds_read_b64_tr_b16 v[24:25], v59 offset:17600
  ds_read_b64_tr_b16 v[26:27], v59 offset:22208
  v_mfma_f32_16x16x32_bf16 a[28:31], v[28:31], v[36:39], a[28:31]
  v_mfma_f32_16x16x32_bf16 a[64:67], v[28:31], v[40:43], a[64:67]
  ds_read_b64_tr_b16 v[28:29], v59 offset:17632
  ds_read_b64_tr_b16 v[30:31], v59 offset:22240
  v_mfma_f32_16x16x32_bf16 a[32:35], v[32:35], v[36:39], a[32:35]
  v_mfma_f32_16x16x32_bf16 a[68:71], v[32:35], v[40:43], a[68:71]
  ds_read_b64_tr_b16 v[32:33], v59 offset:17664
  ds_read_b64_tr_b16 v[34:35], v59 offset:22272
  s_waitcnt vmcnt(5)
  s_waitcnt lgkmcnt(0)
  s_barrier
  ds_read_b128 v[36:39], v60 offset:34816
  ds_read_b128 v[40:43], v60 offset:35840
  v_mfma_f32_16x16x32_bf16 a[0:3], v[0:3], v[44:47], a[0:3]
  s_add_u32 m0, s52, 17408
  s_nop 0
  buffer_load_dwordx4 v52, s[32:35], s26 offen offset:0 lds
  v_mfma_f32_16x16x32_bf16 a[36:39], v[0:3], v[48:51], a[36:39]
  ds_read_b64_tr_b16 v[0:1], v59 offset:34816
  ds_read_b64_tr_b16 v[2:3], v59 offset:39424
  v_mfma_f32_16x16x32_bf16 a[4:7], v[4:7], v[44:47], a[4:7]
  buffer_load_dwordx4 v53, s[32:35], s26 offen offset:1024 lds
  v_mfma_f32_16x16x32_bf16 a[40:43], v[4:7], v[48:51], a[40:43]
  ds_read_b64_tr_b16 v[4:5], v59 offset:34848
  ds_read_b64_tr_b16 v[6:7], v59 offset:39456
  v_mfma_f32_16x16x32_bf16 a[8:11], v[8:11], v[44:47], a[8:11]
  s_mov_b64 exec, 0xffff
  buffer_load_dwordx4 v54, s[32:35], s26 offen offset:2048 lds
  s_mov_b64 exec, -1
  s_add_u32 s26, s26, 36864
  v_mfma_f32_16x16x32_bf16 a[44:47], v[8:11], v[48:51], a[44:47]
  ds_read_b64_tr_b16 v[8:9], v59 offset:34880
  ds_read_b64_tr_b16 v[10:11], v59 offset:39488
  v_mfma_f32_16x16x32_bf16 a[12:15], v[12:15], v[44:47], a[12:15]
  s_add_u32 m0, s53, 17408
  s_nop 0
  buffer_load_dwordx4 v57, s[28:31], s44 offen offset:0 lds
  v_mfma_f32_16x16x32_bf16 a[48:51], v[12:15], v[48:51], a[48:51]
  ds_read_b64_tr_b16 v[12:13], v59 offset:34912
  ds_read_b64_tr_b16 v[14:15], v59 offset:39520
  v_mfma_f32_16x16x32_bf16 a[16:19], v[16:19], v[44:47], a[16:19]
  buffer_load_dwordx4 v58, s[28:31], s44 offen offset:1024 lds
  s_add_u32 s44, s44, 8192
  v_mfma_f32_16x16x32_bf16 a[52:55], v[16:19], v[48:51], a[52:55]
  ds_read_b64_tr_b16 v[16:17], v59 offset:34944
  ds_read_b64_tr_b16 v[18:19], v59 offset:39552
  v_mfma_f32_16x16x32_bf16 a[20:23], v[20:23], v[44:47], a[20:23]
  v_mfma_f32_16x16x32_bf16 a[56:59], v[20:23], v[48:51], a[56:59]
  ds_read_b64_tr_b16 v[20:21], v59 offset:34976
  ds_read_b64_tr_b16 v[22:23], v59 offset:39584
  v_mfma_f32_16x16x32_bf16 a[24:27], v[24:27], v[44:47], a[24:27]
  v_mfma_f32_16x16x32_bf16 a[60:63], v[24:27], v[48:51], a[60:63]
  ds_read_b64_tr_b16 v[24:25], v59 offset:35008
  ds_read_b64_tr_b16 v[26:27], v59 offset:39616
  v_mfma_f32_16x16x32_bf16 a[28:31], v[28:31], v[44:47], a[28:31]
  v_mfma_f32_16x16x32_bf16 a[64:67], v[28:31], v[48:51], a[64:67]
  ds_read_b64_tr_b16 v[28:29], v59 offset:35040
  ds_read_b64_tr_b16 v[30:31], v59 offset:39648
  v_mfma_f32_16x16x32_bf16 a[32:35], v[32:35], v[44:47], a[32:35]
  v_mfma_f32_16x16x32_bf16 a[68:71], v[32:35], v[48:51], a[68:71]
  ds_read_b64_tr_b16 v[32:33], v59 offset:35072
  ds_read_b64_tr_b16 v[34:35], v59 offset:39680
  s_waitcnt vmcnt(5)
  s_waitcnt lgkmcnt(0)
  s_barrier
  ds_read_b128 v[44:47], v60 offset:0
  ds_read_b128 v[48:51], v60 offset:1024
  v_mfma_f32_16x16x32_bf16 a[0:3], v[0:3], v[36:39], a[0:3]
  s_add_u32 m0, s52, 34816
  s_nop 0
  buffer_load_dwordx4 v52, s[32:35], s26 offen offset:0 lds
  v_mfma_f32_16x16x32_bf16 a[36:39], v[0:3], v[40:43], a[36:39]
  ds_read_b64_tr_b16 v[0:1], v59 offset:0
  ds_read_b64_tr_b16 v[2:3], v59 offset:4608
  v_mfma_f32_16x16x32_bf16 a[4:7], v[4:7], v[36:39], a[4:7]
  buffer_load_dwordx4 v53, s[32:35], s26 offen offset:1024 lds
  v_mfma_f32_16x16x32_bf16 a[40:43], v[4:7], v[40:43], a[40:43]
  ds_read_b64_tr_b16 v[4:5], v59 offset:32
  ds_read_b64_tr_b16 v[6:7], v59 offset:4640
  v_mfma_f32_16x16x32_bf16 a[8:11], v[8:11], v[36:39], a[8:11]
  s_mov_b64 exec, 0xffff
  buffer_load_dwordx4 v54, s[32:35], s26 offen offset:2048 lds
  s_mov_b64 exec, -1
  s_add_u32 s26, s26, 36864
  v_mfma_f32_16x16x32_bf16 a[44:47], v[8:11], v[40:43], a[44:47]
  ds_read_b64_tr_b16 v[8:9], v59 offset:64
  ds_read_b64_tr_b16 v[10:11], v59 offset:4672
  v_mfma_f32_16x16x32_bf16 a[12:15], v[12:15], v[36:39], a[12:15]
  s_add_u32 m0, s53, 34816
  s_nop 0
  buffer_load_dwordx4 v57, s[28:31], s44 offen offset:0 lds
  v_mfma_f32_16x16x32_bf16 a[48:51], v[12:15], v[40:43], a[48:51]
  ds_read_b64_tr_b16 v[12:13], v59 offset:96
  ds_read_b64_tr_b16 v[14:15], v59 offset:4704
  v_mfma_f32_16x16x32_bf16 a[16:19], v[16:19], v[36:39], a[16:19]
  buffer_load_dwordx4 v58, s[28:31], s44 offen offset:1024 lds
  s_add_u32 s44, s44, 8192
  v_mfma_f32_16x16x32_bf16 a[52:55], v[16:19], v[40:43], a[52:55]
  ds_read_b64_tr_b16 v[16:17], v59 offset:128
  ds_read_b64_tr_b16 v[18:19], v59 offset:4736
  v_mfma_f32_16x16x32_bf16 a[20:23], v[20:23], v[36:39], a[20:23]
  v_mfma_f32_16x16x32_bf16 a[56:59], v[20:23], v[40:43], a[56:59]
  ds_read_b64_tr_b16 v[20:21], v59 offset:160
  ds_read_b64_tr_b16 v[22:23], v59 offset:4768
  v_mfma_f32_16x16x32_bf16 a[24:27], v[24:27], v[36:39], a[24:27]
  v_mfma_f32_16x16x32_bf16 a[60:63], v[24:27], v[40:43], a[60:63]
  ds_read_b64_tr_b16 v[24:25], v59 offset:192
  ds_read_b64_tr_b16 v[26:27], v59 offset:4800
  v_mfma_f32_16x16x32_bf16 a[28:31], v[28:31], v[36:39], a[28:31]
  v_mfma_f32_16x16x32_bf16 a[64:67], v[28:31], v[40:43], a[64:67]
  ds_read_b64_tr_b16 v[28:29], v59 offset:224
  ds_read_b64_tr_b16 v[30:31], v59 offset:4832
  v_mfma_f32_16x16x32_bf16 a[32:35], v[32:35], v[36:39], a[32:35]
  v_mfma_f32_16x16x32_bf16 a[68:71], v[32:35], v[40:43], a[68:71]
  ds_read_b64_tr_b16 v[32:33], v59 offset:256
  ds_read_b64_tr_b16 v[34:35], v59 offset:4864
  s_waitcnt vmcnt(5)
  s_waitcnt lgkmcnt(0)
  s_barrier
  ds_read_b128 v[36:39], v60 offset:17408
  ds_read_b128 v[40:43], v60 offset:18432
  v_mfma_f32_16x16x32_bf16 a[0:3], v[0:3], v[44:47], a[0:3]
  v_mfma_f32_16x16x32_bf16 a[36:39], v[0:3], v[48:51], a[36:39]
  ds_read_b64_tr_b16 v[0:1], v59 offset:17408
  ds_read_b64_tr_b16 v[2:3], v59 offset:22016
  v_mfma_f32_16x16x32_bf16 a[4:7], v[4:7], v[44:47], a[4:7]
  v_mfma_f32_16x16x32_bf16 a[40:43], v[4:7], v[48:51], a[40:43]
  ds_read_b64_tr_b16 v[4:5], v59 offset:17440
  ds_read_b64_tr_b16 v[6:7], v59 offset:22048
  v_mfma_f32_16x16x32_bf16 a[8:11], v[8:11], v[44:47], a[8:11]
  v_mfma_f32_16x16x32_bf16 a[44:47], v[8:11], v[48:51], a[44:47]
  ds_read_b64_tr_b16 v[8:9], v59 offset:17472
  ds_read_b64_tr_b16 v[10:11], v59 offset:22080
  v_mfma_f32_16x16x32_bf16 a[12:15], v[12:15], v[44:47], a[12:15]
  v_mfma_f32_16x16x32_bf16 a[48:51], v[12:15], v[48:51], a[48:51]
  ds_read_b64_tr_b16 v[12:13], v59 offset:17504
  ds_read_b64_tr_b16 v[14:15], v59 offset:22112
  v_mfma_f32_16x16x32_bf16 a[16:19], v[16:19], v[44:47], a[16:19]
  v_mfma_f32_16x16x32_bf16 a[52:55], v[16:19], v[48:51], a[52:55]
  ds_read_b64_tr_b16 v[16:17], v59 offset:17536
  ds_read_b64_tr_b16 v[18:19], v59 offset:22144
  v_mfma_f32_16x16x32_bf16 a[20:23], v[20:23], v[44:47], a[20:23]
  v_mfma_f32_16x16x32_bf16 a[56:59], v[20:23], v[48:51], a[56:59]
  ds_read_b64_tr_b16 v[20:21], v59 offset:17568
  ds_read_b64_tr_b16 v[22:23], v59 offset:22176
  v_mfma_f32_16x16x32_bf16 a[24:27], v[24:27], v[44:47], a[24:27]
  v_mfma_f32_16x16x32_bf16 a[60:63], v[24:27], v[48:51], a[60:63]
  ds_read_b64_tr_b16 v[24:25], v59 offset:17600
  ds_read_b64_tr_b16 v[26:27], v59 offset:22208
  v_mfma_f32_16x16x32_bf16 a[28:31], v[28:31], v[44:47], a[28:31]
  v_mfma_f32_16x16x32_bf16 a[64:67], v[28:31], v[48:51], a[64:67]
  ds_read_b64_tr_b16 v[28:29], v59 offset:17632
  ds_read_b64_tr_b16 v[30:31], v59 offset:22240
  v_mfma_f32_16x16x32_bf16 a[32:35], v[32:35], v[44:47], a[32:35]
  v_mfma_f32_16x16x32_bf16 a[68:71], v[32:35], v[48:51], a[68:71]
  ds_read_b64_tr_b16 v[32:33], v59 offset:17664
  ds_read_b64_tr_b16 v[34:35], v59 offset:22272
  s_waitcnt vmcnt(0)
  s_waitcnt lgkmcnt(0)
  s_barrier
  ds_read_b128 v[44:47], v60 offset:34816
  ds_read_b128 v[48:51], v60 offset:35840
  v_mfma_f32_16x16x32_bf16 a[0:3], v[0:3], v[36:39], a[0:3]
  v_mfma_f32_16x16x32_bf16 a[36:39], v[0:3], v[40:43], a[36:39]
  ds_read_b64_tr_b16 v[0:1], v59 offset:34816
  ds_read_b64_tr_b16 v[2:3], v59 offset:39424
  v_mfma_f32_16x16x32_bf16 a[4:7], v[4:7], v[36:39], a[4:7]
  v_mfma_f32_16x16x32_bf16 a[40:43], v[4:7], v[40:43], a[40:43]
  ds_read_b64_tr_b16 v[4:5], v59 offset:34848
  ds_read_b64_tr_b16 v[6:7], v59 offset:39456
  v_mfma_f32_16x16x32_bf16 a[8:11], v[8:11], v[36:39], a[8:11]
  v_mfma_f32_16x16x32_bf16 a[44:47], v[8:11], v[40:43], a[44:47]
  ds_read_b64_tr_b16 v[8:9], v59 offset:34880
  ds_read_b64_tr_b16 v[10:11], v59 offset:39488
  v_mfma_f32_16x16x32_bf16 a[12:15], v[12:15], v[36:39], a[12:15]
  v_mfma_f32_16x16x32_bf16 a[48:51], v[12:15], v[40:43], a[48:51]
  ds_read_b64_tr_b16 v[12:13], v59 offset:34912
  ds_read_b64_tr_b16 v[14:15], v59 offset:39520
  v_mfma_f32_16x16x32_bf16 a[16:19], v[16:19], v[36:39], a[16:19]
  v_mfma_f32_16x16x32_bf16 a[52:55], v[16:19], v[40:43], a[52:55]
  ds_read_b64_tr_b16 v[16:17], v59 offset:34944
  ds_read_b64_tr_b16 v[18:19], v59 offset:39552
  v_mfma_f32_16x16x32_bf16 a[20:23], v[20:23], v[36:39], a[20:23]
  v_mfma_f32_16x16x32_bf16 a[56:59], v[20:23], v[40:43], a[56:59]
  ds_read_b64_tr_b16 v[20:21], v59 offset:34976
  ds_read_b64_tr_b16 v[22:23], v59 offset:39584
  v_mfma_f32_16x16x32_bf16 a[24:27], v[24:27], v[36:39], a[24:27]
  v_mfma_f32_16x16x32_bf16 a[60:63], v[24:27], v[40:43], a[60:63]
  ds_read_b64_tr_b16 v[24:25], v59 offset:35008
  ds_read_b64_tr_b16 v[26:27], v59 offset:39616
  v_mfma_f32_16x16x32_bf16 a[28:31], v[28:31], v[36:39], a[28:31]
  v_mfma_f32_16x16x32_bf16 a[64:67], v[28:31], v[40:43], a[64:67]
  ds_read_b64_tr_b16 v[28:29], v59 offset:35040
  ds_read_b64_tr_b16 v[30:31], v59 offset:39648
  v_mfma_f32_16x16x32_bf16 a[32:35], v[32:35], v[36:39], a[32:35]
  v_mfma_f32_16x16x32_bf16 a[68:71], v[32:35], v[40:43], a[68:71]
  ds_read_b64_tr_b16 v[32:33], v59 offset:35072
  ds_read_b64_tr_b16 v[34:35], v59 offset:39680
  s_waitcnt lgkmcnt(0)
  s_barrier
  v_mfma_f32_16x16x32_bf16 a[0:3], v[0:3], v[44:47], a[0:3]
  v_mfma_f32_16x16x32_bf16 a[36:39], v[0:3], v[48:51], a[36:39]
  v_mfma_f32_16x16x32_bf16 a[4:7], v[4:7], v[44:47], a[4:7]
  v_mfma_f32_16x16x32_bf16 a[40:43], v[4:7], v[48:51], a[40:43]
  v_mfma_f32_16x16x32_bf16 a[8:11], v[8:11], v[44:47], a[8:11]
  v_mfma_f32_16x16x32_bf16 a[44:47], v[8:11], v[48:51], a[44:47]
  v_mfma_f32_16x16x32_bf16 a[12:15], v[12:15], v[44:47], a[12:15]
  v_mfma_f32_16x16x32_bf16 a[48:51], v[12:15], v[48:51], a[48:51]
  v_mfma_f32_16x16x32_bf16 a[16:19], v[16:19], v[44:47], a[16:19]
  v_mfma_f32_16x16x32_bf16 a[52:55], v[16:19], v[48:51], a[52:55]
  v_mfma_f32_16x16x32_bf16 a[20:23], v[20:23], v[44:47], a[20:23]
  v_mfma_f32_16x16x32_bf16 a[56:59], v[20:23], v[48:51], a[56:59]
  v_mfma_f32_16x16x32_bf16 a[24:27], v[24:27], v[44:47], a[24:27]
  v_mfma_f32_16x16x32_bf16 a[60:63], v[24:27], v[48:51], a[60:63]
  v_mfma_f32_16x16x32_bf16 a[28:31], v[28:31], v[44:47], a[28:31]
  v_mfma_f32_16x16x32_bf16 a[64:67], v[28:31], v[48:51], a[64:67]
  v_mfma_f32_16x16x32_bf16 a[32:35], v[32:35], v[44:47], a[32:35]
  v_mfma_f32_16x16x32_bf16 a[68:71], v[32:35], v[48:51], a[68:71]
  s_nop 7
  s_nop 1
  s_lshl_b32 s45, s21, 1
  s_lshl_b32 s46, s24, 3
  s_add_u32 s45, s45, s46
  s_mul_i32 s45, s45, 36
  s_mul_i32 s46, s23, 9
  s_add_u32 s45, s45, s46
  s_lshl_b32 s45, s45, 9
  s_mul_i32 s46, s18, 2359296
  s_add_u32 s45, s45, s46
  v_and_b32 v61, 63, v70
  v_lshlrev_b32 v61, 3, v61
  v_accvgpr_read_b32 v72, a0
  v_accvgpr_read_b32 v73, a1
  v_accvgpr_read_b32 v74, a2
  v_accvgpr_read_b32 v75, a3
  v_cvt_pk_bf16_f32 v0, v72, v73
  v_cvt_pk_bf16_f32 v1, v74, v75
  buffer_store_dwordx2 v[0:1], v61, s[40:43], s45 offen offset:0 sc1
  v_accvgpr_read_b32 v76, a4
  v_accvgpr_read_b32 v77, a5
  v_accvgpr_read_b32 v78, a6
  v_accvgpr_read_b32 v79, a7
  v_cvt_pk_bf16_f32 v2, v76, v77
  v_cvt_pk_bf16_f32 v3, v78, v79
  buffer_store_dwordx2 v[2:3], v61, s[40:43], s45 offen offset:512 sc1
  v_accvgpr_read_b32 v80, a8
  v_accvgpr_read_b32 v81, a9
  v_accvgpr_read_b32 v82, a10
  v_accvgpr_read_b32 v83, a11
  v_cvt_pk_bf16_f32 v4, v80, v81
  v_cvt_pk_bf16_f32 v5, v82, v83
  buffer_store_dwordx2 v[4:5], v61, s[40:43], s45 offen offset:1024 sc1
  v_accvgpr_read_b32 v84, a12
  v_accvgpr_read_b32 v85, a13
  v_accvgpr_read_b32 v86, a14
  v_accvgpr_read_b32 v87, a15
  v_cvt_pk_bf16_f32 v6, v84, v85
  v_cvt_pk_bf16_f32 v7, v86, v87
  buffer_store_dwordx2 v[6:7], v61, s[40:43], s45 offen offset:1536 sc1
  v_accvgpr_read_b32 v72, a16
  v_accvgpr_read_b32 v73, a17
  v_accvgpr_read_b32 v74, a18
  v_accvgpr_read_b32 v75, a19
  v_cvt_pk_bf16_f32 v8, v72, v73
  v_cvt_pk_bf16_f32 v9, v74, v75
  buffer_store_dwordx2 v[8:9], v61, s[40:43], s45 offen offset:2048 sc1
  v_accvgpr_read_b32 v76, a20
  v_accvgpr_read_b32 v77, a21
  v_accvgpr_read_b32 v78, a22
  v_accvgpr_read_b32 v79, a23
  v_cvt_pk_bf16_f32 v10, v76, v77
  v_cvt_pk_bf16_f32 v11, v78, v79
  buffer_store_dwordx2 v[10:11], v61, s[40:43], s45 offen offset:2560 sc1
  v_accvgpr_read_b32 v80, a24
  v_accvgpr_read_b32 v81, a25
  v_accvgpr_read_b32 v82, a26
  v_accvgpr_read_b32 v83, a27
  v_cvt_pk_bf16_f32 v12, v80, v81
  v_cvt_pk_bf16_f32 v13, v82, v83
  buffer_store_dwordx2 v[12:13], v61, s[40:43], s45 offen offset:3072 sc1
  v_accvgpr_read_b32 v84, a28
  v_accvgpr_read_b32 v85, a29
  v_accvgpr_read_b32 v86, a30
  v_accvgpr_read_b32 v87, a31
  v_cvt_pk_bf16_f32 v14, v84, v85
  v_cvt_pk_bf16_f32 v15, v86, v87
  buffer_store_dwordx2 v[14:15], v61, s[40:43], s45 offen offset:3584 sc1
  v_accvgpr_read_b32 v72, a32
  v_accvgpr_read_b32 v73, a33
  v_accvgpr_read_b32 v74, a34
  v_accvgpr_read_b32 v75, a35
  v_cvt_pk_bf16_f32 v16, v72, v73
  v_cvt_pk_bf16_f32 v17, v74, v75
  s_add_u32 s46, s45, 4096
  buffer_store_dwordx2 v[16:17], v61, s[40:43], s46 offen offset:0 sc1
  s_add_u32 s45, s45, 18432
  v_accvgpr_read_b32 v76, a36
  v_accvgpr_read_b32 v77, a37
  v_accvgpr_read_b32 v78, a38
  v_accvgpr_read_b32 v79, a39
  v_cvt_pk_bf16_f32 v18, v76, v77
  v_cvt_pk_bf16_f32 v19, v78, v79
  buffer_store_dwordx2 v[18:19], v61, s[40:43], s45 offen offset:0 sc1
  v_accvgpr_read_b32 v80, a40
  v_accvgpr_read_b32 v81, a41
  v_accvgpr_read_b32 v82, a42
  v_accvgpr_read_b32 v83, a43
  v_cvt_pk_bf16_f32 v20, v80, v81
  v_cvt_pk_bf16_f32 v21, v82, v83
  buffer_store_dwordx2 v[20:21], v61, s[40:43], s45 offen offset:512 sc1
  v_accvgpr_read_b32 v84, a44
  v_accvgpr_read_b32 v85, a45
  v_accvgpr_read_b32 v86, a46
  v_accvgpr_read_b32 v87, a47
  v_cvt_pk_bf16_f32 v22, v84, v85
  v_cvt_pk_bf16_f32 v23, v86, v87
  buffer_store_dwordx2 v[22:23], v61, s[40:43], s45 offen offset:1024 sc1
  v_accvgpr_read_b32 v72, a48
  v_accvgpr_read_b32 v73, a49
  v_accvgpr_read_b32 v74, a50
  v_accvgpr_read_b32 v75, a51
  v_cvt_pk_bf16_f32 v24, v72, v73
  v_cvt_pk_bf16_f32 v25, v74, v75
  buffer_store_dwordx2 v[24:25], v61, s[40:43], s45 offen offset:1536 sc1
  v_accvgpr_read_b32 v76, a52
  v_accvgpr_read_b32 v77, a53
  v_accvgpr_read_b32 v78, a54
  v_accvgpr_read_b32 v79, a55
  v_cvt_pk_bf16_f32 v26, v76, v77
  v_cvt_pk_bf16_f32 v27, v78, v79
  buffer_store_dwordx2 v[26:27], v61, s[40:43], s45 offen offset:2048 sc1
  v_accvgpr_read_b32 v80, a56
  v_accvgpr_read_b32 v81, a57
  v_accvgpr_read_b32 v82, a58
  v_accvgpr_read_b32 v83, a59
  v_cvt_pk_bf16_f32 v28, v80, v81
  v_cvt_pk_bf16_f32 v29, v82, v83
  buffer_store_dwordx2 v[28:29], v61, s[40:43], s45 offen offset:2560 sc1
  v_accvgpr_read_b32 v84, a60
  v_accvgpr_read_b32 v85, a61
  v_accvgpr_read_b32 v86, a62
  v_accvgpr_read_b32 v87, a63
  v_cvt_pk_bf16_f32 v30, v84, v85
  v_cvt_pk_bf16_f32 v31, v86, v87
  buffer_store_dwordx2 v[30:31], v61, s[40:43], s45 offen offset:3072 sc1
  v_accvgpr_read_b32 v72, a64
  v_accvgpr_read_b32 v73, a65
  v_accvgpr_read_b32 v74, a66
  v_accvgpr_read_b32 v75, a67
  v_cvt_pk_bf16_f32 v32, v72, v73
  v_cvt_pk_bf16_f32 v33, v74, v75
  buffer_store_dwordx2 v[32:33], v61, s[40:43], s45 offen offset:3584 sc1
  v_accvgpr_read_b32 v76, a68
  v_accvgpr_read_b32 v77, a69
  v_accvgpr_read_b32 v78, a70
  v_accvgpr_read_b32 v79, a71
  v_cvt_pk_bf16_f32 v34, v76, v77
  v_cvt_pk_bf16_f32 v35, v78, v79
  s_add_u32 s46, s45, 4096
  buffer_store_dwordx2 v[34:35], v61, s[40:43], s46 offen offset:0 sc1
  s_add_u32 s45, s45, 18432
  s_endpgm
k2_kernel_ATT:
  s_setprio 3
  s_sub_u32 s18, s2, 256
  s_and_b32 s19, s18, 7
  s_lshr_b32 s18, s18, 3
  s_lshl_b32 s19, s19, 2
  s_lshr_b32 s20, s18, 4
  s_add_u32 s19, s19, s20
  s_and_b32 s18, s18, 15
  s_lshl_b32 s18, s18, 2
  s_add_u32 s18, s18, s21
  s_waitcnt lgkmcnt(0)
  s_add_u32 s28, s16, 18874368
  s_addc_u32 s29, s17, 0
  s_mov_b32 s30, 2359296
  s_mov_b32 s31, 0x20000
  s_add_u32 s32, s16, 21233664
  s_addc_u32 s33, s17, 0
  s_mov_b32 s34, 5242880
  s_mov_b32 s35, 0x20000
  s_add_u32 s36, s16, 26476544
  s_addc_u32 s37, s17, 0
  s_mov_b32 s38, 4096
  s_mov_b32 s39, 0x20000
  s_add_u32 s40, s16, 26488832
  s_addc_u32 s41, s17, 0
  s_mov_b32 s42, 2359296
  s_mov_b32 s43, 0x20000
  v_and_b32 v78, 63, v0
  v_lshlrev_b32 v74, 4, v78
  s_mul_i32 s22, s19, 163840
  s_mul_i32 s23, s21, 2560
  v_add_u32 v79, s23, v74
  s_add_u32 m0, s23, 0
  s_add_u32 s24, s22, 0
  buffer_load_dwordx4 v79, s[32:35], s24 offen lds
  buffer_load_dwordx4 v79, s[32:35], s24 offen offset:1024 lds
  s_mov_b32 exec_hi, 0
  buffer_load_dwordx4 v79, s[32:35], s24 offen offset:2048 lds
  s_mov_b64 exec, -1
  s_mul_i32 s24, s19, 73728
  s_mul_i32 s25, s18, 1152
  s_add_u32 s24, s24, s25
  v_and_b32 v80, 31, v78
  v_lshlrev_b32 v75, 2, v80
  v_add_u32 v75, 1024, v75
  v_mov_b32 v72, 0
  v_mov_b32 v73, 0
  v_mov_b32 v45, 0x3f803f80
  v_mov_b32 v51, 0x3f803f80
  buffer_load_dwordx4 v[68:71], v74, s[28:31], s24 offen offset:0
  s_mov_b32 exec_hi, 0
  buffer_load_dword v72, v75, s[28:31], s24 offen offset:0
  s_mov_b64 exec, -1
  s_lshr_b32 s25, s19, 3
  s_lshl_b32 s25, s25, 8
  v_lshlrev_b32 v81, 2, v78
  buffer_load_dword v82, v81, s[36:39], s25 offen
  buffer_load_dword v83, v81, s[36:39], s25 offen offset:1024
  s_add_u32 m0, s23, 10240
  s_add_u32 s24, s22, 10240
  buffer_load_dwordx4 v79, s[32:35], s24 offen lds
  buffer_load_dwordx4 v79, s[32:35], s24 offen offset:1024 lds
  s_mov_b32 exec_hi, 0
  buffer_load_dwordx4 v79, s[32:35], s24 offen offset:2048 lds
  s_mov_b64 exec, -1
  s_add_u32 m0, s23, 20480
  s_add_u32 s24, s22, 20480
  buffer_load_dwordx4 v79, s[32:35], s24 offen lds
  buffer_load_dwordx4 v79, s[32:35], s24 offen offset:1024 lds
  s_mov_b32 exec_hi, 0
  buffer_load_dwordx4 v79, s[32:35], s24 offen offset:2048 lds
  s_mov_b64 exec, -1
  s_add_u32 m0, s23, 30720
  s_add_u32 s24, s22, 30720
  buffer_load_dwordx4 v79, s[32:35], s24 offen lds
  buffer_load_dwordx4 v79, s[32:35], s24 offen offset:1024 lds
  s_mov_b32 exec_hi, 0
  buffer_load_dwordx4 v79, s[32:35], s24 offen offset:2048 lds
  s_mov_b64 exec, -1
  v_lshrrev_b32 v81, 5, v78
  v_mul_u32_u24 v81, 19, v81
  v_add_u32 v81, v81, v80
  v_lshlrev_b32 v76, 4, v81
  v_add_u32 v76, 1152, v76
  v_accvgpr_write_b32 a0, 0
  v_accvgpr_write_b32 a1, 0
  v_accvgpr_write_b32 a2, 0
  v_accvgpr_write_b32 a3, 0
  v_accvgpr_write_b32 a4, 0
  v_accvgpr_write_b32 a5, 0
  v_accvgpr_write_b32 a6, 0
  v_accvgpr_write_b32 a7, 0
  v_accvgpr_write_b32 a8, 0
  v_accvgpr_write_b32 a9, 0
  v_accvgpr_write_b32 a10, 0
  v_accvgpr_write_b32 a11, 0
  v_accvgpr_write_b32 a12, 0
  v_accvgpr_write_b32 a13, 0
  v_accvgpr_write_b32 a14, 0
  v_accvgpr_write_b32 a15, 0
  s_waitcnt vmcnt(9)
  v_max_f32 v82, v82, v83
  s_nop 1
  v_max_f32_dpp v82, v82, v82 row_ror:8 row_mask:0xf bank_mask:0xf
  s_nop 1
  v_max_f32_dpp v82, v82, v82 row_ror:4 row_mask:0xf bank_mask:0xf
  s_nop 1
  v_max_f32_dpp v82, v82, v82 row_ror:2 row_mask:0xf bank_mask:0xf
  s_nop 1
  v_max_f32_dpp v82, v82, v82 row_ror:1 row_mask:0xf bank_mask:0xf
  v_mov_b32 v83, v82
  s_nop 1
  v_permlane16_swap_b32 v83, v82
  s_nop 1
  v_max_f32 v82, v82, v83
  v_mov_b32 v83, v82
  s_nop 1
  v_permlane32_swap_b32 v83, v82
  s_nop 1
  v_max_f32 v82, v82, v83
  v_mov_b32 v84, 0
  v_mov_b32 v87, 0
  v_lshlrev_b32 v85, 16, v68
  v_and_b32 v86, 0xffff0000, v68
  v_fmac_f32 v84, v85, v85
  v_fmac_f32 v84, v86, v86
  v_lshlrev_b32 v85, 16, v69
  v_and_b32 v86, 0xffff0000, v69
  v_fmac_f32 v84, v85, v85
  v_fmac_f32 v84, v86, v86
  v_lshlrev_b32 v85, 16, v70
  v_and_b32 v86, 0xffff0000, v70
  v_fmac_f32 v84, v85, v85
  v_fmac_f32 v84, v86, v86
  v_lshlrev_b32 v85, 16, v71
  v_and_b32 v86, 0xffff0000, v71
  v_fmac_f32 v84, v85, v85
  v_fmac_f32 v84, v86, v86
  v_lshlrev_b32 v85, 16, v72
  v_and_b32 v86, 0xffff0000, v72
  v_fmac_f32 v84, v85, v85
  v_fmac_f32 v84, v86, v86
  v_mov_b32 v85, v84
  s_nop 1
  v_permlane32_swap_b32 v85, v84
  s_nop 1
  v_add_f32 v84, v84, v85
  v_max_f32 v84, v84, v87
  s_nop 1
  v_max_f32_dpp v84, v84, v84 row_ror:8 row_mask:0xf bank_mask:0xf
  s_nop 1
  v_max_f32_dpp v84, v84, v84 row_ror:4 row_mask:0xf bank_mask:0xf
  s_nop 1
  v_max_f32_dpp v84, v84, v84 row_ror:2 row_mask:0xf bank_mask:0xf
  s_nop 1
  v_max_f32_dpp v84, v84, v84 row_ror:1 row_mask:0xf bank_mask:0xf
  v_mov_b32 v85, v84
  s_nop 1
  v_permlane16_swap_b32 v85, v84
  s_nop 1
  v_max_f32 v84, v84, v85
  v_mov_b32 v85, v84
  s_nop 1
  v_permlane32_swap_b32 v85, v84
  s_nop 1
  v_max_f32 v84, v84, v85
  v_mul_f32 v85, v82, v82
  v_mul_f32 v85, v85, v84
  v_mul_f32 v85, 0x41900000, v85
  v_mov_b32 v86, 0x45c80000
  v_cmp_le_f32 vcc, v85, v86
  s_mov_b64 s[46:47], vcc
  v_mov_b32 v86, 0x49800000
  v_cmp_le_f32 vcc, v82, v86
  s_nop 4
  s_and_b64 s[46:47], s[46:47], vcc
  s_cmp_eq_u64 s[46:47], -1
  s_cbranch_scc1 k2_kernel_FAST
  s_mov_b32 s25, s22
  s_mov_b32 s26, 64
  v_mov_b32 v84, 0xff800000
  v_mov_b32 v85, 0xff800000
  v_mov_b32 v37, 0
k2_kernel_FB:
  buffer_load_dwordx4 v[32:35], v74, s[32:35], s25 offen
  buffer_load_dword v36, v75, s[32:35], s25 offen
  s_waitcnt vmcnt(0)
  v_mfma_f32_32x32x16_bf16 v[0:15], v[32:35], v[68:71], 0
  v_mfma_f32_32x32x8_bf16 v[0:15], v[36:37], v[72:73], v[0:15]
  s_nop 7
  s_nop 7
  s_nop 3
  v_max3_f32 v84, v0, v1, v84
  v_max3_f32 v84, v2, v3, v84
  v_max3_f32 v84, v4, v5, v84
  v_max3_f32 v84, v6, v7, v84
  v_max3_f32 v84, v8, v9, v84
  v_max3_f32 v84, v10, v11, v84
  v_max3_f32 v84, v12, v13, v84
  v_max3_f32 v84, v14, v15, v84
  s_add_u32 s25, s25, 2560
  s_sub_u32 s26, s26, 1
  s_cmp_lg_u32 s26, 0
  s_cbranch_scc1 k2_kernel_FB
  v_mov_b32 v86, v84
  s_nop 1
  v_permlane32_swap_b32 v86, v84
  s_nop 1
  v_max_f32 v84, v84, v86
  v_sub_f32 v86, 0, v84
  v_and_b32 v87, 0xffff0000, v86
  v_sub_f32 v86, v86, v87
  v_lshrrev_b32 v87, 16, v87
  v_and_b32 v86, 0xffff0000, v86
  s_mov_b32 exec_hi, 0
  v_or_b32 v73, v86, v87
  s_mov_b64 exec, -1
k2_kernel_FAST:
  s_barrier
  ds_read_b128 v[40:43], v74 offset:0
  ds_read_b32 v44, v75 offset:0
  ds_read_b128 v[46:49], v74 offset:2560
  ds_read_b32 v50, v75 offset:2560
  s_waitcnt lgkmcnt(2)
  v_mfma_f32_32x32x16_bf16 v[0:15], v[40:43], v[68:71], 0
  v_mfma_f32_32x32x8_bf16 v[0:15], v[44:45], v[72:73], v[0:15]
  s_nop 7
  s_nop 7
  s_waitcnt lgkmcnt(0)
  v_mfma_f32_32x32x16_bf16 v[16:31], v[46:49], v[68:71], 0
  ds_read_b128 v[52:55], v76 offset:0
  ds_read_b128 v[56:59], v76 offset:608
  v_exp_f32 v0, v0
  v_exp_f32 v1, v1
  v_exp_f32 v2, v2
  v_exp_f32 v3, v3
  v_exp_f32 v4, v4
  v_exp_f32 v5, v5
  v_exp_f32 v6, v6
  v_exp_f32 v7, v7
  v_mfma_f32_32x32x8_bf16 v[16:31], v[50:51], v[72:73], v[16:31]
  ds_read_b128 v[40:43], v74 offset:5120
  ds_read_b32 v44, v75 offset:5120
  v_exp_f32 v8, v8
  v_exp_f32 v9, v9
  v_exp_f32 v10, v10
  v_exp_f32 v11, v11
  v_exp_f32 v12, v12
  v_exp_f32 v13, v13
  v_exp_f32 v14, v14
  v_exp_f32 v15, v15
  v_cvt_pk_bf16_f32 v32, v0, v1
  v_cvt_pk_bf16_f32 v33, v2, v3
  v_cvt_pk_bf16_f32 v34, v4, v5
  v_cvt_pk_bf16_f32 v35, v6, v7
  v_cvt_pk_bf16_f32 v36, v8, v9
  v_cvt_pk_bf16_f32 v37, v10, v11
  v_cvt_pk_bf16_f32 v38, v12, v13
  v_cvt_pk_bf16_f32 v39, v14, v15
  s_waitcnt lgkmcnt(0)
  v_mfma_f32_32x32x16_bf16 v[0:15], v[40:43], v[68:71], 0
  ds_read_b128 v[60:63], v76 offset:2560
  ds_read_b128 v[64:67], v76 offset:3168
  v_exp_f32 v16, v16
  v_exp_f32 v17, v17
  v_exp_f32 v18, v18
  v_exp_f32 v19, v19
  v_mfma_f32_32x32x16_bf16 a[0:15], v[52:55], v[32:35], a[0:15]
  v_exp_f32 v20, v20
  v_exp_f32 v21, v21
  v_exp_f32 v22, v22
  v_exp_f32 v23, v23
  v_mfma_f32_32x32x8_bf16 v[0:15], v[44:45], v[72:73], v[0:15]
  ds_read_b128 v[46:49], v74 offset:7680
  ds_read_b32 v50, v75 offset:7680
  v_exp_f32 v24, v24
  v_exp_f32 v25, v25
  v_exp_f32 v26, v26
  v_exp_f32 v27, v27
  v_mfma_f32_32x32x16_bf16 a[0:15], v[56:59], v[36:39], a[0:15]
  v_exp_f32 v28, v28
  v_exp_f32 v29, v29
  v_exp_f32 v30, v30
  v_exp_f32 v31, v31
  v_cvt_pk_bf16_f32 v32, v16, v17
  v_cvt_pk_bf16_f32 v33, v18, v19
  v_cvt_pk_bf16_f32 v34, v20, v21
  v_cvt_pk_bf16_f32 v35, v22, v23
  v_cvt_pk_bf16_f32 v36, v24, v25
  v_cvt_pk_bf16_f32 v37, v26, v27
  v_cvt_pk_bf16_f32 v38, v28, v29
  v_cvt_pk_bf16_f32 v39, v30, v31
  s_waitcnt lgkmcnt(0)
  s_waitcnt vmcnt(6)
  s_barrier
  s_add_u32 m0, s23, 40960
  s_add_u32 s24, s22, 40960
  buffer_load_dwordx4 v79, s[32:35], s24 offen lds
  buffer_load_dwordx4 v79, s[32:35], s24 offen offset:1024 lds
  s_mov_b32 exec_hi, 0
  buffer_load_dwordx4 v79, s[32:35], s24 offen offset:2048 lds
  s_mov_b64 exec, -1
  v_mfma_f32_32x32x16_bf16 v[16:31], v[46:49], v[68:71], 0
  ds_read_b128 v[52:55], v76 offset:5120
  ds_read_b128 v[56:59], v76 offset:5728
  v_exp_f32 v0, v0
  v_exp_f32 v1, v1
  v_exp_f32 v2, v2
  v_exp_f32 v3, v3
  v_mfma_f32_32x32x16_bf16 a[0:15], v[60:63], v[32:35], a[0:15]
  v_exp_f32 v4, v4
  v_exp_f32 v5, v5
  v_exp_f32 v6, v6
  v_exp_f32 v7, v7
  v_mfma_f32_32x32x8_bf16 v[16:31], v[50:51], v[72:73], v[16:31]
  ds_read_b128 v[40:43], v74 offset:10240
  ds_read_b32 v44, v75 offset:10240
  v_exp_f32 v8, v8
  v_exp_f32 v9, v9
  v_exp_f32 v10, v10
  v_exp_f32 v11, v11
  v_mfma_f32_32x32x16_bf16 a[0:15], v[64:67], v[36:39], a[0:15]
  v_exp_f32 v12, v12
  v_exp_f32 v13, v13
  v_exp_f32 v14, v14
  v_exp_f32 v15, v15
  v_cvt_pk_bf16_f32 v32, v0, v1
  v_cvt_pk_bf16_f32 v33, v2, v3
  v_cvt_pk_bf16_f32 v34, v4, v5
  v_cvt_pk_bf16_f32 v35, v6, v7
  v_cvt_pk_bf16_f32 v36, v8, v9
  v_cvt_pk_bf16_f32 v37, v10, v11
  v_cvt_pk_bf16_f32 v38, v12, v13
  v_cvt_pk_bf16_f32 v39, v14, v15
  s_waitcnt lgkmcnt(0)
  v_mfma_f32_32x32x16_bf16 v[0:15], v[40:43], v[68:71], 0
  ds_read_b128 v[60:63], v76 offset:7680
  ds_read_b128 v[64:67], v76 offset:8288
  v_exp_f32 v16, v16
  v_exp_f32 v17, v17
  v_exp_f32 v18, v18
  v_exp_f32 v19, v19
  v_mfma_f32_32x32x16_bf16 a[0:15], v[52:55], v[32:35], a[0:15]
  v_exp_f32 v20, v20
  v_exp_f32 v21, v21
  v_exp_f32 v22, v22
  v_exp_f32 v23, v23
  v_mfma_f32_32x32x8_bf16 v[0:15], v[44:45], v[72:73], v[0:15]
  ds_read_b128 v[46:49], v74 offset:12800
  ds_read_b32 v50, v75 offset:12800
  v_exp_f32 v24, v24
  v_exp_f32 v25, v25
  v_exp_f32 v26, v26
  v_exp_f32 v27, v27
  v_mfma_f32_32x32x16_bf16 a[0:15], v[56:59], v[36:39], a[0:15]
  v_exp_f32 v28, v28
  v_exp_f32 v29, v29
  v_exp_f32 v30, v30
  v_exp_f32 v31, v31
  v_cvt_pk_bf16_f32 v32, v16, v17
  v_cvt_pk_bf16_f32 v33, v18, v19
  v_cvt_pk_bf16_f32 v34, v20, v21
  v_cvt_pk_bf16_f32 v35, v22, v23
  v_cvt_pk_bf16_f32 v36, v24, v25
  v_cvt_pk_bf16_f32 v37, v26, v27
  v_cvt_pk_bf16_f32 v38, v28, v29
  v_cvt_pk_bf16_f32 v39, v30, v31
  s_waitcnt lgkmcnt(0)
  v_mfma_f32_32x32x16_bf16 v[16:31], v[46:49], v[68:71], 0
  ds_read_b128 v[52:55], v76 offset:10240
  ds_read_b128 v[56:59], v76 offset:10848
  v_exp_f32 v0, v0
  v_exp_f32 v1, v1
  v_exp_f32 v2, v2
  v_exp_f32 v3, v3
  v_mfma_f32_32x32x16_bf16 a[0:15], v[60:63], v[32:35], a[0:15]
  v_exp_f32 v4, v4
  v_exp_f32 v5, v5
  v_exp_f32 v6, v6
  v_exp_f32 v7, v7
  v_mfma_f32_32x32x8_bf16 v[16:31], v[50:51], v[72:73], v[16:31]
  ds_read_b128 v[40:43], v74 offset:15360
  ds_read_b32 v44, v75 offset:15360
  v_exp_f32 v8, v8
  v_exp_f32 v9, v9
  v_exp_f32 v10, v10
  v_exp_f32 v11, v11
  v_mfma_f32_32x32x16_bf16 a[0:15], v[64:67], v[36:39], a[0:15]
  v_exp_f32 v12, v12
  v_exp_f32 v13, v13
  v_exp_f32 v14, v14
  v_exp_f32 v15, v15
  v_cvt_pk_bf16_f32 v32, v0, v1
  v_cvt_pk_bf16_f32 v33, v2, v3
  v_cvt_pk_bf16_f32 v34, v4, v5
  v_cvt_pk_bf16_f32 v35, v6, v7
  v_cvt_pk_bf16_f32 v36, v8, v9
  v_cvt_pk_bf16_f32 v37, v10, v11
  v_cvt_pk_bf16_f32 v38, v12, v13
  v_cvt_pk_bf16_f32 v39, v14, v15
  s_waitcnt lgkmcnt(0)
  v_mfma_f32_32x32x16_bf16 v[0:15], v[40:43], v[68:71], 0
  ds_read_b128 v[60:63], v76 offset:12800
  ds_read_b128 v[64:67], v76 offset:13408
  v_exp_f32 v16, v16
  v_exp_f32 v17, v17
  v_exp_f32 v18, v18
  v_exp_f32 v19, v19
  v_mfma_f32_32x32x16_bf16 a[0:15], v[52:55], v[32:35], a[0:15]
  v_exp_f32 v20, v20
  v_exp_f32 v21, v21
  v_exp_f32 v22, v22
  v_exp_f32 v23, v23
  v_mfma_f32_32x32x8_bf16 v[0:15], v[44:45], v[72:73], v[0:15]
  ds_read_b128 v[46:49], v74 offset:17920
  ds_read_b32 v50, v75 offset:17920
  v_exp_f32 v24, v24
  v_exp_f32 v25, v25
  v_exp_f32 v26, v26
  v_exp_f32 v27, v27
  v_mfma_f32_32x32x16_bf16 a[0:15], v[56:59], v[36:39], a[0:15]
  v_exp_f32 v28, v28
  v_exp_f32 v29, v29
  v_exp_f32 v30, v30
  v_exp_f32 v31, v31
  v_cvt_pk_bf16_f32 v32, v16, v17
  v_cvt_pk_bf16_f32 v33, v18, v19
  v_cvt_pk_bf16_f32 v34, v20, v21
  v_cvt_pk_bf16_f32 v35, v22, v23
  v_cvt_pk_bf16_f32 v36, v24, v25
  v_cvt_pk_bf16_f32 v37, v26, v27
  v_cvt_pk_bf16_f32 v38, v28, v29
  v_cvt_pk_bf16_f32 v39, v30, v31
  s_waitcnt lgkmcnt(0)
  s_waitcnt vmcnt(6)
  s_barrier
  s_add_u32 m0, s23, 0
  s_add_u32 s24, s22, 51200
  buffer_load_dwordx4 v79, s[32:35], s24 offen lds
  buffer_load_dwordx4 v79, s[32:35], s24 offen offset:1024 lds
  s_mov_b32 exec_hi, 0
  buffer_load_dwordx4 v79, s[32:35], s24 offen offset:2048 lds
  s_mov_b64 exec, -1
  v_mfma_f32_32x32x16_bf16 v[16:31], v[46:49], v[68:71], 0
  ds_read_b128 v[52:55], v76 offset:15360
  ds_read_b128 v[56:59], v76 offset:15968
  v_exp_f32 v0, v0
  v_exp_f32 v1, v1
  v_exp_f32 v2, v2
  v_exp_f32 v3, v3
  v_mfma_f32_32x32x16_bf16 a[0:15], v[60:63], v[32:35], a[0:15]
  v_exp_f32 v4, v4
  v_exp_f32 v5, v5
  v_exp_f32 v6, v6
  v_exp_f32 v7, v7
  v_mfma_f32_32x32x8_bf16 v[16:31], v[50:51], v[72:73], v[16:31]
  ds_read_b128 v[40:43], v74 offset:20480
  ds_read_b32 v44, v75 offset:20480
  v_exp_f32 v8, v8
  v_exp_f32 v9, v9
  v_exp_f32 v10, v10
  v_exp_f32 v11, v11
  v_mfma_f32_32x32x16_bf16 a[0:15], v[64:67], v[36:39], a[0:15]
  v_exp_f32 v12, v12
  v_exp_f32 v13, v13
  v_exp_f32 v14, v14
  v_exp_f32 v15, v15
  v_cvt_pk_bf16_f32 v32, v0, v1
  v_cvt_pk_bf16_f32 v33, v2, v3
  v_cvt_pk_bf16_f32 v34, v4, v5
  v_cvt_pk_bf16_f32 v35, v6, v7
  v_cvt_pk_bf16_f32 v36, v8, v9
  v_cvt_pk_bf16_f32 v37, v10, v11
  v_cvt_pk_bf16_f32 v38, v12, v13
  v_cvt_pk_bf16_f32 v39, v14, v15
  s_waitcnt lgkmcnt(0)
  v_mfma_f32_32x32x16_bf16 v[0:15], v[40:43], v[68:71], 0
  ds_read_b128 v[60:63], v76 offset:17920
  ds_read_b128 v[64:67], v76 offset:18528
  v_exp_f32 v16, v16
  v_exp_f32 v17, v17
  v_exp_f32 v18, v18
  v_exp_f32 v19, v19
  v_mfma_f32_32x32x16_bf16 a[0:15], v[52:55], v[32:35], a[0:15]
  v_exp_f32 v20, v20
  v_exp_f32 v21, v21
  v_exp_f32 v22, v22
  v_exp_f32 v23, v23
  v_mfma_f32_32x32x8_bf16 v[0:15], v[44:45], v[72:73], v[0:15]
  ds_read_b128 v[46:49], v74 offset:23040
  ds_read_b32 v50, v75 offset:23040
  v_exp_f32 v24, v24
  v_exp_f32 v25, v25
  v_exp_f32 v26, v26
  v_exp_f32 v27, v27
  v_mfma_f32_32x32x16_bf16 a[0:15], v[56:59], v[36:39], a[0:15]
  v_exp_f32 v28, v28
  v_exp_f32 v29, v29
  v_exp_f32 v30, v30
  v_exp_f32 v31, v31
  v_cvt_pk_bf16_f32 v32, v16, v17
  v_cvt_pk_bf16_f32 v33, v18, v19
  v_cvt_pk_bf16_f32 v34, v20, v21
  v_cvt_pk_bf16_f32 v35, v22, v23
  v_cvt_pk_bf16_f32 v36, v24, v25
  v_cvt_pk_bf16_f32 v37, v26, v27
  v_cvt_pk_bf16_f32 v38, v28, v29
  v_cvt_pk_bf16_f32 v39, v30, v31
  s_waitcnt lgkmcnt(0)
  v_mfma_f32_32x32x16_bf16 v[16:31], v[46:49], v[68:71], 0
  ds_read_b128 v[52:55], v76 offset:20480
  ds_read_b128 v[56:59], v76 offset:21088
  v_exp_f32 v0, v0
  v_exp_f32 v1, v1
  v_exp_f32 v2, v2
  v_exp_f32 v3, v3
  v_mfma_f32_32x32x16_bf16 a[0:15], v[60:63], v[32:35], a[0:15]
  v_exp_f32 v4, v4
  v_exp_f32 v5, v5
  v_exp_f32 v6, v6
  v_exp_f32 v7, v7
  v_mfma_f32_32x32x8_bf16 v[16:31], v[50:51], v[72:73], v[16:31]
  ds_read_b128 v[40:43], v74 offset:25600
  ds_read_b32 v44, v75 offset:25600
  v_exp_f32 v8, v8
  v_exp_f32 v9, v9
  v_exp_f32 v10, v10
  v_exp_f32 v11, v11
  v_mfma_f32_32x32x16_bf16 a[0:15], v[64:67], v[36:39], a[0:15]
  v_exp_f32 v12, v12
  v_exp_f32 v13, v13
  v_exp_f32 v14, v14
  v_exp_f32 v15, v15
  v_cvt_pk_bf16_f32 v32, v0, v1
  v_cvt_pk_bf16_f32 v33, v2, v3
  v_cvt_pk_bf16_f32 v34, v4, v5
  v_cvt_pk_bf16_f32 v35, v6, v7
  v_cvt_pk_bf16_f32 v36, v8, v9
  v_cvt_pk_bf16_f32 v37, v10, v11
  v_cvt_pk_bf16_f32 v38, v12, v13
  v_cvt_pk_bf16_f32 v39, v14, v15
  s_waitcnt lgkmcnt(0)
  v_mfma_f32_32x32x16_bf16 v[0:15], v[40:43], v[68:71], 0
  ds_read_b128 v[60:63], v76 offset:23040
  ds_read_b128 v[64:67], v76 offset:23648
  v_exp_f32 v16, v16
  v_exp_f32 v17, v17
  v_exp_f32 v18, v18
  v_exp_f32 v19, v19
  v_mfma_f32_32x32x16_bf16 a[0:15], v[52:55], v[32:35], a[0:15]
  v_exp_f32 v20, v20
  v_exp_f32 v21, v21
  v_exp_f32 v22, v22
  v_exp_f32 v23, v23
  v_mfma_f32_32x32x8_bf16 v[0:15], v[44:45], v[72:73], v[0:15]
  ds_read_b128 v[46:49], v74 offset:28160
  ds_read_b32 v50, v75 offset:28160
  v_exp_f32 v24, v24
  v_exp_f32 v25, v25
  v_exp_f32 v26, v26
  v_exp_f32 v27, v27
  v_mfma_f32_32x32x16_bf16 a[0:15], v[56:59], v[36:39], a[0:15]
  v_exp_f32 v28, v28
  v_exp_f32 v29, v29
  v_exp_f32 v30, v30
  v_exp_f32 v31, v31
  v_cvt_pk_bf16_f32 v32, v16, v17
  v_cvt_pk_bf16_f32 v33, v18, v19
  v_cvt_pk_bf16_f32 v34, v20, v21
  v_cvt_pk_bf16_f32 v35, v22, v23
  v_cvt_pk_bf16_f32 v36, v24, v25
  v_cvt_pk_bf16_f32 v37, v26, v27
  v_cvt_pk_bf16_f32 v38, v28, v29
  v_cvt_pk_bf16_f32 v39, v30, v31
  s_waitcnt lgkmcnt(0)
  s_waitcnt vmcnt(6)
  s_barrier
  s_add_u32 m0, s23, 10240
  s_add_u32 s24, s22, 61440
  buffer_load_dwordx4 v79, s[32:35], s24 offen lds
  buffer_load_dwordx4 v79, s[32:35], s24 offen offset:1024 lds
  s_mov_b32 exec_hi, 0
  buffer_load_dwordx4 v79, s[32:35], s24 offen offset:2048 lds
  s_mov_b64 exec, -1
  v_mfma_f32_32x32x16_bf16 v[16:31], v[46:49], v[68:71], 0
  ds_read_b128 v[52:55], v76 offset:25600
  ds_read_b128 v[56:59], v76 offset:26208
  v_exp_f32 v0, v0
  v_exp_f32 v1, v1
  v_exp_f32 v2, v2
  v_exp_f32 v3, v3
  v_mfma_f32_32x32x16_bf16 a[0:15], v[60:63], v[32:35], a[0:15]
  v_exp_f32 v4, v4
  v_exp_f32 v5, v5
  v_exp_f32 v6, v6
  v_exp_f32 v7, v7
  v_mfma_f32_32x32x8_bf16 v[16:31], v[50:51], v[72:73], v[16:31]
  ds_read_b128 v[40:43], v74 offset:30720
  ds_read_b32 v44, v75 offset:30720
  v_exp_f32 v8, v8
  v_exp_f32 v9, v9
  v_exp_f32 v10, v10
  v_exp_f32 v11, v11
  v_mfma_f32_32x32x16_bf16 a[0:15], v[64:67], v[36:39], a[0:15]
  v_exp_f32 v12, v12
  v_exp_f32 v13, v13
  v_exp_f32 v14, v14
  v_exp_f32 v15, v15
  v_cvt_pk_bf16_f32 v32, v0, v1
  v_cvt_pk_bf16_f32 v33, v2, v3
  v_cvt_pk_bf16_f32 v34, v4, v5
  v_cvt_pk_bf16_f32 v35, v6, v7
  v_cvt_pk_bf16_f32 v36, v8, v9
  v_cvt_pk_bf16_f32 v37, v10, v11
  v_cvt_pk_bf16_f32 v38, v12, v13
  v_cvt_pk_bf16_f32 v39, v14, v15
  s_waitcnt lgkmcnt(0)
  v_mfma_f32_32x32x16_bf16 v[0:15], v[40:43], v[68:71], 0
  ds_read_b128 v[60:63], v76 offset:28160
  ds_read_b128 v[64:67], v76 offset:28768
  v_exp_f32 v16, v16
  v_exp_f32 v17, v17
  v_exp_f32 v18, v18
  v_exp_f32 v19, v19
  v_mfma_f32_32x32x16_bf16 a[0:15], v[52:55], v[32:35], a[0:15]
  v_exp_f32 v20, v20
  v_exp_f32 v21, v21
  v_exp_f32 v22, v22
  v_exp_f32 v23, v23
  v_mfma_f32_32x32x8_bf16 v[0:15], v[44:45], v[72:73], v[0:15]
  ds_read_b128 v[46:49], v74 offset:33280
  ds_read_b32 v50, v75 offset:33280
  v_exp_f32 v24, v24
  v_exp_f32 v25, v25
  v_exp_f32 v26, v26
  v_exp_f32 v27, v27
  v_mfma_f32_32x32x16_bf16 a[0:15], v[56:59], v[36:39], a[0:15]
  v_exp_f32 v28, v28
  v_exp_f32 v29, v29
  v_exp_f32 v30, v30
  v_exp_f32 v31, v31
  v_cvt_pk_bf16_f32 v32, v16, v17
  v_cvt_pk_bf16_f32 v33, v18, v19
  v_cvt_pk_bf16_f32 v34, v20, v21
  v_cvt_pk_bf16_f32 v35, v22, v23
  v_cvt_pk_bf16_f32 v36, v24, v25
  v_cvt_pk_bf16_f32 v37, v26, v27
  v_cvt_pk_bf16_f32 v38, v28, v29
  v_cvt_pk_bf16_f32 v39, v30, v31
  s_waitcnt lgkmcnt(0)
  v_mfma_f32_32x32x16_bf16 v[16:31], v[46:49], v[68:71], 0
  ds_read_b128 v[52:55], v76 offset:30720
  ds_read_b128 v[56:59], v76 offset:31328
  v_exp_f32 v0, v0
  v_exp_f32 v1, v1
  v_exp_f32 v2, v2
  v_exp_f32 v3, v3
  v_mfma_f32_32x32x16_bf16 a[0:15], v[60:63], v[32:35], a[0:15]
  v_exp_f32 v4, v4
  v_exp_f32 v5, v5
  v_exp_f32 v6, v6
  v_exp_f32 v7, v7
  v_mfma_f32_32x32x8_bf16 v[16:31], v[50:51], v[72:73], v[16:31]
  ds_read_b128 v[40:43], v74 offset:35840
  ds_read_b32 v44, v75 offset:35840
  v_exp_f32 v8, v8
  v_exp_f32 v9, v9
  v_exp_f32 v10, v10
  v_exp_f32 v11, v11
  v_mfma_f32_32x32x16_bf16 a[0:15], v[64:67], v[36:39], a[0:15]
  v_exp_f32 v12, v12
  v_exp_f32 v13, v13
  v_exp_f32 v14, v14
  v_exp_f32 v15, v15
  v_cvt_pk_bf16_f32 v32, v0, v1
  v_cvt_pk_bf16_f32 v33, v2, v3
  v_cvt_pk_bf16_f32 v34, v4, v5
  v_cvt_pk_bf16_f32 v35, v6, v7
  v_cvt_pk_bf16_f32 v36, v8, v9
  v_cvt_pk_bf16_f32 v37, v10, v11
  v_cvt_pk_bf16_f32 v38, v12, v13
  v_cvt_pk_bf16_f32 v39, v14, v15
  s_waitcnt lgkmcnt(0)
  v_mfma_f32_32x32x16_bf16 v[0:15], v[40:43], v[68:71], 0
  ds_read_b128 v[60:63], v76 offset:33280
  ds_read_b128 v[64:67], v76 offset:33888
  v_exp_f32 v16, v16
  v_exp_f32 v17, v17
  v_exp_f32 v18, v18
  v_exp_f32 v19, v19
  v_mfma_f32_32x32x16_bf16 a[0:15], v[52:55], v[32:35], a[0:15]
  v_exp_f32 v20, v20
  v_exp_f32 v21, v21
  v_exp_f32 v22, v22
  v_exp_f32 v23, v23
  v_mfma_f32_32x32x8_bf16 v[0:15], v[44:45], v[72:73], v[0:15]
  ds_read_b128 v[46:49], v74 offset:38400
  ds_read_b32 v50, v75 offset:38400
  v_exp_f32 v24, v24
  v_exp_f32 v25, v25
  v_exp_f32 v26, v26
  v_exp_f32 v27, v27
  v_mfma_f32_32x32x16_bf16 a[0:15], v[56:59], v[36:39], a[0:15]
  v_exp_f32 v28, v28
  v_exp_f32 v29, v29
  v_exp_f32 v30, v30
  v_exp_f32 v31, v31
  v_cvt_pk_bf16_f32 v32, v16, v17
  v_cvt_pk_bf16_f32 v33, v18, v19
  v_cvt_pk_bf16_f32 v34, v20, v21
  v_cvt_pk_bf16_f32 v35, v22, v23
  v_cvt_pk_bf16_f32 v36, v24, v25
  v_cvt_pk_bf16_f32 v37, v26, v27
  v_cvt_pk_bf16_f32 v38, v28, v29
  v_cvt_pk_bf16_f32 v39, v30, v31
  s_waitcnt lgkmcnt(0)
  s_waitcnt vmcnt(6)
  s_barrier
  s_add_u32 m0, s23, 20480
  s_add_u32 s24, s22, 71680
  buffer_load_dwordx4 v79, s[32:35], s24 offen lds
  buffer_load_dwordx4 v79, s[32:35], s24 offen offset:1024 lds
  s_mov_b32 exec_hi, 0
  buffer_load_dwordx4 v79, s[32:35], s24 offen offset:2048 lds
  s_mov_b64 exec, -1
  v_mfma_f32_32x32x16_bf16 v[16:31], v[46:49], v[68:71], 0
  ds_read_b128 v[52:55], v76 offset:35840
  ds_read_b128 v[56:59], v76 offset:36448
  v_exp_f32 v0, v0
  v_exp_f32 v1, v1
  v_exp_f32 v2, v2
  v_exp_f32 v3, v3
  v_mfma_f32_32x32x16_bf16 a[0:15], v[60:63], v[32:35], a[0:15]
  v_exp_f32 v4, v4
  v_exp_f32 v5, v5
  v_exp_f32 v6, v6
  v_exp_f32 v7, v7
  v_mfma_f32_32x32x8_bf16 v[16:31], v[50:51], v[72:73], v[16:31]
  ds_read_b128 v[40:43], v74 offset:40960
  ds_read_b32 v44, v75 offset:40960
  v_exp_f32 v8, v8
  v_exp_f32 v9, v9
  v_exp_f32 v10, v10
  v_exp_f32 v11, v11
  v_mfma_f32_32x32x16_bf16 a[0:15], v[64:67], v[36:39], a[0:15]
  v_exp_f32 v12, v12
  v_exp_f32 v13, v13
  v_exp_f32 v14, v14
  v_exp_f32 v15, v15
  v_cvt_pk_bf16_f32 v32, v0, v1
  v_cvt_pk_bf16_f32 v33, v2, v3
  v_cvt_pk_bf16_f32 v34, v4, v5
  v_cvt_pk_bf16_f32 v35, v6, v7
  v_cvt_pk_bf16_f32 v36, v8, v9
  v_cvt_pk_bf16_f32 v37, v10, v11
  v_cvt_pk_bf16_f32 v38, v12, v13
  v_cvt_pk_bf16_f32 v39, v14, v15
  s_waitcnt lgkmcnt(0)
  v_mfma_f32_32x32x16_bf16 v[0:15], v[40:43], v[68:71], 0
  ds_read_b128 v[60:63], v76 offset:38400
  ds_read_b128 v[64:67], v76 offset:39008
  v_exp_f32 v16, v16
  v_exp_f32 v17, v17
  v_exp_f32 v18, v18
  v_exp_f32 v19, v19
  v_mfma_f32_32x32x16_bf16 a[0:15], v[52:55], v[32:35], a[0:15]
  v_exp_f32 v20, v20
  v_exp_f32 v21, v21
  v_exp_f32 v22, v22
  v_exp_f32 v23, v23
  v_mfma_f32_32x32x8_bf16 v[0:15], v[44:45], v[72:73], v[0:15]
  ds_read_b128 v[46:49], v74 offset:43520
  ds_read_b32 v50, v75 offset:43520
  v_exp_f32 v24, v24
  v_exp_f32 v25, v25
  v_exp_f32 v26, v26
  v_exp_f32 v27, v27
  v_mfma_f32_32x32x16_bf16 a[0:15], v[56:59], v[36:39], a[0:15]
  v_exp_f32 v28, v28
  v_exp_f32 v29, v29
  v_exp_f32 v30, v30
  v_exp_f32 v31, v31
  v_cvt_pk_bf16_f32 v32, v16, v17
  v_cvt_pk_bf16_f32 v33, v18, v19
  v_cvt_pk_bf16_f32 v34, v20, v21
  v_cvt_pk_bf16_f32 v35, v22, v23
  v_cvt_pk_bf16_f32 v36, v24, v25
  v_cvt_pk_bf16_f32 v37, v26, v27
  v_cvt_pk_bf16_f32 v38, v28, v29
  v_cvt_pk_bf16_f32 v39, v30, v31
  s_waitcnt lgkmcnt(0)
  v_mfma_f32_32x32x16_bf16 v[16:31], v[46:49], v[68:71], 0
  ds_read_b128 v[52:55], v76 offset:40960
  ds_read_b128 v[56:59], v76 offset:41568
  v_exp_f32 v0, v0
  v_exp_f32 v1, v1
  v_exp_f32 v2, v2
  v_exp_f32 v3, v3
  v_mfma_f32_32x32x16_bf16 a[0:15], v[60:63], v[32:35], a[0:15]
  v_exp_f32 v4, v4
  v_exp_f32 v5, v5
  v_exp_f32 v6, v6
  v_exp_f32 v7, v7
  v_mfma_f32_32x32x8_bf16 v[16:31], v[50:51], v[72:73], v[16:31]
  ds_read_b128 v[40:43], v74 offset:46080
  ds_read_b32 v44, v75 offset:46080
  v_exp_f32 v8, v8
  v_exp_f32 v9, v9
  v_exp_f32 v10, v10
  v_exp_f32 v11, v11
  v_mfma_f32_32x32x16_bf16 a[0:15], v[64:67], v[36:39], a[0:15]
  v_exp_f32 v12, v12
  v_exp_f32 v13, v13
  v_exp_f32 v14, v14
  v_exp_f32 v15, v15
  v_cvt_pk_bf16_f32 v32, v0, v1
  v_cvt_pk_bf16_f32 v33, v2, v3
  v_cvt_pk_bf16_f32 v34, v4, v5
  v_cvt_pk_bf16_f32 v35, v6, v7
  v_cvt_pk_bf16_f32 v36, v8, v9
  v_cvt_pk_bf16_f32 v37, v10, v11
  v_cvt_pk_bf16_f32 v38, v12, v13
  v_cvt_pk_bf16_f32 v39, v14, v15
  s_waitcnt lgkmcnt(0)
  v_mfma_f32_32x32x16_bf16 v[0:15], v[40:43], v[68:71], 0
  ds_read_b128 v[60:63], v76 offset:43520
  ds_read_b128 v[64:67], v76 offset:44128
  v_exp_f32 v16, v16
  v_exp_f32 v17, v17
  v_exp_f32 v18, v18
  v_exp_f32 v19, v19
  v_mfma_f32_32x32x16_bf16 a[0:15], v[52:55], v[32:35], a[0:15]
  v_exp_f32 v20, v20
  v_exp_f32 v21, v21
  v_exp_f32 v22, v22
  v_exp_f32 v23, v23
  v_mfma_f32_32x32x8_bf16 v[0:15], v[44:45], v[72:73], v[0:15]
  ds_read_b128 v[46:49], v74 offset:48640
  ds_read_b32 v50, v75 offset:48640
  v_exp_f32 v24, v24
  v_exp_f32 v25, v25
  v_exp_f32 v26, v26
  v_exp_f32 v27, v27
  v_mfma_f32_32x32x16_bf16 a[0:15], v[56:59], v[36:39], a[0:15]
  v_exp_f32 v28, v28
  v_exp_f32 v29, v29
  v_exp_f32 v30, v30
  v_exp_f32 v31, v31
  v_cvt_pk_bf16_f32 v32, v16, v17
  v_cvt_pk_bf16_f32 v33, v18, v19
  v_cvt_pk_bf16_f32 v34, v20, v21
  v_cvt_pk_bf16_f32 v35, v22, v23
  v_cvt_pk_bf16_f32 v36, v24, v25
  v_cvt_pk_bf16_f32 v37, v26, v27
  v_cvt_pk_bf16_f32 v38, v28, v29
  v_cvt_pk_bf16_f32 v39, v30, v31
  s_waitcnt lgkmcnt(0)
  s_waitcnt vmcnt(6)
  s_barrier
  s_add_u32 m0, s23, 30720
  s_add_u32 s24, s22, 81920
  buffer_load_dwordx4 v79, s[32:35], s24 offen lds
  buffer_load_dwordx4 v79, s[32:35], s24 offen offset:1024 lds
  s_mov_b32 exec_hi, 0
  buffer_load_dwordx4 v79, s[32:35], s24 offen offset:2048 lds
  s_mov_b64 exec, -1
  v_mfma_f32_32x32x16_bf16 v[16:31], v[46:49], v[68:71], 0
  ds_read_b128 v[52:55], v76 offset:46080
  ds_read_b128 v[56:59], v76 offset:46688
  v_exp_f32 v0, v0
  v_exp_f32 v1, v1
  v_exp_f32 v2, v2
  v_exp_f32 v3, v3
  v_mfma_f32_32x32x16_bf16 a[0:15], v[60:63], v[32:35], a[0:15]
  v_exp_f32 v4, v4
  v_exp_f32 v5, v5
  v_exp_f32 v6, v6
  v_exp_f32 v7, v7
  v_mfma_f32_32x32x8_bf16 v[16:31], v[50:51], v[72:73], v[16:31]
  ds_read_b128 v[40:43], v74 offset:0
  ds_read_b32 v44, v75 offset:0
  v_exp_f32 v8, v8
  v_exp_f32 v9, v9
  v_exp_f32 v10, v10
  v_exp_f32 v11, v11
  v_mfma_f32_32x32x16_bf16 a[0:15], v[64:67], v[36:39], a[0:15]
  v_exp_f32 v12, v12
  v_exp_f32 v13, v13
  v_exp_f32 v14, v14
  v_exp_f32 v15, v15
  v_cvt_pk_bf16_f32 v32, v0, v1
  v_cvt_pk_bf16_f32 v33, v2, v3
  v_cvt_pk_bf16_f32 v34, v4, v5
  v_cvt_pk_bf16_f32 v35, v6, v7
  v_cvt_pk_bf16_f32 v36, v8, v9
  v_cvt_pk_bf16_f32 v37, v10, v11
  v_cvt_pk_bf16_f32 v38, v12, v13
  v_cvt_pk_bf16_f32 v39, v14, v15
  s_waitcnt lgkmcnt(0)
  v_mfma_f32_32x32x16_bf16 v[0:15], v[40:43], v[68:71], 0
  ds_read_b128 v[60:63], v76 offset:48640
  ds_read_b128 v[64:67], v76 offset:49248
  v_exp_f32 v16, v16
  v_exp_f32 v17, v17
  v_exp_f32 v18, v18
  v_exp_f32 v19, v19
  v_mfma_f32_32x32x16_bf16 a[0:15], v[52:55], v[32:35], a[0:15]
  v_exp_f32 v20, v20
  v_exp_f32 v21, v21
  v_exp_f32 v22, v22
  v_exp_f32 v23, v23
  v_mfma_f32_32x32x8_bf16 v[0:15], v[44:45], v[72:73], v[0:15]
  ds_read_b128 v[46:49], v74 offset:2560
  ds_read_b32 v50, v75 offset:2560
  v_exp_f32 v24, v24
  v_exp_f32 v25, v25
  v_exp_f32 v26, v26
  v_exp_f32 v27, v27
  v_mfma_f32_32x32x16_bf16 a[0:15], v[56:59], v[36:39], a[0:15]
  v_exp_f32 v28, v28
  v_exp_f32 v29, v29
  v_exp_f32 v30, v30
  v_exp_f32 v31, v31
  v_cvt_pk_bf16_f32 v32, v16, v17
  v_cvt_pk_bf16_f32 v33, v18, v19
  v_cvt_pk_bf16_f32 v34, v20, v21
  v_cvt_pk_bf16_f32 v35, v22, v23
  v_cvt_pk_bf16_f32 v36, v24, v25
  v_cvt_pk_bf16_f32 v37, v26, v27
  v_cvt_pk_bf16_f32 v38, v28, v29
  v_cvt_pk_bf16_f32 v39, v30, v31
  s_waitcnt lgkmcnt(0)
  v_mfma_f32_32x32x16_bf16 v[16:31], v[46:49], v[68:71], 0
  ds_read_b128 v[52:55], v76 offset:0
  ds_read_b128 v[56:59], v76 offset:608
  v_exp_f32 v0, v0
  v_exp_f32 v1, v1
  v_exp_f32 v2, v2
  v_exp_f32 v3, v3
  v_mfma_f32_32x32x16_bf16 a[0:15], v[60:63], v[32:35], a[0:15]
  v_exp_f32 v4, v4
  v_exp_f32 v5, v5
  v_exp_f32 v6, v6
  v_exp_f32 v7, v7
  v_mfma_f32_32x32x8_bf16 v[16:31], v[50:51], v[72:73], v[16:31]
  ds_read_b128 v[40:43], v74 offset:5120
  ds_read_b32 v44, v75 offset:5120
  v_exp_f32 v8, v8
  v_exp_f32 v9, v9
  v_exp_f32 v10, v10
  v_exp_f32 v11, v11
  v_mfma_f32_32x32x16_bf16 a[0:15], v[64:67], v[36:39], a[0:15]
  v_exp_f32 v12, v12
  v_exp_f32 v13, v13
  v_exp_f32 v14, v14
  v_exp_f32 v15, v15
  v_cvt_pk_bf16_f32 v32, v0, v1
  v_cvt_pk_bf16_f32 v33, v2, v3
  v_cvt_pk_bf16_f32 v34, v4, v5
  v_cvt_pk_bf16_f32 v35, v6, v7
  v_cvt_pk_bf16_f32 v36, v8, v9
  v_cvt_pk_bf16_f32 v37, v10, v11
  v_cvt_pk_bf16_f32 v38, v12, v13
  v_cvt_pk_bf16_f32 v39, v14, v15
  s_waitcnt lgkmcnt(0)
  v_mfma_f32_32x32x16_bf16 v[0:15], v[40:43], v[68:71], 0
  ds_read_b128 v[60:63], v76 offset:2560
  ds_read_b128 v[64:67], v76 offset:3168
  v_exp_f32 v16, v16
  v_exp_f32 v17, v17
  v_exp_f32 v18, v18
  v_exp_f32 v19, v19
  v_mfma_f32_32x32x16_bf16 a[0:15], v[52:55], v[32:35], a[0:15]
  v_exp_f32 v20, v20
  v_exp_f32 v21, v21
  v_exp_f32 v22, v22
  v_exp_f32 v23, v23
  v_mfma_f32_32x32x8_bf16 v[0:15], v[44:45], v[72:73], v[0:15]
  ds_read_b128 v[46:49], v74 offset:7680
  ds_read_b32 v50, v75 offset:7680
  v_exp_f32 v24, v24
  v_exp_f32 v25, v25
  v_exp_f32 v26, v26
  v_exp_f32 v27, v27
  v_mfma_f32_32x32x16_bf16 a[0:15], v[56:59], v[36:39], a[0:15]
  v_exp_f32 v28, v28
  v_exp_f32 v29, v29
  v_exp_f32 v30, v30
  v_exp_f32 v31, v31
  v_cvt_pk_bf16_f32 v32, v16, v17
  v_cvt_pk_bf16_f32 v33, v18, v19
  v_cvt_pk_bf16_f32 v34, v20, v21
  v_cvt_pk_bf16_f32 v35, v22, v23
  v_cvt_pk_bf16_f32 v36, v24, v25
  v_cvt_pk_bf16_f32 v37, v26, v27
  v_cvt_pk_bf16_f32 v38, v28, v29
  v_cvt_pk_bf16_f32 v39, v30, v31
  s_waitcnt lgkmcnt(0)
  s_waitcnt vmcnt(6)
  s_barrier
  s_add_u32 m0, s23, 40960
  s_add_u32 s24, s22, 92160
  buffer_load_dwordx4 v79, s[32:35], s24 offen lds
  buffer_load_dwordx4 v79, s[32:35], s24 offen offset:1024 lds
  s_mov_b32 exec_hi, 0
  buffer_load_dwordx4 v79, s[32:35], s24 offen offset:2048 lds
  s_mov_b64 exec, -1
  v_mfma_f32_32x32x16_bf16 v[16:31], v[46:49], v[68:71], 0
  ds_read_b128 v[52:55], v76 offset:5120
  ds_read_b128 v[56:59], v76 offset:5728
  v_exp_f32 v0, v0
  v_exp_f32 v1, v1
  v_exp_f32 v2, v2
  v_exp_f32 v3, v3
  v_mfma_f32_32x32x16_bf16 a[0:15], v[60:63], v[32:35], a[0:15]
  v_exp_f32 v4, v4
  v_exp_f32 v5, v5
  v_exp_f32 v6, v6
  v_exp_f32 v7, v7
  v_mfma_f32_32x32x8_bf16 v[16:31], v[50:51], v[72:73], v[16:31]
  ds_read_b128 v[40:43], v74 offset:10240
  ds_read_b32 v44, v75 offset:10240
  v_exp_f32 v8, v8
  v_exp_f32 v9, v9
  v_exp_f32 v10, v10
  v_exp_f32 v11, v11
  v_mfma_f32_32x32x16_bf16 a[0:15], v[64:67], v[36:39], a[0:15]
  v_exp_f32 v12, v12
  v_exp_f32 v13, v13
  v_exp_f32 v14, v14
  v_exp_f32 v15, v15
  v_cvt_pk_bf16_f32 v32, v0, v1
  v_cvt_pk_bf16_f32 v33, v2, v3
  v_cvt_pk_bf16_f32 v34, v4, v5
  v_cvt_pk_bf16_f32 v35, v6, v7
  v_cvt_pk_bf16_f32 v36, v8, v9
  v_cvt_pk_bf16_f32 v37, v10, v11
  v_cvt_pk_bf16_f32 v38, v12, v13
  v_cvt_pk_bf16_f32 v39, v14, v15
  s_waitcnt lgkmcnt(0)
  v_mfma_f32_32x32x16_bf16 v[0:15], v[40:43], v[68:71], 0
  ds_read_b128 v[60:63], v76 offset:7680
  ds_read_b128 v[64:67], v76 offset:8288
  v_exp_f32 v16, v16
  v_exp_f32 v17, v17
  v_exp_f32 v18, v18
  v_exp_f32 v19, v19
  v_mfma_f32_32x32x16_bf16 a[0:15], v[52:55], v[32:35], a[0:15]
  v_exp_f32 v20, v20
  v_exp_f32 v21, v21
  v_exp_f32 v22, v22
  v_exp_f32 v23, v23
  v_mfma_f32_32x32x8_bf16 v[0:15], v[44:45], v[72:73], v[0:15]
  ds_read_b128 v[46:49], v74 offset:12800
  ds_read_b32 v50, v75 offset:12800
  v_exp_f32 v24, v24
  v_exp_f32 v25, v25
  v_exp_f32 v26, v26
  v_exp_f32 v27, v27
  v_mfma_f32_32x32x16_bf16 a[0:15], v[56:59], v[36:39], a[0:15]
  v_exp_f32 v28, v28
  v_exp_f32 v29, v29
  v_exp_f32 v30, v30
  v_exp_f32 v31, v31
  v_cvt_pk_bf16_f32 v32, v16, v17
  v_cvt_pk_bf16_f32 v33, v18, v19
  v_cvt_pk_bf16_f32 v34, v20, v21
  v_cvt_pk_bf16_f32 v35, v22, v23
  v_cvt_pk_bf16_f32 v36, v24, v25
  v_cvt_pk_bf16_f32 v37, v26, v27
  v_cvt_pk_bf16_f32 v38, v28, v29
  v_cvt_pk_bf16_f32 v39, v30, v31
  s_waitcnt lgkmcnt(0)
  v_mfma_f32_32x32x16_bf16 v[16:31], v[46:49], v[68:71], 0
  ds_read_b128 v[52:55], v76 offset:10240
  ds_read_b128 v[56:59], v76 offset:10848
  v_exp_f32 v0, v0
  v_exp_f32 v1, v1
  v_exp_f32 v2, v2
  v_exp_f32 v3, v3
  v_mfma_f32_32x32x16_bf16 a[0:15], v[60:63], v[32:35], a[0:15]
  v_exp_f32 v4, v4
  v_exp_f32 v5, v5
  v_exp_f32 v6, v6
  v_exp_f32 v7, v7
  v_mfma_f32_32x32x8_bf16 v[16:31], v[50:51], v[72:73], v[16:31]
  ds_read_b128 v[40:43], v74 offset:15360
  ds_read_b32 v44, v75 offset:15360
  v_exp_f32 v8, v8
  v_exp_f32 v9, v9
  v_exp_f32 v10, v10
  v_exp_f32 v11, v11
  v_mfma_f32_32x32x16_bf16 a[0:15], v[64:67], v[36:39], a[0:15]
  v_exp_f32 v12, v12
  v_exp_f32 v13, v13
  v_exp_f32 v14, v14
  v_exp_f32 v15, v15
  v_cvt_pk_bf16_f32 v32, v0, v1
  v_cvt_pk_bf16_f32 v33, v2, v3
  v_cvt_pk_bf16_f32 v34, v4, v5
  v_cvt_pk_bf16_f32 v35, v6, v7
  v_cvt_pk_bf16_f32 v36, v8, v9
  v_cvt_pk_bf16_f32 v37, v10, v11
  v_cvt_pk_bf16_f32 v38, v12, v13
  v_cvt_pk_bf16_f32 v39, v14, v15
  s_waitcnt lgkmcnt(0)
  v_mfma_f32_32x32x16_bf16 v[0:15], v[40:43], v[68:71], 0
  ds_read_b128 v[60:63], v76 offset:12800
  ds_read_b128 v[64:67], v76 offset:13408
  v_exp_f32 v16, v16
  v_exp_f32 v17, v17
  v_exp_f32 v18, v18
  v_exp_f32 v19, v19
  v_mfma_f32_32x32x16_bf16 a[0:15], v[52:55], v[32:35], a[0:15]
  v_exp_f32 v20, v20
  v_exp_f32 v21, v21
  v_exp_f32 v22, v22
  v_exp_f32 v23, v23
  v_mfma_f32_32x32x8_bf16 v[0:15], v[44:45], v[72:73], v[0:15]
  ds_read_b128 v[46:49], v74 offset:17920
  ds_read_b32 v50, v75 offset:17920
  v_exp_f32 v24, v24
  v_exp_f32 v25, v25
  v_exp_f32 v26, v26
  v_exp_f32 v27, v27
  v_mfma_f32_32x32x16_bf16 a[0:15], v[56:59], v[36:39], a[0:15]
  v_exp_f32 v28, v28
  v_exp_f32 v29, v29
  v_exp_f32 v30, v30
  v_exp_f32 v31, v31
  v_cvt_pk_bf16_f32 v32, v16, v17
  v_cvt_pk_bf16_f32 v33, v18, v19
  v_cvt_pk_bf16_f32 v34, v20, v21
  v_cvt_pk_bf16_f32 v35, v22, v23
  v_cvt_pk_bf16_f32 v36, v24, v25
  v_cvt_pk_bf16_f32 v37, v26, v27
  v_cvt_pk_bf16_f32 v38, v28, v29
  v_cvt_pk_bf16_f32 v39, v30, v31
  s_waitcnt lgkmcnt(0)
  s_waitcnt vmcnt(6)
  s_barrier
  s_add_u32 m0, s23, 0
  s_add_u32 s24, s22, 102400
  buffer_load_dwordx4 v79, s[32:35], s24 offen lds
  buffer_load_dwordx4 v79, s[32:35], s24 offen offset:1024 lds
  s_mov_b32 exec_hi, 0
  buffer_load_dwordx4 v79, s[32:35], s24 offen offset:2048 lds
  s_mov_b64 exec, -1
  v_mfma_f32_32x32x16_bf16 v[16:31], v[46:49], v[68:71], 0
  ds_read_b128 v[52:55], v76 offset:15360
  ds_read_b128 v[56:59], v76 offset:15968
  v_exp_f32 v0, v0
  v_exp_f32 v1, v1
  v_exp_f32 v2, v2
  v_exp_f32 v3, v3
  v_mfma_f32_32x32x16_bf16 a[0:15], v[60:63], v[32:35], a[0:15]
  v_exp_f32 v4, v4
  v_exp_f32 v5, v5
  v_exp_f32 v6, v6
  v_exp_f32 v7, v7
  v_mfma_f32_32x32x8_bf16 v[16:31], v[50:51], v[72:73], v[16:31]
  ds_read_b128 v[40:43], v74 offset:20480
  ds_read_b32 v44, v75 offset:20480
  v_exp_f32 v8, v8
  v_exp_f32 v9, v9
  v_exp_f32 v10, v10
  v_exp_f32 v11, v11
  v_mfma_f32_32x32x16_bf16 a[0:15], v[64:67], v[36:39], a[0:15]
  v_exp_f32 v12, v12
  v_exp_f32 v13, v13
  v_exp_f32 v14, v14
  v_exp_f32 v15, v15
  v_cvt_pk_bf16_f32 v32, v0, v1
  v_cvt_pk_bf16_f32 v33, v2, v3
  v_cvt_pk_bf16_f32 v34, v4, v5
  v_cvt_pk_bf16_f32 v35, v6, v7
  v_cvt_pk_bf16_f32 v36, v8, v9
  v_cvt_pk_bf16_f32 v37, v10, v11
  v_cvt_pk_bf16_f32 v38, v12, v13
  v_cvt_pk_bf16_f32 v39, v14, v15
  s_waitcnt lgkmcnt(0)
  v_mfma_f32_32x32x16_bf16 v[0:15], v[40:43], v[68:71], 0
  ds_read_b128 v[60:63], v76 offset:17920
  ds_read_b128 v[64:67], v76 offset:18528
  v_exp_f32 v16, v16
  v_exp_f32 v17, v17
  v_exp_f32 v18, v18
  v_exp_f32 v19, v19
  v_mfma_f32_32x32x16_bf16 a[0:15], v[52:55], v[32:35], a[0:15]
  v_exp_f32 v20, v20
  v_exp_f32 v21, v21
  v_exp_f32 v22, v22
  v_exp_f32 v23, v23
  v_mfma_f32_32x32x8_bf16 v[0:15], v[44:45], v[72:73], v[0:15]
  ds_read_b128 v[46:49], v74 offset:23040
  ds_read_b32 v50, v75 offset:23040
  v_exp_f32 v24, v24
  v_exp_f32 v25, v25
  v_exp_f32 v26, v26
  v_exp_f32 v27, v27
  v_mfma_f32_32x32x16_bf16 a[0:15], v[56:59], v[36:39], a[0:15]
  v_exp_f32 v28, v28
  v_exp_f32 v29, v29
  v_exp_f32 v30, v30
  v_exp_f32 v31, v31
  v_cvt_pk_bf16_f32 v32, v16, v17
  v_cvt_pk_bf16_f32 v33, v18, v19
  v_cvt_pk_bf16_f32 v34, v20, v21
  v_cvt_pk_bf16_f32 v35, v22, v23
  v_cvt_pk_bf16_f32 v36, v24, v25
  v_cvt_pk_bf16_f32 v37, v26, v27
  v_cvt_pk_bf16_f32 v38, v28, v29
  v_cvt_pk_bf16_f32 v39, v30, v31
  s_waitcnt lgkmcnt(0)
  v_mfma_f32_32x32x16_bf16 v[16:31], v[46:49], v[68:71], 0
  ds_read_b128 v[52:55], v76 offset:20480
  ds_read_b128 v[56:59], v76 offset:21088
  v_exp_f32 v0, v0
  v_exp_f32 v1, v1
  v_exp_f32 v2, v2
  v_exp_f32 v3, v3
  v_mfma_f32_32x32x16_bf16 a[0:15], v[60:63], v[32:35], a[0:15]
  v_exp_f32 v4, v4
  v_exp_f32 v5, v5
  v_exp_f32 v6, v6
  v_exp_f32 v7, v7
  v_mfma_f32_32x32x8_bf16 v[16:31], v[50:51], v[72:73], v[16:31]
  ds_read_b128 v[40:43], v74 offset:25600
  ds_read_b32 v44, v75 offset:25600
  v_exp_f32 v8, v8
  v_exp_f32 v9, v9
  v_exp_f32 v10, v10
  v_exp_f32 v11, v11
  v_mfma_f32_32x32x16_bf16 a[0:15], v[64:67], v[36:39], a[0:15]
  v_exp_f32 v12, v12
  v_exp_f32 v13, v13
  v_exp_f32 v14, v14
  v_exp_f32 v15, v15
  v_cvt_pk_bf16_f32 v32, v0, v1
  v_cvt_pk_bf16_f32 v33, v2, v3
  v_cvt_pk_bf16_f32 v34, v4, v5
  v_cvt_pk_bf16_f32 v35, v6, v7
  v_cvt_pk_bf16_f32 v36, v8, v9
  v_cvt_pk_bf16_f32 v37, v10, v11
  v_cvt_pk_bf16_f32 v38, v12, v13
  v_cvt_pk_bf16_f32 v39, v14, v15
  s_waitcnt lgkmcnt(0)
  v_mfma_f32_32x32x16_bf16 v[0:15], v[40:43], v[68:71], 0
  ds_read_b128 v[60:63], v76 offset:23040
  ds_read_b128 v[64:67], v76 offset:23648
  v_exp_f32 v16, v16
  v_exp_f32 v17, v17
  v_exp_f32 v18, v18
  v_exp_f32 v19, v19
  v_mfma_f32_32x32x16_bf16 a[0:15], v[52:55], v[32:35], a[0:15]
  v_exp_f32 v20, v20
  v_exp_f32 v21, v21
  v_exp_f32 v22, v22
  v_exp_f32 v23, v23
  v_mfma_f32_32x32x8_bf16 v[0:15], v[44:45], v[72:73], v[0:15]
  ds_read_b128 v[46:49], v74 offset:28160
  ds_read_b32 v50, v75 offset:28160
  v_exp_f32 v24, v24
  v_exp_f32 v25, v25
  v_exp_f32 v26, v26
  v_exp_f32 v27, v27
  v_mfma_f32_32x32x16_bf16 a[0:15], v[56:59], v[36:39], a[0:15]
  v_exp_f32 v28, v28
  v_exp_f32 v29, v29
  v_exp_f32 v30, v30
  v_exp_f32 v31, v31
  v_cvt_pk_bf16_f32 v32, v16, v17
  v_cvt_pk_bf16_f32 v33, v18, v19
  v_cvt_pk_bf16_f32 v34, v20, v21
  v_cvt_pk_bf16_f32 v35, v22, v23
  v_cvt_pk_bf16_f32 v36, v24, v25
  v_cvt_pk_bf16_f32 v37, v26, v27
  v_cvt_pk_bf16_f32 v38, v28, v29
  v_cvt_pk_bf16_f32 v39, v30, v31
  s_waitcnt lgkmcnt(0)
  s_waitcnt vmcnt(6)
  s_barrier
  s_add_u32 m0, s23, 10240
  s_add_u32 s24, s22, 112640
  buffer_load_dwordx4 v79, s[32:35], s24 offen lds
  buffer_load_dwordx4 v79, s[32:35], s24 offen offset:1024 lds
  s_mov_b32 exec_hi, 0
  buffer_load_dwordx4 v79, s[32:35], s24 offen offset:2048 lds
  s_mov_b64 exec, -1
  v_mfma_f32_32x32x16_bf16 v[16:31], v[46:49], v[68:71], 0
  ds_read_b128 v[52:55], v76 offset:25600
  ds_read_b128 v[56:59], v76 offset:26208
  v_exp_f32 v0, v0
  v_exp_f32 v1, v1
  v_exp_f32 v2, v2
  v_exp_f32 v3, v3
  v_mfma_f32_32x32x16_bf16 a[0:15], v[60:63], v[32:35], a[0:15]
  v_exp_f32 v4, v4
  v_exp_f32 v5, v5
  v_exp_f32 v6, v6
  v_exp_f32 v7, v7
  v_mfma_f32_32x32x8_bf16 v[16:31], v[50:51], v[72:73], v[16:31]
  ds_read_b128 v[40:43], v74 offset:30720
  ds_read_b32 v44, v75 offset:30720
  v_exp_f32 v8, v8
  v_exp_f32 v9, v9
  v_exp_f32 v10, v10
  v_exp_f32 v11, v11
  v_mfma_f32_32x32x16_bf16 a[0:15], v[64:67], v[36:39], a[0:15]
  v_exp_f32 v12, v12
  v_exp_f32 v13, v13
  v_exp_f32 v14, v14
  v_exp_f32 v15, v15
  v_cvt_pk_bf16_f32 v32, v0, v1
  v_cvt_pk_bf16_f32 v33, v2, v3
  v_cvt_pk_bf16_f32 v34, v4, v5
  v_cvt_pk_bf16_f32 v35, v6, v7
  v_cvt_pk_bf16_f32 v36, v8, v9
  v_cvt_pk_bf16_f32 v37, v10, v11
  v_cvt_pk_bf16_f32 v38, v12, v13
  v_cvt_pk_bf16_f32 v39, v14, v15
  s_waitcnt lgkmcnt(0)
  v_mfma_f32_32x32x16_bf16 v[0:15], v[40:43], v[68:71], 0
  ds_read_b128 v[60:63], v76 offset:28160
  ds_read_b128 v[64:67], v76 offset:28768
  v_exp_f32 v16, v16
  v_exp_f32 v17, v17
  v_exp_f32 v18, v18
  v_exp_f32 v19, v19
  v_mfma_f32_32x32x16_bf16 a[0:15], v[52:55], v[32:35], a[0:15]
  v_exp_f32 v20, v20
  v_exp_f32 v21, v21
  v_exp_f32 v22, v22
  v_exp_f32 v23, v23
  v_mfma_f32_32x32x8_bf16 v[0:15], v[44:45], v[72:73], v[0:15]
  ds_read_b128 v[46:49], v74 offset:33280
  ds_read_b32 v50, v75 offset:33280
  v_exp_f32 v24, v24
  v_exp_f32 v25, v25
  v_exp_f32 v26, v26
  v_exp_f32 v27, v27
  v_mfma_f32_32x32x16_bf16 a[0:15], v[56:59], v[36:39], a[0:15]
  v_exp_f32 v28, v28
  v_exp_f32 v29, v29
  v_exp_f32 v30, v30
  v_exp_f32 v31, v31
  v_cvt_pk_bf16_f32 v32, v16, v17
  v_cvt_pk_bf16_f32 v33, v18, v19
  v_cvt_pk_bf16_f32 v34, v20, v21
  v_cvt_pk_bf16_f32 v35, v22, v23
  v_cvt_pk_bf16_f32 v36, v24, v25
  v_cvt_pk_bf16_f32 v37, v26, v27
  v_cvt_pk_bf16_f32 v38, v28, v29
  v_cvt_pk_bf16_f32 v39, v30, v31
  s_waitcnt lgkmcnt(0)
  v_mfma_f32_32x32x16_bf16 v[16:31], v[46:49], v[68:71], 0
  ds_read_b128 v[52:55], v76 offset:30720
  ds_read_b128 v[56:59], v76 offset:31328
  v_exp_f32 v0, v0
  v_exp_f32 v1, v1
  v_exp_f32 v2, v2
  v_exp_f32 v3, v3
  v_mfma_f32_32x32x16_bf16 a[0:15], v[60:63], v[32:35], a[0:15]
  v_exp_f32 v4, v4
  v_exp_f32 v5, v5
  v_exp_f32 v6, v6
  v_exp_f32 v7, v7
  v_mfma_f32_32x32x8_bf16 v[16:31], v[50:51], v[72:73], v[16:31]
  ds_read_b128 v[40:43], v74 offset:35840
  ds_read_b32 v44, v75 offset:35840
  v_exp_f32 v8, v8
  v_exp_f32 v9, v9
  v_exp_f32 v10, v10
  v_exp_f32 v11, v11
  v_mfma_f32_32x32x16_bf16 a[0:15], v[64:67], v[36:39], a[0:15]
  v_exp_f32 v12, v12
  v_exp_f32 v13, v13
  v_exp_f32 v14, v14
  v_exp_f32 v15, v15
  v_cvt_pk_bf16_f32 v32, v0, v1
  v_cvt_pk_bf16_f32 v33, v2, v3
  v_cvt_pk_bf16_f32 v34, v4, v5
  v_cvt_pk_bf16_f32 v35, v6, v7
  v_cvt_pk_bf16_f32 v36, v8, v9
  v_cvt_pk_bf16_f32 v37, v10, v11
  v_cvt_pk_bf16_f32 v38, v12, v13
  v_cvt_pk_bf16_f32 v39, v14, v15
  s_waitcnt lgkmcnt(0)
  v_mfma_f32_32x32x16_bf16 v[0:15], v[40:43], v[68:71], 0
  ds_read_b128 v[60:63], v76 offset:33280
  ds_read_b128 v[64:67], v76 offset:33888
  v_exp_f32 v16, v16
  v_exp_f32 v17, v17
  v_exp_f32 v18, v18
  v_exp_f32 v19, v19
  v_mfma_f32_32x32x16_bf16 a[0:15], v[52:55], v[32:35], a[0:15]
  v_exp_f32 v20, v20
  v_exp_f32 v21, v21
  v_exp_f32 v22, v22
  v_exp_f32 v23, v23
  v_mfma_f32_32x32x8_bf16 v[0:15], v[44:45], v[72:73], v[0:15]
  ds_read_b128 v[46:49], v74 offset:38400
  ds_read_b32 v50, v75 offset:38400
  v_exp_f32 v24, v24
  v_exp_f32 v25, v25
  v_exp_f32 v26, v26
  v_exp_f32 v27, v27
  v_mfma_f32_32x32x16_bf16 a[0:15], v[56:59], v[36:39], a[0:15]
  v_exp_f32 v28, v28
  v_exp_f32 v29, v29
  v_exp_f32 v30, v30
  v_exp_f32 v31, v31
  v_cvt_pk_bf16_f32 v32, v16, v17
  v_cvt_pk_bf16_f32 v33, v18, v19
  v_cvt_pk_bf16_f32 v34, v20, v21
  v_cvt_pk_bf16_f32 v35, v22, v23
  v_cvt_pk_bf16_f32 v36, v24, v25
  v_cvt_pk_bf16_f32 v37, v26, v27
  v_cvt_pk_bf16_f32 v38, v28, v29
  v_cvt_pk_bf16_f32 v39, v30, v31
  s_waitcnt lgkmcnt(0)
  s_waitcnt vmcnt(6)
  s_barrier
  s_add_u32 m0, s23, 20480
  s_add_u32 s24, s22, 122880
  buffer_load_dwordx4 v79, s[32:35], s24 offen lds
  buffer_load_dwordx4 v79, s[32:35], s24 offen offset:1024 lds
  s_mov_b32 exec_hi, 0
  buffer_load_dwordx4 v79, s[32:35], s24 offen offset:2048 lds
  s_mov_b64 exec, -1
  v_mfma_f32_32x32x16_bf16 v[16:31], v[46:49], v[68:71], 0
  ds_read_b128 v[52:55], v76 offset:35840
  ds_read_b128 v[56:59], v76 offset:36448
  v_exp_f32 v0, v0
  v_exp_f32 v1, v1
  v_exp_f32 v2, v2
  v_exp_f32 v3, v3
  v_mfma_f32_32x32x16_bf16 a[0:15], v[60:63], v[32:35], a[0:15]
  v_exp_f32 v4, v4
  v_exp_f32 v5, v5
  v_exp_f32 v6, v6
  v_exp_f32 v7, v7
  v_mfma_f32_32x32x8_bf16 v[16:31], v[50:51], v[72:73], v[16:31]
  ds_read_b128 v[40:43], v74 offset:40960
  ds_read_b32 v44, v75 offset:40960
  v_exp_f32 v8, v8
  v_exp_f32 v9, v9
  v_exp_f32 v10, v10
  v_exp_f32 v11, v11
  v_mfma_f32_32x32x16_bf16 a[0:15], v[64:67], v[36:39], a[0:15]
  v_exp_f32 v12, v12
  v_exp_f32 v13, v13
  v_exp_f32 v14, v14
  v_exp_f32 v15, v15
  v_cvt_pk_bf16_f32 v32, v0, v1
  v_cvt_pk_bf16_f32 v33, v2, v3
  v_cvt_pk_bf16_f32 v34, v4, v5
  v_cvt_pk_bf16_f32 v35, v6, v7
  v_cvt_pk_bf16_f32 v36, v8, v9
  v_cvt_pk_bf16_f32 v37, v10, v11
  v_cvt_pk_bf16_f32 v38, v12, v13
  v_cvt_pk_bf16_f32 v39, v14, v15
  s_waitcnt lgkmcnt(0)
  v_mfma_f32_32x32x16_bf16 v[0:15], v[40:43], v[68:71], 0
  ds_read_b128 v[60:63], v76 offset:38400
  ds_read_b128 v[64:67], v76 offset:39008
  v_exp_f32 v16, v16
  v_exp_f32 v17, v17
  v_exp_f32 v18, v18
  v_exp_f32 v19, v19
  v_mfma_f32_32x32x16_bf16 a[0:15], v[52:55], v[32:35], a[0:15]
  v_exp_f32 v20, v20
  v_exp_f32 v21, v21
  v_exp_f32 v22, v22
  v_exp_f32 v23, v23
  v_mfma_f32_32x32x8_bf16 v[0:15], v[44:45], v[72:73], v[0:15]
  ds_read_b128 v[46:49], v74 offset:43520
  ds_read_b32 v50, v75 offset:43520
  v_exp_f32 v24, v24
  v_exp_f32 v25, v25
  v_exp_f32 v26, v26
  v_exp_f32 v27, v27
  v_mfma_f32_32x32x16_bf16 a[0:15], v[56:59], v[36:39], a[0:15]
  v_exp_f32 v28, v28
  v_exp_f32 v29, v29
  v_exp_f32 v30, v30
  v_exp_f32 v31, v31
  v_cvt_pk_bf16_f32 v32, v16, v17
  v_cvt_pk_bf16_f32 v33, v18, v19
  v_cvt_pk_bf16_f32 v34, v20, v21
  v_cvt_pk_bf16_f32 v35, v22, v23
  v_cvt_pk_bf16_f32 v36, v24, v25
  v_cvt_pk_bf16_f32 v37, v26, v27
  v_cvt_pk_bf16_f32 v38, v28, v29
  v_cvt_pk_bf16_f32 v39, v30, v31
  s_waitcnt lgkmcnt(0)
  v_mfma_f32_32x32x16_bf16 v[16:31], v[46:49], v[68:71], 0
  ds_read_b128 v[52:55], v76 offset:40960
  ds_read_b128 v[56:59], v76 offset:41568
  v_exp_f32 v0, v0
  v_exp_f32 v1, v1
  v_exp_f32 v2, v2
  v_exp_f32 v3, v3
  v_mfma_f32_32x32x16_bf16 a[0:15], v[60:63], v[32:35], a[0:15]
  v_exp_f32 v4, v4
  v_exp_f32 v5, v5
  v_exp_f32 v6, v6
  v_exp_f32 v7, v7
  v_mfma_f32_32x32x8_bf16 v[16:31], v[50:51], v[72:73], v[16:31]
  ds_read_b128 v[40:43], v74 offset:46080
  ds_read_b32 v44, v75 offset:46080
  v_exp_f32 v8, v8
  v_exp_f32 v9, v9
  v_exp_f32 v10, v10
  v_exp_f32 v11, v11
  v_mfma_f32_32x32x16_bf16 a[0:15], v[64:67], v[36:39], a[0:15]
  v_exp_f32 v12, v12
  v_exp_f32 v13, v13
  v_exp_f32 v14, v14
  v_exp_f32 v15, v15
  v_cvt_pk_bf16_f32 v32, v0, v1
  v_cvt_pk_bf16_f32 v33, v2, v3
  v_cvt_pk_bf16_f32 v34, v4, v5
  v_cvt_pk_bf16_f32 v35, v6, v7
  v_cvt_pk_bf16_f32 v36, v8, v9
  v_cvt_pk_bf16_f32 v37, v10, v11
  v_cvt_pk_bf16_f32 v38, v12, v13
  v_cvt_pk_bf16_f32 v39, v14, v15
  s_waitcnt lgkmcnt(0)
  v_mfma_f32_32x32x16_bf16 v[0:15], v[40:43], v[68:71], 0
  ds_read_b128 v[60:63], v76 offset:43520
  ds_read_b128 v[64:67], v76 offset:44128
  v_exp_f32 v16, v16
  v_exp_f32 v17, v17
  v_exp_f32 v18, v18
  v_exp_f32 v19, v19
  v_mfma_f32_32x32x16_bf16 a[0:15], v[52:55], v[32:35], a[0:15]
  v_exp_f32 v20, v20
  v_exp_f32 v21, v21
  v_exp_f32 v22, v22
  v_exp_f32 v23, v23
  v_mfma_f32_32x32x8_bf16 v[0:15], v[44:45], v[72:73], v[0:15]
  ds_read_b128 v[46:49], v74 offset:48640
  ds_read_b32 v50, v75 offset:48640
  v_exp_f32 v24, v24
  v_exp_f32 v25, v25
  v_exp_f32 v26, v26
  v_exp_f32 v27, v27
  v_mfma_f32_32x32x16_bf16 a[0:15], v[56:59], v[36:39], a[0:15]
  v_exp_f32 v28, v28
  v_exp_f32 v29, v29
  v_exp_f32 v30, v30
  v_exp_f32 v31, v31
  v_cvt_pk_bf16_f32 v32, v16, v17
  v_cvt_pk_bf16_f32 v33, v18, v19
  v_cvt_pk_bf16_f32 v34, v20, v21
  v_cvt_pk_bf16_f32 v35, v22, v23
  v_cvt_pk_bf16_f32 v36, v24, v25
  v_cvt_pk_bf16_f32 v37, v26, v27
  v_cvt_pk_bf16_f32 v38, v28, v29
  v_cvt_pk_bf16_f32 v39, v30, v31
  s_waitcnt lgkmcnt(0)
  s_waitcnt vmcnt(6)
  s_barrier
  s_add_u32 m0, s23, 30720
  s_add_u32 s24, s22, 133120
  buffer_load_dwordx4 v79, s[32:35], s24 offen lds
  buffer_load_dwordx4 v79, s[32:35], s24 offen offset:1024 lds
  s_mov_b32 exec_hi, 0
  buffer_load_dwordx4 v79, s[32:35], s24 offen offset:2048 lds
  s_mov_b64 exec, -1
  v_mfma_f32_32x32x16_bf16 v[16:31], v[46:49], v[68:71], 0
  ds_read_b128 v[52:55], v76 offset:46080
  ds_read_b128 v[56:59], v76 offset:46688
  v_exp_f32 v0, v0
  v_exp_f32 v1, v1
  v_exp_f32 v2, v2
  v_exp_f32 v3, v3
  v_mfma_f32_32x32x16_bf16 a[0:15], v[60:63], v[32:35], a[0:15]
  v_exp_f32 v4, v4
  v_exp_f32 v5, v5
  v_exp_f32 v6, v6
  v_exp_f32 v7, v7
  v_mfma_f32_32x32x8_bf16 v[16:31], v[50:51], v[72:73], v[16:31]
  ds_read_b128 v[40:43], v74 offset:0
  ds_read_b32 v44, v75 offset:0
  v_exp_f32 v8, v8
  v_exp_f32 v9, v9
  v_exp_f32 v10, v10
  v_exp_f32 v11, v11
  v_mfma_f32_32x32x16_bf16 a[0:15], v[64:67], v[36:39], a[0:15]
  v_exp_f32 v12, v12
  v_exp_f32 v13, v13
  v_exp_f32 v14, v14
  v_exp_f32 v15, v15
  v_cvt_pk_bf16_f32 v32, v0, v1
  v_cvt_pk_bf16_f32 v33, v2, v3
  v_cvt_pk_bf16_f32 v34, v4, v5
  v_cvt_pk_bf16_f32 v35, v6, v7
  v_cvt_pk_bf16_f32 v36, v8, v9
  v_cvt_pk_bf16_f32 v37, v10, v11
  v_cvt_pk_bf16_f32 v38, v12, v13
  v_cvt_pk_bf16_f32 v39, v14, v15
  s_waitcnt lgkmcnt(0)
  v_mfma_f32_32x32x16_bf16 v[0:15], v[40:43], v[68:71], 0
  ds_read_b128 v[60:63], v76 offset:48640
  ds_read_b128 v[64:67], v76 offset:49248
  v_exp_f32 v16, v16
  v_exp_f32 v17, v17
  v_exp_f32 v18, v18
  v_exp_f32 v19, v19
  v_mfma_f32_32x32x16_bf16 a[0:15], v[52:55], v[32:35], a[0:15]
  v_exp_f32 v20, v20
  v_exp_f32 v21, v21
  v_exp_f32 v22, v22
  v_exp_f32 v23, v23
  v_mfma_f32_32x32x8_bf16 v[0:15], v[44:45], v[72:73], v[0:15]
  ds_read_b128 v[46:49], v74 offset:2560
  ds_read_b32 v50, v75 offset:2560
  v_exp_f32 v24, v24
  v_exp_f32 v25, v25
  v_exp_f32 v26, v26
  v_exp_f32 v27, v27
  v_mfma_f32_32x32x16_bf16 a[0:15], v[56:59], v[36:39], a[0:15]
  v_exp_f32 v28, v28
  v_exp_f32 v29, v29
  v_exp_f32 v30, v30
  v_exp_f32 v31, v31
  v_cvt_pk_bf16_f32 v32, v16, v17
  v_cvt_pk_bf16_f32 v33, v18, v19
  v_cvt_pk_bf16_f32 v34, v20, v21
  v_cvt_pk_bf16_f32 v35, v22, v23
  v_cvt_pk_bf16_f32 v36, v24, v25
  v_cvt_pk_bf16_f32 v37, v26, v27
  v_cvt_pk_bf16_f32 v38, v28, v29
  v_cvt_pk_bf16_f32 v39, v30, v31
  s_waitcnt lgkmcnt(0)
  v_mfma_f32_32x32x16_bf16 v[16:31], v[46:49], v[68:71], 0
  ds_read_b128 v[52:55], v76 offset:0
  ds_read_b128 v[56:59], v76 offset:608
  v_exp_f32 v0, v0
  v_exp_f32 v1, v1
  v_exp_f32 v2, v2
  v_exp_f32 v3, v3
  v_mfma_f32_32x32x16_bf16 a[0:15], v[60:63], v[32:35], a[0:15]
  v_exp_f32 v4, v4
  v_exp_f32 v5, v5
  v_exp_f32 v6, v6
  v_exp_f32 v7, v7
  v_mfma_f32_32x32x8_bf16 v[16:31], v[50:51], v[72:73], v[16:31]
  ds_read_b128 v[40:43], v74 offset:5120
  ds_read_b32 v44, v75 offset:5120
  v_exp_f32 v8, v8
  v_exp_f32 v9, v9
  v_exp_f32 v10, v10
  v_exp_f32 v11, v11
  v_mfma_f32_32x32x16_bf16 a[0:15], v[64:67], v[36:39], a[0:15]
  v_exp_f32 v12, v12
  v_exp_f32 v13, v13
  v_exp_f32 v14, v14
  v_exp_f32 v15, v15
  v_cvt_pk_bf16_f32 v32, v0, v1
  v_cvt_pk_bf16_f32 v33, v2, v3
  v_cvt_pk_bf16_f32 v34, v4, v5
  v_cvt_pk_bf16_f32 v35, v6, v7
  v_cvt_pk_bf16_f32 v36, v8, v9
  v_cvt_pk_bf16_f32 v37, v10, v11
  v_cvt_pk_bf16_f32 v38, v12, v13
  v_cvt_pk_bf16_f32 v39, v14, v15
  s_waitcnt lgkmcnt(0)
  v_mfma_f32_32x32x16_bf16 v[0:15], v[40:43], v[68:71], 0
  ds_read_b128 v[60:63], v76 offset:2560
  ds_read_b128 v[64:67], v76 offset:3168
  v_exp_f32 v16, v16
  v_exp_f32 v17, v17
  v_exp_f32 v18, v18
  v_exp_f32 v19, v19
  v_mfma_f32_32x32x16_bf16 a[0:15], v[52:55], v[32:35], a[0:15]
  v_exp_f32 v20, v20
  v_exp_f32 v21, v21
  v_exp_f32 v22, v22
  v_exp_f32 v23, v23
  v_mfma_f32_32x32x8_bf16 v[0:15], v[44:45], v[72:73], v[0:15]
  ds_read_b128 v[46:49], v74 offset:7680
  ds_read_b32 v50, v75 offset:7680
  v_exp_f32 v24, v24
  v_exp_f32 v25, v25
  v_exp_f32 v26, v26
  v_exp_f32 v27, v27
  v_mfma_f32_32x32x16_bf16 a[0:15], v[56:59], v[36:39], a[0:15]
  v_exp_f32 v28, v28
  v_exp_f32 v29, v29
  v_exp_f32 v30, v30
  v_exp_f32 v31, v31
  v_cvt_pk_bf16_f32 v32, v16, v17
  v_cvt_pk_bf16_f32 v33, v18, v19
  v_cvt_pk_bf16_f32 v34, v20, v21
  v_cvt_pk_bf16_f32 v35, v22, v23
  v_cvt_pk_bf16_f32 v36, v24, v25
  v_cvt_pk_bf16_f32 v37, v26, v27
  v_cvt_pk_bf16_f32 v38, v28, v29
  v_cvt_pk_bf16_f32 v39, v30, v31
  s_waitcnt lgkmcnt(0)
  s_waitcnt vmcnt(6)
  s_barrier
  s_add_u32 m0, s23, 40960
  s_add_u32 s24, s22, 143360
  buffer_load_dwordx4 v79, s[32:35], s24 offen lds
  buffer_load_dwordx4 v79, s[32:35], s24 offen offset:1024 lds
  s_mov_b32 exec_hi, 0
  buffer_load_dwordx4 v79, s[32:35], s24 offen offset:2048 lds
  s_mov_b64 exec, -1
  v_mfma_f32_32x32x16_bf16 v[16:31], v[46:49], v[68:71], 0
  ds_read_b128 v[52:55], v76 offset:5120
  ds_read_b128 v[56:59], v76 offset:5728
  v_exp_f32 v0, v0
  v_exp_f32 v1, v1
  v_exp_f32 v2, v2
  v_exp_f32 v3, v3
  v_mfma_f32_32x32x16_bf16 a[0:15], v[60:63], v[32:35], a[0:15]
  v_exp_f32 v4, v4
  v_exp_f32 v5, v5
  v_exp_f32 v6, v6
  v_exp_f32 v7, v7
  v_mfma_f32_32x32x8_bf16 v[16:31], v[50:51], v[72:73], v[16:31]
  ds_read_b128 v[40:43], v74 offset:10240
  ds_read_b32 v44, v75 offset:10240
  v_exp_f32 v8, v8
  v_exp_f32 v9, v9
  v_exp_f32 v10, v10
  v_exp_f32 v11, v11
  v_mfma_f32_32x32x16_bf16 a[0:15], v[64:67], v[36:39], a[0:15]
  v_exp_f32 v12, v12
  v_exp_f32 v13, v13
  v_exp_f32 v14, v14
  v_exp_f32 v15, v15
  v_cvt_pk_bf16_f32 v32, v0, v1
  v_cvt_pk_bf16_f32 v33, v2, v3
  v_cvt_pk_bf16_f32 v34, v4, v5
  v_cvt_pk_bf16_f32 v35, v6, v7
  v_cvt_pk_bf16_f32 v36, v8, v9
  v_cvt_pk_bf16_f32 v37, v10, v11
  v_cvt_pk_bf16_f32 v38, v12, v13
  v_cvt_pk_bf16_f32 v39, v14, v15
  s_waitcnt lgkmcnt(0)
  v_mfma_f32_32x32x16_bf16 v[0:15], v[40:43], v[68:71], 0
  ds_read_b128 v[60:63], v76 offset:7680
  ds_read_b128 v[64:67], v76 offset:8288
  v_exp_f32 v16, v16
  v_exp_f32 v17, v17
  v_exp_f32 v18, v18
  v_exp_f32 v19, v19
  v_mfma_f32_32x32x16_bf16 a[0:15], v[52:55], v[32:35], a[0:15]
  v_exp_f32 v20, v20
  v_exp_f32 v21, v21
  v_exp_f32 v22, v22
  v_exp_f32 v23, v23
  v_mfma_f32_32x32x8_bf16 v[0:15], v[44:45], v[72:73], v[0:15]
  ds_read_b128 v[46:49], v74 offset:12800
  ds_read_b32 v50, v75 offset:12800
  v_exp_f32 v24, v24
  v_exp_f32 v25, v25
  v_exp_f32 v26, v26
  v_exp_f32 v27, v27
  v_mfma_f32_32x32x16_bf16 a[0:15], v[56:59], v[36:39], a[0:15]
  v_exp_f32 v28, v28
  v_exp_f32 v29, v29
  v_exp_f32 v30, v30
  v_exp_f32 v31, v31
  v_cvt_pk_bf16_f32 v32, v16, v17
  v_cvt_pk_bf16_f32 v33, v18, v19
  v_cvt_pk_bf16_f32 v34, v20, v21
  v_cvt_pk_bf16_f32 v35, v22, v23
  v_cvt_pk_bf16_f32 v36, v24, v25
  v_cvt_pk_bf16_f32 v37, v26, v27
  v_cvt_pk_bf16_f32 v38, v28, v29
  v_cvt_pk_bf16_f32 v39, v30, v31
  s_waitcnt lgkmcnt(0)
  v_mfma_f32_32x32x16_bf16 v[16:31], v[46:49], v[68:71], 0
  ds_read_b128 v[52:55], v76 offset:10240
  ds_read_b128 v[56:59], v76 offset:10848
  v_exp_f32 v0, v0
  v_exp_f32 v1, v1
  v_exp_f32 v2, v2
  v_exp_f32 v3, v3
  v_mfma_f32_32x32x16_bf16 a[0:15], v[60:63], v[32:35], a[0:15]
  v_exp_f32 v4, v4
  v_exp_f32 v5, v5
  v_exp_f32 v6, v6
  v_exp_f32 v7, v7
  v_mfma_f32_32x32x8_bf16 v[16:31], v[50:51], v[72:73], v[16:31]
  ds_read_b128 v[40:43], v74 offset:15360
  ds_read_b32 v44, v75 offset:15360
  v_exp_f32 v8, v8
  v_exp_f32 v9, v9
  v_exp_f32 v10, v10
  v_exp_f32 v11, v11
  v_mfma_f32_32x32x16_bf16 a[0:15], v[64:67], v[36:39], a[0:15]
  v_exp_f32 v12, v12
  v_exp_f32 v13, v13
  v_exp_f32 v14, v14
  v_exp_f32 v15, v15
  v_cvt_pk_bf16_f32 v32, v0, v1
  v_cvt_pk_bf16_f32 v33, v2, v3
  v_cvt_pk_bf16_f32 v34, v4, v5
  v_cvt_pk_bf16_f32 v35, v6, v7
  v_cvt_pk_bf16_f32 v36, v8, v9
  v_cvt_pk_bf16_f32 v37, v10, v11
  v_cvt_pk_bf16_f32 v38, v12, v13
  v_cvt_pk_bf16_f32 v39, v14, v15
  s_waitcnt lgkmcnt(0)
  v_mfma_f32_32x32x16_bf16 v[0:15], v[40:43], v[68:71], 0
  ds_read_b128 v[60:63], v76 offset:12800
  ds_read_b128 v[64:67], v76 offset:13408
  v_exp_f32 v16, v16
  v_exp_f32 v17, v17
  v_exp_f32 v18, v18
  v_exp_f32 v19, v19
  v_mfma_f32_32x32x16_bf16 a[0:15], v[52:55], v[32:35], a[0:15]
  v_exp_f32 v20, v20
  v_exp_f32 v21, v21
  v_exp_f32 v22, v22
  v_exp_f32 v23, v23
  v_mfma_f32_32x32x8_bf16 v[0:15], v[44:45], v[72:73], v[0:15]
  ds_read_b128 v[46:49], v74 offset:17920
  ds_read_b32 v50, v75 offset:17920
  v_exp_f32 v24, v24
  v_exp_f32 v25, v25
  v_exp_f32 v26, v26
  v_exp_f32 v27, v27
  v_mfma_f32_32x32x16_bf16 a[0:15], v[56:59], v[36:39], a[0:15]
  v_exp_f32 v28, v28
  v_exp_f32 v29, v29
  v_exp_f32 v30, v30
  v_exp_f32 v31, v31
  v_cvt_pk_bf16_f32 v32, v16, v17
  v_cvt_pk_bf16_f32 v33, v18, v19
  v_cvt_pk_bf16_f32 v34, v20, v21
  v_cvt_pk_bf16_f32 v35, v22, v23
  v_cvt_pk_bf16_f32 v36, v24, v25
  v_cvt_pk_bf16_f32 v37, v26, v27
  v_cvt_pk_bf16_f32 v38, v28, v29
  v_cvt_pk_bf16_f32 v39, v30, v31
  s_waitcnt lgkmcnt(0)
  s_waitcnt vmcnt(6)
  s_barrier
  s_add_u32 m0, s23, 0
  s_add_u32 s24, s22, 153600
  buffer_load_dwordx4 v79, s[32:35], s24 offen lds
  buffer_load_dwordx4 v79, s[32:35], s24 offen offset:1024 lds
  s_mov_b32 exec_hi, 0
  buffer_load_dwordx4 v79, s[32:35], s24 offen offset:2048 lds
  s_mov_b64 exec, -1
  v_mfma_f32_32x32x16_bf16 v[16:31], v[46:49], v[68:71], 0
  ds_read_b128 v[52:55], v76 offset:15360
  ds_read_b128 v[56:59], v76 offset:15968
  v_exp_f32 v0, v0
  v_exp_f32 v1, v1
  v_exp_f32 v2, v2
  v_exp_f32 v3, v3
  v_mfma_f32_32x32x16_bf16 a[0:15], v[60:63], v[32:35], a[0:15]
  v_exp_f32 v4, v4
  v_exp_f32 v5, v5
  v_exp_f32 v6, v6
  v_exp_f32 v7, v7
  v_mfma_f32_32x32x8_bf16 v[16:31], v[50:51], v[72:73], v[16:31]
  ds_read_b128 v[40:43], v74 offset:20480
  ds_read_b32 v44, v75 offset:20480
  v_exp_f32 v8, v8
  v_exp_f32 v9, v9
  v_exp_f32 v10, v10
  v_exp_f32 v11, v11
  v_mfma_f32_32x32x16_bf16 a[0:15], v[64:67], v[36:39], a[0:15]
  v_exp_f32 v12, v12
  v_exp_f32 v13, v13
  v_exp_f32 v14, v14
  v_exp_f32 v15, v15
  v_cvt_pk_bf16_f32 v32, v0, v1
  v_cvt_pk_bf16_f32 v33, v2, v3
  v_cvt_pk_bf16_f32 v34, v4, v5
  v_cvt_pk_bf16_f32 v35, v6, v7
  v_cvt_pk_bf16_f32 v36, v8, v9
  v_cvt_pk_bf16_f32 v37, v10, v11
  v_cvt_pk_bf16_f32 v38, v12, v13
  v_cvt_pk_bf16_f32 v39, v14, v15
  s_waitcnt lgkmcnt(0)
  v_mfma_f32_32x32x16_bf16 v[0:15], v[40:43], v[68:71], 0
  ds_read_b128 v[60:63], v76 offset:17920
  ds_read_b128 v[64:67], v76 offset:18528
  v_exp_f32 v16, v16
  v_exp_f32 v17, v17
  v_exp_f32 v18, v18
  v_exp_f32 v19, v19
  v_mfma_f32_32x32x16_bf16 a[0:15], v[52:55], v[32:35], a[0:15]
  v_exp_f32 v20, v20
  v_exp_f32 v21, v21
  v_exp_f32 v22, v22
  v_exp_f32 v23, v23
  v_mfma_f32_32x32x8_bf16 v[0:15], v[44:45], v[72:73], v[0:15]
  ds_read_b128 v[46:49], v74 offset:23040
  ds_read_b32 v50, v75 offset:23040
  v_exp_f32 v24, v24
  v_exp_f32 v25, v25
  v_exp_f32 v26, v26
  v_exp_f32 v27, v27
  v_mfma_f32_32x32x16_bf16 a[0:15], v[56:59], v[36:39], a[0:15]
  v_exp_f32 v28, v28
  v_exp_f32 v29, v29
  v_exp_f32 v30, v30
  v_exp_f32 v31, v31
  v_cvt_pk_bf16_f32 v32, v16, v17
  v_cvt_pk_bf16_f32 v33, v18, v19
  v_cvt_pk_bf16_f32 v34, v20, v21
  v_cvt_pk_bf16_f32 v35, v22, v23
  v_cvt_pk_bf16_f32 v36, v24, v25
  v_cvt_pk_bf16_f32 v37, v26, v27
  v_cvt_pk_bf16_f32 v38, v28, v29
  v_cvt_pk_bf16_f32 v39, v30, v31
  s_waitcnt lgkmcnt(0)
  v_mfma_f32_32x32x16_bf16 v[16:31], v[46:49], v[68:71], 0
  ds_read_b128 v[52:55], v76 offset:20480
  ds_read_b128 v[56:59], v76 offset:21088
  v_exp_f32 v0, v0
  v_exp_f32 v1, v1
  v_exp_f32 v2, v2
  v_exp_f32 v3, v3
  v_mfma_f32_32x32x16_bf16 a[0:15], v[60:63], v[32:35], a[0:15]
  v_exp_f32 v4, v4
  v_exp_f32 v5, v5
  v_exp_f32 v6, v6
  v_exp_f32 v7, v7
  v_mfma_f32_32x32x8_bf16 v[16:31], v[50:51], v[72:73], v[16:31]
  ds_read_b128 v[40:43], v74 offset:25600
  ds_read_b32 v44, v75 offset:25600
  v_exp_f32 v8, v8
  v_exp_f32 v9, v9
  v_exp_f32 v10, v10
  v_exp_f32 v11, v11
  v_mfma_f32_32x32x16_bf16 a[0:15], v[64:67], v[36:39], a[0:15]
  v_exp_f32 v12, v12
  v_exp_f32 v13, v13
  v_exp_f32 v14, v14
  v_exp_f32 v15, v15
  v_cvt_pk_bf16_f32 v32, v0, v1
  v_cvt_pk_bf16_f32 v33, v2, v3
  v_cvt_pk_bf16_f32 v34, v4, v5
  v_cvt_pk_bf16_f32 v35, v6, v7
  v_cvt_pk_bf16_f32 v36, v8, v9
  v_cvt_pk_bf16_f32 v37, v10, v11
  v_cvt_pk_bf16_f32 v38, v12, v13
  v_cvt_pk_bf16_f32 v39, v14, v15
  s_waitcnt lgkmcnt(0)
  v_mfma_f32_32x32x16_bf16 v[0:15], v[40:43], v[68:71], 0
  ds_read_b128 v[60:63], v76 offset:23040
  ds_read_b128 v[64:67], v76 offset:23648
  v_exp_f32 v16, v16
  v_exp_f32 v17, v17
  v_exp_f32 v18, v18
  v_exp_f32 v19, v19
  v_mfma_f32_32x32x16_bf16 a[0:15], v[52:55], v[32:35], a[0:15]
  v_exp_f32 v20, v20
  v_exp_f32 v21, v21
  v_exp_f32 v22, v22
  v_exp_f32 v23, v23
  v_mfma_f32_32x32x8_bf16 v[0:15], v[44:45], v[72:73], v[0:15]
  ds_read_b128 v[46:49], v74 offset:28160
  ds_read_b32 v50, v75 offset:28160
  v_exp_f32 v24, v24
  v_exp_f32 v25, v25
  v_exp_f32 v26, v26
  v_exp_f32 v27, v27
  v_mfma_f32_32x32x16_bf16 a[0:15], v[56:59], v[36:39], a[0:15]
  v_exp_f32 v28, v28
  v_exp_f32 v29, v29
  v_exp_f32 v30, v30
  v_exp_f32 v31, v31
  v_cvt_pk_bf16_f32 v32, v16, v17
  v_cvt_pk_bf16_f32 v33, v18, v19
  v_cvt_pk_bf16_f32 v34, v20, v21
  v_cvt_pk_bf16_f32 v35, v22, v23
  v_cvt_pk_bf16_f32 v36, v24, v25
  v_cvt_pk_bf16_f32 v37, v26, v27
  v_cvt_pk_bf16_f32 v38, v28, v29
  v_cvt_pk_bf16_f32 v39, v30, v31
  s_waitcnt lgkmcnt(0)
  s_waitcnt vmcnt(6)
  s_barrier
  v_mfma_f32_32x32x16_bf16 v[16:31], v[46:49], v[68:71], 0
  ds_read_b128 v[52:55], v76 offset:25600
  ds_read_b128 v[56:59], v76 offset:26208
  v_exp_f32 v0, v0
  v_exp_f32 v1, v1
  v_exp_f32 v2, v2
  v_exp_f32 v3, v3
  v_mfma_f32_32x32x16_bf16 a[0:15], v[60:63], v[32:35], a[0:15]
  v_exp_f32 v4, v4
  v_exp_f32 v5, v5
  v_exp_f32 v6, v6
  v_exp_f32 v7, v7
  v_mfma_f32_32x32x8_bf16 v[16:31], v[50:51], v[72:73], v[16:31]
  ds_read_b128 v[40:43], v74 offset:30720
  ds_read_b32 v44, v75 offset:30720
  v_exp_f32 v8, v8
  v_exp_f32 v9, v9
  v_exp_f32 v10, v10
  v_exp_f32 v11, v11
  v_mfma_f32_32x32x16_bf16 a[0:15], v[64:67], v[36:39], a[0:15]
  v_exp_f32 v12, v12
  v_exp_f32 v13, v13
  v_exp_f32 v14, v14
  v_exp_f32 v15, v15
  v_cvt_pk_bf16_f32 v32, v0, v1
  v_cvt_pk_bf16_f32 v33, v2, v3
  v_cvt_pk_bf16_f32 v34, v4, v5
  v_cvt_pk_bf16_f32 v35, v6, v7
  v_cvt_pk_bf16_f32 v36, v8, v9
  v_cvt_pk_bf16_f32 v37, v10, v11
  v_cvt_pk_bf16_f32 v38, v12, v13
  v_cvt_pk_bf16_f32 v39, v14, v15
  s_waitcnt lgkmcnt(0)
  v_mfma_f32_32x32x16_bf16 v[0:15], v[40:43], v[68:71], 0
  ds_read_b128 v[60:63], v76 offset:28160
  ds_read_b128 v[64:67], v76 offset:28768
  v_exp_f32 v16, v16
  v_exp_f32 v17, v17
  v_exp_f32 v18, v18
  v_exp_f32 v19, v19
  v_mfma_f32_32x32x16_bf16 a[0:15], v[52:55], v[32:35], a[0:15]
  v_exp_f32 v20, v20
  v_exp_f32 v21, v21
  v_exp_f32 v22, v22
  v_exp_f32 v23, v23
  v_mfma_f32_32x32x8_bf16 v[0:15], v[44:45], v[72:73], v[0:15]
  ds_read_b128 v[46:49], v74 offset:33280
  ds_read_b32 v50, v75 offset:33280
  v_exp_f32 v24, v24
  v_exp_f32 v25, v25
  v_exp_f32 v26, v26
  v_exp_f32 v27, v27
  v_mfma_f32_32x32x16_bf16 a[0:15], v[56:59], v[36:39], a[0:15]
  v_exp_f32 v28, v28
  v_exp_f32 v29, v29
  v_exp_f32 v30, v30
  v_exp_f32 v31, v31
  v_cvt_pk_bf16_f32 v32, v16, v17
  v_cvt_pk_bf16_f32 v33, v18, v19
  v_cvt_pk_bf16_f32 v34, v20, v21
  v_cvt_pk_bf16_f32 v35, v22, v23
  v_cvt_pk_bf16_f32 v36, v24, v25
  v_cvt_pk_bf16_f32 v37, v26, v27
  v_cvt_pk_bf16_f32 v38, v28, v29
  v_cvt_pk_bf16_f32 v39, v30, v31
  s_waitcnt lgkmcnt(0)
  v_mfma_f32_32x32x16_bf16 v[16:31], v[46:49], v[68:71], 0
  ds_read_b128 v[52:55], v76 offset:30720
  ds_read_b128 v[56:59], v76 offset:31328
  v_exp_f32 v0, v0
  v_exp_f32 v1, v1
  v_exp_f32 v2, v2
  v_exp_f32 v3, v3
  v_mfma_f32_32x32x16_bf16 a[0:15], v[60:63], v[32:35], a[0:15]
  v_exp_f32 v4, v4
  v_exp_f32 v5, v5
  v_exp_f32 v6, v6
  v_exp_f32 v7, v7
  v_mfma_f32_32x32x8_bf16 v[16:31], v[50:51], v[72:73], v[16:31]
  ds_read_b128 v[40:43], v74 offset:35840
  ds_read_b32 v44, v75 offset:35840
  v_exp_f32 v8, v8
  v_exp_f32 v9, v9
  v_exp_f32 v10, v10
  v_exp_f32 v11, v11
  v_mfma_f32_32x32x16_bf16 a[0:15], v[64:67], v[36:39], a[0:15]
  v_exp_f32 v12, v12
  v_exp_f32 v13, v13
  v_exp_f32 v14, v14
  v_exp_f32 v15, v15
  v_cvt_pk_bf16_f32 v32, v0, v1
  v_cvt_pk_bf16_f32 v33, v2, v3
  v_cvt_pk_bf16_f32 v34, v4, v5
  v_cvt_pk_bf16_f32 v35, v6, v7
  v_cvt_pk_bf16_f32 v36, v8, v9
  v_cvt_pk_bf16_f32 v37, v10, v11
  v_cvt_pk_bf16_f32 v38, v12, v13
  v_cvt_pk_bf16_f32 v39, v14, v15
  s_waitcnt lgkmcnt(0)
  v_mfma_f32_32x32x16_bf16 v[0:15], v[40:43], v[68:71], 0
  ds_read_b128 v[60:63], v76 offset:33280
  ds_read_b128 v[64:67], v76 offset:33888
  v_exp_f32 v16, v16
  v_exp_f32 v17, v17
  v_exp_f32 v18, v18
  v_exp_f32 v19, v19
  v_mfma_f32_32x32x16_bf16 a[0:15], v[52:55], v[32:35], a[0:15]
  v_exp_f32 v20, v20
  v_exp_f32 v21, v21
  v_exp_f32 v22, v22
  v_exp_f32 v23, v23
  v_mfma_f32_32x32x8_bf16 v[0:15], v[44:45], v[72:73], v[0:15]
  ds_read_b128 v[46:49], v74 offset:38400
  ds_read_b32 v50, v75 offset:38400
  v_exp_f32 v24, v24
  v_exp_f32 v25, v25
  v_exp_f32 v26, v26
  v_exp_f32 v27, v27
  v_mfma_f32_32x32x16_bf16 a[0:15], v[56:59], v[36:39], a[0:15]
  v_exp_f32 v28, v28
  v_exp_f32 v29, v29
  v_exp_f32 v30, v30
  v_exp_f32 v31, v31
  v_cvt_pk_bf16_f32 v32, v16, v17
  v_cvt_pk_bf16_f32 v33, v18, v19
  v_cvt_pk_bf16_f32 v34, v20, v21
  v_cvt_pk_bf16_f32 v35, v22, v23
  v_cvt_pk_bf16_f32 v36, v24, v25
  v_cvt_pk_bf16_f32 v37, v26, v27
  v_cvt_pk_bf16_f32 v38, v28, v29
  v_cvt_pk_bf16_f32 v39, v30, v31
  s_waitcnt lgkmcnt(0)
  s_waitcnt vmcnt(3)
  s_barrier
  v_mfma_f32_32x32x16_bf16 v[16:31], v[46:49], v[68:71], 0
  ds_read_b128 v[52:55], v76 offset:35840
  ds_read_b128 v[56:59], v76 offset:36448
  v_exp_f32 v0, v0
  v_exp_f32 v1, v1
  v_exp_f32 v2, v2
  v_exp_f32 v3, v3
  v_mfma_f32_32x32x16_bf16 a[0:15], v[60:63], v[32:35], a[0:15]
  v_exp_f32 v4, v4
  v_exp_f32 v5, v5
  v_exp_f32 v6, v6
  v_exp_f32 v7, v7
  v_mfma_f32_32x32x8_bf16 v[16:31], v[50:51], v[72:73], v[16:31]
  ds_read_b128 v[40:43], v74 offset:40960
  ds_read_b32 v44, v75 offset:40960
  v_exp_f32 v8, v8
  v_exp_f32 v9, v9
  v_exp_f32 v10, v10
  v_exp_f32 v11, v11
  v_mfma_f32_32x32x16_bf16 a[0:15], v[64:67], v[36:39], a[0:15]
  v_exp_f32 v12, v12
  v_exp_f32 v13, v13
  v_exp_f32 v14, v14
  v_exp_f32 v15, v15
  v_cvt_pk_bf16_f32 v32, v0, v1
  v_cvt_pk_bf16_f32 v33, v2, v3
  v_cvt_pk_bf16_f32 v34, v4, v5
  v_cvt_pk_bf16_f32 v35, v6, v7
  v_cvt_pk_bf16_f32 v36, v8, v9
  v_cvt_pk_bf16_f32 v37, v10, v11
  v_cvt_pk_bf16_f32 v38, v12, v13
  v_cvt_pk_bf16_f32 v39, v14, v15
  s_waitcnt lgkmcnt(0)
  v_mfma_f32_32x32x16_bf16 v[0:15], v[40:43], v[68:71], 0
  ds_read_b128 v[60:63], v76 offset:38400
  ds_read_b128 v[64:67], v76 offset:39008
  v_exp_f32 v16, v16
  v_exp_f32 v17, v17
  v_exp_f32 v18, v18
  v_exp_f32 v19, v19
  v_mfma_f32_32x32x16_bf16 a[0:15], v[52:55], v[32:35], a[0:15]
  v_exp_f32 v20, v20
  v_exp_f32 v21, v21
  v_exp_f32 v22, v22
  v_exp_f32 v23, v23
  v_mfma_f32_32x32x8_bf16 v[0:15], v[44:45], v[72:73], v[0:15]
  ds_read_b128 v[46:49], v74 offset:43520
  ds_read_b32 v50, v75 offset:43520
  v_exp_f32 v24, v24
  v_exp_f32 v25, v25
  v_exp_f32 v26, v26
  v_exp_f32 v27, v27
  v_mfma_f32_32x32x16_bf16 a[0:15], v[56:59], v[36:39], a[0:15]
  v_exp_f32 v28, v28
  v_exp_f32 v29, v29
  v_exp_f32 v30, v30
  v_exp_f32 v31, v31
  v_cvt_pk_bf16_f32 v32, v16, v17
  v_cvt_pk_bf16_f32 v33, v18, v19
  v_cvt_pk_bf16_f32 v34, v20, v21
  v_cvt_pk_bf16_f32 v35, v22, v23
  v_cvt_pk_bf16_f32 v36, v24, v25
  v_cvt_pk_bf16_f32 v37, v26, v27
  v_cvt_pk_bf16_f32 v38, v28, v29
  v_cvt_pk_bf16_f32 v39, v30, v31
  s_waitcnt lgkmcnt(0)
  v_mfma_f32_32x32x16_bf16 v[16:31], v[46:49], v[68:71], 0
  ds_read_b128 v[52:55], v76 offset:40960
  ds_read_b128 v[56:59], v76 offset:41568
  v_exp_f32 v0, v0
  v_exp_f32 v1, v1
  v_exp_f32 v2, v2
  v_exp_f32 v3, v3
  v_mfma_f32_32x32x16_bf16 a[0:15], v[60:63], v[32:35], a[0:15]
  v_exp_f32 v4, v4
  v_exp_f32 v5, v5
  v_exp_f32 v6, v6
  v_exp_f32 v7, v7
  v_mfma_f32_32x32x8_bf16 v[16:31], v[50:51], v[72:73], v[16:31]
  ds_read_b128 v[40:43], v74 offset:46080
  ds_read_b32 v44, v75 offset:46080
  v_exp_f32 v8, v8
  v_exp_f32 v9, v9
  v_exp_f32 v10, v10
  v_exp_f32 v11, v11
  v_mfma_f32_32x32x16_bf16 a[0:15], v[64:67], v[36:39], a[0:15]
  v_exp_f32 v12, v12
  v_exp_f32 v13, v13
  v_exp_f32 v14, v14
  v_exp_f32 v15, v15
  v_cvt_pk_bf16_f32 v32, v0, v1
  v_cvt_pk_bf16_f32 v33, v2, v3
  v_cvt_pk_bf16_f32 v34, v4, v5
  v_cvt_pk_bf16_f32 v35, v6, v7
  v_cvt_pk_bf16_f32 v36, v8, v9
  v_cvt_pk_bf16_f32 v37, v10, v11
  v_cvt_pk_bf16_f32 v38, v12, v13
  v_cvt_pk_bf16_f32 v39, v14, v15
  s_waitcnt lgkmcnt(0)
  v_mfma_f32_32x32x16_bf16 v[0:15], v[40:43], v[68:71], 0
  ds_read_b128 v[60:63], v76 offset:43520
  ds_read_b128 v[64:67], v76 offset:44128
  v_exp_f32 v16, v16
  v_exp_f32 v17, v17
  v_exp_f32 v18, v18
  v_exp_f32 v19, v19
  v_mfma_f32_32x32x16_bf16 a[0:15], v[52:55], v[32:35], a[0:15]
  v_exp_f32 v20, v20
  v_exp_f32 v21, v21
  v_exp_f32 v22, v22
  v_exp_f32 v23, v23
  v_mfma_f32_32x32x8_bf16 v[0:15], v[44:45], v[72:73], v[0:15]
  ds_read_b128 v[46:49], v74 offset:48640
  ds_read_b32 v50, v75 offset:48640
  v_exp_f32 v24, v24
  v_exp_f32 v25, v25
  v_exp_f32 v26, v26
  v_exp_f32 v27, v27
  v_mfma_f32_32x32x16_bf16 a[0:15], v[56:59], v[36:39], a[0:15]
  v_exp_f32 v28, v28
  v_exp_f32 v29, v29
  v_exp_f32 v30, v30
  v_exp_f32 v31, v31
  v_cvt_pk_bf16_f32 v32, v16, v17
  v_cvt_pk_bf16_f32 v33, v18, v19
  v_cvt_pk_bf16_f32 v34, v20, v21
  v_cvt_pk_bf16_f32 v35, v22, v23
  v_cvt_pk_bf16_f32 v36, v24, v25
  v_cvt_pk_bf16_f32 v37, v26, v27
  v_cvt_pk_bf16_f32 v38, v28, v29
  v_cvt_pk_bf16_f32 v39, v30, v31
  s_waitcnt lgkmcnt(0)
  s_waitcnt vmcnt(0)
  s_barrier
  v_mfma_f32_32x32x16_bf16 v[16:31], v[46:49], v[68:71], 0
  ds_read_b128 v[52:55], v76 offset:46080
  ds_read_b128 v[56:59], v76 offset:46688
  v_exp_f32 v0, v0
  v_exp_f32 v1, v1
  v_exp_f32 v2, v2
  v_exp_f32 v3, v3
  v_mfma_f32_32x32x16_bf16 a[0:15], v[60:63], v[32:35], a[0:15]
  v_exp_f32 v4, v4
  v_exp_f32 v5, v5
  v_exp_f32 v6, v6
  v_exp_f32 v7, v7
  v_mfma_f32_32x32x8_bf16 v[16:31], v[50:51], v[72:73], v[16:31]
  ds_read_b128 v[40:43], v74 offset:0
  ds_read_b32 v44, v75 offset:0
  v_exp_f32 v8, v8
  v_exp_f32 v9, v9
  v_exp_f32 v10, v10
  v_exp_f32 v11, v11
  v_mfma_f32_32x32x16_bf16 a[0:15], v[64:67], v[36:39], a[0:15]
  v_exp_f32 v12, v12
  v_exp_f32 v13, v13
  v_exp_f32 v14, v14
  v_exp_f32 v15, v15
  v_cvt_pk_bf16_f32 v32, v0, v1
  v_cvt_pk_bf16_f32 v33, v2, v3
  v_cvt_pk_bf16_f32 v34, v4, v5
  v_cvt_pk_bf16_f32 v35, v6, v7
  v_cvt_pk_bf16_f32 v36, v8, v9
  v_cvt_pk_bf16_f32 v37, v10, v11
  v_cvt_pk_bf16_f32 v38, v12, v13
  v_cvt_pk_bf16_f32 v39, v14, v15
  s_waitcnt lgkmcnt(0)
  v_mfma_f32_32x32x16_bf16 v[0:15], v[40:43], v[68:71], 0
  ds_read_b128 v[60:63], v76 offset:48640
  ds_read_b128 v[64:67], v76 offset:49248
  v_exp_f32 v16, v16
  v_exp_f32 v17, v17
  v_exp_f32 v18, v18
  v_exp_f32 v19, v19
  v_mfma_f32_32x32x16_bf16 a[0:15], v[52:55], v[32:35], a[0:15]
  v_exp_f32 v20, v20
  v_exp_f32 v21, v21
  v_exp_f32 v22, v22
  v_exp_f32 v23, v23
  v_mfma_f32_32x32x8_bf16 v[0:15], v[44:45], v[72:73], v[0:15]
  ds_read_b128 v[46:49], v74 offset:2560
  ds_read_b32 v50, v75 offset:2560
  v_exp_f32 v24, v24
  v_exp_f32 v25, v25
  v_exp_f32 v26, v26
  v_exp_f32 v27, v27
  v_mfma_f32_32x32x16_bf16 a[0:15], v[56:59], v[36:39], a[0:15]
  v_exp_f32 v28, v28
  v_exp_f32 v29, v29
  v_exp_f32 v30, v30
  v_exp_f32 v31, v31
  v_cvt_pk_bf16_f32 v32, v16, v17
  v_cvt_pk_bf16_f32 v33, v18, v19
  v_cvt_pk_bf16_f32 v34, v20, v21
  v_cvt_pk_bf16_f32 v35, v22, v23
  v_cvt_pk_bf16_f32 v36, v24, v25
  v_cvt_pk_bf16_f32 v37, v26, v27
  v_cvt_pk_bf16_f32 v38, v28, v29
  v_cvt_pk_bf16_f32 v39, v30, v31
  s_waitcnt lgkmcnt(0)
  v_mfma_f32_32x32x16_bf16 v[16:31], v[46:49], v[68:71], 0
  ds_read_b128 v[52:55], v76 offset:0
  ds_read_b128 v[56:59], v76 offset:608
  v_exp_f32 v0, v0
  v_exp_f32 v1, v1
  v_exp_f32 v2, v2
  v_exp_f32 v3, v3
  v_mfma_f32_32x32x16_bf16 a[0:15], v[60:63], v[32:35], a[0:15]
  v_exp_f32 v4, v4
  v_exp_f32 v5, v5
  v_exp_f32 v6, v6
  v_exp_f32 v7, v7
  v_mfma_f32_32x32x8_bf16 v[16:31], v[50:51], v[72:73], v[16:31]
  ds_read_b128 v[40:43], v74 offset:5120
  ds_read_b32 v44, v75 offset:5120
  v_exp_f32 v8, v8
  v_exp_f32 v9, v9
  v_exp_f32 v10, v10
  v_exp_f32 v11, v11
  v_mfma_f32_32x32x16_bf16 a[0:15], v[64:67], v[36:39], a[0:15]
  v_exp_f32 v12, v12
  v_exp_f32 v13, v13
  v_exp_f32 v14, v14
  v_exp_f32 v15, v15
  v_cvt_pk_bf16_f32 v32, v0, v1
  v_cvt_pk_bf16_f32 v33, v2, v3
  v_cvt_pk_bf16_f32 v34, v4, v5
  v_cvt_pk_bf16_f32 v35, v6, v7
  v_cvt_pk_bf16_f32 v36, v8, v9
  v_cvt_pk_bf16_f32 v37, v10, v11
  v_cvt_pk_bf16_f32 v38, v12, v13
  v_cvt_pk_bf16_f32 v39, v14, v15
  s_waitcnt lgkmcnt(0)
  v_mfma_f32_32x32x16_bf16 v[0:15], v[40:43], v[68:71], 0
  ds_read_b128 v[60:63], v76 offset:2560
  ds_read_b128 v[64:67], v76 offset:3168
  v_exp_f32 v16, v16
  v_exp_f32 v17, v17
  v_exp_f32 v18, v18
  v_exp_f32 v19, v19
  v_mfma_f32_32x32x16_bf16 a[0:15], v[52:55], v[32:35], a[0:15]
  v_exp_f32 v20, v20
  v_exp_f32 v21, v21
  v_exp_f32 v22, v22
  v_exp_f32 v23, v23
  v_mfma_f32_32x32x8_bf16 v[0:15], v[44:45], v[72:73], v[0:15]
  ds_read_b128 v[46:49], v74 offset:7680
  ds_read_b32 v50, v75 offset:7680
  v_exp_f32 v24, v24
  v_exp_f32 v25, v25
  v_exp_f32 v26, v26
  v_exp_f32 v27, v27
  v_mfma_f32_32x32x16_bf16 a[0:15], v[56:59], v[36:39], a[0:15]
  v_exp_f32 v28, v28
  v_exp_f32 v29, v29
  v_exp_f32 v30, v30
  v_exp_f32 v31, v31
  v_cvt_pk_bf16_f32 v32, v16, v17
  v_cvt_pk_bf16_f32 v33, v18, v19
  v_cvt_pk_bf16_f32 v34, v20, v21
  v_cvt_pk_bf16_f32 v35, v22, v23
  v_cvt_pk_bf16_f32 v36, v24, v25
  v_cvt_pk_bf16_f32 v37, v26, v27
  v_cvt_pk_bf16_f32 v38, v28, v29
  v_cvt_pk_bf16_f32 v39, v30, v31
  s_waitcnt lgkmcnt(0)
  v_mfma_f32_32x32x16_bf16 v[16:31], v[46:49], v[68:71], 0
  ds_read_b128 v[52:55], v76 offset:5120
  ds_read_b128 v[56:59], v76 offset:5728
  v_exp_f32 v0, v0
  v_exp_f32 v1, v1
  v_exp_f32 v2, v2
  v_exp_f32 v3, v3
  v_mfma_f32_32x32x16_bf16 a[0:15], v[60:63], v[32:35], a[0:15]
  v_exp_f32 v4, v4
  v_exp_f32 v5, v5
  v_exp_f32 v6, v6
  v_exp_f32 v7, v7
  v_mfma_f32_32x32x8_bf16 v[16:31], v[50:51], v[72:73], v[16:31]
  v_exp_f32 v8, v8
  v_exp_f32 v9, v9
  v_exp_f32 v10, v10
  v_exp_f32 v11, v11
  v_mfma_f32_32x32x16_bf16 a[0:15], v[64:67], v[36:39], a[0:15]
  v_exp_f32 v12, v12
  v_exp_f32 v13, v13
  v_exp_f32 v14, v14
  v_exp_f32 v15, v15
  v_cvt_pk_bf16_f32 v32, v0, v1
  v_cvt_pk_bf16_f32 v33, v2, v3
  v_cvt_pk_bf16_f32 v34, v4, v5
  v_cvt_pk_bf16_f32 v35, v6, v7
  v_cvt_pk_bf16_f32 v36, v8, v9
  v_cvt_pk_bf16_f32 v37, v10, v11
  v_cvt_pk_bf16_f32 v38, v12, v13
  v_cvt_pk_bf16_f32 v39, v14, v15
  s_waitcnt lgkmcnt(0)
  ds_read_b128 v[60:63], v76 offset:7680
  ds_read_b128 v[64:67], v76 offset:8288
  v_exp_f32 v16, v16
  v_exp_f32 v17, v17
  v_exp_f32 v18, v18
  v_exp_f32 v19, v19
  v_mfma_f32_32x32x16_bf16 a[0:15], v[52:55], v[32:35], a[0:15]
  v_exp_f32 v20, v20
  v_exp_f32 v21, v21
  v_exp_f32 v22, v22
  v_exp_f32 v23, v23
  v_exp_f32 v24, v24
  v_exp_f32 v25, v25
  v_exp_f32 v26, v26
  v_exp_f32 v27, v27
  v_mfma_f32_32x32x16_bf16 a[0:15], v[56:59], v[36:39], a[0:15]
  v_exp_f32 v28, v28
  v_exp_f32 v29, v29
  v_exp_f32 v30, v30
  v_exp_f32 v31, v31
  v_cvt_pk_bf16_f32 v32, v16, v17
  v_cvt_pk_bf16_f32 v33, v18, v19
  v_cvt_pk_bf16_f32 v34, v20, v21
  v_cvt_pk_bf16_f32 v35, v22, v23
  v_cvt_pk_bf16_f32 v36, v24, v25
  v_cvt_pk_bf16_f32 v37, v26, v27
  v_cvt_pk_bf16_f32 v38, v28, v29
  v_cvt_pk_bf16_f32 v39, v30, v31
  s_waitcnt lgkmcnt(0)
  v_mfma_f32_32x32x16_bf16 a[0:15], v[60:63], v[32:35], a[0:15]
  v_mfma_f32_32x32x16_bf16 a[0:15], v[64:67], v[36:39], a[0:15]
  s_nop 7
  s_nop 7
  s_nop 3
  v_and_b32 v81, 15, v78
  v_lshlrev_b32 v81, 4, v81
  v_bfe_u32 v82, v78, 4, 1
  s_lshl_b32 s24, s18, 1
  v_add_u32 v82, s24, v82
  v_mul_u32_u24 v82, 18432, v82
  v_add_u32 v81, v81, v82
  s_mul_i32 s24, s19, 18
  v_lshrrev_b32 v82, 5, v78
  v_lshlrev_b32 v82, 2, v82
  v_add_u32 v82, s24, v82
  v_add_u32 v83, 0, v82
  v_lshrrev_b32 v84, 3, v83
  v_lshlrev_b32 v84, 8, v84
  v_and_b32 v83, 7, v83
  v_lshl_add_u32 v84, v83, 1, v84
  v_add_u32 v88, v84, v81
  v_add_u32 v83, 2, v82
  v_lshrrev_b32 v84, 3, v83
  v_lshlrev_b32 v84, 8, v84
  v_and_b32 v83, 7, v83
  v_lshl_add_u32 v84, v83, 1, v84
  v_add_u32 v89, v84, v81
  v_add_u32 v83, 8, v82
  v_lshrrev_b32 v84, 3, v83
  v_lshlrev_b32 v84, 8, v84
  v_and_b32 v83, 7, v83
  v_lshl_add_u32 v84, v83, 1, v84
  v_add_u32 v90, v84, v81
  v_add_u32 v83, 10, v82
  v_lshrrev_b32 v84, 3, v83
  v_lshlrev_b32 v84, 8, v84
  v_and_b32 v83, 7, v83
  v_lshl_add_u32 v84, v83, 1, v84
  v_add_u32 v91, v84, v81
  v_add_u32 v83, 16, v82
  v_lshrrev_b32 v84, 3, v83
  v_lshlrev_b32 v84, 8, v84
  v_and_b32 v83, 7, v83
  v_lshl_add_u32 v84, v83, 1, v84
  v_add_u32 v92, v84, v81
  s_mov_b32 s25, 36864
  v_accvgpr_read_b32 v0, a0
  v_accvgpr_read_b32 v1, a1
  v_accvgpr_read_b32 v2, a2
  v_accvgpr_read_b32 v3, a3
  v_accvgpr_read_b32 v4, a4
  v_accvgpr_read_b32 v5, a5
  v_accvgpr_read_b32 v6, a6
  v_accvgpr_read_b32 v7, a7
  v_accvgpr_read_b32 v8, a8
  v_accvgpr_read_b32 v9, a9
  v_accvgpr_read_b32 v10, a10
  s_nop 0
  v_mov_b32 v79, v10
  v_mov_b32 v80, v10
  s_nop 1
  v_permlane32_swap_b32 v79, v80
  s_nop 1
  v_rcp_f32 v79, v79
  s_nop 0
  v_mul_f32 v0, v0, v79
  v_mul_f32 v1, v1, v79
  v_cvt_pk_bf16_f32 v32, v0, v1
  buffer_store_dword v32, v88, s[40:43], 0 offen
  v_mul_f32 v2, v2, v79
  v_mul_f32 v3, v3, v79
  v_cvt_pk_bf16_f32 v33, v2, v3
  buffer_store_dword v33, v89, s[40:43], 0 offen
  v_mul_f32 v4, v4, v79
  v_mul_f32 v5, v5, v79
  v_cvt_pk_bf16_f32 v34, v4, v5
  buffer_store_dword v34, v90, s[40:43], 0 offen
  v_mul_f32 v6, v6, v79
  v_mul_f32 v7, v7, v79
  v_cvt_pk_bf16_f32 v35, v6, v7
  buffer_store_dword v35, v91, s[40:43], 0 offen
  v_mul_f32 v8, v8, v79
  v_mul_f32 v9, v9, v79
  v_cvt_pk_bf16_f32 v36, v8, v9
  s_mov_b32 exec_hi, 0
  buffer_store_dword v36, v92, s[40:43], 0 offen
  s_mov_b64 exec, -1
  s_endpgm
k2_kernel_END:
  s_endpgm
.globl k3_kernel
.p2align 8
.type k3_kernel,@function
k3_kernel:
  s_cmp_ge_u32 s2, 256
  s_cbranch_scc1 k3_kernel_END
  v_mov_b32 v63, v0
  s_load_dwordx2 s[8:9], s[0:1], 16
  s_load_dwordx2 s[10:11], s[0:1], 56
  s_load_dwordx2 s[12:13], s[0:1], 72
  s_load_dwordx2 s[16:17], s[0:1], 88
  v_lshrrev_b32 v56, 6, v63
  s_nop 0
  v_readfirstlane_b32 s21, v56
  s_and_b32 s18, s2, 7
  s_lshr_b32 s19, s2, 3
  s_and_b32 s23, s19, 3
  s_lshr_b32 s24, s19, 2
  s_lshl_b32 s18, s18, 3
  s_add_u32 s24, s24, s18
  s_mul_i32 s44, s24, 2*18*1024
  s_mul_i32 s26, s23, 288
  s_waitcnt lgkmcnt(0)
  s_add_u32 s28, s16, 26488832
  s_addc_u32 s29, s17, 0
  s_mov_b32 s30, 2359296
  s_mov_b32 s31, 0x20000
  s_mov_b32 s32, s8
  s_mov_b32 s33, s9
  s_mov_b32 s34, 663552
  s_mov_b32 s35, 0x20000
  s_add_u32 s36, s16, 28848128
  s_addc_u32 s37, s17, 0
  s_mov_b32 s38, 9437184
  s_mov_b32 s39, 0x20000
  s_mov_b32 s40, s12
  s_mov_b32 s41, s13
  s_mov_b32 s42, 2359296
  s_mov_b32 s43, 0x20000
  s_add_u32 s48, s16, 26480640
  s_addc_u32 s49, s17, 0
  s_mov_b32 s50, 8192
  s_mov_b32 s51, 0x20000
  s_mov_b32 s56, s10
  s_mov_b32 s57, s11
  s_mov_b32 s58, 1152
  s_mov_b32 s59, 0x20000
  v_and_b32 v56, 63, v63
  v_lshlrev_b32 v41, 4, v56
  v_add_u32 v42, 18432, v41
  v_and_b32 v57, 63, v63
  s_mul_i32 s52, s21, 192
  v_add_u32 v58, s52, v57
  v_min_u32 v58, 575, v58
  v_mul_u32_u24 v59, 3641, v58
  v_lshrrev_b32 v59, 16, v59
  v_mul_u32_u24 v60, 18, v59
  v_sub_u32 v60, v58, v60
  v_bfe_u32 v61, v59, 2, 2
  v_lshlrev_b32 v61, 3, v61
  v_and_b32 v58, 3, v59
  v_add_u32 v61, v61, v58
  v_lshrrev_b32 v58, 4, v59
  v_lshl_add_u32 v61, v58, 2, v61
  v_mul_u32_u24 v61, 1152, v61
  v_lshl_add_u32 v61, v60, 4, v61
  v_mov_b32 v36, v61
  v_add_u32 v58, s52, v57
  v_add_u32 v58, 64, v58
  v_min_u32 v58, 575, v58
  v_mul_u32_u24 v59, 3641, v58
  v_lshrrev_b32 v59, 16, v59
  v_mul_u32_u24 v60, 18, v59
  v_sub_u32 v60, v58, v60
  v_bfe_u32 v61, v59, 2, 2
  v_lshlrev_b32 v61, 3, v61
  v_and_b32 v58, 3, v59
  v_add_u32 v61, v61, v58
  v_lshrrev_b32 v58, 4, v59
  v_lshl_add_u32 v61, v58, 2, v61
  v_mul_u32_u24 v61, 1152, v61
  v_lshl_add_u32 v61, v60, 4, v61
  v_subrev_u32 v37, 1024, v61
  v_add_u32 v58, s52, v57
  v_add_u32 v58, 128, v58
  v_min_u32 v58, 575, v58
  v_mul_u32_u24 v59, 3641, v58
  v_lshrrev_b32 v59, 16, v59
  v_mul_u32_u24 v60, 18, v59
  v_sub_u32 v60, v58, v60
  v_bfe_u32 v61, v59, 2, 2
  v_lshlrev_b32 v61, 3, v61
  v_and_b32 v58, 3, v59
  v_add_u32 v61, v61, v58
  v_lshrrev_b32 v58, 4, v59
  v_lshl_add_u32 v61, v58, 2, v61
  v_mul_u32_u24 v61, 1152, v61
  v_lshl_add_u32 v61, v60, 4, v61
  v_subrev_u32 v38, 2048, v61
  s_lshl_b32 s52, s52, 4
  s_add_u32 s52, s52, 0
  v_lshrrev_b32 v58, 2, v57
  v_mul_u32_u24 v58, 288, v58
  v_and_b32 v59, 3, v57
  v_lshl_add_u32 v43, v59, 3, v58
  s_mul_i32 s54, s21, 96
  v_add_u32 v43, s54, v43
  s_add_u32 m0, s52, 0
  s_nop 0
  buffer_load_dwordx4 v36, s[32:35], s26 offen offset:0 lds
  buffer_load_dwordx4 v37, s[32:35], s26 offen offset:1024 lds
  buffer_load_dwordx4 v38, s[32:35], s26 offen offset:2048 lds
  s_add_u32 s26, s26, 36864
  s_add_u32 m0, s52, 9216
  s_nop 0
  buffer_load_dwordx4 v36, s[32:35], s26 offen offset:0 lds
  buffer_load_dwordx4 v37, s[32:35], s26 offen offset:1024 lds
  buffer_load_dwordx4 v38, s[32:35], s26 offen offset:2048 lds
  s_add_u32 s26, s26, 36864
  buffer_load_dwordx4 v[64:67], v41, s[28:31], s44 offen
  buffer_load_dwordx4 v[68:71], v42, s[28:31], s44 offen
  s_add_u32 s44, s44, 1024
  s_add_u32 m0, s52, 18432
  s_nop 0
  buffer_load_dwordx4 v36, s[32:35], s26 offen offset:0 lds
  buffer_load_dwordx4 v37, s[32:35], s26 offen offset:1024 lds
  buffer_load_dwordx4 v38, s[32:35], s26 offen offset:2048 lds
  s_add_u32 s26, s26, 36864
  buffer_load_dwordx4 v[72:75], v41, s[28:31], s44 offen
  buffer_load_dwordx4 v[76:79], v42, s[28:31], s44 offen
  s_add_u32 s44, s44, 1024
  s_add_u32 m0, s52, 27648
  s_nop 0
  buffer_load_dwordx4 v36, s[32:35], s26 offen offset:0 lds
  buffer_load_dwordx4 v37, s[32:35], s26 offen offset:1024 lds
  buffer_load_dwordx4 v38, s[32:35], s26 offen offset:2048 lds
  s_add_u32 s26, s26, 36864
  buffer_load_dwordx4 v[80:83], v41, s[28:31], s44 offen
  buffer_load_dwordx4 v[84:87], v42, s[28:31], s44 offen
  s_add_u32 s44, s44, 1024
  s_add_u32 m0, s52, 36864
  s_nop 0
  buffer_load_dwordx4 v36, s[32:35], s26 offen offset:0 lds
  buffer_load_dwordx4 v37, s[32:35], s26 offen offset:1024 lds
  buffer_load_dwordx4 v38, s[32:35], s26 offen offset:2048 lds
  s_add_u32 s26, s26, 36864
  buffer_load_dwordx4 v[88:91], v41, s[28:31], s44 offen
  buffer_load_dwordx4 v[92:95], v42, s[28:31], s44 offen
  s_add_u32 s44, s44, 1024
  s_add_u32 m0, s52, 46080
  s_nop 0
  buffer_load_dwordx4 v36, s[32:35], s26 offen offset:0 lds
  buffer_load_dwordx4 v37, s[32:35], s26 offen offset:1024 lds
  buffer_load_dwordx4 v38, s[32:35], s26 offen offset:2048 lds
  s_add_u32 s26, s26, 36864
  buffer_load_dwordx4 v[96:99], v41, s[28:31], s44 offen
  buffer_load_dwordx4 v[100:103], v42, s[28:31], s44 offen
  s_add_u32 s44, s44, 1024
  v_mov_b32 v0, 0
  v_mov_b32 v1, 0
  v_mov_b32 v2, 0
  v_mov_b32 v3, 0
  v_mov_b32 v4, 0
  v_mov_b32 v5, 0
  v_mov_b32 v6, 0
  v_mov_b32 v7, 0
  v_mov_b32 v8, 0
  v_mov_b32 v9, 0
  v_mov_b32 v10, 0
  v_mov_b32 v11, 0
  v_mov_b32 v12, 0
  v_mov_b32 v13, 0
  v_mov_b32 v14, 0
  v_mov_b32 v15, 0
  v_mov_b32 v16, 0
  v_mov_b32 v17, 0
  v_mov_b32 v18, 0
  v_mov_b32 v19, 0
  v_mov_b32 v20, 0
  v_mov_b32 v21, 0
  v_mov_b32 v22, 0
  v_mov_b32 v23, 0
  s_mul_i32 s45, s24, 72
  s_mul_i32 s46, s23, 9
  s_add_u32 s45, s45, s46
  s_mul_i32 s46, s21, 3
  s_add_u32 s45, s45, s46
  s_lshl_b32 s45, s45, 9
  v_lshlrev_b32 v57, 3, v56
  s_add_u32 s46, s45, 0
  buffer_load_dwordx2 v[128:129], v57, s[36:39], s46 offen offset:0
  buffer_load_dwordx2 v[144:145], v57, s[36:39], s46 offen offset:512
  buffer_load_dwordx2 v[160:161], v57, s[36:39], s46 offen offset:1024
  s_add_u32 s46, s45, 18432
  buffer_load_dwordx2 v[176:177], v57, s[36:39], s46 offen offset:0
  buffer_load_dwordx2 v[192:193], v57, s[36:39], s46 offen offset:512
  buffer_load_dwordx2 v[208:209], v57, s[36:39], s46 offen offset:1024
  s_add_u32 s46, s45, 2359296
  buffer_load_dwordx2 v[130:131], v57, s[36:39], s46 offen offset:0
  buffer_load_dwordx2 v[146:147], v57, s[36:39], s46 offen offset:512
  buffer_load_dwordx2 v[162:163], v57, s[36:39], s46 offen offset:1024
  s_add_u32 s46, s45, 2377728
  buffer_load_dwordx2 v[178:179], v57, s[36:39], s46 offen offset:0
  buffer_load_dwordx2 v[194:195], v57, s[36:39], s46 offen offset:512
  buffer_load_dwordx2 v[210:211], v57, s[36:39], s46 offen offset:1024
  s_add_u32 s46, s45, 4718592
  buffer_load_dwordx2 v[132:133], v57, s[36:39], s46 offen offset:0
  buffer_load_dwordx2 v[148:149], v57, s[36:39], s46 offen offset:512
  buffer_load_dwordx2 v[164:165], v57, s[36:39], s46 offen offset:1024
  s_add_u32 s46, s45, 4737024
  buffer_load_dwordx2 v[180:181], v57, s[36:39], s46 offen offset:0
  buffer_load_dwordx2 v[196:197], v57, s[36:39], s46 offen offset:512
  buffer_load_dwordx2 v[212:213], v57, s[36:39], s46 offen offset:1024
  s_add_u32 s46, s45, 7077888
  buffer_load_dwordx2 v[134:135], v57, s[36:39], s46 offen offset:0
  buffer_load_dwordx2 v[150:151], v57, s[36:39], s46 offen offset:512
  buffer_load_dwordx2 v[166:167], v57, s[36:39], s46 offen offset:1024
  s_add_u32 s46, s45, 7096320
  buffer_load_dwordx2 v[182:183], v57, s[36:39], s46 offen offset:0
  buffer_load_dwordx2 v[198:199], v57, s[36:39], s46 offen offset:512
  buffer_load_dwordx2 v[214:215], v57, s[36:39], s46 offen offset:1024
  v_and_b32 v58, 15, v56
  s_lshl_b32 s46, s24, 5
  v_add_u32 v58, s46, v58
  v_lshlrev_b32 v59, 2, v58
  buffer_load_dword v47, v59, s[48:51], 0 offen
  buffer_load_dword v48, v59, s[48:51], 0 offen offset:64
  s_mul_i32 s46, s21, 96
  s_add_u32 s47, s46, s23
  s_mul_i32 s47, s23, 288
  s_add_u32 s47, s47, s46
  v_lshrrev_b32 v59, 4, v56
  v_lshlrev_b32 v59, 3, v59
  v_add_u32 v59, s47, v59
  buffer_load_dwordx2 v[50:51], v59, s[56:59], 0 offen offset:0
  buffer_load_dwordx2 v[52:53], v59, s[56:59], 0 offen offset:32
  buffer_load_dwordx2 v[54:55], v59, s[56:59], 0 offen offset:64
  v_mul_u32_u24 v45, 1152, v58
  v_add_u32 v45, v45, v59
  v_add_u32 v46, 18432, v45
  s_waitcnt vmcnt(54)
  s_barrier
  ds_read_b64_tr_b16 v[24:25], v43 offset:0
  ds_read_b64_tr_b16 v[26:27], v43 offset:4608
  ds_read_b64_tr_b16 v[28:29], v43 offset:32
  ds_read_b64_tr_b16 v[30:31], v43 offset:4640
  ds_read_b64_tr_b16 v[32:33], v43 offset:64
  ds_read_b64_tr_b16 v[34:35], v43 offset:4672
  s_waitcnt vmcnt(49)
  s_barrier
  s_waitcnt lgkmcnt(4)
  v_mfma_f32_16x16x32_bf16 v[0:3], v[24:27], v[64:67], v[0:3]
  s_add_u32 m0, s52, 55296
  s_nop 0
  buffer_load_dwordx4 v36, s[32:35], s26 offen offset:0 lds
  buffer_load_dwordx4 v37, s[32:35], s26 offen offset:1024 lds
  v_mfma_f32_16x16x32_bf16 v[12:15], v[24:27], v[68:71], v[12:15]
  ds_read_b64_tr_b16 v[24:25], v43 offset:9216
  ds_read_b64_tr_b16 v[26:27], v43 offset:13824
  s_waitcnt lgkmcnt(4)
  v_mfma_f32_16x16x32_bf16 v[4:7], v[28:31], v[64:67], v[4:7]
  buffer_load_dwordx4 v38, s[32:35], s26 offen offset:2048 lds
  s_add_u32 s26, s26, 36864
  buffer_load_dwordx4 v[104:107], v41, s[28:31], s44 offen
  v_mfma_f32_16x16x32_bf16 v[16:19], v[28:31], v[68:71], v[16:19]
  ds_read_b64_tr_b16 v[28:29], v43 offset:9248
  ds_read_b64_tr_b16 v[30:31], v43 offset:13856
  s_waitcnt lgkmcnt(4)
  v_mfma_f32_16x16x32_bf16 v[8:11], v[32:35], v[64:67], v[8:11]
  buffer_load_dwordx4 v[108:111], v42, s[28:31], s44 offen
  s_add_u32 s44, s44, 1024
  v_mfma_f32_16x16x32_bf16 v[20:23], v[32:35], v[68:71], v[20:23]
  ds_read_b64_tr_b16 v[32:33], v43 offset:9280
  ds_read_b64_tr_b16 v[34:35], v43 offset:13888
  s_waitcnt vmcnt(49)
  s_barrier
  s_waitcnt lgkmcnt(4)
  v_mfma_f32_16x16x32_bf16 v[0:3], v[24:27], v[72:75], v[0:3]
  s_add_u32 m0, s52, 0
  s_nop 0
  buffer_load_dwordx4 v36, s[32:35], s26 offen offset:0 lds
  buffer_load_dwordx4 v37, s[32:35], s26 offen offset:1024 lds
  v_mfma_f32_16x16x32_bf16 v[12:15], v[24:27], v[76:79], v[12:15]
  ds_read_b64_tr_b16 v[24:25], v43 offset:18432
  ds_read_b64_tr_b16 v[26:27], v43 offset:23040
  s_waitcnt lgkmcnt(4)
  v_mfma_f32_16x16x32_bf16 v[4:7], v[28:31], v[72:75], v[4:7]
  buffer_load_dwordx4 v38, s[32:35], s26 offen offset:2048 lds
  s_add_u32 s26, s26, 36864
  buffer_load_dwordx4 v[64:67], v41, s[28:31], s44 offen
  v_mfma_f32_16x16x32_bf16 v[16:19], v[28:31], v[76:79], v[16:19]
  ds_read_b64_tr_b16 v[28:29], v43 offset:18464
  ds_read_b64_tr_b16 v[30:31], v43 offset:23072
  s_waitcnt lgkmcnt(4)
  v_mfma_f32_16x16x32_bf16 v[8:11], v[32:35], v[72:75], v[8:11]
  buffer_load_dwordx4 v[68:71], v42, s[28:31], s44 offen
  s_add_u32 s44, s44, 1024
  v_mfma_f32_16x16x32_bf16 v[20:23], v[32:35], v[76:79], v[20:23]
  ds_read_b64_tr_b16 v[32:33], v43 offset:18496
  ds_read_b64_tr_b16 v[34:35], v43 offset:23104
  s_waitcnt vmcnt(49)
  s_barrier
  s_waitcnt lgkmcnt(4)
  v_mfma_f32_16x16x32_bf16 v[0:3], v[24:27], v[80:83], v[0:3]
  s_add_u32 m0, s52, 9216
  s_nop 0
  buffer_load_dwordx4 v36, s[32:35], s26 offen offset:0 lds
  buffer_load_dwordx4 v37, s[32:35], s26 offen offset:1024 lds
  v_mfma_f32_16x16x32_bf16 v[12:15], v[24:27], v[84:87], v[12:15]
  ds_read_b64_tr_b16 v[24:25], v43 offset:27648
  ds_read_b64_tr_b16 v[26:27], v43 offset:32256
  s_waitcnt lgkmcnt(4)
  v_mfma_f32_16x16x32_bf16 v[4:7], v[28:31], v[80:83], v[4:7]
  buffer_load_dwordx4 v38, s[32:35], s26 offen offset:2048 lds
  s_add_u32 s26, s26, 36864
  buffer_load_dwordx4 v[72:75], v41, s[28:31], s44 offen
  v_mfma_f32_16x16x32_bf16 v[16:19], v[28:31], v[84:87], v[16:19]
  ds_read_b64_tr_b16 v[28:29], v43 offset:27680
  ds_read_b64_tr_b16 v[30:31], v43 offset:32288
  s_waitcnt lgkmcnt(4)
  v_mfma_f32_16x16x32_bf16 v[8:11], v[32:35], v[80:83], v[8:11]
  buffer_load_dwordx4 v[76:79], v42, s[28:31], s44 offen
  s_add_u32 s44, s44, 1024
  v_mfma_f32_16x16x32_bf16 v[20:23], v[32:35], v[84:87], v[20:23]
  ds_read_b64_tr_b16 v[32:33], v43 offset:27712
  ds_read_b64_tr_b16 v[34:35], v43 offset:32320
  s_waitcnt vmcnt(49)
  s_barrier
  s_waitcnt lgkmcnt(4)
  v_mfma_f32_16x16x32_bf16 v[0:3], v[24:27], v[88:91], v[0:3]
  s_add_u32 m0, s52, 18432
  s_nop 0
  buffer_load_dwordx4 v36, s[32:35], s26 offen offset:0 lds
  buffer_load_dwordx4 v37, s[32:35], s26 offen offset:1024 lds
  v_mfma_f32_16x16x32_bf16 v[12:15], v[24:27], v[92:95], v[12:15]
  ds_read_b64_tr_b16 v[24:25], v43 offset:36864
  ds_read_b64_tr_b16 v[26:27], v43 offset:41472
  s_waitcnt lgkmcnt(4)
  v_mfma_f32_16x16x32_bf16 v[4:7], v[28:31], v[88:91], v[4:7]
  buffer_load_dwordx4 v38, s[32:35], s26 offen offset:2048 lds
  s_add_u32 s26, s26, 36864
  buffer_load_dwordx4 v[80:83], v41, s[28:31], s44 offen
  v_mfma_f32_16x16x32_bf16 v[16:19], v[28:31], v[92:95], v[16:19]
  ds_read_b64_tr_b16 v[28:29], v43 offset:36896
  ds_read_b64_tr_b16 v[30:31], v43 offset:41504
  s_waitcnt lgkmcnt(4)
  v_mfma_f32_16x16x32_bf16 v[8:11], v[32:35], v[88:91], v[8:11]
  buffer_load_dwordx4 v[84:87], v42, s[28:31], s44 offen
  s_add_u32 s44, s44, 1024
  v_mfma_f32_16x16x32_bf16 v[20:23], v[32:35], v[92:95], v[20:23]
  ds_read_b64_tr_b16 v[32:33], v43 offset:36928
  ds_read_b64_tr_b16 v[34:35], v43 offset:41536
  s_waitcnt vmcnt(49)
  s_barrier
  s_waitcnt lgkmcnt(4)
  v_mfma_f32_16x16x32_bf16 v[0:3], v[24:27], v[96:99], v[0:3]
  s_add_u32 m0, s52, 27648
  s_nop 0
  buffer_load_dwordx4 v36, s[32:35], s26 offen offset:0 lds
  buffer_load_dwordx4 v37, s[32:35], s26 offen offset:1024 lds
  v_mfma_f32_16x16x32_bf16 v[12:15], v[24:27], v[100:103], v[12:15]
  ds_read_b64_tr_b16 v[24:25], v43 offset:46080
  ds_read_b64_tr_b16 v[26:27], v43 offset:50688
  s_waitcnt lgkmcnt(4)
  v_mfma_f32_16x16x32_bf16 v[4:7], v[28:31], v[96:99], v[4:7]
  buffer_load_dwordx4 v38, s[32:35], s26 offen offset:2048 lds
  s_add_u32 s26, s26, 36864
  buffer_load_dwordx4 v[88:91], v41, s[28:31], s44 offen
  v_mfma_f32_16x16x32_bf16 v[16:19], v[28:31], v[100:103], v[16:19]
  ds_read_b64_tr_b16 v[28:29], v43 offset:46112
  ds_read_b64_tr_b16 v[30:31], v43 offset:50720
  s_waitcnt lgkmcnt(4)
  v_mfma_f32_16x16x32_bf16 v[8:11], v[32:35], v[96:99], v[8:11]
  buffer_load_dwordx4 v[92:95], v42, s[28:31], s44 offen
  s_add_u32 s44, s44, 1024
  v_mfma_f32_16x16x32_bf16 v[20:23], v[32:35], v[100:103], v[20:23]
  ds_read_b64_tr_b16 v[32:33], v43 offset:46144
  ds_read_b64_tr_b16 v[34:35], v43 offset:50752
  s_waitcnt vmcnt(20)
  s_barrier
  s_waitcnt lgkmcnt(4)
  v_mfma_f32_16x16x32_bf16 v[0:3], v[24:27], v[104:107], v[0:3]
  s_add_u32 m0, s52, 36864
  s_nop 0
  buffer_load_dwordx4 v36, s[32:35], s26 offen offset:0 lds
  buffer_load_dwordx4 v37, s[32:35], s26 offen offset:1024 lds
  v_mfma_f32_16x16x32_bf16 v[12:15], v[24:27], v[108:111], v[12:15]
  ds_read_b64_tr_b16 v[24:25], v43 offset:55296
  ds_read_b64_tr_b16 v[26:27], v43 offset:59904
  s_waitcnt lgkmcnt(4)
  v_mfma_f32_16x16x32_bf16 v[4:7], v[28:31], v[104:107], v[4:7]
  buffer_load_dwordx4 v38, s[32:35], s26 offen offset:2048 lds
  s_add_u32 s26, s26, 36864
  buffer_load_dwordx4 v[96:99], v41, s[28:31], s44 offen
  v_mfma_f32_16x16x32_bf16 v[16:19], v[28:31], v[108:111], v[16:19]
  ds_read_b64_tr_b16 v[28:29], v43 offset:55328
  ds_read_b64_tr_b16 v[30:31], v43 offset:59936
  s_waitcnt lgkmcnt(4)
  v_mfma_f32_16x16x32_bf16 v[8:11], v[32:35], v[104:107], v[8:11]
  buffer_load_dwordx4 v[100:103], v42, s[28:31], s44 offen
  s_add_u32 s44, s44, 1024
  v_mfma_f32_16x16x32_bf16 v[20:23], v[32:35], v[108:111], v[20:23]
  ds_read_b64_tr_b16 v[32:33], v43 offset:55360
  ds_read_b64_tr_b16 v[34:35], v43 offset:59968
  s_waitcnt vmcnt(20)
  s_barrier
  s_waitcnt lgkmcnt(4)
  v_mfma_f32_16x16x32_bf16 v[0:3], v[24:27], v[64:67], v[0:3]
  s_add_u32 m0, s52, 46080
  s_nop 0
  buffer_load_dwordx4 v36, s[32:35], s26 offen offset:0 lds
  buffer_load_dwordx4 v37, s[32:35], s26 offen offset:1024 lds
  v_mfma_f32_16x16x32_bf16 v[12:15], v[24:27], v[68:71], v[12:15]
  ds_read_b64_tr_b16 v[24:25], v43 offset:0
  ds_read_b64_tr_b16 v[26:27], v43 offset:4608
  s_waitcnt lgkmcnt(4)
  v_mfma_f32_16x16x32_bf16 v[4:7], v[28:31], v[64:67], v[4:7]
  buffer_load_dwordx4 v38, s[32:35], s26 offen offset:2048 lds
  s_add_u32 s26, s26, 36864
  buffer_load_dwordx4 v[104:107], v41, s[28:31], s44 offen
  v_mfma_f32_16x16x32_bf16 v[16:19], v[28:31], v[68:71], v[16:19]
  ds_read_b64_tr_b16 v[28:29], v43 offset:32
  ds_read_b64_tr_b16 v[30:31], v43 offset:4640
  s_waitcnt lgkmcnt(4)
  v_mfma_f32_16x16x32_bf16 v[8:11], v[32:35], v[64:67], v[8:11]
  buffer_load_dwordx4 v[108:111], v42, s[28:31], s44 offen
  s_add_u32 s44, s44, 1024
  v_mfma_f32_16x16x32_bf16 v[20:23], v[32:35], v[68:71], v[20:23]
  ds_read_b64_tr_b16 v[32:33], v43 offset:64
  ds_read_b64_tr_b16 v[34:35], v43 offset:4672
  s_waitcnt vmcnt(20)
  s_barrier
  s_waitcnt lgkmcnt(4)
  v_mfma_f32_16x16x32_bf16 v[0:3], v[24:27], v[72:75], v[0:3]
  s_add_u32 m0, s52, 55296
  s_nop 0
  buffer_load_dwordx4 v36, s[32:35], s26 offen offset:0 lds
  buffer_load_dwordx4 v37, s[32:35], s26 offen offset:1024 lds
  v_mfma_f32_16x16x32_bf16 v[12:15], v[24:27], v[76:79], v[12:15]
  ds_read_b64_tr_b16 v[24:25], v43 offset:9216
  ds_read_b64_tr_b16 v[26:27], v43 offset:13824
  s_waitcnt lgkmcnt(4)
  v_mfma_f32_16x16x32_bf16 v[4:7], v[28:31], v[72:75], v[4:7]
  buffer_load_dwordx4 v38, s[32:35], s26 offen offset:2048 lds
  s_add_u32 s26, s26, 36864
  buffer_load_dwordx4 v[64:67], v41, s[28:31], s44 offen
  v_mfma_f32_16x16x32_bf16 v[16:19], v[28:31], v[76:79], v[16:19]
  ds_read_b64_tr_b16 v[28:29], v43 offset:9248
  ds_read_b64_tr_b16 v[30:31], v43 offset:13856
  s_waitcnt lgkmcnt(4)
  v_mfma_f32_16x16x32_bf16 v[8:11], v[32:35], v[72:75], v[8:11]
  buffer_load_dwordx4 v[68:71], v42, s[28:31], s44 offen
  s_add_u32 s44, s44, 1024
  v_mfma_f32_16x16x32_bf16 v[20:23], v[32:35], v[76:79], v[20:23]
  ds_read_b64_tr_b16 v[32:33], v43 offset:9280
  ds_read_b64_tr_b16 v[34:35], v43 offset:13888
  s_waitcnt vmcnt(20)
  s_barrier
  s_waitcnt lgkmcnt(4)
  v_mfma_f32_16x16x32_bf16 v[0:3], v[24:27], v[80:83], v[0:3]
  s_add_u32 m0, s52, 0
  s_nop 0
  buffer_load_dwordx4 v36, s[32:35], s26 offen offset:0 lds
  buffer_load_dwordx4 v37, s[32:35], s26 offen offset:1024 lds
  v_mfma_f32_16x16x32_bf16 v[12:15], v[24:27], v[84:87], v[12:15]
  ds_read_b64_tr_b16 v[24:25], v43 offset:18432
  ds_read_b64_tr_b16 v[26:27], v43 offset:23040
  s_waitcnt lgkmcnt(4)
  v_mfma_f32_16x16x32_bf16 v[4:7], v[28:31], v[80:83], v[4:7]
  buffer_load_dwordx4 v38, s[32:35], s26 offen offset:2048 lds
  s_add_u32 s26, s26, 36864
  buffer_load_dwordx4 v[72:75], v41, s[28:31], s44 offen
  v_mfma_f32_16x16x32_bf16 v[16:19], v[28:31], v[84:87], v[16:19]
  ds_read_b64_tr_b16 v[28:29], v43 offset:18464
  ds_read_b64_tr_b16 v[30:31], v43 offset:23072
  s_waitcnt lgkmcnt(4)
  v_mfma_f32_16x16x32_bf16 v[8:11], v[32:35], v[80:83], v[8:11]
  buffer_load_dwordx4 v[76:79], v42, s[28:31], s44 offen
  s_add_u32 s44, s44, 1024
  v_mfma_f32_16x16x32_bf16 v[20:23], v[32:35], v[84:87], v[20:23]
  ds_read_b64_tr_b16 v[32:33], v43 offset:18496
  ds_read_b64_tr_b16 v[34:35], v43 offset:23104
  s_waitcnt vmcnt(20)
  s_barrier
  s_waitcnt lgkmcnt(4)
  v_mfma_f32_16x16x32_bf16 v[0:3], v[24:27], v[88:91], v[0:3]
  s_add_u32 m0, s52, 9216
  s_nop 0
  buffer_load_dwordx4 v36, s[32:35], s26 offen offset:0 lds
  buffer_load_dwordx4 v37, s[32:35], s26 offen offset:1024 lds
  v_mfma_f32_16x16x32_bf16 v[12:15], v[24:27], v[92:95], v[12:15]
  ds_read_b64_tr_b16 v[24:25], v43 offset:27648
  ds_read_b64_tr_b16 v[26:27], v43 offset:32256
  s_waitcnt lgkmcnt(4)
  v_mfma_f32_16x16x32_bf16 v[4:7], v[28:31], v[88:91], v[4:7]
  buffer_load_dwordx4 v38, s[32:35], s26 offen offset:2048 lds
  s_add_u32 s26, s26, 36864
  buffer_load_dwordx4 v[80:83], v41, s[28:31], s44 offen
  v_mfma_f32_16x16x32_bf16 v[16:19], v[28:31], v[92:95], v[16:19]
  ds_read_b64_tr_b16 v[28:29], v43 offset:27680
  ds_read_b64_tr_b16 v[30:31], v43 offset:32288
  s_waitcnt lgkmcnt(4)
  v_mfma_f32_16x16x32_bf16 v[8:11], v[32:35], v[88:91], v[8:11]
  buffer_load_dwordx4 v[84:87], v42, s[28:31], s44 offen
  s_add_u32 s44, s44, 1024
  v_mfma_f32_16x16x32_bf16 v[20:23], v[32:35], v[92:95], v[20:23]
  ds_read_b64_tr_b16 v[32:33], v43 offset:27712
  ds_read_b64_tr_b16 v[34:35], v43 offset:32320
  s_waitcnt vmcnt(20)
  s_barrier
  s_waitcnt lgkmcnt(4)
  v_mfma_f32_16x16x32_bf16 v[0:3], v[24:27], v[96:99], v[0:3]
  s_add_u32 m0, s52, 18432
  s_nop 0
  buffer_load_dwordx4 v36, s[32:35], s26 offen offset:0 lds
  buffer_load_dwordx4 v37, s[32:35], s26 offen offset:1024 lds
  v_mfma_f32_16x16x32_bf16 v[12:15], v[24:27], v[100:103], v[12:15]
  ds_read_b64_tr_b16 v[24:25], v43 offset:36864
  ds_read_b64_tr_b16 v[26:27], v43 offset:41472
  s_waitcnt lgkmcnt(4)
  v_mfma_f32_16x16x32_bf16 v[4:7], v[28:31], v[96:99], v[4:7]
  buffer_load_dwordx4 v38, s[32:35], s26 offen offset:2048 lds
  s_add_u32 s26, s26, 36864
  buffer_load_dwordx4 v[88:91], v41, s[28:31], s44 offen
  v_mfma_f32_16x16x32_bf16 v[16:19], v[28:31], v[100:103], v[16:19]
  ds_read_b64_tr_b16 v[28:29], v43 offset:36896
  ds_read_b64_tr_b16 v[30:31], v43 offset:41504
  s_waitcnt lgkmcnt(4)
  v_mfma_f32_16x16x32_bf16 v[8:11], v[32:35], v[96:99], v[8:11]
  buffer_load_dwordx4 v[92:95], v42, s[28:31], s44 offen
  s_add_u32 s44, s44, 1024
  v_mfma_f32_16x16x32_bf16 v[20:23], v[32:35], v[100:103], v[20:23]
  ds_read_b64_tr_b16 v[32:33], v43 offset:36928
  ds_read_b64_tr_b16 v[34:35], v43 offset:41536
  s_waitcnt vmcnt(20)
  s_barrier
  s_waitcnt lgkmcnt(4)
  v_mfma_f32_16x16x32_bf16 v[0:3], v[24:27], v[104:107], v[0:3]
  s_add_u32 m0, s52, 27648
  s_nop 0
  buffer_load_dwordx4 v36, s[32:35], s26 offen offset:0 lds
  buffer_load_dwordx4 v37, s[32:35], s26 offen offset:1024 lds
  v_mfma_f32_16x16x32_bf16 v[12:15], v[24:27], v[108:111], v[12:15]
  ds_read_b64_tr_b16 v[24:25], v43 offset:46080
  ds_read_b64_tr_b16 v[26:27], v43 offset:50688
  s_waitcnt lgkmcnt(4)
  v_mfma_f32_16x16x32_bf16 v[4:7], v[28:31], v[104:107], v[4:7]
  buffer_load_dwordx4 v38, s[32:35], s26 offen offset:2048 lds
  s_add_u32 s26, s26, 36864
  buffer_load_dwordx4 v[96:99], v41, s[28:31], s44 offen
  v_mfma_f32_16x16x32_bf16 v[16:19], v[28:31], v[108:111], v[16:19]
  ds_read_b64_tr_b16 v[28:29], v43 offset:46112
  ds_read_b64_tr_b16 v[30:31], v43 offset:50720
  s_waitcnt lgkmcnt(4)
  v_mfma_f32_16x16x32_bf16 v[8:11], v[32:35], v[104:107], v[8:11]
  buffer_load_dwordx4 v[100:103], v42, s[28:31], s44 offen
  s_add_u32 s44, s44, 1024
  v_mfma_f32_16x16x32_bf16 v[20:23], v[32:35], v[108:111], v[20:23]
  ds_read_b64_tr_b16 v[32:33], v43 offset:46144
  ds_read_b64_tr_b16 v[34:35], v43 offset:50752
  s_waitcnt vmcnt(20)
  s_barrier
  s_waitcnt lgkmcnt(4)
  v_mfma_f32_16x16x32_bf16 v[0:3], v[24:27], v[64:67], v[0:3]
  buffer_load_dwordx4 v[104:107], v41, s[28:31], s44 offen
  v_mfma_f32_16x16x32_bf16 v[12:15], v[24:27], v[68:71], v[12:15]
  ds_read_b64_tr_b16 v[24:25], v43 offset:55296
  ds_read_b64_tr_b16 v[26:27], v43 offset:59904
  s_waitcnt lgkmcnt(4)
  v_mfma_f32_16x16x32_bf16 v[4:7], v[28:31], v[64:67], v[4:7]
  buffer_load_dwordx4 v[108:111], v42, s[28:31], s44 offen
  s_add_u32 s44, s44, 1024
  v_mfma_f32_16x16x32_bf16 v[16:19], v[28:31], v[68:71], v[16:19]
  ds_read_b64_tr_b16 v[28:29], v43 offset:55328
  ds_read_b64_tr_b16 v[30:31], v43 offset:59936
  s_waitcnt lgkmcnt(4)
  v_mfma_f32_16x16x32_bf16 v[8:11], v[32:35], v[64:67], v[8:11]
  v_mfma_f32_16x16x32_bf16 v[20:23], v[32:35], v[68:71], v[20:23]
  ds_read_b64_tr_b16 v[32:33], v43 offset:55360
  ds_read_b64_tr_b16 v[34:35], v43 offset:59968
  s_waitcnt vmcnt(17)
  s_barrier
  s_waitcnt lgkmcnt(4)
  v_mfma_f32_16x16x32_bf16 v[0:3], v[24:27], v[72:75], v[0:3]
  v_mfma_f32_16x16x32_bf16 v[12:15], v[24:27], v[76:79], v[12:15]
  ds_read_b64_tr_b16 v[24:25], v43 offset:0
  ds_read_b64_tr_b16 v[26:27], v43 offset:4608
  s_waitcnt lgkmcnt(4)
  v_mfma_f32_16x16x32_bf16 v[4:7], v[28:31], v[72:75], v[4:7]
  v_mfma_f32_16x16x32_bf16 v[16:19], v[28:31], v[76:79], v[16:19]
  ds_read_b64_tr_b16 v[28:29], v43 offset:32
  ds_read_b64_tr_b16 v[30:31], v43 offset:4640
  s_waitcnt lgkmcnt(4)
  v_mfma_f32_16x16x32_bf16 v[8:11], v[32:35], v[72:75], v[8:11]
  v_mfma_f32_16x16x32_bf16 v[20:23], v[32:35], v[76:79], v[20:23]
  ds_read_b64_tr_b16 v[32:33], v43 offset:64
  ds_read_b64_tr_b16 v[34:35], v43 offset:4672
  s_waitcnt vmcnt(12)
  s_barrier
  s_waitcnt lgkmcnt(4)
  v_mfma_f32_16x16x32_bf16 v[0:3], v[24:27], v[80:83], v[0:3]
  v_mfma_f32_16x16x32_bf16 v[12:15], v[24:27], v[84:87], v[12:15]
  ds_read_b64_tr_b16 v[24:25], v43 offset:9216
  ds_read_b64_tr_b16 v[26:27], v43 offset:13824
  s_waitcnt lgkmcnt(4)
  v_mfma_f32_16x16x32_bf16 v[4:7], v[28:31], v[80:83], v[4:7]
  v_mfma_f32_16x16x32_bf16 v[16:19], v[28:31], v[84:87], v[16:19]
  ds_read_b64_tr_b16 v[28:29], v43 offset:9248
  ds_read_b64_tr_b16 v[30:31], v43 offset:13856
  s_waitcnt lgkmcnt(4)
  v_mfma_f32_16x16x32_bf16 v[8:11], v[32:35], v[80:83], v[8:11]
  v_mfma_f32_16x16x32_bf16 v[20:23], v[32:35], v[84:87], v[20:23]
  ds_read_b64_tr_b16 v[32:33], v43 offset:9280
  ds_read_b64_tr_b16 v[34:35], v43 offset:13888
  s_waitcnt vmcnt(7)
  s_barrier
  s_waitcnt lgkmcnt(4)
  v_mfma_f32_16x16x32_bf16 v[0:3], v[24:27], v[88:91], v[0:3]
  v_mfma_f32_16x16x32_bf16 v[12:15], v[24:27], v[92:95], v[12:15]
  ds_read_b64_tr_b16 v[24:25], v43 offset:18432
  ds_read_b64_tr_b16 v[26:27], v43 offset:23040
  s_waitcnt lgkmcnt(4)
  v_mfma_f32_16x16x32_bf16 v[4:7], v[28:31], v[88:91], v[4:7]
  v_mfma_f32_16x16x32_bf16 v[16:19], v[28:31], v[92:95], v[16:19]
  ds_read_b64_tr_b16 v[28:29], v43 offset:18464
  ds_read_b64_tr_b16 v[30:31], v43 offset:23072
  s_waitcnt lgkmcnt(4)
  v_mfma_f32_16x16x32_bf16 v[8:11], v[32:35], v[88:91], v[8:11]
  v_mfma_f32_16x16x32_bf16 v[20:23], v[32:35], v[92:95], v[20:23]
  ds_read_b64_tr_b16 v[32:33], v43 offset:18496
  ds_read_b64_tr_b16 v[34:35], v43 offset:23104
  s_waitcnt vmcnt(2)
  s_barrier
  s_waitcnt lgkmcnt(4)
  v_mfma_f32_16x16x32_bf16 v[0:3], v[24:27], v[96:99], v[0:3]
  v_mfma_f32_16x16x32_bf16 v[12:15], v[24:27], v[100:103], v[12:15]
  ds_read_b64_tr_b16 v[24:25], v43 offset:27648
  ds_read_b64_tr_b16 v[26:27], v43 offset:32256
  s_waitcnt lgkmcnt(4)
  v_mfma_f32_16x16x32_bf16 v[4:7], v[28:31], v[96:99], v[4:7]
  v_mfma_f32_16x16x32_bf16 v[16:19], v[28:31], v[100:103], v[16:19]
  ds_read_b64_tr_b16 v[28:29], v43 offset:27680
  ds_read_b64_tr_b16 v[30:31], v43 offset:32288
  s_waitcnt lgkmcnt(4)
  v_mfma_f32_16x16x32_bf16 v[8:11], v[32:35], v[96:99], v[8:11]
  v_mfma_f32_16x16x32_bf16 v[20:23], v[32:35], v[100:103], v[20:23]
  ds_read_b64_tr_b16 v[32:33], v43 offset:27712
  ds_read_b64_tr_b16 v[34:35], v43 offset:32320
  s_waitcnt vmcnt(0)
  s_waitcnt lgkmcnt(4)
  v_mfma_f32_16x16x32_bf16 v[0:3], v[24:27], v[104:107], v[0:3]
  v_mfma_f32_16x16x32_bf16 v[12:15], v[24:27], v[108:111], v[12:15]
  s_waitcnt lgkmcnt(2)
  v_mfma_f32_16x16x32_bf16 v[4:7], v[28:31], v[104:107], v[4:7]
  v_mfma_f32_16x16x32_bf16 v[16:19], v[28:31], v[108:111], v[16:19]
  s_waitcnt lgkmcnt(0)
  v_mfma_f32_16x16x32_bf16 v[8:11], v[32:35], v[104:107], v[8:11]
  v_mfma_f32_16x16x32_bf16 v[20:23], v[32:35], v[108:111], v[20:23]
  s_nop 7
  s_nop 1
  v_sub_f32 v60, 1.0, v47
  v_lshlrev_b32 v24, 16, v50
  v_and_b32 v25, 0xffff0000, v50
  v_lshlrev_b32 v26, 16, v51
  v_and_b32 v27, 0xffff0000, v51
  v_lshlrev_b32 v28, 16, v128
  v_and_b32 v29, 0xffff0000, v128
  v_lshlrev_b32 v30, 16, v129
  v_and_b32 v31, 0xffff0000, v129
  v_pk_add_f32 v[24:25], v[24:25], v[28:29]
  v_pk_add_f32 v[26:27], v[26:27], v[30:31]
  v_lshlrev_b32 v28, 16, v130
  v_and_b32 v29, 0xffff0000, v130
  v_lshlrev_b32 v30, 16, v131
  v_and_b32 v31, 0xffff0000, v131
  v_pk_add_f32 v[24:25], v[24:25], v[28:29]
  v_pk_add_f32 v[26:27], v[26:27], v[30:31]
  v_lshlrev_b32 v28, 16, v132
  v_and_b32 v29, 0xffff0000, v132
  v_lshlrev_b32 v30, 16, v133
  v_and_b32 v31, 0xffff0000, v133
  v_pk_add_f32 v[24:25], v[24:25], v[28:29]
  v_pk_add_f32 v[26:27], v[26:27], v[30:31]
  v_lshlrev_b32 v28, 16, v134
  v_and_b32 v29, 0xffff0000, v134
  v_lshlrev_b32 v30, 16, v135
  v_and_b32 v31, 0xffff0000, v135
  v_pk_add_f32 v[24:25], v[24:25], v[28:29]
  v_pk_add_f32 v[26:27], v[26:27], v[30:31]
  v_mul_f32 v24, v60, v24
  v_fmac_f32 v24, v47, v0
  v_mul_f32 v25, v60, v25
  v_fmac_f32 v25, v47, v1
  v_mul_f32 v26, v60, v26
  v_fmac_f32 v26, v47, v2
  v_mul_f32 v27, v60, v27
  v_fmac_f32 v27, v47, v3
  v_cvt_pk_bf16_f32 v64, v24, v25
  v_cvt_pk_bf16_f32 v65, v26, v27
  buffer_store_dwordx2 v[64:65], v45, s[40:43], 0 offen offset:0
  v_lshlrev_b32 v24, 16, v52
  v_and_b32 v25, 0xffff0000, v52
  v_lshlrev_b32 v26, 16, v53
  v_and_b32 v27, 0xffff0000, v53
  v_lshlrev_b32 v28, 16, v144
  v_and_b32 v29, 0xffff0000, v144
  v_lshlrev_b32 v30, 16, v145
  v_and_b32 v31, 0xffff0000, v145
  v_pk_add_f32 v[24:25], v[24:25], v[28:29]
  v_pk_add_f32 v[26:27], v[26:27], v[30:31]
  v_lshlrev_b32 v28, 16, v146
  v_and_b32 v29, 0xffff0000, v146
  v_lshlrev_b32 v30, 16, v147
  v_and_b32 v31, 0xffff0000, v147
  v_pk_add_f32 v[24:25], v[24:25], v[28:29]
  v_pk_add_f32 v[26:27], v[26:27], v[30:31]
  v_lshlrev_b32 v28, 16, v148
  v_and_b32 v29, 0xffff0000, v148
  v_lshlrev_b32 v30, 16, v149
  v_and_b32 v31, 0xffff0000, v149
  v_pk_add_f32 v[24:25], v[24:25], v[28:29]
  v_pk_add_f32 v[26:27], v[26:27], v[30:31]
  v_lshlrev_b32 v28, 16, v150
  v_and_b32 v29, 0xffff0000, v150
  v_lshlrev_b32 v30, 16, v151
  v_and_b32 v31, 0xffff0000, v151
  v_pk_add_f32 v[24:25], v[24:25], v[28:29]
  v_pk_add_f32 v[26:27], v[26:27], v[30:31]
  v_mul_f32 v24, v60, v24
  v_fmac_f32 v24, v47, v4
  v_mul_f32 v25, v60, v25
  v_fmac_f32 v25, v47, v5
  v_mul_f32 v26, v60, v26
  v_fmac_f32 v26, v47, v6
  v_mul_f32 v27, v60, v27
  v_fmac_f32 v27, v47, v7
  v_cvt_pk_bf16_f32 v66, v24, v25
  v_cvt_pk_bf16_f32 v67, v26, v27
  buffer_store_dwordx2 v[66:67], v45, s[40:43], 0 offen offset:32
  v_lshlrev_b32 v24, 16, v54
  v_and_b32 v25, 0xffff0000, v54
  v_lshlrev_b32 v26, 16, v55
  v_and_b32 v27, 0xffff0000, v55
  v_lshlrev_b32 v28, 16, v160
  v_and_b32 v29, 0xffff0000, v160
  v_lshlrev_b32 v30, 16, v161
  v_and_b32 v31, 0xffff0000, v161
  v_pk_add_f32 v[24:25], v[24:25], v[28:29]
  v_pk_add_f32 v[26:27], v[26:27], v[30:31]
  v_lshlrev_b32 v28, 16, v162
  v_and_b32 v29, 0xffff0000, v162
  v_lshlrev_b32 v30, 16, v163
  v_and_b32 v31, 0xffff0000, v163
  v_pk_add_f32 v[24:25], v[24:25], v[28:29]
  v_pk_add_f32 v[26:27], v[26:27], v[30:31]
  v_lshlrev_b32 v28, 16, v164
  v_and_b32 v29, 0xffff0000, v164
  v_lshlrev_b32 v30, 16, v165
  v_and_b32 v31, 0xffff0000, v165
  v_pk_add_f32 v[24:25], v[24:25], v[28:29]
  v_pk_add_f32 v[26:27], v[26:27], v[30:31]
  v_lshlrev_b32 v28, 16, v166
  v_and_b32 v29, 0xffff0000, v166
  v_lshlrev_b32 v30, 16, v167
  v_and_b32 v31, 0xffff0000, v167
  v_pk_add_f32 v[24:25], v[24:25], v[28:29]
  v_pk_add_f32 v[26:27], v[26:27], v[30:31]
  v_mul_f32 v24, v60, v24
  v_fmac_f32 v24, v47, v8
  v_mul_f32 v25, v60, v25
  v_fmac_f32 v25, v47, v9
  v_mul_f32 v26, v60, v26
  v_fmac_f32 v26, v47, v10
  v_mul_f32 v27, v60, v27
  v_fmac_f32 v27, v47, v11
  v_cvt_pk_bf16_f32 v68, v24, v25
  v_cvt_pk_bf16_f32 v69, v26, v27
  buffer_store_dwordx2 v[68:69], v45, s[40:43], 0 offen offset:64
  v_sub_f32 v60, 1.0, v48
  v_lshlrev_b32 v24, 16, v50
  v_and_b32 v25, 0xffff0000, v50
  v_lshlrev_b32 v26, 16, v51
  v_and_b32 v27, 0xffff0000, v51
  v_lshlrev_b32 v28, 16, v176
  v_and_b32 v29, 0xffff0000, v176
  v_lshlrev_b32 v30, 16, v177
  v_and_b32 v31, 0xffff0000, v177
  v_pk_add_f32 v[24:25], v[24:25], v[28:29]
  v_pk_add_f32 v[26:27], v[26:27], v[30:31]
  v_lshlrev_b32 v28, 16, v178
  v_and_b32 v29, 0xffff0000, v178
  v_lshlrev_b32 v30, 16, v179
  v_and_b32 v31, 0xffff0000, v179
  v_pk_add_f32 v[24:25], v[24:25], v[28:29]
  v_pk_add_f32 v[26:27], v[26:27], v[30:31]
  v_lshlrev_b32 v28, 16, v180
  v_and_b32 v29, 0xffff0000, v180
  v_lshlrev_b32 v30, 16, v181
  v_and_b32 v31, 0xffff0000, v181
  v_pk_add_f32 v[24:25], v[24:25], v[28:29]
  v_pk_add_f32 v[26:27], v[26:27], v[30:31]
  v_lshlrev_b32 v28, 16, v182
  v_and_b32 v29, 0xffff0000, v182
  v_lshlrev_b32 v30, 16, v183
  v_and_b32 v31, 0xffff0000, v183
  v_pk_add_f32 v[24:25], v[24:25], v[28:29]
  v_pk_add_f32 v[26:27], v[26:27], v[30:31]
  v_mul_f32 v24, v60, v24
  v_fmac_f32 v24, v48, v12
  v_mul_f32 v25, v60, v25
  v_fmac_f32 v25, v48, v13
  v_mul_f32 v26, v60, v26
  v_fmac_f32 v26, v48, v14
  v_mul_f32 v27, v60, v27
  v_fmac_f32 v27, v48, v15
  v_cvt_pk_bf16_f32 v70, v24, v25
  v_cvt_pk_bf16_f32 v71, v26, v27
  buffer_store_dwordx2 v[70:71], v46, s[40:43], 0 offen offset:0
  v_lshlrev_b32 v24, 16, v52
  v_and_b32 v25, 0xffff0000, v52
  v_lshlrev_b32 v26, 16, v53
  v_and_b32 v27, 0xffff0000, v53
  v_lshlrev_b32 v28, 16, v192
  v_and_b32 v29, 0xffff0000, v192
  v_lshlrev_b32 v30, 16, v193
  v_and_b32 v31, 0xffff0000, v193
  v_pk_add_f32 v[24:25], v[24:25], v[28:29]
  v_pk_add_f32 v[26:27], v[26:27], v[30:31]
  v_lshlrev_b32 v28, 16, v194
  v_and_b32 v29, 0xffff0000, v194
  v_lshlrev_b32 v30, 16, v195
  v_and_b32 v31, 0xffff0000, v195
  v_pk_add_f32 v[24:25], v[24:25], v[28:29]
  v_pk_add_f32 v[26:27], v[26:27], v[30:31]
  v_lshlrev_b32 v28, 16, v196
  v_and_b32 v29, 0xffff0000, v196
  v_lshlrev_b32 v30, 16, v197
  v_and_b32 v31, 0xffff0000, v197
  v_pk_add_f32 v[24:25], v[24:25], v[28:29]
  v_pk_add_f32 v[26:27], v[26:27], v[30:31]
  v_lshlrev_b32 v28, 16, v198
  v_and_b32 v29, 0xffff0000, v198
  v_lshlrev_b32 v30, 16, v199
  v_and_b32 v31, 0xffff0000, v199
  v_pk_add_f32 v[24:25], v[24:25], v[28:29]
  v_pk_add_f32 v[26:27], v[26:27], v[30:31]
  v_mul_f32 v24, v60, v24
  v_fmac_f32 v24, v48, v16
  v_mul_f32 v25, v60, v25
  v_fmac_f32 v25, v48, v17
  v_mul_f32 v26, v60, v26
  v_fmac_f32 v26, v48, v18
  v_mul_f32 v27, v60, v27
  v_fmac_f32 v27, v48, v19
  v_cvt_pk_bf16_f32 v72, v24, v25
  v_cvt_pk_bf16_f32 v73, v26, v27
  buffer_store_dwordx2 v[72:73], v46, s[40:43], 0 offen offset:32
  v_lshlrev_b32 v24, 16, v54
  v_and_b32 v25, 0xffff0000, v54
  v_lshlrev_b32 v26, 16, v55
  v_and_b32 v27, 0xffff0000, v55
  v_lshlrev_b32 v28, 16, v208
  v_and_b32 v29, 0xffff0000, v208
  v_lshlrev_b32 v30, 16, v209
  v_and_b32 v31, 0xffff0000, v209
  v_pk_add_f32 v[24:25], v[24:25], v[28:29]
  v_pk_add_f32 v[26:27], v[26:27], v[30:31]
  v_lshlrev_b32 v28, 16, v210
  v_and_b32 v29, 0xffff0000, v210
  v_lshlrev_b32 v30, 16, v211
  v_and_b32 v31, 0xffff0000, v211
  v_pk_add_f32 v[24:25], v[24:25], v[28:29]
  v_pk_add_f32 v[26:27], v[26:27], v[30:31]
  v_lshlrev_b32 v28, 16, v212
  v_and_b32 v29, 0xffff0000, v212
  v_lshlrev_b32 v30, 16, v213
  v_and_b32 v31, 0xffff0000, v213
  v_pk_add_f32 v[24:25], v[24:25], v[28:29]
  v_pk_add_f32 v[26:27], v[26:27], v[30:31]
  v_lshlrev_b32 v28, 16, v214
  v_and_b32 v29, 0xffff0000, v214
  v_lshlrev_b32 v30, 16, v215
  v_and_b32 v31, 0xffff0000, v215
  v_pk_add_f32 v[24:25], v[24:25], v[28:29]
  v_pk_add_f32 v[26:27], v[26:27], v[30:31]
  v_mul_f32 v24, v60, v24
  v_fmac_f32 v24, v48, v20
  v_mul_f32 v25, v60, v25
  v_fmac_f32 v25, v48, v21
  v_mul_f32 v26, v60, v26
  v_fmac_f32 v26, v48, v22
  v_mul_f32 v27, v60, v27
  v_fmac_f32 v27, v48, v23
  v_cvt_pk_bf16_f32 v74, v24, v25
  v_cvt_pk_bf16_f32 v75, v26, v27
  buffer_store_dwordx2 v[74:75], v46, s[40:43], 0 offen offset:64
k3_kernel_END:
  s_endpgm
.section .rodata,"a"
.p2align 6
.amdhsa_kernel k1_kernel
  .amdhsa_next_free_vgpr 232
  .amdhsa_next_free_sgpr 96
  .amdhsa_accum_offset 232
  .amdhsa_group_segment_fixed_size 0
  .amdhsa_kernarg_size 96
  .amdhsa_user_sgpr_count 2
  .amdhsa_user_sgpr_kernarg_segment_ptr 1
  .amdhsa_system_sgpr_workgroup_id_x 1
.end_amdhsa_kernel
.p2align 6
.amdhsa_kernel k2_kernel
  .amdhsa_next_free_vgpr 168
  .amdhsa_next_free_sgpr 96
  .amdhsa_accum_offset 96
  .amdhsa_group_segment_fixed_size 0
  .amdhsa_kernarg_size 96
  .amdhsa_user_sgpr_count 2
  .amdhsa_user_sgpr_kernarg_segment_ptr 1
  .amdhsa_system_sgpr_workgroup_id_x 1
.end_amdhsa_kernel
.p2align 6
.amdhsa_kernel k3_kernel
  .amdhsa_next_free_vgpr 224
  .amdhsa_next_free_sgpr 96
  .amdhsa_accum_offset 224
  .amdhsa_group_segment_fixed_size 0
  .amdhsa_kernarg_size 96
  .amdhsa_user_sgpr_count 2
  .amdhsa_user_sgpr_kernarg_segment_ptr 1
  .amdhsa_system_sgpr_workgroup_id_x 1
.end_amdhsa_kernel
```
